```python
import torch

def _softmax(x, axis=-1):
    return torch.softmax(x, dim=axis)
def _gelu(x):
    return torch.nn.functional.gelu(x, approximate="tanh")
def _silu(x):
    return torch.nn.functional.silu(x)
def _sigmoid(x):
    return torch.sigmoid(x)
def _layernorm(x, axis=-1, eps=1e-5):
    m = x.mean(dim=axis, keepdim=True)
    v = x.var(dim=axis, keepdim=True, unbiased=False)
    return (x - m) / torch.sqrt(v + eps)
def _scatter_add(tgt, idx, src, axis=0):
    return tgt.clone().index_add_(axis, idx, src)
def _segment_sum(src, seg, n):
    out = torch.zeros((n,) + src.shape[1:], dtype=src.dtype)
    return out.index_add_(0, seg, src)
def _pad(x, pw):
    flat = tuple(v for pair in reversed(pw) for v in pair)
    return torch.nn.functional.pad(x, flat)

kernel_name = 'gated_mix__linear_attn_block__dense_activation_gelu__prompt'

def setup_inputs():

    _w = (lambda a: (lambda t: t.to(torch.bfloat16) if t.is_floating_point() else t)(torch.as_tensor(a)))
    def _A_setup():
        B, S, D = 1, 2048, 1024
        return {
            "x": _w((lambda *s: torch.randn(*s, dtype=torch.bfloat16) * 0.05)(B, S, D)),
            "wqkv": _w((lambda *s: torch.randn(*s, dtype=torch.bfloat16) * 1.6)(D, 3 * D)),
            "wo": _w((lambda *s: torch.randn(*s, dtype=torch.bfloat16) * 0.05)(D, D)),
        }
    _A_in = _A_setup()

    def _B_setup():
        B, S, D, F = 1, 2048, 1024, 3584
        return {
            "x": _w((lambda *s: torch.randn(*s, dtype=torch.bfloat16) * 0.05)(B, S, D)),
            "w1": _w((lambda *s: torch.randn(*s, dtype=torch.bfloat16) * 3.2)(D, F) * (D ** -0.5)),
            "b1": _w((lambda *s: torch.randn(*s, dtype=torch.bfloat16) * 3.2)(F) * 0.01),
            "w2": _w((lambda *s: torch.randn(*s, dtype=torch.bfloat16) * 1.6)(F, D) * (F ** -0.5)),
            "b2": _w((lambda *s: torch.randn(*s, dtype=torch.bfloat16) * 3.2)(D) * 0.01),
        }
    _B_in = _B_setup()

    return {
        "A_x": _A_in["x"],
        "A_wqkv": _A_in["wqkv"],
        "A_wo": _A_in["wo"],
        "B_x": _B_in["x"],
        "B_w1": _B_in["w1"],
        "B_b1": _B_in["b1"],
        "B_w2": _B_in["w2"],
        "B_b2": _B_in["b2"],
        "gate_w": _w((lambda *s: torch.randn(*s, dtype=torch.bfloat16) * 0.05)(1024) * 16.0),
    }

def reference(A_x, A_wqkv, A_wo, B_x, B_w1, B_b1, B_w2, B_b2, gate_w):
    def _A_ref(x, wqkv, wo):
        B, S, D = x.shape
        H = 32; Dh = D // H
        qkv = (lambda x, *d: x.permute(*d))((x @ wqkv).reshape(B, S, 3, H, Dh), 2, 0, 3, 1, 4)
        q, k, v = qkv[0], qkv[1], qkv[2]
        phi = lambda t: torch.where(t > 0, t + 1, torch.exp(t)) + 1e-6
        pq, pk = phi(q), phi(k)
        kv = torch.einsum("bhsd,bhse->bhde", pk, v)
        z = torch.einsum("bhsd->bhd", pk)
        num = torch.einsum("bhqd,bhde->bhqe", pq, kv)
        den = torch.einsum("bhqd,bhd->bhq", pq, z)[..., None] + 1e-6
        o = num / den
        return (lambda x, *d: x.permute(*d))(o, 0, 2, 1, 3).reshape(B, S, D) @ wo

    def _B_ref(x, w1, b1, w2, b2):
        h = torch.einsum("bsd,df->bsf", x, w1) + b1
        h = _gelu(h)
        return torch.einsum("bsf,fd->bsd", h, w2) + b2

    x = A_x
    g = _sigmoid((x * gate_w).sum(-1, keepdims=True))
    a = _A_ref(x, A_wqkv, A_wo)
    b = _B_ref(x, B_w1, B_b1, B_w2, B_b2)
    return g * a + (1 - g) * b
```

```asm
; @launch kernel=gated_mix__linear_attn_block__dense_activation_gelu__prompt_kernel grid=(256,1,1) block=(256,1,1) lds=163840
.amdgcn_target "amdgcn-amd-amdhsa--gfx950"
.text
.globl gated_mix__linear_attn_block__dense_activation_gelu__prompt_kernel
.p2align 8
.type gated_mix__linear_attn_block__dense_activation_gelu__prompt_kernel,@function
gated_mix__linear_attn_block__dense_activation_gelu__prompt_kernel:
    s_cmp_ge_u32 s2, 256
    s_cbranch_scc1 L_end
    s_load_dwordx16 s[76:91], s[0:1], 0
    s_load_dwordx8 s[92:99], s[0:1], 64
    v_lshrrev_b32 v2, 6, v0
    v_and_b32 v0, 63, v0
    v_readfirstlane_b32 s28, v2
    s_getpc_b64 s[44:45]
L_pc:
    s_lshr_b32 s32, s2, 3
    s_lshl_b32 s32, s32, 2
    s_add_u32 s32, s32, s28
    s_lshl_b32 s32, s32, 7
    v_min_u32 v24, 4, v0
    v_lshlrev_b32 v24, 14, v24
    v_add_u32 v24, s32, v24
    v_min_u32 v24, L_end-L_pc, v24
    global_load_dword v22, v24, s[44:45]
    v_lshlrev_b32 v1, 4, v0
    s_bfe_u32 s29, s2, 0x20001
    s_lshl_b32 s29, s29, 2
    s_bfe_u32 s32, s2, 0x20003
    s_add_u32 s29, s29, s32
    s_bfe_u32 s30, s2, 0x10000
    s_lshl_b32 s30, s30, 3
    s_lshr_b32 s32, s2, 5
    s_add_u32 s30, s30, s32
    s_bfe_u32 s3, s2, 0x20001
    s_mul_i32 s3, s3, 4
    s_and_b32 s32, s2, 1
    s_mul_i32 s32, s32, 8
    s_add_u32 s3, s3, s32
    s_lshl_b32 s35, s3, 7
    s_mul_i32 s37, s28, 6144
    s_lshl_b32 s38, s28, 12
    s_add_u32 s38, s38, 24576
    s_lshl_b32 s39, s28, 13
    s_lshl_b32 s32, s29, 2
    s_add_u32 s32, s32, s28
    s_mul_i32 s47, s32, 294912
    s_lshl_b32 s32, s32, 16
    v_lshrrev_b32 v2, 3, v0
    v_lshlrev_b32 v3, 11, v2
    v_add_u32 v3, s32, v3
    v_and_b32 v4, 7, v0
    v_lshrrev_b32 v5, 4, v0
    v_xor_b32 v4, v4, v5
    v_lshlrev_b32 v4, 4, v4
    v_xor_b32 v5, 64, v4
    v_add_u32 v10, v3, v4
    v_add_u32 v5, v3, v5
    v_add_u32 v11, 15360, v5
    v_add_u32 v12, 30720, v10
    v_add_u32 v13, 46080, v5
    v_bfe_u32 v2, v0, 3, 2
    v_mul_u32_u24 v3, 6144, v2
    v_lshrrev_b32 v2, 3, v1
    v_and_b32 v2, 32, v2
    v_and_b32 v4, 112, v1
    v_xor_b32 v2, v2, v4
    v_add_u32 v3, v2, v3
    s_mul_i32 s32, s28, 98304
    s_lshl_b32 s33, s30, 7
    s_add_u32 s32, s32, s33
    v_add_u32 v3, s32, v3
    v_lshrrev_b32 v2, 5, v0
    v_lshl_add_u32 v8, v2, 11, v3
    v_mul_u32_u24 v2, 20480, v2
    v_add_u32 v9, v2, v3
    v_add_u32 v2, 0, v8
    v_add_u32 v3, 3072, v9
    v_add_u32 v4, 24576, v8
    v_xor_b32 v8, 64, v8
    v_xor_b32 v9, 64, v9
    v_add_u32 v5, 46080, v8
    v_add_u32 v6, 53248, v9
    v_add_u32 v7, 74752, v8
    s_xor_b32 s32, s30, 4
    s_sub_u32 s32, s32, s30
    s_lshl_b32 s32, s32, 7
    v_cmp_gt_u32 vcc, 32, v0
    v_mov_b32 v8, s32
    s_nop 0
    v_cndmask_b32 v9, v8, 0, vcc
    v_cndmask_b32 v8, 0, v8, vcc
    v_add_u32 v2, v8, v2
    v_add_u32 v3, v9, v3
    v_add_u32 v5, v8, v5
    v_add_u32 v6, v9, v6
    s_waitcnt lgkmcnt(0)
    s_add_u32 m0, s37, 0
    s_and_b32 s35, s35, 2047
    s_mul_i32 s34, s35, 3072
    s_add_u32 s8, s78, s34
    s_addc_u32 s9, s79, 0
    global_load_lds_dwordx4 v2, s[8:9] offset:0
    global_load_lds_dwordx4 v3, s[8:9] offset:1024
    s_add_u32 s10, s76, s35
    s_addc_u32 s11, s77, 0
    global_load_lds_dwordx4 v4, s[8:9] offset:2048
    global_load_lds_dwordx4 v5, s[8:9] offset:3072
    s_add_u32 m0, s37, 4096
    s_nop 0
    global_load_lds_dwordx4 v6, s[8:9] offset:0
    global_load_lds_dwordx4 v7, s[8:9] offset:1024
    s_add_u32 m0, s38, 0
    s_nop 0
    global_load_lds_dwordx4 v10, s[10:11] offset:0
    global_load_lds_dwordx4 v11, s[10:11] offset:1024
    global_load_lds_dwordx4 v12, s[10:11] offset:2048
    global_load_lds_dwordx4 v13, s[10:11] offset:3072
    s_add_u32 m0, s37, 40960
    s_add_u32 s35, s35, 128
    s_and_b32 s35, s35, 2047
    s_mul_i32 s34, s35, 3072
    s_add_u32 s8, s78, s34
    s_addc_u32 s9, s79, 0
    global_load_lds_dwordx4 v2, s[8:9] offset:0
    global_load_lds_dwordx4 v3, s[8:9] offset:1024
    s_add_u32 s10, s76, s35
    s_addc_u32 s11, s77, 0
    global_load_lds_dwordx4 v4, s[8:9] offset:2048
    global_load_lds_dwordx4 v5, s[8:9] offset:3072
    s_add_u32 m0, s37, 45056
    s_nop 0
    global_load_lds_dwordx4 v6, s[8:9] offset:0
    global_load_lds_dwordx4 v7, s[8:9] offset:1024
    s_add_u32 m0, s38, 40960
    s_nop 0
    global_load_lds_dwordx4 v10, s[10:11] offset:0
    global_load_lds_dwordx4 v11, s[10:11] offset:1024
    global_load_lds_dwordx4 v12, s[10:11] offset:2048
    global_load_lds_dwordx4 v13, s[10:11] offset:3072
    s_mov_b32 s12, s98
    s_mov_b32 s13, s99
    s_mov_b32 s14, 67108864
    s_mov_b32 s15, 0x20000
    s_lshl_b32 s32, s29, 4
    s_add_u32 s32, s32, s30
    s_lshl_b32 s49, s32, 7
    s_add_u32 s49, s49, 20185088
    s_lshl_b32 s43, s30, 4
    s_add_u32 s43, s43, s29
    s_lshl_b32 s43, s43, 7
    s_add_u32 s43, s43, 20217856
    s_mov_b32 s16, s84
    s_mov_b32 s17, s85
    s_mov_b32 s18, 7340032
    s_mov_b32 s19, 0x20000
    s_mov_b32 s20, s86
    s_mov_b32 s21, s87
    s_mov_b32 s22, 7168
    s_mov_b32 s23, 0x20000
    s_mov_b32 s24, s96
    s_mov_b32 s25, s97
    s_mov_b32 s26, 256
    s_mov_b32 s27, 0x20000
    v_bfe_u32 v24, v0, 2, 2
    v_lshlrev_b32 v25, 7, v24
    v_bfe_u32 v24, v0, 3, 2
    v_lshl_add_u32 v25, v24, 5, v25
    v_and_b32 v24, 3, v0
    v_lshl_add_u32 v25, v24, 3, v25
    v_lshrrev_b32 v24, 4, v0
    v_lshl_add_u32 v14, v24, 10, v25
    v_mul_u32_u24 v224, 3072, v24
    v_add_u32 v224, v224, v25
    s_and_b32 s32, s28, 1
    s_lshl_b32 s32, s32, 6
    v_xor_b32 v224, s32, v224
    v_xor_b32 v225, 32, v224
    v_bfe_u32 v25, v0, 1, 3
    v_xor_b32 v25, v25, v24
    v_lshlrev_b32 v25, 4, v25
    v_and_b32 v24, 15, v0
    v_lshl_add_u32 v25, v24, 7, v25
    v_add_u32 v228, s38, v25
    v_xor_b32 v229, 64, v228
    v_xor_b32 v226, 0x1000, v228
    v_xor_b32 v227, 0x1000, v229
    v_xor_b32 v15, 32, v14
    v_xor_b32 v16, 64, v14
    v_xor_b32 v17, 96, v14
    v_mov_b32 v23, 0xc0135761
    s_mov_b32 s42, 0xbdd2d3e8
    v_cmp_gt_u32 vcc, 16, v0
    v_mov_b32 v26, 0x3f80
    s_lshl_b32 s32, s28, 6
    v_cndmask_b32 v26, 0, v26, vcc
    v_add_u32 v24, s32, v0
    v_cmp_eq_u32 vcc, 0, v24
    v_mov_b32 v27, 2147483648
    s_mul_i32 s40, s30, 384
    s_cmp_eq_u32 s28, 0
    s_cselect_b32 s1, -1, 0
    v_cndmask_b32 v27, v27, 0, vcc
    s_and_b32 s0, s30, 7
    s_lshl_b32 s0, s0, 1
    s_lshr_b32 s31, s30, 3
    s_add_u32 s0, s0, s31
    s_and_b32 s31, s0, 1
    s_lshl_b32 s41, s31, 17
    s_add_u32 s41, s41, s47
    s_waitcnt vmcnt(10)
    s_barrier
    ds_read_b128 a[0:3], v228 offset:0
    ds_read_b128 a[4:7], v228 offset:2048
    ds_read_b128 v[232:235], v226 offset:0
    ds_read_b128 v[236:239], v226 offset:2048
    ds_read_b64_tr_b16 v[32:33], v224 offset:0
    ds_read_b64_tr_b16 v[34:35], v224 offset:1536
    ds_read_b64_tr_b16 v[36:37], v225 offset:0
    ds_read_b64_tr_b16 v[38:39], v225 offset:1536
    ds_read_b64_tr_b16 v[40:41], v224 offset:512
    ds_read_b64_tr_b16 v[42:43], v224 offset:2048
    ds_read_b64_tr_b16 v[44:45], v225 offset:512
    ds_read_b64_tr_b16 v[46:47], v225 offset:2048
    s_waitcnt lgkmcnt(6)
    v_mfma_f32_16x16x32_bf16 v[64:67], v[32:35], a[0:3], 0
    ds_read_b64_tr_b16 v[48:49], v224 offset:1024
    s_add_u32 m0, s37, 81920
    s_add_u32 s35, s35, 128
    s_and_b32 s35, s35, 2047
    s_mul_i32 s34, s35, 3072
    v_mfma_f32_16x16x32_bf16 v[72:75], v[32:35], a[4:7], 0
    ds_read_b64_tr_b16 v[50:51], v224 offset:2560
    s_add_u32 s8, s78, s34
    s_addc_u32 s9, s79, 0
    global_load_lds_dwordx4 v2, s[8:9] offset:0
    v_mfma_f32_16x16x32_bf16 v[80:83], v[32:35], v[232:235], 0
    v_mfma_f32_16x16x32_bf16 v[88:91], v[32:35], v[236:239], 0
    s_waitcnt lgkmcnt(2)
    v_mfma_f32_16x16x32_bf16 v[68:71], v[36:39], a[0:3], 0
    ds_read_b64_tr_b16 v[52:53], v225 offset:1024
    v_mfma_f32_16x16x32_bf16 v[76:79], v[36:39], a[4:7], 0
    ds_read_b64_tr_b16 v[54:55], v225 offset:2560
    global_load_lds_dwordx4 v3, s[8:9] offset:1024
    s_add_u32 s10, s76, s35
    s_addc_u32 s11, s77, 0
    global_load_lds_dwordx4 v4, s[8:9] offset:2048
    v_mfma_f32_16x16x32_bf16 v[84:87], v[36:39], v[232:235], 0
    ds_read_b128 a[8:11], v229 offset:0
    v_mfma_f32_16x16x32_bf16 v[92:95], v[36:39], v[236:239], 0
    global_load_lds_dwordx4 v5, s[8:9] offset:3072
    s_add_u32 m0, s37, 86016
    v_mfma_f32_16x16x32_bf16 v[96:99], a[0:3], v[40:43], 0
    ds_read_b64_tr_b16 v[56:57], v224 offset:12288
    v_mfma_f32_16x16x32_bf16 v[100:103], a[4:7], v[40:43], 0
    ds_read_b64_tr_b16 v[58:59], v224 offset:13824
    global_load_lds_dwordx4 v6, s[8:9] offset:0
    v_mfma_f32_16x16x32_bf16 v[112:115], v[232:235], v[40:43], 0
    ds_read_b128 a[12:15], v229 offset:2048
    v_mfma_f32_16x16x32_bf16 v[116:119], v[236:239], v[40:43], 0
    global_load_lds_dwordx4 v7, s[8:9] offset:1024
    s_add_u32 m0, s38, 81920
    s_nop 0
    global_load_lds_dwordx4 v10, s[10:11] offset:0
    v_mfma_f32_16x16x32_bf16 v[104:107], a[0:3], v[44:47], 0
    ds_read_b64_tr_b16 v[60:61], v225 offset:12288
    v_mfma_f32_16x16x32_bf16 v[108:111], a[4:7], v[44:47], 0
    ds_read_b64_tr_b16 v[62:63], v225 offset:13824
    global_load_lds_dwordx4 v11, s[10:11] offset:1024
    global_load_lds_dwordx4 v12, s[10:11] offset:2048
    v_mfma_f32_16x16x32_bf16 v[120:123], v[232:235], v[44:47], 0
    ds_read_b128 v[240:243], v227 offset:0
    v_mfma_f32_16x16x32_bf16 v[124:127], v[236:239], v[44:47], 0
    global_load_lds_dwordx4 v13, s[10:11] offset:3072
    s_waitcnt lgkmcnt(4)
    v_mfma_f32_16x16x32_bf16 v[128:131], a[0:3], v[48:51], 0
    ds_read_b64_tr_b16 v[32:33], v224 offset:12800
    v_mfma_f32_16x16x32_bf16 v[132:135], a[4:7], v[48:51], 0
    ds_read_b64_tr_b16 v[34:35], v224 offset:14336
    v_mfma_f32_16x16x32_bf16 v[144:147], v[232:235], v[48:51], 0
    ds_read_b128 v[244:247], v227 offset:2048
    v_mfma_f32_16x16x32_bf16 v[148:151], v[236:239], v[48:51], 0
    v_mfma_f32_16x16x32_bf16 v[136:139], a[0:3], v[52:55], 0
    ds_read_b64_tr_b16 v[36:37], v225 offset:12800
    s_add_u32 m0, s37, 122880
    s_add_u32 s35, s35, 128
    s_and_b32 s35, s35, 2047
    s_mul_i32 s34, s35, 3072
    v_mfma_f32_16x16x32_bf16 v[140:143], a[4:7], v[52:55], 0
    ds_read_b64_tr_b16 v[38:39], v225 offset:14336
    s_add_u32 s8, s78, s34
    s_addc_u32 s9, s79, 0
    global_load_lds_dwordx4 v2, s[8:9] offset:0
    v_mfma_f32_16x16x32_bf16 v[152:155], v[232:235], v[52:55], 0
    global_load_lds_dwordx4 v3, s[8:9] offset:1024
    s_add_u32 s10, s76, s35
    v_mfma_f32_16x16x32_bf16 v[156:159], v[236:239], v[52:55], 0
    s_addc_u32 s11, s77, 0
    global_load_lds_dwordx4 v4, s[8:9] offset:2048
    s_waitcnt lgkmcnt(3)
    v_mfma_f32_16x16x32_bf16 v[64:67], v[56:59], a[8:11], v[64:67]
    ds_read_b64_tr_b16 v[40:41], v224 offset:13312
    v_mfma_f32_16x16x32_bf16 v[72:75], v[56:59], a[12:15], v[72:75]
    ds_read_b64_tr_b16 v[42:43], v224 offset:14848
    global_load_lds_dwordx4 v5, s[8:9] offset:3072
    s_add_u32 m0, s37, 126976
    s_nop 0
    global_load_lds_dwordx4 v6, s[8:9] offset:0
    s_waitcnt lgkmcnt(4)
    v_mfma_f32_16x16x32_bf16 v[80:83], v[56:59], v[240:243], v[80:83]
    global_load_lds_dwordx4 v7, s[8:9] offset:1024
    s_add_u32 m0, s38, 122880
    v_mfma_f32_16x16x32_bf16 v[88:91], v[56:59], v[244:247], v[88:91]
    s_nop 0
    global_load_lds_dwordx4 v10, s[10:11] offset:0
    v_mfma_f32_16x16x32_bf16 v[68:71], v[60:63], a[8:11], v[68:71]
    ds_read_b64_tr_b16 v[44:45], v225 offset:13312
    v_mfma_f32_16x16x32_bf16 v[76:79], v[60:63], a[12:15], v[76:79]
    ds_read_b64_tr_b16 v[46:47], v225 offset:14848
    global_load_lds_dwordx4 v11, s[10:11] offset:1024
    global_load_lds_dwordx4 v12, s[10:11] offset:2048
    global_load_lds_dwordx4 v13, s[10:11] offset:3072
    v_mfma_f32_16x16x32_bf16 v[84:87], v[60:63], v[240:243], v[84:87]
    v_mfma_f32_16x16x32_bf16 v[92:95], v[60:63], v[244:247], v[92:95]
    v_mfma_f32_16x16x32_bf16 v[96:99], a[8:11], v[32:35], v[96:99]
    v_mfma_f32_16x16x32_bf16 v[100:103], a[12:15], v[32:35], v[100:103]
    s_waitcnt vmcnt(20) lgkmcnt(0)
    s_barrier
    ds_read_b64_tr_b16 v[48:49], v224 offset:40960
    ds_read_b64_tr_b16 v[50:51], v224 offset:42496
    v_mfma_f32_16x16x32_bf16 v[112:115], v[240:243], v[32:35], v[112:115]
    ds_read_b128 a[16:19], v228 offset:40960
    v_mfma_f32_16x16x32_bf16 v[116:119], v[244:247], v[32:35], v[116:119]
    v_mfma_f32_16x16x32_bf16 v[104:107], a[8:11], v[36:39], v[104:107]
    ds_read_b64_tr_b16 v[52:53], v225 offset:40960
    s_add_u32 m0, s37, 0
    s_add_u32 s35, s35, 128
    s_and_b32 s35, s35, 2047
    s_mul_i32 s34, s35, 3072
    v_mfma_f32_16x16x32_bf16 v[108:111], a[12:15], v[36:39], v[108:111]
    ds_read_b64_tr_b16 v[54:55], v225 offset:42496
    s_add_u32 s8, s78, s34
    s_addc_u32 s9, s79, 0
    global_load_lds_dwordx4 v2, s[8:9] offset:0
    v_mfma_f32_16x16x32_bf16 v[120:123], v[240:243], v[36:39], v[120:123]
    ds_read_b128 a[20:23], v228 offset:43008
    v_mfma_f32_16x16x32_bf16 v[124:127], v[244:247], v[36:39], v[124:127]
    v_mfma_f32_16x16x32_bf16 v[128:131], a[8:11], v[40:43], v[128:131]
    ds_read_b64_tr_b16 v[56:57], v224 offset:41472
    v_mfma_f32_16x16x32_bf16 v[132:135], a[12:15], v[40:43], v[132:135]
    ds_read_b64_tr_b16 v[58:59], v224 offset:43008
    v_mfma_f32_16x16x32_bf16 v[144:147], v[240:243], v[40:43], v[144:147]
    ds_read_b128 v[232:235], v226 offset:40960
    v_mfma_f32_16x16x32_bf16 v[148:151], v[244:247], v[40:43], v[148:151]
    v_mfma_f32_16x16x32_bf16 v[136:139], a[8:11], v[44:47], v[136:139]
    ds_read_b64_tr_b16 v[60:61], v225 offset:41472
    v_mfma_f32_16x16x32_bf16 v[140:143], a[12:15], v[44:47], v[140:143]
    ds_read_b64_tr_b16 v[62:63], v225 offset:43008
    v_mfma_f32_16x16x32_bf16 v[152:155], v[240:243], v[44:47], v[152:155]
    ds_read_b128 v[236:239], v226 offset:43008
    v_mfma_f32_16x16x32_bf16 v[156:159], v[244:247], v[44:47], v[156:159]
    global_load_lds_dwordx4 v3, s[8:9] offset:1024
    s_waitcnt lgkmcnt(4)
    v_mfma_f32_16x16x32_bf16 v[64:67], v[48:51], a[16:19], v[64:67]
    ds_read_b64_tr_b16 v[32:33], v224 offset:41984
    v_mfma_f32_16x16x32_bf16 v[72:75], v[48:51], a[20:23], v[72:75]
    ds_read_b64_tr_b16 v[34:35], v224 offset:43520
    s_waitcnt lgkmcnt(2)
    v_mfma_f32_16x16x32_bf16 v[80:83], v[48:51], v[232:235], v[80:83]
    s_add_u32 s10, s76, s35
    s_addc_u32 s11, s77, 0
    v_mfma_f32_16x16x32_bf16 v[88:91], v[48:51], v[236:239], v[88:91]
    global_load_lds_dwordx4 v4, s[8:9] offset:2048
    v_mfma_f32_16x16x32_bf16 v[68:71], v[52:55], a[16:19], v[68:71]
    ds_read_b64_tr_b16 v[36:37], v225 offset:41984
    v_mfma_f32_16x16x32_bf16 v[76:79], v[52:55], a[20:23], v[76:79]
    ds_read_b64_tr_b16 v[38:39], v225 offset:43520
    v_mfma_f32_16x16x32_bf16 v[84:87], v[52:55], v[232:235], v[84:87]
    ds_read_b128 a[24:27], v229 offset:40960
    v_mfma_f32_16x16x32_bf16 v[92:95], v[52:55], v[236:239], v[92:95]
    global_load_lds_dwordx4 v5, s[8:9] offset:3072
    s_add_u32 m0, s37, 4096
    v_mfma_f32_16x16x32_bf16 v[96:99], a[16:19], v[56:59], v[96:99]
    ds_read_b64_tr_b16 v[40:41], v224 offset:53248
    v_mfma_f32_16x16x32_bf16 v[100:103], a[20:23], v[56:59], v[100:103]
    ds_read_b64_tr_b16 v[42:43], v224 offset:54784
    v_mfma_f32_16x16x32_bf16 v[112:115], v[232:235], v[56:59], v[112:115]
    ds_read_b128 a[28:31], v229 offset:43008
    v_mfma_f32_16x16x32_bf16 v[116:119], v[236:239], v[56:59], v[116:119]
    global_load_lds_dwordx4 v6, s[8:9] offset:0
    v_mfma_f32_16x16x32_bf16 v[104:107], a[16:19], v[60:63], v[104:107]
    ds_read_b64_tr_b16 v[44:45], v225 offset:53248
    v_mfma_f32_16x16x32_bf16 v[108:111], a[20:23], v[60:63], v[108:111]
    ds_read_b64_tr_b16 v[46:47], v225 offset:54784
    v_mfma_f32_16x16x32_bf16 v[120:123], v[232:235], v[60:63], v[120:123]
    ds_read_b128 v[240:243], v227 offset:40960
    v_mfma_f32_16x16x32_bf16 v[124:127], v[236:239], v[60:63], v[124:127]
    global_load_lds_dwordx4 v7, s[8:9] offset:1024
    s_add_u32 m0, s38, 0
    s_waitcnt lgkmcnt(4)
    v_mfma_f32_16x16x32_bf16 v[128:131], a[16:19], v[32:35], v[128:131]
    ds_read_b64_tr_b16 v[48:49], v224 offset:53760
    v_mfma_f32_16x16x32_bf16 v[132:135], a[20:23], v[32:35], v[132:135]
    ds_read_b64_tr_b16 v[50:51], v224 offset:55296
    v_mfma_f32_16x16x32_bf16 v[144:147], v[232:235], v[32:35], v[144:147]
    ds_read_b128 v[244:247], v227 offset:43008
    v_mfma_f32_16x16x32_bf16 v[148:151], v[236:239], v[32:35], v[148:151]
    global_load_lds_dwordx4 v10, s[10:11] offset:0
    v_mfma_f32_16x16x32_bf16 v[136:139], a[16:19], v[36:39], v[136:139]
    ds_read_b64_tr_b16 v[52:53], v225 offset:53760
    v_mfma_f32_16x16x32_bf16 v[140:143], a[20:23], v[36:39], v[140:143]
    ds_read_b64_tr_b16 v[54:55], v225 offset:55296
    global_load_lds_dwordx4 v11, s[10:11] offset:1024
    v_mfma_f32_16x16x32_bf16 v[152:155], v[232:235], v[36:39], v[152:155]
    v_mfma_f32_16x16x32_bf16 v[156:159], v[236:239], v[36:39], v[156:159]
    s_waitcnt lgkmcnt(3)
    v_mfma_f32_16x16x32_bf16 v[64:67], v[40:43], a[24:27], v[64:67]
    ds_read_b64_tr_b16 v[56:57], v224 offset:54272
    v_mfma_f32_16x16x32_bf16 v[72:75], v[40:43], a[28:31], v[72:75]
    ds_read_b64_tr_b16 v[58:59], v224 offset:55808
    global_load_lds_dwordx4 v12, s[10:11] offset:2048
    s_waitcnt lgkmcnt(4)
    v_mfma_f32_16x16x32_bf16 v[80:83], v[40:43], v[240:243], v[80:83]
    global_load_lds_dwordx4 v13, s[10:11] offset:3072
    v_mfma_f32_16x16x32_bf16 v[88:91], v[40:43], v[244:247], v[88:91]
    v_mfma_f32_16x16x32_bf16 v[68:71], v[44:47], a[24:27], v[68:71]
    ds_read_b64_tr_b16 v[60:61], v225 offset:54272
    v_mfma_f32_16x16x32_bf16 v[76:79], v[44:47], a[28:31], v[76:79]
    ds_read_b64_tr_b16 v[62:63], v225 offset:55808
    v_mfma_f32_16x16x32_bf16 v[84:87], v[44:47], v[240:243], v[84:87]
    v_mfma_f32_16x16x32_bf16 v[92:95], v[44:47], v[244:247], v[92:95]
    v_mfma_f32_16x16x32_bf16 v[96:99], a[24:27], v[48:51], v[96:99]
    v_add_u32 v224, 81920, v224
    v_add_u32 v225, 81920, v225
    v_add_u32 v226, 81920, v226
    v_add_u32 v227, 81920, v227
    v_add_u32 v228, 81920, v228
    v_add_u32 v229, 81920, v229
    v_mfma_f32_16x16x32_bf16 v[100:103], a[28:31], v[48:51], v[100:103]
    s_waitcnt vmcnt(20) lgkmcnt(0)
    s_barrier
    ds_read_b64_tr_b16 v[32:33], v224 offset:0
    ds_read_b64_tr_b16 v[34:35], v224 offset:1536
    v_mfma_f32_16x16x32_bf16 v[112:115], v[240:243], v[48:51], v[112:115]
    ds_read_b128 a[32:35], v228 offset:0
    v_mfma_f32_16x16x32_bf16 v[116:119], v[244:247], v[48:51], v[116:119]
    v_mfma_f32_16x16x32_bf16 v[104:107], a[24:27], v[52:55], v[104:107]
    ds_read_b64_tr_b16 v[36:37], v225 offset:0
    s_add_u32 m0, s37, 40960
    s_add_u32 s35, s35, 128
    s_and_b32 s35, s35, 2047
    s_mul_i32 s34, s35, 3072
    v_mfma_f32_16x16x32_bf16 v[108:111], a[28:31], v[52:55], v[108:111]
    ds_read_b64_tr_b16 v[38:39], v225 offset:1536
    s_add_u32 s8, s78, s34
    s_addc_u32 s9, s79, 0
    global_load_lds_dwordx4 v2, s[8:9] offset:0
    v_mfma_f32_16x16x32_bf16 v[120:123], v[240:243], v[52:55], v[120:123]
    ds_read_b128 a[36:39], v228 offset:2048
    v_mfma_f32_16x16x32_bf16 v[124:127], v[244:247], v[52:55], v[124:127]
    v_mfma_f32_16x16x32_bf16 v[128:131], a[24:27], v[56:59], v[128:131]
    ds_read_b64_tr_b16 v[40:41], v224 offset:512
    v_mfma_f32_16x16x32_bf16 v[132:135], a[28:31], v[56:59], v[132:135]
    ds_read_b64_tr_b16 v[42:43], v224 offset:2048
    v_mfma_f32_16x16x32_bf16 v[144:147], v[240:243], v[56:59], v[144:147]
    ds_read_b128 v[232:235], v226 offset:0
    v_mfma_f32_16x16x32_bf16 v[148:151], v[244:247], v[56:59], v[148:151]
    v_mfma_f32_16x16x32_bf16 v[136:139], a[24:27], v[60:63], v[136:139]
    ds_read_b64_tr_b16 v[44:45], v225 offset:512
    v_mfma_f32_16x16x32_bf16 v[140:143], a[28:31], v[60:63], v[140:143]
    ds_read_b64_tr_b16 v[46:47], v225 offset:2048
    v_mfma_f32_16x16x32_bf16 v[152:155], v[240:243], v[60:63], v[152:155]
    ds_read_b128 v[236:239], v226 offset:2048
    s_lshr_b32 s82, s2, 3
    s_lshl_b32 s82, s82, 2
    s_add_u32 s82, s82, s28
    v_mfma_f32_16x16x32_bf16 v[156:159], v[244:247], v[60:63], v[156:159]
    s_lshl_b32 s82, s82, 7
    s_add_u32 s82, s82, 6144
    global_load_lds_dwordx4 v3, s[8:9] offset:1024
    s_waitcnt lgkmcnt(4)
    v_mfma_f32_16x16x32_bf16 v[64:67], v[32:35], a[32:35], v[64:67]
    ds_read_b64_tr_b16 v[48:49], v224 offset:1024
    v_mfma_f32_16x16x32_bf16 v[72:75], v[32:35], a[36:39], v[72:75]
    ds_read_b64_tr_b16 v[50:51], v224 offset:2560
    s_waitcnt lgkmcnt(2)
    v_mfma_f32_16x16x32_bf16 v[80:83], v[32:35], v[232:235], v[80:83]
    s_add_u32 s10, s76, s35
    s_addc_u32 s11, s77, 0
    v_mfma_f32_16x16x32_bf16 v[88:91], v[32:35], v[236:239], v[88:91]
    global_load_lds_dwordx4 v4, s[8:9] offset:2048
    v_mfma_f32_16x16x32_bf16 v[68:71], v[36:39], a[32:35], v[68:71]
    ds_read_b64_tr_b16 v[52:53], v225 offset:1024
    s_lshl_b32 s83, s2, 2
    s_add_u32 s83, s83, s28
    v_mfma_f32_16x16x32_bf16 v[76:79], v[36:39], a[36:39], v[76:79]
    ds_read_b64_tr_b16 v[54:55], v225 offset:2560
    s_mul_i32 s83, s83, 7168
    v_mfma_f32_16x16x32_bf16 v[84:87], v[36:39], v[232:235], v[84:87]
    ds_read_b128 a[40:43], v229 offset:0
    v_mfma_f32_16x16x32_bf16 v[92:95], v[36:39], v[236:239], v[92:95]
    global_load_lds_dwordx4 v5, s[8:9] offset:3072
    s_add_u32 m0, s37, 45056
    v_mfma_f32_16x16x32_bf16 v[96:99], a[32:35], v[40:43], v[96:99]
    ds_read_b64_tr_b16 v[56:57], v224 offset:12288
    v_min_u32 v25, 240, v1
    v_mul_u32_u24 v24, 24, v25
    v_mfma_f32_16x16x32_bf16 v[100:103], a[36:39], v[40:43], v[100:103]
    ds_read_b64_tr_b16 v[58:59], v224 offset:13824
    v_lshlrev_b32 v25, 3, v25
    v_mfma_f32_16x16x32_bf16 v[112:115], v[232:235], v[40:43], v[112:115]
    ds_read_b128 a[44:47], v229 offset:2048
    v_mfma_f32_16x16x32_bf16 v[116:119], v[236:239], v[40:43], v[116:119]
    global_load_lds_dwordx4 v6, s[8:9] offset:0
    v_mfma_f32_16x16x32_bf16 v[104:107], a[32:35], v[44:47], v[104:107]
    ds_read_b64_tr_b16 v[60:61], v225 offset:12288
    v_mfma_f32_16x16x32_bf16 v[108:111], a[36:39], v[44:47], v[108:111]
    ds_read_b64_tr_b16 v[62:63], v225 offset:13824
    v_mfma_f32_16x16x32_bf16 v[120:123], v[232:235], v[44:47], v[120:123]
    ds_read_b128 v[240:243], v227 offset:0
    v_mfma_f32_16x16x32_bf16 v[124:127], v[236:239], v[44:47], v[124:127]
    global_load_lds_dwordx4 v7, s[8:9] offset:1024
    s_add_u32 m0, s38, 40960
    s_waitcnt lgkmcnt(4)
    v_mfma_f32_16x16x32_bf16 v[128:131], a[32:35], v[48:51], v[128:131]
    ds_read_b64_tr_b16 v[32:33], v224 offset:12800
    v_mfma_f32_16x16x32_bf16 v[132:135], a[36:39], v[48:51], v[132:135]
    ds_read_b64_tr_b16 v[34:35], v224 offset:14336
    v_mfma_f32_16x16x32_bf16 v[144:147], v[232:235], v[48:51], v[144:147]
    ds_read_b128 v[244:247], v227 offset:2048
    v_mfma_f32_16x16x32_bf16 v[148:151], v[236:239], v[48:51], v[148:151]
    global_load_lds_dwordx4 v10, s[10:11] offset:0
    v_mfma_f32_16x16x32_bf16 v[136:139], a[32:35], v[52:55], v[136:139]
    ds_read_b64_tr_b16 v[36:37], v225 offset:12800
    v_mfma_f32_16x16x32_bf16 v[140:143], a[36:39], v[52:55], v[140:143]
    ds_read_b64_tr_b16 v[38:39], v225 offset:14336
    global_load_lds_dwordx4 v11, s[10:11] offset:1024
    v_mfma_f32_16x16x32_bf16 v[152:155], v[232:235], v[52:55], v[152:155]
    v_mfma_f32_16x16x32_bf16 v[156:159], v[236:239], v[52:55], v[156:159]
    s_waitcnt lgkmcnt(3)
    v_mfma_f32_16x16x32_bf16 v[64:67], v[56:59], a[40:43], v[64:67]
    ds_read_b64_tr_b16 v[40:41], v224 offset:13312
    v_mfma_f32_16x16x32_bf16 v[72:75], v[56:59], a[44:47], v[72:75]
    ds_read_b64_tr_b16 v[42:43], v224 offset:14848
    global_load_lds_dwordx4 v12, s[10:11] offset:2048
    s_waitcnt lgkmcnt(4)
    v_mfma_f32_16x16x32_bf16 v[80:83], v[56:59], v[240:243], v[80:83]
    global_load_lds_dwordx4 v13, s[10:11] offset:3072
    v_mfma_f32_16x16x32_bf16 v[88:91], v[56:59], v[244:247], v[88:91]
    v_mfma_f32_16x16x32_bf16 v[68:71], v[60:63], a[40:43], v[68:71]
    ds_read_b64_tr_b16 v[44:45], v225 offset:13312
    v_mfma_f32_16x16x32_bf16 v[76:79], v[60:63], a[44:47], v[76:79]
    ds_read_b64_tr_b16 v[46:47], v225 offset:14848
    v_mfma_f32_16x16x32_bf16 v[84:87], v[60:63], v[240:243], v[84:87]
    v_mfma_f32_16x16x32_bf16 v[92:95], v[60:63], v[244:247], v[92:95]
    v_mfma_f32_16x16x32_bf16 v[96:99], a[40:43], v[32:35], v[96:99]
    v_mfma_f32_16x16x32_bf16 v[100:103], a[44:47], v[32:35], v[100:103]
    s_waitcnt vmcnt(20) lgkmcnt(0)
    s_barrier
    ds_read_b64_tr_b16 v[48:49], v224 offset:40960
    ds_read_b64_tr_b16 v[50:51], v224 offset:42496
    v_mfma_f32_16x16x32_bf16 v[112:115], v[240:243], v[32:35], v[112:115]
    ds_read_b128 a[48:51], v228 offset:40960
    v_mfma_f32_16x16x32_bf16 v[116:119], v[244:247], v[32:35], v[116:119]
    v_mfma_f32_16x16x32_bf16 v[104:107], a[40:43], v[36:39], v[104:107]
    ds_read_b64_tr_b16 v[52:53], v225 offset:40960
    s_add_u32 m0, s37, 81920
    s_add_u32 s35, s35, 128
    s_and_b32 s35, s35, 2047
    s_mul_i32 s34, s35, 3072
    v_mfma_f32_16x16x32_bf16 v[108:111], a[44:47], v[36:39], v[108:111]
    ds_read_b64_tr_b16 v[54:55], v225 offset:42496
    s_add_u32 s8, s78, s34
    s_addc_u32 s9, s79, 0
    global_load_lds_dwordx4 v2, s[8:9] offset:0
    v_mfma_f32_16x16x32_bf16 v[120:123], v[240:243], v[36:39], v[120:123]
    ds_read_b128 a[52:55], v228 offset:43008
    v_mfma_f32_16x16x32_bf16 v[124:127], v[244:247], v[36:39], v[124:127]
    v_mfma_f32_16x16x32_bf16 v[128:131], a[40:43], v[40:43], v[128:131]
    ds_read_b64_tr_b16 v[56:57], v224 offset:41472
    v_mfma_f32_16x16x32_bf16 v[132:135], a[44:47], v[40:43], v[132:135]
    ds_read_b64_tr_b16 v[58:59], v224 offset:43008
    v_mfma_f32_16x16x32_bf16 v[144:147], v[240:243], v[40:43], v[144:147]
    ds_read_b128 v[232:235], v226 offset:40960
    v_mfma_f32_16x16x32_bf16 v[148:151], v[244:247], v[40:43], v[148:151]
    v_mfma_f32_16x16x32_bf16 v[136:139], a[40:43], v[44:47], v[136:139]
    ds_read_b64_tr_b16 v[60:61], v225 offset:41472
    v_mfma_f32_16x16x32_bf16 v[140:143], a[44:47], v[44:47], v[140:143]
    ds_read_b64_tr_b16 v[62:63], v225 offset:43008
    v_mfma_f32_16x16x32_bf16 v[152:155], v[240:243], v[44:47], v[152:155]
    ds_read_b128 v[236:239], v226 offset:43008
    v_mfma_f32_16x16x32_bf16 v[156:159], v[244:247], v[44:47], v[156:159]
    global_load_lds_dwordx4 v3, s[8:9] offset:1024
    s_waitcnt lgkmcnt(4)
    v_mfma_f32_16x16x32_bf16 v[64:67], v[48:51], a[48:51], v[64:67]
    ds_read_b64_tr_b16 v[32:33], v224 offset:41984
    v_mfma_f32_16x16x32_bf16 v[72:75], v[48:51], a[52:55], v[72:75]
    ds_read_b64_tr_b16 v[34:35], v224 offset:43520
    s_waitcnt lgkmcnt(2)
    v_mfma_f32_16x16x32_bf16 v[80:83], v[48:51], v[232:235], v[80:83]
    s_add_u32 s10, s76, s35
    s_addc_u32 s11, s77, 0
    v_mfma_f32_16x16x32_bf16 v[88:91], v[48:51], v[236:239], v[88:91]
    global_load_lds_dwordx4 v4, s[8:9] offset:2048
    v_mfma_f32_16x16x32_bf16 v[68:71], v[52:55], a[48:51], v[68:71]
    ds_read_b64_tr_b16 v[36:37], v225 offset:41984
    v_mfma_f32_16x16x32_bf16 v[76:79], v[52:55], a[52:55], v[76:79]
    ds_read_b64_tr_b16 v[38:39], v225 offset:43520
    v_mfma_f32_16x16x32_bf16 v[84:87], v[52:55], v[232:235], v[84:87]
    ds_read_b128 a[56:59], v229 offset:40960
    v_mfma_f32_16x16x32_bf16 v[92:95], v[52:55], v[236:239], v[92:95]
    global_load_lds_dwordx4 v5, s[8:9] offset:3072
    s_add_u32 m0, s37, 86016
    v_mfma_f32_16x16x32_bf16 v[96:99], a[48:51], v[56:59], v[96:99]
    ds_read_b64_tr_b16 v[40:41], v224 offset:53248
    v_mfma_f32_16x16x32_bf16 v[100:103], a[52:55], v[56:59], v[100:103]
    ds_read_b64_tr_b16 v[42:43], v224 offset:54784
    v_mfma_f32_16x16x32_bf16 v[112:115], v[232:235], v[56:59], v[112:115]
    ds_read_b128 a[60:63], v229 offset:43008
    v_mfma_f32_16x16x32_bf16 v[116:119], v[236:239], v[56:59], v[116:119]
    global_load_lds_dwordx4 v6, s[8:9] offset:0
    v_mfma_f32_16x16x32_bf16 v[104:107], a[48:51], v[60:63], v[104:107]
    ds_read_b64_tr_b16 v[44:45], v225 offset:53248
    v_mfma_f32_16x16x32_bf16 v[108:111], a[52:55], v[60:63], v[108:111]
    ds_read_b64_tr_b16 v[46:47], v225 offset:54784
    v_mfma_f32_16x16x32_bf16 v[120:123], v[232:235], v[60:63], v[120:123]
    ds_read_b128 v[240:243], v227 offset:40960
    v_mfma_f32_16x16x32_bf16 v[124:127], v[236:239], v[60:63], v[124:127]
    global_load_lds_dwordx4 v7, s[8:9] offset:1024
    s_add_u32 m0, s38, 81920
    s_waitcnt lgkmcnt(4)
    v_mfma_f32_16x16x32_bf16 v[128:131], a[48:51], v[32:35], v[128:131]
    ds_read_b64_tr_b16 v[48:49], v224 offset:53760
    v_mfma_f32_16x16x32_bf16 v[132:135], a[52:55], v[32:35], v[132:135]
    ds_read_b64_tr_b16 v[50:51], v224 offset:55296
    v_mfma_f32_16x16x32_bf16 v[144:147], v[232:235], v[32:35], v[144:147]
    ds_read_b128 v[244:247], v227 offset:43008
    v_mfma_f32_16x16x32_bf16 v[148:151], v[236:239], v[32:35], v[148:151]
    global_load_lds_dwordx4 v10, s[10:11] offset:0
    v_mfma_f32_16x16x32_bf16 v[136:139], a[48:51], v[36:39], v[136:139]
    ds_read_b64_tr_b16 v[52:53], v225 offset:53760
    v_mfma_f32_16x16x32_bf16 v[140:143], a[52:55], v[36:39], v[140:143]
    ds_read_b64_tr_b16 v[54:55], v225 offset:55296
    global_load_lds_dwordx4 v11, s[10:11] offset:1024
    v_mfma_f32_16x16x32_bf16 v[152:155], v[232:235], v[36:39], v[152:155]
    v_mfma_f32_16x16x32_bf16 v[156:159], v[236:239], v[36:39], v[156:159]
    s_waitcnt lgkmcnt(3)
    v_mfma_f32_16x16x32_bf16 v[64:67], v[40:43], a[56:59], v[64:67]
    ds_read_b64_tr_b16 v[56:57], v224 offset:54272
    v_mfma_f32_16x16x32_bf16 v[72:75], v[40:43], a[60:63], v[72:75]
    ds_read_b64_tr_b16 v[58:59], v224 offset:55808
    global_load_lds_dwordx4 v12, s[10:11] offset:2048
    s_waitcnt lgkmcnt(4)
    v_mfma_f32_16x16x32_bf16 v[80:83], v[40:43], v[240:243], v[80:83]
    global_load_lds_dwordx4 v13, s[10:11] offset:3072
    v_mfma_f32_16x16x32_bf16 v[88:91], v[40:43], v[244:247], v[88:91]
    v_mfma_f32_16x16x32_bf16 v[68:71], v[44:47], a[56:59], v[68:71]
    ds_read_b64_tr_b16 v[60:61], v225 offset:54272
    v_mfma_f32_16x16x32_bf16 v[76:79], v[44:47], a[60:63], v[76:79]
    ds_read_b64_tr_b16 v[62:63], v225 offset:55808
    v_mfma_f32_16x16x32_bf16 v[84:87], v[44:47], v[240:243], v[84:87]
    v_mfma_f32_16x16x32_bf16 v[92:95], v[44:47], v[244:247], v[92:95]
    v_mfma_f32_16x16x32_bf16 v[96:99], a[56:59], v[48:51], v[96:99]
    v_subrev_u32 v224, 81920, v224
    v_subrev_u32 v225, 81920, v225
    v_subrev_u32 v226, 81920, v226
    v_subrev_u32 v227, 81920, v227
    v_subrev_u32 v228, 81920, v228
    v_subrev_u32 v229, 81920, v229
    v_mfma_f32_16x16x32_bf16 v[100:103], a[60:63], v[48:51], v[100:103]
    s_waitcnt vmcnt(20) lgkmcnt(0)
    s_barrier
    s_getpc_b64 vcc
L_ct0:
    s_min_u32 s32, s82, L_end-L_ct0
    v_mov_b32 v0, s32
    global_load_dword v22, v0, vcc
    ds_read_b64_tr_b16 v[32:33], v224 offset:0
    ds_read_b64_tr_b16 v[34:35], v224 offset:1536
    v_mfma_f32_16x16x32_bf16 v[112:115], v[240:243], v[48:51], v[112:115]
    ds_read_b128 a[64:67], v228 offset:0
    v_mfma_f32_16x16x32_bf16 v[116:119], v[244:247], v[48:51], v[116:119]
    v_mfma_f32_16x16x32_bf16 v[104:107], a[56:59], v[52:55], v[104:107]
    ds_read_b64_tr_b16 v[36:37], v225 offset:0
    s_add_u32 m0, s37, 122880
    s_add_u32 s35, s35, 128
    s_and_b32 s35, s35, 2047
    s_mul_i32 s34, s35, 3072
    v_mfma_f32_16x16x32_bf16 v[108:111], a[60:63], v[52:55], v[108:111]
    ds_read_b64_tr_b16 v[38:39], v225 offset:1536
    s_add_u32 s8, s78, s34
    s_addc_u32 s9, s79, 0
    global_load_lds_dwordx4 v2, s[8:9] offset:0
    v_mfma_f32_16x16x32_bf16 v[120:123], v[240:243], v[52:55], v[120:123]
    ds_read_b128 a[68:71], v228 offset:2048
    v_mfma_f32_16x16x32_bf16 v[124:127], v[244:247], v[52:55], v[124:127]
    v_mfma_f32_16x16x32_bf16 v[128:131], a[56:59], v[56:59], v[128:131]
    ds_read_b64_tr_b16 v[40:41], v224 offset:512
    v_mfma_f32_16x16x32_bf16 v[132:135], a[60:63], v[56:59], v[132:135]
    ds_read_b64_tr_b16 v[42:43], v224 offset:2048
    v_mfma_f32_16x16x32_bf16 v[144:147], v[240:243], v[56:59], v[144:147]
    ds_read_b128 v[232:235], v226 offset:0
    v_mfma_f32_16x16x32_bf16 v[148:151], v[244:247], v[56:59], v[148:151]
    v_mfma_f32_16x16x32_bf16 v[136:139], a[56:59], v[60:63], v[136:139]
    ds_read_b64_tr_b16 v[44:45], v225 offset:512
    v_mfma_f32_16x16x32_bf16 v[140:143], a[60:63], v[60:63], v[140:143]
    ds_read_b64_tr_b16 v[46:47], v225 offset:2048
    v_mfma_f32_16x16x32_bf16 v[152:155], v[240:243], v[60:63], v[152:155]
    ds_read_b128 v[236:239], v226 offset:2048
    v_mfma_f32_16x16x32_bf16 v[156:159], v[244:247], v[60:63], v[156:159]
    global_load_lds_dwordx4 v3, s[8:9] offset:1024
    s_waitcnt lgkmcnt(4)
    v_mfma_f32_16x16x32_bf16 v[64:67], v[32:35], a[64:67], v[64:67]
    ds_read_b64_tr_b16 v[48:49], v224 offset:1024
    v_mfma_f32_16x16x32_bf16 v[72:75], v[32:35], a[68:71], v[72:75]
    ds_read_b64_tr_b16 v[50:51], v224 offset:2560
    s_waitcnt lgkmcnt(2)
    v_mfma_f32_16x16x32_bf16 v[80:83], v[32:35], v[232:235], v[80:83]
    s_add_u32 s10, s76, s35
    s_addc_u32 s11, s77, 0
    v_mfma_f32_16x16x32_bf16 v[88:91], v[32:35], v[236:239], v[88:91]
    global_load_lds_dwordx4 v4, s[8:9] offset:2048
    v_mfma_f32_16x16x32_bf16 v[68:71], v[36:39], a[64:67], v[68:71]
    ds_read_b64_tr_b16 v[52:53], v225 offset:1024
    v_mfma_f32_16x16x32_bf16 v[76:79], v[36:39], a[68:71], v[76:79]
    ds_read_b64_tr_b16 v[54:55], v225 offset:2560
    v_mfma_f32_16x16x32_bf16 v[84:87], v[36:39], v[232:235], v[84:87]
    ds_read_b128 a[72:75], v229 offset:0
    v_mfma_f32_16x16x32_bf16 v[92:95], v[36:39], v[236:239], v[92:95]
    global_load_lds_dwordx4 v5, s[8:9] offset:3072
    s_add_u32 m0, s37, 126976
    v_mfma_f32_16x16x32_bf16 v[96:99], a[64:67], v[40:43], v[96:99]
    ds_read_b64_tr_b16 v[56:57], v224 offset:12288
    v_mfma_f32_16x16x32_bf16 v[100:103], a[68:71], v[40:43], v[100:103]
    ds_read_b64_tr_b16 v[58:59], v224 offset:13824
    v_mfma_f32_16x16x32_bf16 v[112:115], v[232:235], v[40:43], v[112:115]
    ds_read_b128 a[76:79], v229 offset:2048
    v_mfma_f32_16x16x32_bf16 v[116:119], v[236:239], v[40:43], v[116:119]
    global_load_lds_dwordx4 v6, s[8:9] offset:0
    v_mfma_f32_16x16x32_bf16 v[104:107], a[64:67], v[44:47], v[104:107]
    ds_read_b64_tr_b16 v[60:61], v225 offset:12288
    v_mfma_f32_16x16x32_bf16 v[108:111], a[68:71], v[44:47], v[108:111]
    ds_read_b64_tr_b16 v[62:63], v225 offset:13824
    v_mfma_f32_16x16x32_bf16 v[120:123], v[232:235], v[44:47], v[120:123]
    ds_read_b128 v[240:243], v227 offset:0
    v_mfma_f32_16x16x32_bf16 v[124:127], v[236:239], v[44:47], v[124:127]
    global_load_lds_dwordx4 v7, s[8:9] offset:1024
    s_add_u32 m0, s38, 122880
    s_waitcnt lgkmcnt(4)
    v_mfma_f32_16x16x32_bf16 v[128:131], a[64:67], v[48:51], v[128:131]
    ds_read_b64_tr_b16 v[32:33], v224 offset:12800
    v_mfma_f32_16x16x32_bf16 v[132:135], a[68:71], v[48:51], v[132:135]
    ds_read_b64_tr_b16 v[34:35], v224 offset:14336
    v_mfma_f32_16x16x32_bf16 v[144:147], v[232:235], v[48:51], v[144:147]
    ds_read_b128 v[244:247], v227 offset:2048
    v_mfma_f32_16x16x32_bf16 v[148:151], v[236:239], v[48:51], v[148:151]
    global_load_lds_dwordx4 v10, s[10:11] offset:0
    v_mfma_f32_16x16x32_bf16 v[136:139], a[64:67], v[52:55], v[136:139]
    ds_read_b64_tr_b16 v[36:37], v225 offset:12800
    v_mfma_f32_16x16x32_bf16 v[140:143], a[68:71], v[52:55], v[140:143]
    ds_read_b64_tr_b16 v[38:39], v225 offset:14336
    global_load_lds_dwordx4 v11, s[10:11] offset:1024
    v_mfma_f32_16x16x32_bf16 v[152:155], v[232:235], v[52:55], v[152:155]
    v_mfma_f32_16x16x32_bf16 v[156:159], v[236:239], v[52:55], v[156:159]
    s_waitcnt lgkmcnt(3)
    v_mfma_f32_16x16x32_bf16 v[64:67], v[56:59], a[72:75], v[64:67]
    ds_read_b64_tr_b16 v[40:41], v224 offset:13312
    v_mfma_f32_16x16x32_bf16 v[72:75], v[56:59], a[76:79], v[72:75]
    ds_read_b64_tr_b16 v[42:43], v224 offset:14848
    global_load_lds_dwordx4 v12, s[10:11] offset:2048
    s_waitcnt lgkmcnt(4)
    v_mfma_f32_16x16x32_bf16 v[80:83], v[56:59], v[240:243], v[80:83]
    global_load_lds_dwordx4 v13, s[10:11] offset:3072
    v_mfma_f32_16x16x32_bf16 v[88:91], v[56:59], v[244:247], v[88:91]
    v_mfma_f32_16x16x32_bf16 v[68:71], v[60:63], a[72:75], v[68:71]
    ds_read_b64_tr_b16 v[44:45], v225 offset:13312
    v_mfma_f32_16x16x32_bf16 v[76:79], v[60:63], a[76:79], v[76:79]
    ds_read_b64_tr_b16 v[46:47], v225 offset:14848
    v_mfma_f32_16x16x32_bf16 v[84:87], v[60:63], v[240:243], v[84:87]
    v_mfma_f32_16x16x32_bf16 v[92:95], v[60:63], v[244:247], v[92:95]
    v_mfma_f32_16x16x32_bf16 v[96:99], a[72:75], v[32:35], v[96:99]
    v_mfma_f32_16x16x32_bf16 v[100:103], a[76:79], v[32:35], v[100:103]
    s_waitcnt vmcnt(21) lgkmcnt(0)
    s_barrier
    ds_read_b64_tr_b16 v[48:49], v224 offset:40960
    ds_read_b64_tr_b16 v[50:51], v224 offset:42496
    v_mfma_f32_16x16x32_bf16 v[112:115], v[240:243], v[32:35], v[112:115]
    ds_read_b128 a[80:83], v228 offset:40960
    v_mfma_f32_16x16x32_bf16 v[116:119], v[244:247], v[32:35], v[116:119]
    v_mfma_f32_16x16x32_bf16 v[104:107], a[72:75], v[36:39], v[104:107]
    ds_read_b64_tr_b16 v[52:53], v225 offset:40960
    s_add_u32 m0, s37, 0
    s_add_u32 s35, s35, 128
    s_and_b32 s35, s35, 2047
    s_mul_i32 s34, s35, 3072
    v_mfma_f32_16x16x32_bf16 v[108:111], a[76:79], v[36:39], v[108:111]
    ds_read_b64_tr_b16 v[54:55], v225 offset:42496
    s_add_u32 s8, s78, s34
    s_addc_u32 s9, s79, 0
    global_load_lds_dwordx4 v2, s[8:9] offset:0
    v_mfma_f32_16x16x32_bf16 v[120:123], v[240:243], v[36:39], v[120:123]
    ds_read_b128 a[84:87], v228 offset:43008
    v_mfma_f32_16x16x32_bf16 v[124:127], v[244:247], v[36:39], v[124:127]
    v_mfma_f32_16x16x32_bf16 v[128:131], a[72:75], v[40:43], v[128:131]
    ds_read_b64_tr_b16 v[56:57], v224 offset:41472
    v_mfma_f32_16x16x32_bf16 v[132:135], a[76:79], v[40:43], v[132:135]
    ds_read_b64_tr_b16 v[58:59], v224 offset:43008
    v_mfma_f32_16x16x32_bf16 v[144:147], v[240:243], v[40:43], v[144:147]
    ds_read_b128 v[232:235], v226 offset:40960
    v_mfma_f32_16x16x32_bf16 v[148:151], v[244:247], v[40:43], v[148:151]
    v_mfma_f32_16x16x32_bf16 v[136:139], a[72:75], v[44:47], v[136:139]
    ds_read_b64_tr_b16 v[60:61], v225 offset:41472
    v_mfma_f32_16x16x32_bf16 v[140:143], a[76:79], v[44:47], v[140:143]
    ds_read_b64_tr_b16 v[62:63], v225 offset:43008
    v_mfma_f32_16x16x32_bf16 v[152:155], v[240:243], v[44:47], v[152:155]
    ds_read_b128 v[236:239], v226 offset:43008
    v_mfma_f32_16x16x32_bf16 v[156:159], v[244:247], v[44:47], v[156:159]
    global_load_lds_dwordx4 v3, s[8:9] offset:1024
    s_waitcnt lgkmcnt(4)
    v_mfma_f32_16x16x32_bf16 v[64:67], v[48:51], a[80:83], v[64:67]
    ds_read_b64_tr_b16 v[32:33], v224 offset:41984
    v_mfma_f32_16x16x32_bf16 v[72:75], v[48:51], a[84:87], v[72:75]
    ds_read_b64_tr_b16 v[34:35], v224 offset:43520
    s_waitcnt lgkmcnt(2)
    v_mfma_f32_16x16x32_bf16 v[80:83], v[48:51], v[232:235], v[80:83]
    s_add_u32 s10, s76, s35
    s_addc_u32 s11, s77, 0
    v_mfma_f32_16x16x32_bf16 v[88:91], v[48:51], v[236:239], v[88:91]
    global_load_lds_dwordx4 v4, s[8:9] offset:2048
    v_mfma_f32_16x16x32_bf16 v[68:71], v[52:55], a[80:83], v[68:71]
    ds_read_b64_tr_b16 v[36:37], v225 offset:41984
    v_mfma_f32_16x16x32_bf16 v[76:79], v[52:55], a[84:87], v[76:79]
    ds_read_b64_tr_b16 v[38:39], v225 offset:43520
    v_mfma_f32_16x16x32_bf16 v[84:87], v[52:55], v[232:235], v[84:87]
    ds_read_b128 a[88:91], v229 offset:40960
    v_mfma_f32_16x16x32_bf16 v[92:95], v[52:55], v[236:239], v[92:95]
    global_load_lds_dwordx4 v5, s[8:9] offset:3072
    s_add_u32 m0, s37, 4096
    v_mfma_f32_16x16x32_bf16 v[96:99], a[80:83], v[56:59], v[96:99]
    ds_read_b64_tr_b16 v[40:41], v224 offset:53248
    v_mfma_f32_16x16x32_bf16 v[100:103], a[84:87], v[56:59], v[100:103]
    ds_read_b64_tr_b16 v[42:43], v224 offset:54784
    v_mfma_f32_16x16x32_bf16 v[112:115], v[232:235], v[56:59], v[112:115]
    ds_read_b128 a[92:95], v229 offset:43008
    v_mfma_f32_16x16x32_bf16 v[116:119], v[236:239], v[56:59], v[116:119]
    global_load_lds_dwordx4 v6, s[8:9] offset:0
    v_mfma_f32_16x16x32_bf16 v[104:107], a[80:83], v[60:63], v[104:107]
    ds_read_b64_tr_b16 v[44:45], v225 offset:53248
    v_mfma_f32_16x16x32_bf16 v[108:111], a[84:87], v[60:63], v[108:111]
    ds_read_b64_tr_b16 v[46:47], v225 offset:54784
    v_mfma_f32_16x16x32_bf16 v[120:123], v[232:235], v[60:63], v[120:123]
    ds_read_b128 v[240:243], v227 offset:40960
    v_mfma_f32_16x16x32_bf16 v[124:127], v[236:239], v[60:63], v[124:127]
    global_load_lds_dwordx4 v7, s[8:9] offset:1024
    s_add_u32 m0, s38, 0
    s_waitcnt lgkmcnt(4)
    v_mfma_f32_16x16x32_bf16 v[128:131], a[80:83], v[32:35], v[128:131]
    ds_read_b64_tr_b16 v[48:49], v224 offset:53760
    v_mfma_f32_16x16x32_bf16 v[132:135], a[84:87], v[32:35], v[132:135]
    ds_read_b64_tr_b16 v[50:51], v224 offset:55296
    v_mfma_f32_16x16x32_bf16 v[144:147], v[232:235], v[32:35], v[144:147]
    ds_read_b128 v[244:247], v227 offset:43008
    v_mfma_f32_16x16x32_bf16 v[148:151], v[236:239], v[32:35], v[148:151]
    global_load_lds_dwordx4 v10, s[10:11] offset:0
    v_mfma_f32_16x16x32_bf16 v[136:139], a[80:83], v[36:39], v[136:139]
    ds_read_b64_tr_b16 v[52:53], v225 offset:53760
    v_mfma_f32_16x16x32_bf16 v[140:143], a[84:87], v[36:39], v[140:143]
    ds_read_b64_tr_b16 v[54:55], v225 offset:55296
    global_load_lds_dwordx4 v11, s[10:11] offset:1024
    v_mfma_f32_16x16x32_bf16 v[152:155], v[232:235], v[36:39], v[152:155]
    v_mfma_f32_16x16x32_bf16 v[156:159], v[236:239], v[36:39], v[156:159]
    s_waitcnt lgkmcnt(3)
    v_mfma_f32_16x16x32_bf16 v[64:67], v[40:43], a[88:91], v[64:67]
    ds_read_b64_tr_b16 v[56:57], v224 offset:54272
    v_mfma_f32_16x16x32_bf16 v[72:75], v[40:43], a[92:95], v[72:75]
    ds_read_b64_tr_b16 v[58:59], v224 offset:55808
    global_load_lds_dwordx4 v12, s[10:11] offset:2048
    s_waitcnt lgkmcnt(4)
    v_mfma_f32_16x16x32_bf16 v[80:83], v[40:43], v[240:243], v[80:83]
    global_load_lds_dwordx4 v13, s[10:11] offset:3072
    v_mfma_f32_16x16x32_bf16 v[88:91], v[40:43], v[244:247], v[88:91]
    v_mfma_f32_16x16x32_bf16 v[68:71], v[44:47], a[88:91], v[68:71]
    ds_read_b64_tr_b16 v[60:61], v225 offset:54272
    v_mfma_f32_16x16x32_bf16 v[76:79], v[44:47], a[92:95], v[76:79]
    ds_read_b64_tr_b16 v[62:63], v225 offset:55808
    v_mfma_f32_16x16x32_bf16 v[84:87], v[44:47], v[240:243], v[84:87]
    v_mfma_f32_16x16x32_bf16 v[92:95], v[44:47], v[244:247], v[92:95]
    v_mfma_f32_16x16x32_bf16 v[96:99], a[88:91], v[48:51], v[96:99]
    v_add_u32 v224, 81920, v224
    v_add_u32 v225, 81920, v225
    v_add_u32 v226, 81920, v226
    v_add_u32 v227, 81920, v227
    v_add_u32 v228, 81920, v228
    v_add_u32 v229, 81920, v229
    v_mfma_f32_16x16x32_bf16 v[100:103], a[92:95], v[48:51], v[100:103]
    s_waitcnt vmcnt(21) lgkmcnt(0)
    s_barrier
    ds_read_b64_tr_b16 v[32:33], v224 offset:0
    ds_read_b64_tr_b16 v[34:35], v224 offset:1536
    v_mfma_f32_16x16x32_bf16 v[112:115], v[240:243], v[48:51], v[112:115]
    ds_read_b128 a[96:99], v228 offset:0
    v_mfma_f32_16x16x32_bf16 v[116:119], v[244:247], v[48:51], v[116:119]
    v_mfma_f32_16x16x32_bf16 v[104:107], a[88:91], v[52:55], v[104:107]
    ds_read_b64_tr_b16 v[36:37], v225 offset:0
    s_add_u32 m0, s37, 40960
    s_add_u32 s35, s35, 128
    s_and_b32 s35, s35, 2047
    s_mul_i32 s34, s35, 3072
    v_mfma_f32_16x16x32_bf16 v[108:111], a[92:95], v[52:55], v[108:111]
    ds_read_b64_tr_b16 v[38:39], v225 offset:1536
    s_add_u32 s8, s78, s34
    s_addc_u32 s9, s79, 0
    global_load_lds_dwordx4 v2, s[8:9] offset:0
    v_mfma_f32_16x16x32_bf16 v[120:123], v[240:243], v[52:55], v[120:123]
    ds_read_b128 a[100:103], v228 offset:2048
    v_mfma_f32_16x16x32_bf16 v[124:127], v[244:247], v[52:55], v[124:127]
    v_mfma_f32_16x16x32_bf16 v[128:131], a[88:91], v[56:59], v[128:131]
    ds_read_b64_tr_b16 v[40:41], v224 offset:512
    v_mfma_f32_16x16x32_bf16 v[132:135], a[92:95], v[56:59], v[132:135]
    ds_read_b64_tr_b16 v[42:43], v224 offset:2048
    v_mfma_f32_16x16x32_bf16 v[144:147], v[240:243], v[56:59], v[144:147]
    ds_read_b128 v[232:235], v226 offset:0
    v_mfma_f32_16x16x32_bf16 v[148:151], v[244:247], v[56:59], v[148:151]
    v_mfma_f32_16x16x32_bf16 v[136:139], a[88:91], v[60:63], v[136:139]
    ds_read_b64_tr_b16 v[44:45], v225 offset:512
    v_mfma_f32_16x16x32_bf16 v[140:143], a[92:95], v[60:63], v[140:143]
    ds_read_b64_tr_b16 v[46:47], v225 offset:2048
    v_mfma_f32_16x16x32_bf16 v[152:155], v[240:243], v[60:63], v[152:155]
    ds_read_b128 v[236:239], v226 offset:2048
    v_mfma_f32_16x16x32_bf16 v[156:159], v[244:247], v[60:63], v[156:159]
    global_load_lds_dwordx4 v3, s[8:9] offset:1024
    s_waitcnt lgkmcnt(4)
    v_mfma_f32_16x16x32_bf16 v[64:67], v[32:35], a[96:99], v[64:67]
    ds_read_b64_tr_b16 v[48:49], v224 offset:1024
    v_mfma_f32_16x16x32_bf16 v[72:75], v[32:35], a[100:103], v[72:75]
    ds_read_b64_tr_b16 v[50:51], v224 offset:2560
    s_waitcnt lgkmcnt(2)
    v_mfma_f32_16x16x32_bf16 v[80:83], v[32:35], v[232:235], v[80:83]
    s_add_u32 s10, s76, s35
    s_addc_u32 s11, s77, 0
    v_mfma_f32_16x16x32_bf16 v[88:91], v[32:35], v[236:239], v[88:91]
    global_load_lds_dwordx4 v4, s[8:9] offset:2048
    v_mfma_f32_16x16x32_bf16 v[68:71], v[36:39], a[96:99], v[68:71]
    ds_read_b64_tr_b16 v[52:53], v225 offset:1024
    v_mfma_f32_16x16x32_bf16 v[76:79], v[36:39], a[100:103], v[76:79]
    ds_read_b64_tr_b16 v[54:55], v225 offset:2560
    v_mfma_f32_16x16x32_bf16 v[84:87], v[36:39], v[232:235], v[84:87]
    ds_read_b128 a[104:107], v229 offset:0
    v_mfma_f32_16x16x32_bf16 v[92:95], v[36:39], v[236:239], v[92:95]
    global_load_lds_dwordx4 v5, s[8:9] offset:3072
    s_add_u32 m0, s37, 45056
    v_mfma_f32_16x16x32_bf16 v[96:99], a[96:99], v[40:43], v[96:99]
    ds_read_b64_tr_b16 v[56:57], v224 offset:12288
    v_mfma_f32_16x16x32_bf16 v[100:103], a[100:103], v[40:43], v[100:103]
    ds_read_b64_tr_b16 v[58:59], v224 offset:13824
    v_mfma_f32_16x16x32_bf16 v[112:115], v[232:235], v[40:43], v[112:115]
    ds_read_b128 a[108:111], v229 offset:2048
    v_mfma_f32_16x16x32_bf16 v[116:119], v[236:239], v[40:43], v[116:119]
    global_load_lds_dwordx4 v6, s[8:9] offset:0
    v_mfma_f32_16x16x32_bf16 v[104:107], a[96:99], v[44:47], v[104:107]
    ds_read_b64_tr_b16 v[60:61], v225 offset:12288
    v_mfma_f32_16x16x32_bf16 v[108:111], a[100:103], v[44:47], v[108:111]
    ds_read_b64_tr_b16 v[62:63], v225 offset:13824
    v_mfma_f32_16x16x32_bf16 v[120:123], v[232:235], v[44:47], v[120:123]
    ds_read_b128 v[240:243], v227 offset:0
    v_mfma_f32_16x16x32_bf16 v[124:127], v[236:239], v[44:47], v[124:127]
    global_load_lds_dwordx4 v7, s[8:9] offset:1024
    s_add_u32 m0, s38, 40960
    s_waitcnt lgkmcnt(4)
    v_mfma_f32_16x16x32_bf16 v[128:131], a[96:99], v[48:51], v[128:131]
    ds_read_b64_tr_b16 v[32:33], v224 offset:12800
    v_mfma_f32_16x16x32_bf16 v[132:135], a[100:103], v[48:51], v[132:135]
    ds_read_b64_tr_b16 v[34:35], v224 offset:14336
    v_mfma_f32_16x16x32_bf16 v[144:147], v[232:235], v[48:51], v[144:147]
    ds_read_b128 v[244:247], v227 offset:2048
    v_mfma_f32_16x16x32_bf16 v[148:151], v[236:239], v[48:51], v[148:151]
    global_load_lds_dwordx4 v10, s[10:11] offset:0
    v_mfma_f32_16x16x32_bf16 v[136:139], a[96:99], v[52:55], v[136:139]
    ds_read_b64_tr_b16 v[36:37], v225 offset:12800
    v_mfma_f32_16x16x32_bf16 v[140:143], a[100:103], v[52:55], v[140:143]
    ds_read_b64_tr_b16 v[38:39], v225 offset:14336
    global_load_lds_dwordx4 v11, s[10:11] offset:1024
    v_mfma_f32_16x16x32_bf16 v[152:155], v[232:235], v[52:55], v[152:155]
    v_mfma_f32_16x16x32_bf16 v[156:159], v[236:239], v[52:55], v[156:159]
    s_waitcnt lgkmcnt(3)
    v_mfma_f32_16x16x32_bf16 v[64:67], v[56:59], a[104:107], v[64:67]
    ds_read_b64_tr_b16 v[40:41], v224 offset:13312
    v_mfma_f32_16x16x32_bf16 v[72:75], v[56:59], a[108:111], v[72:75]
    ds_read_b64_tr_b16 v[42:43], v224 offset:14848
    global_load_lds_dwordx4 v12, s[10:11] offset:2048
    s_waitcnt lgkmcnt(4)
    v_mfma_f32_16x16x32_bf16 v[80:83], v[56:59], v[240:243], v[80:83]
    global_load_lds_dwordx4 v13, s[10:11] offset:3072
    v_mfma_f32_16x16x32_bf16 v[88:91], v[56:59], v[244:247], v[88:91]
    v_mfma_f32_16x16x32_bf16 v[68:71], v[60:63], a[104:107], v[68:71]
    ds_read_b64_tr_b16 v[44:45], v225 offset:13312
    v_mfma_f32_16x16x32_bf16 v[76:79], v[60:63], a[108:111], v[76:79]
    ds_read_b64_tr_b16 v[46:47], v225 offset:14848
    v_mfma_f32_16x16x32_bf16 v[84:87], v[60:63], v[240:243], v[84:87]
    v_mfma_f32_16x16x32_bf16 v[92:95], v[60:63], v[244:247], v[92:95]
    v_mfma_f32_16x16x32_bf16 v[96:99], a[104:107], v[32:35], v[96:99]
    v_mfma_f32_16x16x32_bf16 v[100:103], a[108:111], v[32:35], v[100:103]
    s_waitcnt vmcnt(20) lgkmcnt(0)
    s_barrier
    ds_read_b64_tr_b16 v[48:49], v224 offset:40960
    ds_read_b64_tr_b16 v[50:51], v224 offset:42496
    v_mfma_f32_16x16x32_bf16 v[112:115], v[240:243], v[32:35], v[112:115]
    ds_read_b128 a[112:115], v228 offset:40960
    v_mfma_f32_16x16x32_bf16 v[116:119], v[244:247], v[32:35], v[116:119]
    v_mfma_f32_16x16x32_bf16 v[104:107], a[104:107], v[36:39], v[104:107]
    ds_read_b64_tr_b16 v[52:53], v225 offset:40960
    s_add_u32 m0, s37, 81920
    s_add_u32 s35, s35, 128
    s_and_b32 s35, s35, 2047
    s_mul_i32 s34, s35, 3072
    v_mfma_f32_16x16x32_bf16 v[108:111], a[108:111], v[36:39], v[108:111]
    ds_read_b64_tr_b16 v[54:55], v225 offset:42496
    s_add_u32 s8, s78, s34
    s_addc_u32 s9, s79, 0
    global_load_lds_dwordx4 v2, s[8:9] offset:0
    v_mfma_f32_16x16x32_bf16 v[120:123], v[240:243], v[36:39], v[120:123]
    ds_read_b128 a[116:119], v228 offset:43008
    v_mfma_f32_16x16x32_bf16 v[124:127], v[244:247], v[36:39], v[124:127]
    v_mfma_f32_16x16x32_bf16 v[128:131], a[104:107], v[40:43], v[128:131]
    ds_read_b64_tr_b16 v[56:57], v224 offset:41472
    v_mfma_f32_16x16x32_bf16 v[132:135], a[108:111], v[40:43], v[132:135]
    ds_read_b64_tr_b16 v[58:59], v224 offset:43008
    v_mfma_f32_16x16x32_bf16 v[144:147], v[240:243], v[40:43], v[144:147]
    ds_read_b128 v[232:235], v226 offset:40960
    v_mfma_f32_16x16x32_bf16 v[148:151], v[244:247], v[40:43], v[148:151]
    v_mfma_f32_16x16x32_bf16 v[136:139], a[104:107], v[44:47], v[136:139]
    ds_read_b64_tr_b16 v[60:61], v225 offset:41472
    v_mfma_f32_16x16x32_bf16 v[140:143], a[108:111], v[44:47], v[140:143]
    ds_read_b64_tr_b16 v[62:63], v225 offset:43008
    v_mfma_f32_16x16x32_bf16 v[152:155], v[240:243], v[44:47], v[152:155]
    ds_read_b128 v[236:239], v226 offset:43008
    v_mfma_f32_16x16x32_bf16 v[156:159], v[244:247], v[44:47], v[156:159]
    global_load_lds_dwordx4 v3, s[8:9] offset:1024
    s_waitcnt lgkmcnt(4)
    v_mfma_f32_16x16x32_bf16 v[64:67], v[48:51], a[112:115], v[64:67]
    ds_read_b64_tr_b16 v[32:33], v224 offset:41984
    v_mfma_f32_16x16x32_bf16 v[72:75], v[48:51], a[116:119], v[72:75]
    ds_read_b64_tr_b16 v[34:35], v224 offset:43520
    s_waitcnt lgkmcnt(2)
    v_mfma_f32_16x16x32_bf16 v[80:83], v[48:51], v[232:235], v[80:83]
    s_add_u32 s10, s76, s35
    s_addc_u32 s11, s77, 0
    v_mfma_f32_16x16x32_bf16 v[88:91], v[48:51], v[236:239], v[88:91]
    global_load_lds_dwordx4 v4, s[8:9] offset:2048
    v_mfma_f32_16x16x32_bf16 v[68:71], v[52:55], a[112:115], v[68:71]
    ds_read_b64_tr_b16 v[36:37], v225 offset:41984
    v_mfma_f32_16x16x32_bf16 v[76:79], v[52:55], a[116:119], v[76:79]
    ds_read_b64_tr_b16 v[38:39], v225 offset:43520
    v_mfma_f32_16x16x32_bf16 v[84:87], v[52:55], v[232:235], v[84:87]
    ds_read_b128 a[120:123], v229 offset:40960
    v_mfma_f32_16x16x32_bf16 v[92:95], v[52:55], v[236:239], v[92:95]
    global_load_lds_dwordx4 v5, s[8:9] offset:3072
    s_add_u32 m0, s37, 86016
    v_mfma_f32_16x16x32_bf16 v[96:99], a[112:115], v[56:59], v[96:99]
    ds_read_b64_tr_b16 v[40:41], v224 offset:53248
    v_mfma_f32_16x16x32_bf16 v[100:103], a[116:119], v[56:59], v[100:103]
    ds_read_b64_tr_b16 v[42:43], v224 offset:54784
    v_mfma_f32_16x16x32_bf16 v[112:115], v[232:235], v[56:59], v[112:115]
    ds_read_b128 a[124:127], v229 offset:43008
    v_mfma_f32_16x16x32_bf16 v[116:119], v[236:239], v[56:59], v[116:119]
    global_load_lds_dwordx4 v6, s[8:9] offset:0
    v_mfma_f32_16x16x32_bf16 v[104:107], a[112:115], v[60:63], v[104:107]
    ds_read_b64_tr_b16 v[44:45], v225 offset:53248
    v_mfma_f32_16x16x32_bf16 v[108:111], a[116:119], v[60:63], v[108:111]
    ds_read_b64_tr_b16 v[46:47], v225 offset:54784
    v_mfma_f32_16x16x32_bf16 v[120:123], v[232:235], v[60:63], v[120:123]
    ds_read_b128 v[240:243], v227 offset:40960
    v_mfma_f32_16x16x32_bf16 v[124:127], v[236:239], v[60:63], v[124:127]
    global_load_lds_dwordx4 v7, s[8:9] offset:1024
    s_add_u32 m0, s38, 81920
    s_waitcnt lgkmcnt(4)
    v_mfma_f32_16x16x32_bf16 v[128:131], a[112:115], v[32:35], v[128:131]
    ds_read_b64_tr_b16 v[48:49], v224 offset:53760
    v_mfma_f32_16x16x32_bf16 v[132:135], a[116:119], v[32:35], v[132:135]
    ds_read_b64_tr_b16 v[50:51], v224 offset:55296
    v_mfma_f32_16x16x32_bf16 v[144:147], v[232:235], v[32:35], v[144:147]
    ds_read_b128 v[244:247], v227 offset:43008
    v_mfma_f32_16x16x32_bf16 v[148:151], v[236:239], v[32:35], v[148:151]
    global_load_lds_dwordx4 v10, s[10:11] offset:0
    v_mfma_f32_16x16x32_bf16 v[136:139], a[112:115], v[36:39], v[136:139]
    ds_read_b64_tr_b16 v[52:53], v225 offset:53760
    v_mfma_f32_16x16x32_bf16 v[140:143], a[116:119], v[36:39], v[140:143]
    ds_read_b64_tr_b16 v[54:55], v225 offset:55296
    global_load_lds_dwordx4 v11, s[10:11] offset:1024
    v_mfma_f32_16x16x32_bf16 v[152:155], v[232:235], v[36:39], v[152:155]
    v_mfma_f32_16x16x32_bf16 v[156:159], v[236:239], v[36:39], v[156:159]
    s_waitcnt lgkmcnt(3)
    v_mfma_f32_16x16x32_bf16 v[64:67], v[40:43], a[120:123], v[64:67]
    ds_read_b64_tr_b16 v[56:57], v224 offset:54272
    v_mfma_f32_16x16x32_bf16 v[72:75], v[40:43], a[124:127], v[72:75]
    ds_read_b64_tr_b16 v[58:59], v224 offset:55808
    global_load_lds_dwordx4 v12, s[10:11] offset:2048
    s_waitcnt lgkmcnt(4)
    v_mfma_f32_16x16x32_bf16 v[80:83], v[40:43], v[240:243], v[80:83]
    global_load_lds_dwordx4 v13, s[10:11] offset:3072
    v_mfma_f32_16x16x32_bf16 v[88:91], v[40:43], v[244:247], v[88:91]
    v_mfma_f32_16x16x32_bf16 v[68:71], v[44:47], a[120:123], v[68:71]
    ds_read_b64_tr_b16 v[60:61], v225 offset:54272
    v_mfma_f32_16x16x32_bf16 v[76:79], v[44:47], a[124:127], v[76:79]
    ds_read_b64_tr_b16 v[62:63], v225 offset:55808
    v_mfma_f32_16x16x32_bf16 v[84:87], v[44:47], v[240:243], v[84:87]
    v_mfma_f32_16x16x32_bf16 v[92:95], v[44:47], v[244:247], v[92:95]
    v_mfma_f32_16x16x32_bf16 v[96:99], a[120:123], v[48:51], v[96:99]
    v_subrev_u32 v224, 81920, v224
    v_subrev_u32 v225, 81920, v225
    v_subrev_u32 v226, 81920, v226
    v_subrev_u32 v227, 81920, v227
    v_subrev_u32 v228, 81920, v228
    v_subrev_u32 v229, 81920, v229
    v_mfma_f32_16x16x32_bf16 v[100:103], a[124:127], v[48:51], v[100:103]
    s_waitcnt vmcnt(20) lgkmcnt(0)
    s_barrier
    ds_read_b64_tr_b16 v[32:33], v224 offset:0
    ds_read_b64_tr_b16 v[34:35], v224 offset:1536
    v_mfma_f32_16x16x32_bf16 v[112:115], v[240:243], v[48:51], v[112:115]
    ds_read_b128 a[128:131], v228 offset:0
    v_mfma_f32_16x16x32_bf16 v[116:119], v[244:247], v[48:51], v[116:119]
    v_mfma_f32_16x16x32_bf16 v[104:107], a[120:123], v[52:55], v[104:107]
    ds_read_b64_tr_b16 v[36:37], v225 offset:0
    s_add_u32 m0, s37, 122880
    s_add_u32 s35, s35, 128
    s_and_b32 s35, s35, 2047
    s_mul_i32 s34, s35, 3072
    v_mfma_f32_16x16x32_bf16 v[108:111], a[124:127], v[52:55], v[108:111]
    ds_read_b64_tr_b16 v[38:39], v225 offset:1536
    s_add_u32 s8, s78, s34
    s_addc_u32 s9, s79, 0
    global_load_lds_dwordx4 v2, s[8:9] offset:0
    v_mfma_f32_16x16x32_bf16 v[120:123], v[240:243], v[52:55], v[120:123]
    ds_read_b128 a[132:135], v228 offset:2048
    v_mfma_f32_16x16x32_bf16 v[124:127], v[244:247], v[52:55], v[124:127]
    v_mfma_f32_16x16x32_bf16 v[128:131], a[120:123], v[56:59], v[128:131]
    ds_read_b64_tr_b16 v[40:41], v224 offset:512
    v_mfma_f32_16x16x32_bf16 v[132:135], a[124:127], v[56:59], v[132:135]
    ds_read_b64_tr_b16 v[42:43], v224 offset:2048
    v_mfma_f32_16x16x32_bf16 v[144:147], v[240:243], v[56:59], v[144:147]
    ds_read_b128 v[232:235], v226 offset:0
    v_mfma_f32_16x16x32_bf16 v[148:151], v[244:247], v[56:59], v[148:151]
    v_mfma_f32_16x16x32_bf16 v[136:139], a[120:123], v[60:63], v[136:139]
    ds_read_b64_tr_b16 v[44:45], v225 offset:512
    v_mfma_f32_16x16x32_bf16 v[140:143], a[124:127], v[60:63], v[140:143]
    ds_read_b64_tr_b16 v[46:47], v225 offset:2048
    v_mfma_f32_16x16x32_bf16 v[152:155], v[240:243], v[60:63], v[152:155]
    ds_read_b128 v[236:239], v226 offset:2048
    v_mfma_f32_16x16x32_bf16 v[156:159], v[244:247], v[60:63], v[156:159]
    global_load_lds_dwordx4 v3, s[8:9] offset:1024
    s_waitcnt lgkmcnt(4)
    v_mfma_f32_16x16x32_bf16 v[64:67], v[32:35], a[128:131], v[64:67]
    ds_read_b64_tr_b16 v[48:49], v224 offset:1024
    v_mfma_f32_16x16x32_bf16 v[72:75], v[32:35], a[132:135], v[72:75]
    ds_read_b64_tr_b16 v[50:51], v224 offset:2560
    s_waitcnt lgkmcnt(2)
    v_mfma_f32_16x16x32_bf16 v[80:83], v[32:35], v[232:235], v[80:83]
    s_add_u32 s10, s76, s35
    s_addc_u32 s11, s77, 0
    v_mfma_f32_16x16x32_bf16 v[88:91], v[32:35], v[236:239], v[88:91]
    global_load_lds_dwordx4 v4, s[8:9] offset:2048
    v_mfma_f32_16x16x32_bf16 v[68:71], v[36:39], a[128:131], v[68:71]
    ds_read_b64_tr_b16 v[52:53], v225 offset:1024
    v_mfma_f32_16x16x32_bf16 v[76:79], v[36:39], a[132:135], v[76:79]
    ds_read_b64_tr_b16 v[54:55], v225 offset:2560
    v_mfma_f32_16x16x32_bf16 v[84:87], v[36:39], v[232:235], v[84:87]
    ds_read_b128 a[136:139], v229 offset:0
    v_mfma_f32_16x16x32_bf16 v[92:95], v[36:39], v[236:239], v[92:95]
    global_load_lds_dwordx4 v5, s[8:9] offset:3072
    s_add_u32 m0, s37, 126976
    v_mfma_f32_16x16x32_bf16 v[96:99], a[128:131], v[40:43], v[96:99]
    ds_read_b64_tr_b16 v[56:57], v224 offset:12288
    v_mfma_f32_16x16x32_bf16 v[100:103], a[132:135], v[40:43], v[100:103]
    ds_read_b64_tr_b16 v[58:59], v224 offset:13824
    v_mfma_f32_16x16x32_bf16 v[112:115], v[232:235], v[40:43], v[112:115]
    ds_read_b128 a[140:143], v229 offset:2048
    v_mfma_f32_16x16x32_bf16 v[116:119], v[236:239], v[40:43], v[116:119]
    global_load_lds_dwordx4 v6, s[8:9] offset:0
    v_mfma_f32_16x16x32_bf16 v[104:107], a[128:131], v[44:47], v[104:107]
    ds_read_b64_tr_b16 v[60:61], v225 offset:12288
    v_mfma_f32_16x16x32_bf16 v[108:111], a[132:135], v[44:47], v[108:111]
    ds_read_b64_tr_b16 v[62:63], v225 offset:13824
    v_mfma_f32_16x16x32_bf16 v[120:123], v[232:235], v[44:47], v[120:123]
    ds_read_b128 v[240:243], v227 offset:0
    v_mfma_f32_16x16x32_bf16 v[124:127], v[236:239], v[44:47], v[124:127]
    global_load_lds_dwordx4 v7, s[8:9] offset:1024
    s_add_u32 m0, s38, 122880
    s_waitcnt lgkmcnt(4)
    v_mfma_f32_16x16x32_bf16 v[128:131], a[128:131], v[48:51], v[128:131]
    ds_read_b64_tr_b16 v[32:33], v224 offset:12800
    v_mfma_f32_16x16x32_bf16 v[132:135], a[132:135], v[48:51], v[132:135]
    ds_read_b64_tr_b16 v[34:35], v224 offset:14336
    v_mfma_f32_16x16x32_bf16 v[144:147], v[232:235], v[48:51], v[144:147]
    ds_read_b128 v[244:247], v227 offset:2048
    v_mfma_f32_16x16x32_bf16 v[148:151], v[236:239], v[48:51], v[148:151]
    global_load_lds_dwordx4 v10, s[10:11] offset:0
    v_mfma_f32_16x16x32_bf16 v[136:139], a[128:131], v[52:55], v[136:139]
    ds_read_b64_tr_b16 v[36:37], v225 offset:12800
    v_mfma_f32_16x16x32_bf16 v[140:143], a[132:135], v[52:55], v[140:143]
    ds_read_b64_tr_b16 v[38:39], v225 offset:14336
    global_load_lds_dwordx4 v11, s[10:11] offset:1024
    v_mfma_f32_16x16x32_bf16 v[152:155], v[232:235], v[52:55], v[152:155]
    v_mfma_f32_16x16x32_bf16 v[156:159], v[236:239], v[52:55], v[156:159]
    s_waitcnt lgkmcnt(3)
    v_mfma_f32_16x16x32_bf16 v[64:67], v[56:59], a[136:139], v[64:67]
    ds_read_b64_tr_b16 v[40:41], v224 offset:13312
    v_mfma_f32_16x16x32_bf16 v[72:75], v[56:59], a[140:143], v[72:75]
    ds_read_b64_tr_b16 v[42:43], v224 offset:14848
    global_load_lds_dwordx4 v12, s[10:11] offset:2048
    s_waitcnt lgkmcnt(4)
    v_mfma_f32_16x16x32_bf16 v[80:83], v[56:59], v[240:243], v[80:83]
    global_load_lds_dwordx4 v13, s[10:11] offset:3072
    v_mfma_f32_16x16x32_bf16 v[88:91], v[56:59], v[244:247], v[88:91]
    v_mfma_f32_16x16x32_bf16 v[68:71], v[60:63], a[136:139], v[68:71]
    ds_read_b64_tr_b16 v[44:45], v225 offset:13312
    v_mfma_f32_16x16x32_bf16 v[76:79], v[60:63], a[140:143], v[76:79]
    ds_read_b64_tr_b16 v[46:47], v225 offset:14848
    v_mfma_f32_16x16x32_bf16 v[84:87], v[60:63], v[240:243], v[84:87]
    v_mfma_f32_16x16x32_bf16 v[92:95], v[60:63], v[244:247], v[92:95]
    v_mfma_f32_16x16x32_bf16 v[96:99], a[136:139], v[32:35], v[96:99]
    v_mfma_f32_16x16x32_bf16 v[100:103], a[140:143], v[32:35], v[100:103]
    s_waitcnt vmcnt(20) lgkmcnt(0)
    s_barrier
    s_getpc_b64 vcc
L_ct1:
    s_min_u32 s32, s82, L_end-L_ct1
    v_mov_b32 v0, s32
    global_load_dword v22, v0, vcc
    ds_read_b64_tr_b16 v[48:49], v224 offset:40960
    ds_read_b64_tr_b16 v[50:51], v224 offset:42496
    v_mfma_f32_16x16x32_bf16 v[112:115], v[240:243], v[32:35], v[112:115]
    ds_read_b128 a[144:147], v228 offset:40960
    v_mfma_f32_16x16x32_bf16 v[116:119], v[244:247], v[32:35], v[116:119]
    v_mfma_f32_16x16x32_bf16 v[104:107], a[136:139], v[36:39], v[104:107]
    ds_read_b64_tr_b16 v[52:53], v225 offset:40960
    s_add_u32 m0, s37, 0
    s_add_u32 s35, s35, 128
    s_and_b32 s35, s35, 2047
    s_mul_i32 s34, s35, 3072
    v_mfma_f32_16x16x32_bf16 v[108:111], a[140:143], v[36:39], v[108:111]
    ds_read_b64_tr_b16 v[54:55], v225 offset:42496
    s_add_u32 s8, s78, s34
    s_addc_u32 s9, s79, 0
    global_load_lds_dwordx4 v2, s[8:9] offset:0
    v_mfma_f32_16x16x32_bf16 v[120:123], v[240:243], v[36:39], v[120:123]
    ds_read_b128 a[148:151], v228 offset:43008
    v_mfma_f32_16x16x32_bf16 v[124:127], v[244:247], v[36:39], v[124:127]
    v_mfma_f32_16x16x32_bf16 v[128:131], a[136:139], v[40:43], v[128:131]
    ds_read_b64_tr_b16 v[56:57], v224 offset:41472
    v_mfma_f32_16x16x32_bf16 v[132:135], a[140:143], v[40:43], v[132:135]
    ds_read_b64_tr_b16 v[58:59], v224 offset:43008
    v_mfma_f32_16x16x32_bf16 v[144:147], v[240:243], v[40:43], v[144:147]
    ds_read_b128 v[232:235], v226 offset:40960
    v_mfma_f32_16x16x32_bf16 v[148:151], v[244:247], v[40:43], v[148:151]
    v_mfma_f32_16x16x32_bf16 v[136:139], a[136:139], v[44:47], v[136:139]
    ds_read_b64_tr_b16 v[60:61], v225 offset:41472
    v_mfma_f32_16x16x32_bf16 v[140:143], a[140:143], v[44:47], v[140:143]
    ds_read_b64_tr_b16 v[62:63], v225 offset:43008
    v_mfma_f32_16x16x32_bf16 v[152:155], v[240:243], v[44:47], v[152:155]
    ds_read_b128 v[236:239], v226 offset:43008
    v_mfma_f32_16x16x32_bf16 v[156:159], v[244:247], v[44:47], v[156:159]
    global_load_lds_dwordx4 v3, s[8:9] offset:1024
    s_waitcnt lgkmcnt(4)
    v_mfma_f32_16x16x32_bf16 v[64:67], v[48:51], a[144:147], v[64:67]
    ds_read_b64_tr_b16 v[32:33], v224 offset:41984
    v_mfma_f32_16x16x32_bf16 v[72:75], v[48:51], a[148:151], v[72:75]
    ds_read_b64_tr_b16 v[34:35], v224 offset:43520
    s_waitcnt lgkmcnt(2)
    v_mfma_f32_16x16x32_bf16 v[80:83], v[48:51], v[232:235], v[80:83]
    s_add_u32 s10, s76, s35
    s_addc_u32 s11, s77, 0
    v_mfma_f32_16x16x32_bf16 v[88:91], v[48:51], v[236:239], v[88:91]
    global_load_lds_dwordx4 v4, s[8:9] offset:2048
    v_mfma_f32_16x16x32_bf16 v[68:71], v[52:55], a[144:147], v[68:71]
    ds_read_b64_tr_b16 v[36:37], v225 offset:41984
    v_mfma_f32_16x16x32_bf16 v[76:79], v[52:55], a[148:151], v[76:79]
    ds_read_b64_tr_b16 v[38:39], v225 offset:43520
    v_mfma_f32_16x16x32_bf16 v[84:87], v[52:55], v[232:235], v[84:87]
    ds_read_b128 a[152:155], v229 offset:40960
    v_mfma_f32_16x16x32_bf16 v[92:95], v[52:55], v[236:239], v[92:95]
    global_load_lds_dwordx4 v5, s[8:9] offset:3072
    s_add_u32 m0, s37, 4096
    v_mfma_f32_16x16x32_bf16 v[96:99], a[144:147], v[56:59], v[96:99]
    ds_read_b64_tr_b16 v[40:41], v224 offset:53248
    v_mfma_f32_16x16x32_bf16 v[100:103], a[148:151], v[56:59], v[100:103]
    ds_read_b64_tr_b16 v[42:43], v224 offset:54784
    v_mfma_f32_16x16x32_bf16 v[112:115], v[232:235], v[56:59], v[112:115]
    ds_read_b128 a[156:159], v229 offset:43008
    v_mfma_f32_16x16x32_bf16 v[116:119], v[236:239], v[56:59], v[116:119]
    global_load_lds_dwordx4 v6, s[8:9] offset:0
    v_mfma_f32_16x16x32_bf16 v[104:107], a[144:147], v[60:63], v[104:107]
    ds_read_b64_tr_b16 v[44:45], v225 offset:53248
    v_mfma_f32_16x16x32_bf16 v[108:111], a[148:151], v[60:63], v[108:111]
    ds_read_b64_tr_b16 v[46:47], v225 offset:54784
    v_mfma_f32_16x16x32_bf16 v[120:123], v[232:235], v[60:63], v[120:123]
    ds_read_b128 v[240:243], v227 offset:40960
    v_mfma_f32_16x16x32_bf16 v[124:127], v[236:239], v[60:63], v[124:127]
    global_load_lds_dwordx4 v7, s[8:9] offset:1024
    s_add_u32 m0, s38, 0
    s_waitcnt lgkmcnt(4)
    v_mfma_f32_16x16x32_bf16 v[128:131], a[144:147], v[32:35], v[128:131]
    ds_read_b64_tr_b16 v[48:49], v224 offset:53760
    v_mfma_f32_16x16x32_bf16 v[132:135], a[148:151], v[32:35], v[132:135]
    ds_read_b64_tr_b16 v[50:51], v224 offset:55296
    v_mfma_f32_16x16x32_bf16 v[144:147], v[232:235], v[32:35], v[144:147]
    ds_read_b128 v[244:247], v227 offset:43008
    v_mfma_f32_16x16x32_bf16 v[148:151], v[236:239], v[32:35], v[148:151]
    global_load_lds_dwordx4 v10, s[10:11] offset:0
    v_mfma_f32_16x16x32_bf16 v[136:139], a[144:147], v[36:39], v[136:139]
    ds_read_b64_tr_b16 v[52:53], v225 offset:53760
    v_mfma_f32_16x16x32_bf16 v[140:143], a[148:151], v[36:39], v[140:143]
    ds_read_b64_tr_b16 v[54:55], v225 offset:55296
    global_load_lds_dwordx4 v11, s[10:11] offset:1024
    v_mfma_f32_16x16x32_bf16 v[152:155], v[232:235], v[36:39], v[152:155]
    v_mfma_f32_16x16x32_bf16 v[156:159], v[236:239], v[36:39], v[156:159]
    s_waitcnt lgkmcnt(3)
    v_mfma_f32_16x16x32_bf16 v[64:67], v[40:43], a[152:155], v[64:67]
    ds_read_b64_tr_b16 v[56:57], v224 offset:54272
    v_mfma_f32_16x16x32_bf16 v[72:75], v[40:43], a[156:159], v[72:75]
    ds_read_b64_tr_b16 v[58:59], v224 offset:55808
    global_load_lds_dwordx4 v12, s[10:11] offset:2048
    s_waitcnt lgkmcnt(4)
    v_mfma_f32_16x16x32_bf16 v[80:83], v[40:43], v[240:243], v[80:83]
    global_load_lds_dwordx4 v13, s[10:11] offset:3072
    v_mfma_f32_16x16x32_bf16 v[88:91], v[40:43], v[244:247], v[88:91]
    v_mfma_f32_16x16x32_bf16 v[68:71], v[44:47], a[152:155], v[68:71]
    ds_read_b64_tr_b16 v[60:61], v225 offset:54272
    v_mfma_f32_16x16x32_bf16 v[76:79], v[44:47], a[156:159], v[76:79]
    ds_read_b64_tr_b16 v[62:63], v225 offset:55808
    v_mfma_f32_16x16x32_bf16 v[84:87], v[44:47], v[240:243], v[84:87]
    v_mfma_f32_16x16x32_bf16 v[92:95], v[44:47], v[244:247], v[92:95]
    v_mfma_f32_16x16x32_bf16 v[96:99], a[152:155], v[48:51], v[96:99]
    v_add_u32 v224, 81920, v224
    v_add_u32 v225, 81920, v225
    v_add_u32 v226, 81920, v226
    v_add_u32 v227, 81920, v227
    v_add_u32 v228, 81920, v228
    v_add_u32 v229, 81920, v229
    v_mfma_f32_16x16x32_bf16 v[100:103], a[156:159], v[48:51], v[100:103]
    s_waitcnt vmcnt(21) lgkmcnt(0)
    s_barrier
    ds_read_b64_tr_b16 v[32:33], v224 offset:0
    ds_read_b64_tr_b16 v[34:35], v224 offset:1536
    v_mfma_f32_16x16x32_bf16 v[112:115], v[240:243], v[48:51], v[112:115]
    ds_read_b128 a[160:163], v228 offset:0
    v_mfma_f32_16x16x32_bf16 v[116:119], v[244:247], v[48:51], v[116:119]
    v_mfma_f32_16x16x32_bf16 v[104:107], a[152:155], v[52:55], v[104:107]
    ds_read_b64_tr_b16 v[36:37], v225 offset:0
    s_add_u32 m0, s37, 40960
    s_add_u32 s35, s35, 128
    s_and_b32 s35, s35, 2047
    s_mul_i32 s34, s35, 3072
    v_mfma_f32_16x16x32_bf16 v[108:111], a[156:159], v[52:55], v[108:111]
    ds_read_b64_tr_b16 v[38:39], v225 offset:1536
    s_add_u32 s8, s78, s34
    s_addc_u32 s9, s79, 0
    global_load_lds_dwordx4 v2, s[8:9] offset:0
    v_mfma_f32_16x16x32_bf16 v[120:123], v[240:243], v[52:55], v[120:123]
    ds_read_b128 a[164:167], v228 offset:2048
    v_mfma_f32_16x16x32_bf16 v[124:127], v[244:247], v[52:55], v[124:127]
    v_mfma_f32_16x16x32_bf16 v[128:131], a[152:155], v[56:59], v[128:131]
    ds_read_b64_tr_b16 v[40:41], v224 offset:512
    v_mfma_f32_16x16x32_bf16 v[132:135], a[156:159], v[56:59], v[132:135]
    ds_read_b64_tr_b16 v[42:43], v224 offset:2048
    v_mfma_f32_16x16x32_bf16 v[144:147], v[240:243], v[56:59], v[144:147]
    ds_read_b128 v[232:235], v226 offset:0
    v_mfma_f32_16x16x32_bf16 v[148:151], v[244:247], v[56:59], v[148:151]
    v_mfma_f32_16x16x32_bf16 v[136:139], a[152:155], v[60:63], v[136:139]
    ds_read_b64_tr_b16 v[44:45], v225 offset:512
    v_mfma_f32_16x16x32_bf16 v[140:143], a[156:159], v[60:63], v[140:143]
    ds_read_b64_tr_b16 v[46:47], v225 offset:2048
    v_mfma_f32_16x16x32_bf16 v[152:155], v[240:243], v[60:63], v[152:155]
    ds_read_b128 v[236:239], v226 offset:2048
    v_mfma_f32_16x16x32_bf16 v[156:159], v[244:247], v[60:63], v[156:159]
    global_load_lds_dwordx4 v3, s[8:9] offset:1024
    s_waitcnt lgkmcnt(4)
    v_mfma_f32_16x16x32_bf16 v[64:67], v[32:35], a[160:163], v[64:67]
    ds_read_b64_tr_b16 v[48:49], v224 offset:1024
    v_mfma_f32_16x16x32_bf16 v[72:75], v[32:35], a[164:167], v[72:75]
    ds_read_b64_tr_b16 v[50:51], v224 offset:2560
    s_waitcnt lgkmcnt(2)
    v_mfma_f32_16x16x32_bf16 v[80:83], v[32:35], v[232:235], v[80:83]
    s_add_u32 s10, s76, s35
    s_addc_u32 s11, s77, 0
    v_mfma_f32_16x16x32_bf16 v[88:91], v[32:35], v[236:239], v[88:91]
    global_load_lds_dwordx4 v4, s[8:9] offset:2048
    v_mfma_f32_16x16x32_bf16 v[68:71], v[36:39], a[160:163], v[68:71]
    ds_read_b64_tr_b16 v[52:53], v225 offset:1024
    v_mfma_f32_16x16x32_bf16 v[76:79], v[36:39], a[164:167], v[76:79]
    ds_read_b64_tr_b16 v[54:55], v225 offset:2560
    v_mfma_f32_16x16x32_bf16 v[84:87], v[36:39], v[232:235], v[84:87]
    ds_read_b128 a[168:171], v229 offset:0
    v_mfma_f32_16x16x32_bf16 v[92:95], v[36:39], v[236:239], v[92:95]
    global_load_lds_dwordx4 v5, s[8:9] offset:3072
    s_add_u32 m0, s37, 45056
    v_mfma_f32_16x16x32_bf16 v[96:99], a[160:163], v[40:43], v[96:99]
    ds_read_b64_tr_b16 v[56:57], v224 offset:12288
    v_mfma_f32_16x16x32_bf16 v[100:103], a[164:167], v[40:43], v[100:103]
    ds_read_b64_tr_b16 v[58:59], v224 offset:13824
    v_mfma_f32_16x16x32_bf16 v[112:115], v[232:235], v[40:43], v[112:115]
    ds_read_b128 a[172:175], v229 offset:2048
    v_mfma_f32_16x16x32_bf16 v[116:119], v[236:239], v[40:43], v[116:119]
    global_load_lds_dwordx4 v6, s[8:9] offset:0
    v_mfma_f32_16x16x32_bf16 v[104:107], a[160:163], v[44:47], v[104:107]
    ds_read_b64_tr_b16 v[60:61], v225 offset:12288
    v_mfma_f32_16x16x32_bf16 v[108:111], a[164:167], v[44:47], v[108:111]
    ds_read_b64_tr_b16 v[62:63], v225 offset:13824
    v_mfma_f32_16x16x32_bf16 v[120:123], v[232:235], v[44:47], v[120:123]
    ds_read_b128 v[240:243], v227 offset:0
    v_mfma_f32_16x16x32_bf16 v[124:127], v[236:239], v[44:47], v[124:127]
    global_load_lds_dwordx4 v7, s[8:9] offset:1024
    s_add_u32 m0, s38, 40960
    s_waitcnt lgkmcnt(4)
    v_mfma_f32_16x16x32_bf16 v[128:131], a[160:163], v[48:51], v[128:131]
    ds_read_b64_tr_b16 v[32:33], v224 offset:12800
    v_mfma_f32_16x16x32_bf16 v[132:135], a[164:167], v[48:51], v[132:135]
    ds_read_b64_tr_b16 v[34:35], v224 offset:14336
    v_mfma_f32_16x16x32_bf16 v[144:147], v[232:235], v[48:51], v[144:147]
    ds_read_b128 v[244:247], v227 offset:2048
    v_mfma_f32_16x16x32_bf16 v[148:151], v[236:239], v[48:51], v[148:151]
    global_load_lds_dwordx4 v10, s[10:11] offset:0
    v_mfma_f32_16x16x32_bf16 v[136:139], a[160:163], v[52:55], v[136:139]
    ds_read_b64_tr_b16 v[36:37], v225 offset:12800
    v_mfma_f32_16x16x32_bf16 v[140:143], a[164:167], v[52:55], v[140:143]
    ds_read_b64_tr_b16 v[38:39], v225 offset:14336
    global_load_lds_dwordx4 v11, s[10:11] offset:1024
    v_mfma_f32_16x16x32_bf16 v[152:155], v[232:235], v[52:55], v[152:155]
    v_mfma_f32_16x16x32_bf16 v[156:159], v[236:239], v[52:55], v[156:159]
    s_waitcnt lgkmcnt(3)
    v_mfma_f32_16x16x32_bf16 v[64:67], v[56:59], a[168:171], v[64:67]
    ds_read_b64_tr_b16 v[40:41], v224 offset:13312
    v_mfma_f32_16x16x32_bf16 v[72:75], v[56:59], a[172:175], v[72:75]
    ds_read_b64_tr_b16 v[42:43], v224 offset:14848
    global_load_lds_dwordx4 v12, s[10:11] offset:2048
    s_waitcnt lgkmcnt(4)
    v_mfma_f32_16x16x32_bf16 v[80:83], v[56:59], v[240:243], v[80:83]
    global_load_lds_dwordx4 v13, s[10:11] offset:3072
    v_mfma_f32_16x16x32_bf16 v[88:91], v[56:59], v[244:247], v[88:91]
    v_mfma_f32_16x16x32_bf16 v[68:71], v[60:63], a[168:171], v[68:71]
    ds_read_b64_tr_b16 v[44:45], v225 offset:13312
    v_mfma_f32_16x16x32_bf16 v[76:79], v[60:63], a[172:175], v[76:79]
    ds_read_b64_tr_b16 v[46:47], v225 offset:14848
    v_mfma_f32_16x16x32_bf16 v[84:87], v[60:63], v[240:243], v[84:87]
    v_mfma_f32_16x16x32_bf16 v[92:95], v[60:63], v[244:247], v[92:95]
    v_mfma_f32_16x16x32_bf16 v[96:99], a[168:171], v[32:35], v[96:99]
    v_mfma_f32_16x16x32_bf16 v[100:103], a[172:175], v[32:35], v[100:103]
    s_waitcnt vmcnt(21) lgkmcnt(0)
    s_barrier
    ds_read_b64_tr_b16 v[48:49], v224 offset:40960
    ds_read_b64_tr_b16 v[50:51], v224 offset:42496
    v_mfma_f32_16x16x32_bf16 v[112:115], v[240:243], v[32:35], v[112:115]
    ds_read_b128 a[176:179], v228 offset:40960
    v_mfma_f32_16x16x32_bf16 v[116:119], v[244:247], v[32:35], v[116:119]
    v_mfma_f32_16x16x32_bf16 v[104:107], a[168:171], v[36:39], v[104:107]
    ds_read_b64_tr_b16 v[52:53], v225 offset:40960
    s_add_u32 m0, s37, 81920
    s_add_u32 s35, s35, 128
    s_and_b32 s35, s35, 2047
    s_mul_i32 s34, s35, 3072
    v_mfma_f32_16x16x32_bf16 v[108:111], a[172:175], v[36:39], v[108:111]
    ds_read_b64_tr_b16 v[54:55], v225 offset:42496
    s_add_u32 s8, s78, s34
    s_addc_u32 s9, s79, 0
    global_load_lds_dwordx4 v2, s[8:9] offset:0
    v_mfma_f32_16x16x32_bf16 v[120:123], v[240:243], v[36:39], v[120:123]
    ds_read_b128 a[180:183], v228 offset:43008
    v_mfma_f32_16x16x32_bf16 v[124:127], v[244:247], v[36:39], v[124:127]
    v_mfma_f32_16x16x32_bf16 v[128:131], a[168:171], v[40:43], v[128:131]
    ds_read_b64_tr_b16 v[56:57], v224 offset:41472
    v_mfma_f32_16x16x32_bf16 v[132:135], a[172:175], v[40:43], v[132:135]
    ds_read_b64_tr_b16 v[58:59], v224 offset:43008
    v_mfma_f32_16x16x32_bf16 v[144:147], v[240:243], v[40:43], v[144:147]
    ds_read_b128 v[232:235], v226 offset:40960
    v_mfma_f32_16x16x32_bf16 v[148:151], v[244:247], v[40:43], v[148:151]
    v_mfma_f32_16x16x32_bf16 v[136:139], a[168:171], v[44:47], v[136:139]
    ds_read_b64_tr_b16 v[60:61], v225 offset:41472
    v_mfma_f32_16x16x32_bf16 v[140:143], a[172:175], v[44:47], v[140:143]
    ds_read_b64_tr_b16 v[62:63], v225 offset:43008
    v_mfma_f32_16x16x32_bf16 v[152:155], v[240:243], v[44:47], v[152:155]
    ds_read_b128 v[236:239], v226 offset:43008
    v_mfma_f32_16x16x32_bf16 v[156:159], v[244:247], v[44:47], v[156:159]
    global_load_lds_dwordx4 v3, s[8:9] offset:1024
    s_waitcnt lgkmcnt(4)
    v_mfma_f32_16x16x32_bf16 v[64:67], v[48:51], a[176:179], v[64:67]
    ds_read_b64_tr_b16 v[32:33], v224 offset:41984
    v_mfma_f32_16x16x32_bf16 v[72:75], v[48:51], a[180:183], v[72:75]
    ds_read_b64_tr_b16 v[34:35], v224 offset:43520
    s_waitcnt lgkmcnt(2)
    v_mfma_f32_16x16x32_bf16 v[80:83], v[48:51], v[232:235], v[80:83]
    s_add_u32 s10, s76, s35
    s_addc_u32 s11, s77, 0
    v_mfma_f32_16x16x32_bf16 v[88:91], v[48:51], v[236:239], v[88:91]
    global_load_lds_dwordx4 v4, s[8:9] offset:2048
    v_mfma_f32_16x16x32_bf16 v[68:71], v[52:55], a[176:179], v[68:71]
    ds_read_b64_tr_b16 v[36:37], v225 offset:41984
    v_mfma_f32_16x16x32_bf16 v[76:79], v[52:55], a[180:183], v[76:79]
    ds_read_b64_tr_b16 v[38:39], v225 offset:43520
    v_mfma_f32_16x16x32_bf16 v[84:87], v[52:55], v[232:235], v[84:87]
    ds_read_b128 a[184:187], v229 offset:40960
    v_mfma_f32_16x16x32_bf16 v[92:95], v[52:55], v[236:239], v[92:95]
    global_load_lds_dwordx4 v5, s[8:9] offset:3072
    s_add_u32 m0, s37, 86016
    v_mfma_f32_16x16x32_bf16 v[96:99], a[176:179], v[56:59], v[96:99]
    ds_read_b64_tr_b16 v[40:41], v224 offset:53248
    v_mfma_f32_16x16x32_bf16 v[100:103], a[180:183], v[56:59], v[100:103]
    ds_read_b64_tr_b16 v[42:43], v224 offset:54784
    v_mfma_f32_16x16x32_bf16 v[112:115], v[232:235], v[56:59], v[112:115]
    ds_read_b128 a[188:191], v229 offset:43008
    v_mfma_f32_16x16x32_bf16 v[116:119], v[236:239], v[56:59], v[116:119]
    global_load_lds_dwordx4 v6, s[8:9] offset:0
    v_mfma_f32_16x16x32_bf16 v[104:107], a[176:179], v[60:63], v[104:107]
    ds_read_b64_tr_b16 v[44:45], v225 offset:53248
    v_mfma_f32_16x16x32_bf16 v[108:111], a[180:183], v[60:63], v[108:111]
    ds_read_b64_tr_b16 v[46:47], v225 offset:54784
    v_mfma_f32_16x16x32_bf16 v[120:123], v[232:235], v[60:63], v[120:123]
    ds_read_b128 v[240:243], v227 offset:40960
    v_mfma_f32_16x16x32_bf16 v[124:127], v[236:239], v[60:63], v[124:127]
    global_load_lds_dwordx4 v7, s[8:9] offset:1024
    s_add_u32 m0, s38, 81920
    s_waitcnt lgkmcnt(4)
    v_mfma_f32_16x16x32_bf16 v[128:131], a[176:179], v[32:35], v[128:131]
    ds_read_b64_tr_b16 v[48:49], v224 offset:53760
    v_mfma_f32_16x16x32_bf16 v[132:135], a[180:183], v[32:35], v[132:135]
    ds_read_b64_tr_b16 v[50:51], v224 offset:55296
    v_mfma_f32_16x16x32_bf16 v[144:147], v[232:235], v[32:35], v[144:147]
    ds_read_b128 v[244:247], v227 offset:43008
    v_mfma_f32_16x16x32_bf16 v[148:151], v[236:239], v[32:35], v[148:151]
    global_load_lds_dwordx4 v10, s[10:11] offset:0
    v_mfma_f32_16x16x32_bf16 v[136:139], a[176:179], v[36:39], v[136:139]
    ds_read_b64_tr_b16 v[52:53], v225 offset:53760
    v_mfma_f32_16x16x32_bf16 v[140:143], a[180:183], v[36:39], v[140:143]
    ds_read_b64_tr_b16 v[54:55], v225 offset:55296
    global_load_lds_dwordx4 v11, s[10:11] offset:1024
    v_mfma_f32_16x16x32_bf16 v[152:155], v[232:235], v[36:39], v[152:155]
    v_mfma_f32_16x16x32_bf16 v[156:159], v[236:239], v[36:39], v[156:159]
    s_waitcnt lgkmcnt(3)
    v_mfma_f32_16x16x32_bf16 v[64:67], v[40:43], a[184:187], v[64:67]
    ds_read_b64_tr_b16 v[56:57], v224 offset:54272
    v_mfma_f32_16x16x32_bf16 v[72:75], v[40:43], a[188:191], v[72:75]
    ds_read_b64_tr_b16 v[58:59], v224 offset:55808
    global_load_lds_dwordx4 v12, s[10:11] offset:2048
    s_waitcnt lgkmcnt(4)
    v_mfma_f32_16x16x32_bf16 v[80:83], v[40:43], v[240:243], v[80:83]
    global_load_lds_dwordx4 v13, s[10:11] offset:3072
    v_mfma_f32_16x16x32_bf16 v[88:91], v[40:43], v[244:247], v[88:91]
    v_mfma_f32_16x16x32_bf16 v[68:71], v[44:47], a[184:187], v[68:71]
    ds_read_b64_tr_b16 v[60:61], v225 offset:54272
    v_mfma_f32_16x16x32_bf16 v[76:79], v[44:47], a[188:191], v[76:79]
    ds_read_b64_tr_b16 v[62:63], v225 offset:55808
    v_mfma_f32_16x16x32_bf16 v[84:87], v[44:47], v[240:243], v[84:87]
    v_mfma_f32_16x16x32_bf16 v[92:95], v[44:47], v[244:247], v[92:95]
    v_mfma_f32_16x16x32_bf16 v[96:99], a[184:187], v[48:51], v[96:99]
    v_subrev_u32 v224, 81920, v224
    v_subrev_u32 v225, 81920, v225
    v_subrev_u32 v226, 81920, v226
    v_subrev_u32 v227, 81920, v227
    v_subrev_u32 v228, 81920, v228
    v_subrev_u32 v229, 81920, v229
    v_mfma_f32_16x16x32_bf16 v[100:103], a[188:191], v[48:51], v[100:103]
    s_waitcnt vmcnt(20) lgkmcnt(0)
    s_barrier
    ds_read_b64_tr_b16 v[32:33], v224 offset:0
    ds_read_b64_tr_b16 v[34:35], v224 offset:1536
    v_mfma_f32_16x16x32_bf16 v[112:115], v[240:243], v[48:51], v[112:115]
    ds_read_b128 a[192:195], v228 offset:0
    v_mfma_f32_16x16x32_bf16 v[116:119], v[244:247], v[48:51], v[116:119]
    v_mfma_f32_16x16x32_bf16 v[104:107], a[184:187], v[52:55], v[104:107]
    ds_read_b64_tr_b16 v[36:37], v225 offset:0
    s_add_u32 m0, s37, 122880
    s_add_u32 s35, s35, 128
    s_and_b32 s35, s35, 2047
    s_mul_i32 s34, s35, 3072
    v_mfma_f32_16x16x32_bf16 v[108:111], a[188:191], v[52:55], v[108:111]
    ds_read_b64_tr_b16 v[38:39], v225 offset:1536
    s_add_u32 s8, s78, s34
    s_addc_u32 s9, s79, 0
    global_load_lds_dwordx4 v2, s[8:9] offset:0
    v_mfma_f32_16x16x32_bf16 v[120:123], v[240:243], v[52:55], v[120:123]
    ds_read_b128 a[196:199], v228 offset:2048
    v_mfma_f32_16x16x32_bf16 v[124:127], v[244:247], v[52:55], v[124:127]
    v_mfma_f32_16x16x32_bf16 v[128:131], a[184:187], v[56:59], v[128:131]
    ds_read_b64_tr_b16 v[40:41], v224 offset:512
    v_mfma_f32_16x16x32_bf16 v[132:135], a[188:191], v[56:59], v[132:135]
    ds_read_b64_tr_b16 v[42:43], v224 offset:2048
    v_mfma_f32_16x16x32_bf16 v[144:147], v[240:243], v[56:59], v[144:147]
    ds_read_b128 v[232:235], v226 offset:0
    v_mfma_f32_16x16x32_bf16 v[148:151], v[244:247], v[56:59], v[148:151]
    v_mfma_f32_16x16x32_bf16 v[136:139], a[184:187], v[60:63], v[136:139]
    ds_read_b64_tr_b16 v[44:45], v225 offset:512
    v_mfma_f32_16x16x32_bf16 v[140:143], a[188:191], v[60:63], v[140:143]
    ds_read_b64_tr_b16 v[46:47], v225 offset:2048
    v_mfma_f32_16x16x32_bf16 v[152:155], v[240:243], v[60:63], v[152:155]
    ds_read_b128 v[236:239], v226 offset:2048
    v_lshlrev_b32 v219, 2, v1
    s_lshl_b32 s32, s29, 12
    v_mfma_f32_16x16x32_bf16 v[156:159], v[244:247], v[60:63], v[156:159]
    s_add_u32 s32, s32, 20250624
    v_add_u32 v219, s32, v219
    global_load_lds_dwordx4 v3, s[8:9] offset:1024
    s_waitcnt lgkmcnt(4)
    v_mfma_f32_16x16x32_bf16 v[64:67], v[32:35], a[192:195], v[64:67]
    ds_read_b64_tr_b16 v[48:49], v224 offset:1024
    v_and_b32 v223, 0xf0, v1
    v_lshlrev_b32 v223, 3, v223
    v_and_b32 v218, 256, v1
    v_lshl_add_u32 v223, v218, 7, v223
    v_mfma_f32_16x16x32_bf16 v[72:75], v[32:35], a[196:199], v[72:75]
    ds_read_b64_tr_b16 v[50:51], v224 offset:2560
    s_lshl_b32 s32, s29, 11
    s_add_u32 s32, s32, 20185088
    v_add_u32 v223, s32, v223
    s_waitcnt lgkmcnt(2)
    v_mfma_f32_16x16x32_bf16 v[80:83], v[32:35], v[232:235], v[80:83]
    s_add_u32 s10, s76, s35
    s_addc_u32 s11, s77, 0
    v_mfma_f32_16x16x32_bf16 v[88:91], v[32:35], v[236:239], v[88:91]
    global_load_lds_dwordx4 v4, s[8:9] offset:2048
    v_mfma_f32_16x16x32_bf16 v[68:71], v[36:39], a[192:195], v[68:71]
    ds_read_b64_tr_b16 v[52:53], v225 offset:1024
    s_cmp_eq_u32 s28, 1
    s_cselect_b64 vcc, -1, 0
    s_lshr_b32 s32, s28, 1
    v_cndmask_b32 v219, v219, v223, vcc
    s_xor_b32 s48, s29, s30
    v_mfma_f32_16x16x32_bf16 v[76:79], v[36:39], a[196:199], v[76:79]
    ds_read_b64_tr_b16 v[54:55], v225 offset:2560
    s_or_b32 s32, s32, s48
    s_cmp_eq_u32 s32, 0
    s_cselect_b32 s48, 0, 2147483648
    v_mov_b32 v223, 0
    v_mfma_f32_16x16x32_bf16 v[84:87], v[36:39], v[232:235], v[84:87]
    ds_read_b128 a[200:203], v229 offset:0
    v_mfma_f32_16x16x32_bf16 v[92:95], v[36:39], v[236:239], v[92:95]
    global_load_lds_dwordx4 v5, s[8:9] offset:3072
    s_add_u32 m0, s37, 126976
    v_mfma_f32_16x16x32_bf16 v[96:99], a[192:195], v[40:43], v[96:99]
    ds_read_b64_tr_b16 v[56:57], v224 offset:12288
    v_mfma_f32_16x16x32_bf16 v[100:103], a[196:199], v[40:43], v[100:103]
    ds_read_b64_tr_b16 v[58:59], v224 offset:13824
    v_mfma_f32_16x16x32_bf16 v[112:115], v[232:235], v[40:43], v[112:115]
    ds_read_b128 a[204:207], v229 offset:2048
    v_mfma_f32_16x16x32_bf16 v[116:119], v[236:239], v[40:43], v[116:119]
    global_load_lds_dwordx4 v6, s[8:9] offset:0
    v_mfma_f32_16x16x32_bf16 v[104:107], a[192:195], v[44:47], v[104:107]
    ds_read_b64_tr_b16 v[60:61], v225 offset:12288
    v_mfma_f32_16x16x32_bf16 v[108:111], a[196:199], v[44:47], v[108:111]
    ds_read_b64_tr_b16 v[62:63], v225 offset:13824
    v_mfma_f32_16x16x32_bf16 v[120:123], v[232:235], v[44:47], v[120:123]
    ds_read_b128 v[240:243], v227 offset:0
    v_mfma_f32_16x16x32_bf16 v[124:127], v[236:239], v[44:47], v[124:127]
    global_load_lds_dwordx4 v7, s[8:9] offset:1024
    s_add_u32 m0, s38, 122880
    s_waitcnt lgkmcnt(4)
    v_mfma_f32_16x16x32_bf16 v[128:131], a[192:195], v[48:51], v[128:131]
    ds_read_b64_tr_b16 v[32:33], v224 offset:12800
    v_mfma_f32_16x16x32_bf16 v[132:135], a[196:199], v[48:51], v[132:135]
    ds_read_b64_tr_b16 v[34:35], v224 offset:14336
    v_mfma_f32_16x16x32_bf16 v[144:147], v[232:235], v[48:51], v[144:147]
    ds_read_b128 v[244:247], v227 offset:2048
    v_mfma_f32_16x16x32_bf16 v[148:151], v[236:239], v[48:51], v[148:151]
    global_load_lds_dwordx4 v10, s[10:11] offset:0
    v_mfma_f32_16x16x32_bf16 v[136:139], a[192:195], v[52:55], v[136:139]
    ds_read_b64_tr_b16 v[36:37], v225 offset:12800
    v_mfma_f32_16x16x32_bf16 v[140:143], a[196:199], v[52:55], v[140:143]
    ds_read_b64_tr_b16 v[38:39], v225 offset:14336
    global_load_lds_dwordx4 v11, s[10:11] offset:1024
    v_mfma_f32_16x16x32_bf16 v[152:155], v[232:235], v[52:55], v[152:155]
    v_mfma_f32_16x16x32_bf16 v[156:159], v[236:239], v[52:55], v[156:159]
    s_waitcnt lgkmcnt(3)
    v_mfma_f32_16x16x32_bf16 v[64:67], v[56:59], a[200:203], v[64:67]
    ds_read_b64_tr_b16 v[40:41], v224 offset:13312
    v_mfma_f32_16x16x32_bf16 v[72:75], v[56:59], a[204:207], v[72:75]
    ds_read_b64_tr_b16 v[42:43], v224 offset:14848
    global_load_lds_dwordx4 v12, s[10:11] offset:2048
    s_waitcnt lgkmcnt(4)
    v_mfma_f32_16x16x32_bf16 v[80:83], v[56:59], v[240:243], v[80:83]
    global_load_lds_dwordx4 v13, s[10:11] offset:3072
    v_mfma_f32_16x16x32_bf16 v[88:91], v[56:59], v[244:247], v[88:91]
    v_mfma_f32_16x16x32_bf16 v[68:71], v[60:63], a[200:203], v[68:71]
    ds_read_b64_tr_b16 v[44:45], v225 offset:13312
    v_mfma_f32_16x16x32_bf16 v[76:79], v[60:63], a[204:207], v[76:79]
    ds_read_b64_tr_b16 v[46:47], v225 offset:14848
    v_mfma_f32_16x16x32_bf16 v[84:87], v[60:63], v[240:243], v[84:87]
    v_mfma_f32_16x16x32_bf16 v[92:95], v[60:63], v[244:247], v[92:95]
    v_mfma_f32_16x16x32_bf16 v[96:99], a[200:203], v[32:35], v[96:99]
    v_mfma_f32_16x16x32_bf16 v[100:103], a[204:207], v[32:35], v[100:103]
    s_waitcnt vmcnt(20) lgkmcnt(0)
    s_barrier
    buffer_store_dword v223, v219, s[12:15], s48 offen sc1
    ds_read_b64_tr_b16 v[48:49], v224 offset:40960
    ds_read_b64_tr_b16 v[50:51], v224 offset:42496
    v_and_b32 v28, 0xf0, v1
    v_lshrrev_b32 v28, 3, v28
    v_bfe_u32 v29, v1, 8, 1
    s_mul_i32 s33, s30, 320
    s_sub_u32 s33, 6016, s33
    v_mfma_f32_16x16x32_bf16 v[112:115], v[240:243], v[32:35], v[112:115]
    ds_read_b128 a[208:211], v228 offset:40960
    v_mfma_f32_16x16x32_bf16 v[116:119], v[244:247], v[32:35], v[116:119]
    v_mfma_f32_16x16x32_bf16 v[104:107], a[200:203], v[36:39], v[104:107]
    ds_read_b64_tr_b16 v[52:53], v225 offset:40960
    v_lshrrev_b32 v2, 7, v1
    v_mul_u32_u24 v2, 7168, v2
    v_mfma_f32_16x16x32_bf16 v[108:111], a[204:207], v[36:39], v[108:111]
    ds_read_b64_tr_b16 v[54:55], v225 offset:42496
    v_lshrrev_b32 v3, 3, v1
    v_mfma_f32_16x16x32_bf16 v[120:123], v[240:243], v[36:39], v[120:123]
    ds_read_b128 a[212:215], v228 offset:43008
    v_and_b32 v3, 32, v3
    v_and_b32 v4, 112, v1
    v_mfma_f32_16x16x32_bf16 v[124:127], v[244:247], v[36:39], v[124:127]
    v_xor_b32 v3, v3, v4
    v_mfma_f32_16x16x32_bf16 v[128:131], a[200:203], v[40:43], v[128:131]
    ds_read_b64_tr_b16 v[56:57], v224 offset:41472
    v_add_u32 v2, v2, v3
    s_add_u32 s3, s3, s28
    v_mfma_f32_16x16x32_bf16 v[132:135], a[204:207], v[40:43], v[132:135]
    ds_read_b64_tr_b16 v[58:59], v224 offset:43008
    s_add_u32 s44, s84, s40
    s_addc_u32 s45, s85, 0
    v_mfma_f32_16x16x32_bf16 v[144:147], v[240:243], v[40:43], v[144:147]
    ds_read_b128 v[232:235], v226 offset:40960
    v_mad_u32_u24 v30, v29, s33, v28
    v_mfma_f32_16x16x32_bf16 v[148:151], v[244:247], v[40:43], v[148:151]
    v_lshl_add_u32 v28, v29, 8, v28
    v_xor_b32 v3, 64, v2
    v_add_u32 v9, 398336, v3
    v_mfma_f32_16x16x32_bf16 v[136:139], a[200:203], v[44:47], v[136:139]
    ds_read_b64_tr_b16 v[60:61], v225 offset:41472
    v_add_u32 v8, 342016, v2
    v_add_u32 v7, 285696, v3
    v_mfma_f32_16x16x32_bf16 v[140:143], a[204:207], v[44:47], v[140:143]
    ds_read_b64_tr_b16 v[62:63], v225 offset:43008
    v_add_u32 v6, 229376, v2
    v_mfma_f32_16x16x32_bf16 v[152:155], v[240:243], v[44:47], v[152:155]
    ds_read_b128 v[236:239], v226 offset:43008
    buffer_load_ushort v184, v28, s[20:23], s40 offen offset:0
    v_mfma_f32_16x16x32_bf16 v[156:159], v[244:247], v[44:47], v[156:159]
    v_add_u32 v5, 168960, v3
    v_add_u32 v4, 112640, v2
    v_add_u32 v3, 56320, v3
    s_waitcnt lgkmcnt(4)
    v_mfma_f32_16x16x32_bf16 v[64:67], v[48:51], a[208:211], v[64:67]
    ds_read_b64_tr_b16 v[32:33], v224 offset:41984
    s_add_u32 m0, s39, 0
    s_add_u32 s34, s3, 0
    s_and_b32 s34, s34, 15
    s_mul_i32 s34, s34, 458752
    v_mfma_f32_16x16x32_bf16 v[72:75], v[48:51], a[212:215], v[72:75]
    ds_read_b64_tr_b16 v[34:35], v224 offset:43520
    s_add_u32 s8, s44, s34
    s_addc_u32 s9, s45, 0
    global_load_lds_dwordx4 v2, s[8:9] offset:0
    s_waitcnt lgkmcnt(2)
    v_mfma_f32_16x16x32_bf16 v[80:83], v[48:51], v[232:235], v[80:83]
    buffer_load_ushort v185, v28, s[20:23], s40 offen offset:32
    v_mfma_f32_16x16x32_bf16 v[88:91], v[48:51], v[236:239], v[88:91]
    v_mfma_f32_16x16x32_bf16 v[68:71], v[52:55], a[208:211], v[68:71]
    ds_read_b64_tr_b16 v[36:37], v225 offset:41984
    v_mfma_f32_16x16x32_bf16 v[76:79], v[52:55], a[212:215], v[76:79]
    ds_read_b64_tr_b16 v[38:39], v225 offset:43520
    v_mfma_f32_16x16x32_bf16 v[84:87], v[52:55], v[232:235], v[84:87]
    ds_read_b128 a[216:219], v229 offset:40960
    buffer_load_ushort v186, v28, s[20:23], s40 offen offset:64
    v_mfma_f32_16x16x32_bf16 v[92:95], v[52:55], v[236:239], v[92:95]
    v_mfma_f32_16x16x32_bf16 v[96:99], a[208:211], v[56:59], v[96:99]
    ds_read_b64_tr_b16 v[40:41], v224 offset:53248
    v_mfma_f32_16x16x32_bf16 v[100:103], a[212:215], v[56:59], v[100:103]
    ds_read_b64_tr_b16 v[42:43], v224 offset:54784
    v_mfma_f32_16x16x32_bf16 v[112:115], v[232:235], v[56:59], v[112:115]
    ds_read_b128 a[220:223], v229 offset:43008
    buffer_load_ushort v187, v28, s[20:23], s40 offen offset:96
    v_mfma_f32_16x16x32_bf16 v[116:119], v[236:239], v[56:59], v[116:119]
    global_load_lds_dwordx4 v3, s[8:9] offset:1024
    v_mfma_f32_16x16x32_bf16 v[104:107], a[208:211], v[60:63], v[104:107]
    ds_read_b64_tr_b16 v[44:45], v225 offset:53248
    v_mfma_f32_16x16x32_bf16 v[108:111], a[212:215], v[60:63], v[108:111]
    ds_read_b64_tr_b16 v[46:47], v225 offset:54784
    global_load_lds_dwordx4 v4, s[8:9] offset:2048
    v_mfma_f32_16x16x32_bf16 v[120:123], v[232:235], v[60:63], v[120:123]
    ds_read_b128 v[240:243], v227 offset:40960
    buffer_load_ushort v188, v30, s[20:23], s40 offen offset:128
    v_mfma_f32_16x16x32_bf16 v[124:127], v[236:239], v[60:63], v[124:127]
    global_load_lds_dwordx4 v5, s[8:9] offset:3072
    s_add_u32 m0, s39, 4096
    s_waitcnt lgkmcnt(4)
    v_mfma_f32_16x16x32_bf16 v[128:131], a[208:211], v[32:35], v[128:131]
    ds_read_b64_tr_b16 v[48:49], v224 offset:53760
    v_mfma_f32_16x16x32_bf16 v[132:135], a[212:215], v[32:35], v[132:135]
    ds_read_b64_tr_b16 v[50:51], v224 offset:55296
    v_mfma_f32_16x16x32_bf16 v[144:147], v[232:235], v[32:35], v[144:147]
    ds_read_b128 v[244:247], v227 offset:43008
    buffer_load_ushort v189, v30, s[20:23], s40 offen offset:160
    v_mfma_f32_16x16x32_bf16 v[148:151], v[236:239], v[32:35], v[148:151]
    global_load_lds_dwordx4 v6, s[8:9] offset:0
    v_mfma_f32_16x16x32_bf16 v[136:139], a[208:211], v[36:39], v[136:139]
    ds_read_b64_tr_b16 v[52:53], v225 offset:53760
    v_mfma_f32_16x16x32_bf16 v[140:143], a[212:215], v[36:39], v[140:143]
    ds_read_b64_tr_b16 v[54:55], v225 offset:55296
    v_mfma_f32_16x16x32_bf16 v[152:155], v[232:235], v[36:39], v[152:155]
    buffer_load_ushort v190, v30, s[20:23], s40 offen offset:192
    v_mfma_f32_16x16x32_bf16 v[156:159], v[236:239], v[36:39], v[156:159]
    global_load_lds_dwordx4 v7, s[8:9] offset:1024
    s_waitcnt lgkmcnt(3)
    v_mfma_f32_16x16x32_bf16 v[64:67], v[40:43], a[216:219], v[64:67]
    ds_read_b64_tr_b16 v[56:57], v224 offset:54272
    v_mfma_f32_16x16x32_bf16 v[72:75], v[40:43], a[220:223], v[72:75]
    ds_read_b64_tr_b16 v[58:59], v224 offset:55808
    global_load_lds_dwordx4 v8, s[8:9] offset:2048
    s_waitcnt lgkmcnt(4)
    v_mfma_f32_16x16x32_bf16 v[80:83], v[40:43], v[240:243], v[80:83]
    buffer_load_ushort v191, v30, s[20:23], s40 offen offset:224
    v_mfma_f32_16x16x32_bf16 v[88:91], v[40:43], v[244:247], v[88:91]
    global_load_lds_dwordx4 v9, s[8:9] offset:3072
    v_mfma_f32_16x16x32_bf16 v[68:71], v[44:47], a[216:219], v[68:71]
    ds_read_b64_tr_b16 v[60:61], v225 offset:54272
    v_mfma_f32_16x16x32_bf16 v[76:79], v[44:47], a[220:223], v[76:79]
    ds_read_b64_tr_b16 v[62:63], v225 offset:55808
    v_mfma_f32_16x16x32_bf16 v[84:87], v[44:47], v[240:243], v[84:87]
    v_mfma_f32_16x16x32_bf16 v[92:95], v[44:47], v[244:247], v[92:95]
    v_mfma_f32_16x16x32_bf16 v[96:99], a[216:219], v[48:51], v[96:99]
    v_add_u32 v224, 81920, v224
    v_add_u32 v225, 81920, v225
    v_add_u32 v226, 81920, v226
    v_add_u32 v227, 81920, v227
    v_add_u32 v228, 81920, v228
    v_add_u32 v229, 81920, v229
    v_mfma_f32_16x16x32_bf16 v[100:103], a[220:223], v[48:51], v[100:103]
    s_waitcnt vmcnt(27) lgkmcnt(0)
    s_barrier
    s_getpc_b64 vcc
L_ct2:
    s_min_u32 s32, s82, L_end-L_ct2
    v_mov_b32 v0, s32
    global_load_dword v22, v0, vcc
    ds_read_b64_tr_b16 v[32:33], v224 offset:0
    ds_read_b64_tr_b16 v[34:35], v224 offset:1536
    v_mfma_f32_16x16x32_bf16 v[112:115], v[240:243], v[48:51], v[112:115]
    ds_read_b128 a[224:227], v228 offset:0
    v_mfma_f32_16x16x32_bf16 v[116:119], v[244:247], v[48:51], v[116:119]
    v_mfma_f32_16x16x32_bf16 v[104:107], a[216:219], v[52:55], v[104:107]
    ds_read_b64_tr_b16 v[36:37], v225 offset:0
    s_add_u32 m0, s39, 32768
    s_add_u32 s34, s3, 4
    s_and_b32 s34, s34, 15
    s_mul_i32 s34, s34, 458752
    v_mfma_f32_16x16x32_bf16 v[108:111], a[220:223], v[52:55], v[108:111]
    ds_read_b64_tr_b16 v[38:39], v225 offset:1536
    s_add_u32 s8, s44, s34
    s_addc_u32 s9, s45, 0
    global_load_lds_dwordx4 v2, s[8:9] offset:0
    v_mfma_f32_16x16x32_bf16 v[120:123], v[240:243], v[52:55], v[120:123]
    ds_read_b128 a[228:231], v228 offset:2048
    v_mfma_f32_16x16x32_bf16 v[124:127], v[244:247], v[52:55], v[124:127]
    v_mfma_f32_16x16x32_bf16 v[128:131], a[216:219], v[56:59], v[128:131]
    ds_read_b64_tr_b16 v[40:41], v224 offset:512
    v_mfma_f32_16x16x32_bf16 v[132:135], a[220:223], v[56:59], v[132:135]
    ds_read_b64_tr_b16 v[42:43], v224 offset:2048
    v_mfma_f32_16x16x32_bf16 v[144:147], v[240:243], v[56:59], v[144:147]
    ds_read_b128 v[232:235], v226 offset:0
    v_mfma_f32_16x16x32_bf16 v[148:151], v[244:247], v[56:59], v[148:151]
    v_mfma_f32_16x16x32_bf16 v[136:139], a[216:219], v[60:63], v[136:139]
    ds_read_b64_tr_b16 v[44:45], v225 offset:512
    v_mfma_f32_16x16x32_bf16 v[140:143], a[220:223], v[60:63], v[140:143]
    ds_read_b64_tr_b16 v[46:47], v225 offset:2048
    v_mfma_f32_16x16x32_bf16 v[152:155], v[240:243], v[60:63], v[152:155]
    ds_read_b128 v[236:239], v226 offset:2048
    v_mfma_f32_16x16x32_bf16 v[156:159], v[244:247], v[60:63], v[156:159]
    s_waitcnt lgkmcnt(4)
    v_mfma_f32_16x16x32_bf16 v[64:67], v[32:35], a[224:227], v[64:67]
    ds_read_b64_tr_b16 v[48:49], v224 offset:1024
    v_mfma_f32_16x16x32_bf16 v[72:75], v[32:35], a[228:231], v[72:75]
    ds_read_b64_tr_b16 v[50:51], v224 offset:2560
    s_waitcnt lgkmcnt(2)
    v_mfma_f32_16x16x32_bf16 v[80:83], v[32:35], v[232:235], v[80:83]
    global_load_lds_dwordx4 v3, s[8:9] offset:1024
    v_mfma_f32_16x16x32_bf16 v[88:91], v[32:35], v[236:239], v[88:91]
    v_mfma_f32_16x16x32_bf16 v[68:71], v[36:39], a[224:227], v[68:71]
    ds_read_b64_tr_b16 v[52:53], v225 offset:1024
    v_mfma_f32_16x16x32_bf16 v[76:79], v[36:39], a[228:231], v[76:79]
    ds_read_b64_tr_b16 v[54:55], v225 offset:2560
    v_mfma_f32_16x16x32_bf16 v[84:87], v[36:39], v[232:235], v[84:87]
    ds_read_b128 a[232:235], v229 offset:0
    v_mfma_f32_16x16x32_bf16 v[92:95], v[36:39], v[236:239], v[92:95]
    global_load_lds_dwordx4 v4, s[8:9] offset:2048
    v_mfma_f32_16x16x32_bf16 v[96:99], a[224:227], v[40:43], v[96:99]
    ds_read_b64_tr_b16 v[56:57], v224 offset:12288
    v_mfma_f32_16x16x32_bf16 v[100:103], a[228:231], v[40:43], v[100:103]
    ds_read_b64_tr_b16 v[58:59], v224 offset:13824
    global_load_lds_dwordx4 v5, s[8:9] offset:3072
    s_add_u32 m0, s39, 36864
    v_mfma_f32_16x16x32_bf16 v[112:115], v[232:235], v[40:43], v[112:115]
    ds_read_b128 a[236:239], v229 offset:2048
    v_mfma_f32_16x16x32_bf16 v[116:119], v[236:239], v[40:43], v[116:119]
    v_mfma_f32_16x16x32_bf16 v[104:107], a[224:227], v[44:47], v[104:107]
    ds_read_b64_tr_b16 v[60:61], v225 offset:12288
    v_mfma_f32_16x16x32_bf16 v[108:111], a[228:231], v[44:47], v[108:111]
    ds_read_b64_tr_b16 v[62:63], v225 offset:13824
    v_mfma_f32_16x16x32_bf16 v[120:123], v[232:235], v[44:47], v[120:123]
    ds_read_b128 v[240:243], v227 offset:0
    v_mfma_f32_16x16x32_bf16 v[124:127], v[236:239], v[44:47], v[124:127]
    global_load_lds_dwordx4 v6, s[8:9] offset:0
    s_waitcnt lgkmcnt(4)
    v_mfma_f32_16x16x32_bf16 v[128:131], a[224:227], v[48:51], v[128:131]
    ds_read_b64_tr_b16 v[32:33], v224 offset:12800
    v_mfma_f32_16x16x32_bf16 v[132:135], a[228:231], v[48:51], v[132:135]
    ds_read_b64_tr_b16 v[34:35], v224 offset:14336
    v_mfma_f32_16x16x32_bf16 v[144:147], v[232:235], v[48:51], v[144:147]
    ds_read_b128 v[244:247], v227 offset:2048
    v_mfma_f32_16x16x32_bf16 v[148:151], v[236:239], v[48:51], v[148:151]
    global_load_lds_dwordx4 v7, s[8:9] offset:1024
    v_mfma_f32_16x16x32_bf16 v[136:139], a[224:227], v[52:55], v[136:139]
    ds_read_b64_tr_b16 v[36:37], v225 offset:12800
    v_mfma_f32_16x16x32_bf16 v[140:143], a[228:231], v[52:55], v[140:143]
    ds_read_b64_tr_b16 v[38:39], v225 offset:14336
    v_mfma_f32_16x16x32_bf16 v[152:155], v[232:235], v[52:55], v[152:155]
    global_load_lds_dwordx4 v8, s[8:9] offset:2048
    v_mfma_f32_16x16x32_bf16 v[156:159], v[236:239], v[52:55], v[156:159]
    s_waitcnt lgkmcnt(3)
    v_mfma_f32_16x16x32_bf16 v[64:67], v[56:59], a[232:235], v[64:67]
    ds_read_b64_tr_b16 v[40:41], v224 offset:13312
    v_mfma_f32_16x16x32_bf16 v[72:75], v[56:59], a[236:239], v[72:75]
    ds_read_b64_tr_b16 v[42:43], v224 offset:14848
    s_waitcnt lgkmcnt(4)
    v_mfma_f32_16x16x32_bf16 v[80:83], v[56:59], v[240:243], v[80:83]
    global_load_lds_dwordx4 v9, s[8:9] offset:3072
    v_mfma_f32_16x16x32_bf16 v[88:91], v[56:59], v[244:247], v[88:91]
    v_mfma_f32_16x16x32_bf16 v[68:71], v[60:63], a[232:235], v[68:71]
    ds_read_b64_tr_b16 v[44:45], v225 offset:13312
    v_mfma_f32_16x16x32_bf16 v[76:79], v[60:63], a[236:239], v[76:79]
    ds_read_b64_tr_b16 v[46:47], v225 offset:14848
    v_mfma_f32_16x16x32_bf16 v[84:87], v[60:63], v[240:243], v[84:87]
    v_mfma_f32_16x16x32_bf16 v[92:95], v[60:63], v[244:247], v[92:95]
    v_mfma_f32_16x16x32_bf16 v[96:99], a[232:235], v[32:35], v[96:99]
    v_mfma_f32_16x16x32_bf16 v[100:103], a[236:239], v[32:35], v[100:103]
    s_waitcnt vmcnt(26) lgkmcnt(0)
    s_barrier
    ds_read_b64_tr_b16 v[48:49], v224 offset:40960
    ds_read_b64_tr_b16 v[50:51], v224 offset:42496
    v_mfma_f32_16x16x32_bf16 v[112:115], v[240:243], v[32:35], v[112:115]
    ds_read_b128 a[240:243], v228 offset:40960
    v_mfma_f32_16x16x32_bf16 v[116:119], v[244:247], v[32:35], v[116:119]
    v_mfma_f32_16x16x32_bf16 v[104:107], a[232:235], v[36:39], v[104:107]
    ds_read_b64_tr_b16 v[52:53], v225 offset:40960
    s_add_u32 m0, s39, 65536
    s_add_u32 s34, s3, 8
    s_and_b32 s34, s34, 15
    s_mul_i32 s34, s34, 458752
    v_mfma_f32_16x16x32_bf16 v[108:111], a[236:239], v[36:39], v[108:111]
    ds_read_b64_tr_b16 v[54:55], v225 offset:42496
    s_add_u32 s8, s44, s34
    s_addc_u32 s9, s45, 0
    global_load_lds_dwordx4 v2, s[8:9] offset:0
    v_mfma_f32_16x16x32_bf16 v[120:123], v[240:243], v[36:39], v[120:123]
    ds_read_b128 a[244:247], v228 offset:43008
    v_mfma_f32_16x16x32_bf16 v[124:127], v[244:247], v[36:39], v[124:127]
    v_mfma_f32_16x16x32_bf16 v[128:131], a[232:235], v[40:43], v[128:131]
    ds_read_b64_tr_b16 v[56:57], v224 offset:41472
    v_mfma_f32_16x16x32_bf16 v[132:135], a[236:239], v[40:43], v[132:135]
    ds_read_b64_tr_b16 v[58:59], v224 offset:43008
    v_mfma_f32_16x16x32_bf16 v[144:147], v[240:243], v[40:43], v[144:147]
    ds_read_b128 v[232:235], v226 offset:40960
    v_mfma_f32_16x16x32_bf16 v[148:151], v[244:247], v[40:43], v[148:151]
    s_mov_b32 s37, 0x3fb8aa3b
    s_mov_b32 s38, 0x358637bd
    v_mfma_f32_16x16x32_bf16 v[136:139], a[232:235], v[44:47], v[136:139]
    ds_read_b64_tr_b16 v[60:61], v225 offset:41472
    v_mfma_f32_16x16x32_bf16 v[140:143], a[236:239], v[44:47], v[140:143]
    ds_read_b64_tr_b16 v[62:63], v225 offset:43008
    v_mfma_f32_16x16x32_bf16 v[152:155], v[240:243], v[44:47], v[152:155]
    ds_read_b128 v[236:239], v226 offset:43008
    v_mfma_f32_16x16x32_bf16 v[156:159], v[244:247], v[44:47], v[156:159]
    s_waitcnt lgkmcnt(4)
    v_mfma_f32_16x16x32_bf16 v[64:67], v[48:51], a[240:243], v[64:67]
    ds_read_b64_tr_b16 v[32:33], v224 offset:41984
    v_mfma_f32_16x16x32_bf16 v[72:75], v[48:51], a[244:247], v[72:75]
    ds_read_b64_tr_b16 v[34:35], v224 offset:43520
    s_waitcnt lgkmcnt(2)
    v_mfma_f32_16x16x32_bf16 v[80:83], v[48:51], v[232:235], v[80:83]
    v_mfma_f32_16x16x32_bf16 v[88:91], v[48:51], v[236:239], v[88:91]
    v_mfma_f32_16x16x32_bf16 v[68:71], v[52:55], a[240:243], v[68:71]
    ds_read_b64_tr_b16 v[36:37], v225 offset:41984
    v_mfma_f32_16x16x32_bf16 v[76:79], v[52:55], a[244:247], v[76:79]
    ds_read_b64_tr_b16 v[38:39], v225 offset:43520
    global_load_lds_dwordx4 v3, s[8:9] offset:1024
    v_mfma_f32_16x16x32_bf16 v[84:87], v[52:55], v[232:235], v[84:87]
    ds_read_b128 a[248:251], v229 offset:40960
    v_mfma_f32_16x16x32_bf16 v[92:95], v[52:55], v[236:239], v[92:95]
    v_mfma_f32_16x16x32_bf16 v[96:99], a[240:243], v[56:59], v[96:99]
    ds_read_b64_tr_b16 v[40:41], v224 offset:53248
    v_mfma_f32_16x16x32_bf16 v[100:103], a[244:247], v[56:59], v[100:103]
    ds_read_b64_tr_b16 v[42:43], v224 offset:54784
    global_load_lds_dwordx4 v4, s[8:9] offset:2048
    v_mfma_f32_16x16x32_bf16 v[112:115], v[232:235], v[56:59], v[112:115]
    ds_read_b128 a[252:255], v229 offset:43008
    v_mfma_f32_16x16x32_bf16 v[116:119], v[236:239], v[56:59], v[116:119]
    v_mfma_f32_16x16x32_bf16 v[104:107], a[240:243], v[60:63], v[104:107]
    ds_read_b64_tr_b16 v[44:45], v225 offset:53248
    v_mfma_f32_16x16x32_bf16 v[108:111], a[244:247], v[60:63], v[108:111]
    ds_read_b64_tr_b16 v[46:47], v225 offset:54784
    v_mfma_f32_16x16x32_bf16 v[120:123], v[232:235], v[60:63], v[120:123]
    ds_read_b128 v[240:243], v227 offset:40960
    v_mfma_f32_16x16x32_bf16 v[124:127], v[236:239], v[60:63], v[124:127]
    global_load_lds_dwordx4 v5, s[8:9] offset:3072
    s_add_u32 m0, s39, 69632
    s_waitcnt lgkmcnt(4)
    v_mfma_f32_16x16x32_bf16 v[128:131], a[240:243], v[32:35], v[128:131]
    ds_read_b64_tr_b16 v[48:49], v224 offset:53760
    v_mfma_f32_16x16x32_bf16 v[132:135], a[244:247], v[32:35], v[132:135]
    ds_read_b64_tr_b16 v[50:51], v224 offset:55296
    s_waitcnt vmcnt(14)
    v_mfma_f32_16x16x32_bf16 v[144:147], v[232:235], v[32:35], v[144:147]
    ds_read_b128 v[244:247], v227 offset:43008
    v_mfma_f32_16x16x32_bf16 v[148:151], v[236:239], v[32:35], v[148:151]
    v_lshl_or_b32 v28, v185, 16, v184
    v_mfma_f32_16x16x32_bf16 v[136:139], a[240:243], v[36:39], v[136:139]
    ds_read_b64_tr_b16 v[52:53], v225 offset:53760
    v_lshl_or_b32 v29, v187, 16, v186
    v_mfma_f32_16x16x32_bf16 v[140:143], a[244:247], v[36:39], v[140:143]
    ds_read_b64_tr_b16 v[54:55], v225 offset:55296
    global_load_lds_dwordx4 v6, s[8:9] offset:0
    v_mfma_f32_16x16x32_bf16 v[152:155], v[232:235], v[36:39], v[152:155]
    v_lshl_or_b32 v30, v189, 16, v188
    v_mfma_f32_16x16x32_bf16 v[156:159], v[236:239], v[36:39], v[156:159]
    s_waitcnt lgkmcnt(3)
    v_mfma_f32_16x16x32_bf16 v[64:67], v[40:43], a[248:251], v[64:67]
    ds_read_b64_tr_b16 v[56:57], v224 offset:54272
    v_lshl_or_b32 v31, v191, 16, v190
    v_mfma_f32_16x16x32_bf16 v[72:75], v[40:43], a[252:255], v[72:75]
    ds_read_b64_tr_b16 v[58:59], v224 offset:55808
    global_load_lds_dwordx4 v7, s[8:9] offset:1024
    s_waitcnt lgkmcnt(4)
    v_mfma_f32_16x16x32_bf16 v[80:83], v[40:43], v[240:243], v[80:83]
    v_mfma_f32_16x16x32_bf16 v[88:91], v[40:43], v[244:247], v[88:91]
    v_mfma_f32_16x16x32_bf16 v[68:71], v[44:47], a[248:251], v[68:71]
    ds_read_b64_tr_b16 v[60:61], v225 offset:54272
    v_mfma_f32_16x16x32_bf16 v[76:79], v[44:47], a[252:255], v[76:79]
    ds_read_b64_tr_b16 v[62:63], v225 offset:55808
    global_load_lds_dwordx4 v8, s[8:9] offset:2048
    v_mfma_f32_16x16x32_bf16 v[84:87], v[44:47], v[240:243], v[84:87]
    v_mfma_f32_16x16x32_bf16 v[92:95], v[44:47], v[244:247], v[92:95]
    v_mfma_f32_16x16x32_bf16 v[96:99], a[248:251], v[48:51], v[96:99]
    global_load_lds_dwordx4 v9, s[8:9] offset:3072
    v_mfma_f32_16x16x32_bf16 v[100:103], a[252:255], v[48:51], v[100:103]
    v_mfma_f32_16x16x32_bf16 v[112:115], v[240:243], v[48:51], v[112:115]
    v_mfma_f32_16x16x32_bf16 v[116:119], v[244:247], v[48:51], v[116:119]
    s_waitcnt lgkmcnt(0)
    v_mfma_f32_16x16x32_bf16 v[104:107], a[248:251], v[52:55], v[104:107]
    v_mfma_f32_16x16x32_bf16 v[108:111], a[252:255], v[52:55], v[108:111]
    v_mfma_f32_16x16x32_bf16 v[120:123], v[240:243], v[52:55], v[120:123]
    v_mfma_f32_16x16x32_bf16 v[124:127], v[244:247], v[52:55], v[124:127]
    v_mfma_f32_16x16x32_bf16 v[128:131], a[248:251], v[56:59], v[128:131]
    v_mfma_f32_16x16x32_bf16 v[132:135], a[252:255], v[56:59], v[132:135]
    s_waitcnt vmcnt(17)
    s_barrier
    s_lshl_b32 s32, s29, 4
    s_cmp_eq_u32 s29, s30
    s_cselect_b32 s32, s32, 2147483648
    v_mov_b32 v0, 1
    buffer_store_dword v0, v27, s[24:27], s32 offen sc1
    v_mov_b32 v32, v26
    v_mov_b32 v33, 0
    v_mov_b32 v34, 0
    v_mov_b32 v35, 0
    v_lshlrev_b32 v36, 16, v26
    v_mov_b32 v37, 0
    v_mov_b32 v38, 0
    v_mov_b32 v39, 0
    v_mfma_f32_16x16x32_bf16 v[144:147], v[240:243], v[56:59], v[144:147]
    v_mov_b32 v40, 0
    v_mov_b32 v41, v26
    v_mov_b32 v42, 0
    v_mov_b32 v43, 0
    v_mfma_f32_16x16x32_bf16 v[148:151], v[244:247], v[56:59], v[148:151]
    v_mov_b32 v44, 0
    v_lshlrev_b32 v45, 16, v26
    v_mov_b32 v46, 0
    v_mov_b32 v47, 0
    v_mfma_f32_16x16x32_bf16 v[136:139], a[248:251], v[60:63], v[136:139]
    ds_read_b64_tr_b16 v[48:49], v14 offset:0
    s_add_u32 m0, s39, 98304
    s_add_u32 s34, s3, 12
    s_and_b32 s34, s34, 15
    s_mul_i32 s34, s34, 458752
    v_mfma_f32_16x16x32_bf16 v[140:143], a[252:255], v[60:63], v[140:143]
    ds_read_b64_tr_b16 v[50:51], v14 offset:512
    s_add_u32 s8, s44, s34
    s_addc_u32 s9, s45, 0
    global_load_lds_dwordx4 v2, s[8:9] offset:0
    v_mfma_f32_16x16x32_bf16 v[152:155], v[240:243], v[60:63], v[152:155]
    ds_read_b64_tr_b16 v[52:53], v15 offset:0
    v_mfma_f32_16x16x32_bf16 v[156:159], v[244:247], v[60:63], v[156:159]
    ds_read_b64_tr_b16 v[54:55], v15 offset:512
    v_mfma_f32_16x16x32_bf16 v[160:163], v[28:31], v[32:35], 0
    ds_read_b64_tr_b16 v[56:57], v16 offset:0
    v_mfma_f32_16x16x32_bf16 v[168:171], v[28:31], v[32:35], 0
    ds_read_b64_tr_b16 v[58:59], v16 offset:512
    v_mfma_f32_16x16x32_bf16 v[164:167], v[28:31], v[36:39], 0
    ds_read_b64_tr_b16 v[60:61], v17 offset:0
    v_mfma_f32_16x16x32_bf16 v[172:175], v[28:31], v[36:39], 0
    ds_read_b64_tr_b16 v[62:63], v17 offset:512
    v_mfma_f32_16x16x32_bf16 v[176:179], v[28:31], v[40:43], 0
    ds_read_b64_tr_b16 v[32:33], v14 offset:4096
    v_mfma_f32_16x16x32_bf16 v[184:187], v[28:31], v[40:43], 0
    ds_read_b64_tr_b16 v[34:35], v14 offset:4608
    v_mfma_f32_16x16x32_bf16 v[180:183], v[28:31], v[44:47], 0
    ds_read_b64_tr_b16 v[36:37], v15 offset:4096
    s_mov_b32 s20, s92
    s_mov_b32 s21, s93
    s_mov_b32 s22, 2048
    s_lshl_b32 s36, s29, 4
    s_add_u32 s36, s36, s30
    v_mfma_f32_16x16x32_bf16 v[188:191], v[28:31], v[44:47], 0
    ds_read_b64_tr_b16 v[38:39], v15 offset:4608
    s_lshl_b32 s36, s36, 2
    s_add_u32 s36, s36, s28
    s_lshl_b32 s35, s36, 12
    s_add_u32 s10, s76, s35
    s_addc_u32 s11, s77, 0
    s_waitcnt lgkmcnt(4)
    v_mfma_f32_16x16x32_bf16 v[160:163], v[48:51], a[0:3], v[160:163]
    ds_read_b64_tr_b16 v[40:41], v16 offset:4096
    v_mul_f32 v10, s37, v96
    v_mul_f32 v11, s37, v97
    v_mfma_f32_16x16x32_bf16 v[168:171], v[48:51], a[4:7], v[168:171]
    ds_read_b64_tr_b16 v[42:43], v16 offset:4608
    v_mul_f32 v12, s37, v98
    v_mul_f32 v13, s37, v99
    v_mfma_f32_16x16x32_bf16 v[164:167], v[52:55], a[0:3], v[164:167]
    ds_read_b64_tr_b16 v[44:45], v17 offset:4096
    v_mul_f32 v18, s37, v100
    v_mul_f32 v19, s37, v101
    v_mfma_f32_16x16x32_bf16 v[172:175], v[52:55], a[4:7], v[172:175]
    ds_read_b64_tr_b16 v[46:47], v17 offset:4608
    v_mul_f32 v20, s37, v102
    v_mfma_f32_16x16x32_bf16 v[176:179], v[56:59], a[0:3], v[176:179]
    ds_read_b64_tr_b16 v[48:49], v14 offset:8192
    v_mul_f32 v21, s37, v103
    v_mfma_f32_16x16x32_bf16 v[184:187], v[56:59], a[4:7], v[184:187]
    ds_read_b64_tr_b16 v[50:51], v14 offset:8704
    v_exp_f32 v10, v10 clamp
    v_mfma_f32_16x16x32_bf16 v[180:183], v[60:63], a[0:3], v[180:183]
    ds_read_b64_tr_b16 v[52:53], v15 offset:8192
    v_exp_f32 v11, v11 clamp
    v_mfma_f32_16x16x32_bf16 v[188:191], v[60:63], a[4:7], v[188:191]
    ds_read_b64_tr_b16 v[54:55], v15 offset:8704
    v_exp_f32 v12, v12 clamp
    s_waitcnt lgkmcnt(4)
    v_mfma_f32_16x16x32_bf16 v[160:163], v[32:35], a[8:11], v[160:163]
    ds_read_b64_tr_b16 v[56:57], v16 offset:8192
    v_exp_f32 v13, v13 clamp
    v_mfma_f32_16x16x32_bf16 v[168:171], v[32:35], a[12:15], v[168:171]
    ds_read_b64_tr_b16 v[58:59], v16 offset:8704
    v_mfma_f32_16x16x32_bf16 v[164:167], v[36:39], a[8:11], v[164:167]
    ds_read_b64_tr_b16 v[60:61], v17 offset:8192
    v_exp_f32 v18, v18 clamp
    v_exp_f32 v19, v19 clamp
    v_mfma_f32_16x16x32_bf16 v[172:175], v[36:39], a[12:15], v[172:175]
    ds_read_b64_tr_b16 v[62:63], v17 offset:8704
    global_load_lds_dwordx4 v3, s[8:9] offset:1024
    v_mfma_f32_16x16x32_bf16 v[176:179], v[40:43], a[8:11], v[176:179]
    ds_read_b64_tr_b16 v[32:33], v14 offset:12288
    v_exp_f32 v20, v20 clamp
    v_mfma_f32_16x16x32_bf16 v[184:187], v[40:43], a[12:15], v[184:187]
    ds_read_b64_tr_b16 v[34:35], v14 offset:12800
    v_mfma_f32_16x16x32_bf16 v[180:183], v[44:47], a[8:11], v[180:183]
    ds_read_b64_tr_b16 v[36:37], v15 offset:12288
    v_exp_f32 v21, v21 clamp
    v_mfma_f32_16x16x32_bf16 v[188:191], v[44:47], a[12:15], v[188:191]
    ds_read_b64_tr_b16 v[38:39], v15 offset:12800
    v_max_f32 v96, s38, v96
    v_max_f32 v97, s38, v97
    s_waitcnt lgkmcnt(4)
    v_mfma_f32_16x16x32_bf16 v[160:163], v[48:51], a[16:19], v[160:163]
    ds_read_b64_tr_b16 v[40:41], v16 offset:12288
    v_max_f32 v98, s38, v98
    v_max_f32 v99, s38, v99
    v_max_f32 v100, s38, v100
    v_mfma_f32_16x16x32_bf16 v[168:171], v[48:51], a[20:23], v[168:171]
    ds_read_b64_tr_b16 v[42:43], v16 offset:12800
    global_load_lds_dwordx4 v4, s[8:9] offset:2048
    v_mfma_f32_16x16x32_bf16 v[164:167], v[52:55], a[16:19], v[164:167]
    ds_read_b64_tr_b16 v[44:45], v17 offset:12288
    v_max_f32 v101, s38, v101
    v_max_f32 v102, s38, v102
    v_mfma_f32_16x16x32_bf16 v[172:175], v[52:55], a[20:23], v[172:175]
    ds_read_b64_tr_b16 v[46:47], v17 offset:12800
    v_max_f32 v103, s38, v103
    v_mfma_f32_16x16x32_bf16 v[176:179], v[56:59], a[16:19], v[176:179]
    ds_read_b64_tr_b16 v[48:49], v14 offset:16384
    v_add_f32 v10, v10, v96
    v_add_f32 v11, v11, v97
    v_mfma_f32_16x16x32_bf16 v[184:187], v[56:59], a[20:23], v[184:187]
    ds_read_b64_tr_b16 v[50:51], v14 offset:16896
    v_add_f32 v12, v12, v98
    v_mfma_f32_16x16x32_bf16 v[180:183], v[60:63], a[16:19], v[180:183]
    ds_read_b64_tr_b16 v[52:53], v15 offset:16384
    v_add_f32 v13, v13, v99
    v_add_f32 v18, v18, v100
    v_add_f32 v19, v19, v101
    v_mfma_f32_16x16x32_bf16 v[188:191], v[60:63], a[20:23], v[188:191]
    ds_read_b64_tr_b16 v[54:55], v15 offset:16896
    global_load_lds_dwordx4 v5, s[8:9] offset:3072
    s_add_u32 m0, s39, 102400
    s_waitcnt lgkmcnt(4)
    v_mfma_f32_16x16x32_bf16 v[160:163], v[32:35], a[24:27], v[160:163]
    ds_read_b64_tr_b16 v[56:57], v16 offset:16384
    buffer_load_dwordx4 v[208:211], v1, s[20:23], 0 offen
    v_add_f32 v20, v20, v102
    v_mfma_f32_16x16x32_bf16 v[168:171], v[32:35], a[28:31], v[168:171]
    ds_read_b64_tr_b16 v[58:59], v16 offset:16896
    v_add_f32 v21, v21, v103
    v_cvt_pk_bf16_f32 v96, v10, v11
    v_mfma_f32_16x16x32_bf16 v[164:167], v[36:39], a[24:27], v[164:167]
    ds_read_b64_tr_b16 v[60:61], v17 offset:16384
    v_cvt_pk_bf16_f32 v97, v12, v13
    v_cvt_pk_bf16_f32 v98, v18, v19
    v_mfma_f32_16x16x32_bf16 v[172:175], v[36:39], a[28:31], v[172:175]
    ds_read_b64_tr_b16 v[62:63], v17 offset:16896
    v_cvt_pk_bf16_f32 v99, v20, v21
    v_mfma_f32_16x16x32_bf16 v[176:179], v[40:43], a[24:27], v[176:179]
    ds_read_b64_tr_b16 v[32:33], v14 offset:20480
    buffer_load_dwordx4 v[212:215], v1, s[20:23], 0 offen offset:1024
    v_add_f32 v240, v10, v11
    v_mfma_f32_16x16x32_bf16 v[184:187], v[40:43], a[28:31], v[184:187]
    ds_read_b64_tr_b16 v[34:35], v14 offset:20992
    v_add_f32 v240, v240, v12
    v_add_f32 v240, v240, v13
    v_add_f32 v240, v240, v18
    v_mfma_f32_16x16x32_bf16 v[180:183], v[44:47], a[24:27], v[180:183]
    ds_read_b64_tr_b16 v[36:37], v15 offset:20480
    v_add_f32 v240, v240, v19
    v_add_f32 v240, v240, v20
    v_add_f32 v240, v240, v21
    v_mfma_f32_16x16x32_bf16 v[188:191], v[44:47], a[28:31], v[188:191]
    ds_read_b64_tr_b16 v[38:39], v15 offset:20992
    global_load_lds_dwordx4 v6, s[8:9] offset:0
    s_waitcnt lgkmcnt(4)
    v_mfma_f32_16x16x32_bf16 v[160:163], v[48:51], a[32:35], v[160:163]
    ds_read_b64_tr_b16 v[40:41], v16 offset:20480
    v_mul_f32 v10, s37, v104
    v_mul_f32 v11, s37, v105
    v_mfma_f32_16x16x32_bf16 v[168:171], v[48:51], a[36:39], v[168:171]
    ds_read_b64_tr_b16 v[42:43], v16 offset:20992
    v_mul_f32 v12, s37, v106
    v_mfma_f32_16x16x32_bf16 v[164:167], v[52:55], a[32:35], v[164:167]
    ds_read_b64_tr_b16 v[44:45], v17 offset:20480
    global_load_dwordx4 v[192:195], v1, s[10:11] offset:0
    v_mul_f32 v13, s37, v107
    v_mfma_f32_16x16x32_bf16 v[172:175], v[52:55], a[36:39], v[172:175]
    ds_read_b64_tr_b16 v[46:47], v17 offset:20992
    v_mul_f32 v18, s37, v108
    v_mul_f32 v19, s37, v109
    v_mfma_f32_16x16x32_bf16 v[176:179], v[56:59], a[32:35], v[176:179]
    ds_read_b64_tr_b16 v[48:49], v14 offset:24576
    v_mul_f32 v20, s37, v110
    v_mul_f32 v21, s37, v111
    v_exp_f32 v10, v10 clamp
    v_mfma_f32_16x16x32_bf16 v[184:187], v[56:59], a[36:39], v[184:187]
    ds_read_b64_tr_b16 v[50:51], v14 offset:25088
    global_load_lds_dwordx4 v7, s[8:9] offset:1024
    v_mfma_f32_16x16x32_bf16 v[180:183], v[60:63], a[32:35], v[180:183]
    ds_read_b64_tr_b16 v[52:53], v15 offset:24576
    v_exp_f32 v11, v11 clamp
    v_mfma_f32_16x16x32_bf16 v[188:191], v[60:63], a[36:39], v[188:191]
    ds_read_b64_tr_b16 v[54:55], v15 offset:25088
    s_waitcnt lgkmcnt(4)
    v_mfma_f32_16x16x32_bf16 v[160:163], v[32:35], a[40:43], v[160:163]
    ds_read_b64_tr_b16 v[56:57], v16 offset:24576
    global_load_dwordx4 v[196:199], v1, s[10:11] offset:1024
    v_exp_f32 v12, v12 clamp
    v_mfma_f32_16x16x32_bf16 v[168:171], v[32:35], a[44:47], v[168:171]
    ds_read_b64_tr_b16 v[58:59], v16 offset:25088
    v_exp_f32 v13, v13 clamp
    v_mfma_f32_16x16x32_bf16 v[164:167], v[36:39], a[40:43], v[164:167]
    ds_read_b64_tr_b16 v[60:61], v17 offset:24576
    v_exp_f32 v18, v18 clamp
    v_exp_f32 v19, v19 clamp
    v_mfma_f32_16x16x32_bf16 v[172:175], v[36:39], a[44:47], v[172:175]
    ds_read_b64_tr_b16 v[62:63], v17 offset:25088
    global_load_lds_dwordx4 v8, s[8:9] offset:2048
    v_mfma_f32_16x16x32_bf16 v[176:179], v[40:43], a[40:43], v[176:179]
    ds_read_b64_tr_b16 v[32:33], v14 offset:28672
    global_load_dwordx4 v[200:203], v1, s[10:11] offset:2048
    v_mfma_f32_16x16x32_bf16 v[184:187], v[40:43], a[44:47], v[184:187]
    ds_read_b64_tr_b16 v[34:35], v14 offset:29184
    v_exp_f32 v20, v20 clamp
    v_mfma_f32_16x16x32_bf16 v[180:183], v[44:47], a[40:43], v[180:183]
    ds_read_b64_tr_b16 v[36:37], v15 offset:28672
    v_exp_f32 v21, v21 clamp
    v_mfma_f32_16x16x32_bf16 v[188:191], v[44:47], a[44:47], v[188:191]
    ds_read_b64_tr_b16 v[38:39], v15 offset:29184
    v_max_f32 v104, s38, v104
    s_waitcnt lgkmcnt(4)
    v_mfma_f32_16x16x32_bf16 v[160:163], v[48:51], a[48:51], v[160:163]
    ds_read_b64_tr_b16 v[40:41], v16 offset:28672
    v_max_f32 v105, s38, v105
    v_max_f32 v106, s38, v106
    v_max_f32 v107, s38, v107
    v_mfma_f32_16x16x32_bf16 v[168:171], v[48:51], a[52:55], v[168:171]
    ds_read_b64_tr_b16 v[42:43], v16 offset:29184
    global_load_lds_dwordx4 v9, s[8:9] offset:3072
    v_mfma_f32_16x16x32_bf16 v[164:167], v[52:55], a[48:51], v[164:167]
    ds_read_b64_tr_b16 v[44:45], v17 offset:28672
    global_load_dwordx4 v[204:207], v1, s[10:11] offset:3072
    v_max_f32 v108, s38, v108
    v_mfma_f32_16x16x32_bf16 v[172:175], v[52:55], a[52:55], v[172:175]
    ds_read_b64_tr_b16 v[46:47], v17 offset:29184
    v_max_f32 v109, s38, v109
    v_max_f32 v110, s38, v110
    v_mfma_f32_16x16x32_bf16 v[176:179], v[56:59], a[48:51], v[176:179]
    v_max_f32 v111, s38, v111
    v_add_f32 v10, v10, v104
    v_mfma_f32_16x16x32_bf16 v[184:187], v[56:59], a[52:55], v[184:187]
    v_add_f32 v11, v11, v105
    v_mfma_f32_16x16x32_bf16 v[180:183], v[60:63], a[48:51], v[180:183]
    v_add_f32 v12, v12, v106
    v_add_f32 v13, v13, v107
    v_mfma_f32_16x16x32_bf16 v[188:191], v[60:63], a[52:55], v[188:191]
    v_add_f32 v18, v18, v108
    s_waitcnt lgkmcnt(0)
    v_mfma_f32_16x16x32_bf16 v[160:163], v[32:35], a[56:59], v[160:163]
    v_mfma_f32_16x16x32_bf16 v[168:171], v[32:35], a[60:63], v[168:171]
    s_waitcnt vmcnt(23)
    s_barrier
    ds_read_b64_tr_b16 v[48:49], v14 offset:32768
    ds_read_b64_tr_b16 v[50:51], v14 offset:33280
    ds_read_b64_tr_b16 v[52:53], v15 offset:32768
    ds_read_b64_tr_b16 v[54:55], v15 offset:33280
    v_add_f32 v19, v19, v109
    v_add_f32 v20, v20, v110
    v_add_f32 v21, v21, v111
    v_cvt_pk_bf16_f32 v100, v10, v11
    v_mfma_f32_16x16x32_bf16 v[164:167], v[36:39], a[56:59], v[164:167]
    ds_read_b64_tr_b16 v[56:57], v16 offset:32768
    ds_read_b64_tr_b16 v[58:59], v16 offset:33280
    v_cvt_pk_bf16_f32 v101, v12, v13
    v_cvt_pk_bf16_f32 v102, v18, v19
    v_mfma_f32_16x16x32_bf16 v[172:175], v[36:39], a[60:63], v[172:175]
    ds_read_b64_tr_b16 v[60:61], v17 offset:32768
    ds_read_b64_tr_b16 v[62:63], v17 offset:33280
    v_cvt_pk_bf16_f32 v103, v20, v21
    v_mfma_f32_16x16x32_bf16 v[176:179], v[40:43], a[56:59], v[176:179]
    v_add_f32 v241, v10, v11
    v_add_f32 v241, v241, v12
    v_add_f32 v241, v241, v13
    s_add_u32 m0, s39, 0
    s_add_u32 s34, s3, 0
    s_and_b32 s34, s34, 15
    v_mfma_f32_16x16x32_bf16 v[184:187], v[40:43], a[60:63], v[184:187]
    s_mul_i32 s34, s34, 458752
    s_add_u32 s34, s34, 128
    s_add_u32 s8, s44, s34
    s_addc_u32 s9, s45, 0
    global_load_lds_dwordx4 v2, s[8:9] offset:0
    v_mfma_f32_16x16x32_bf16 v[180:183], v[44:47], a[56:59], v[180:183]
    v_add_f32 v241, v241, v18
    v_add_f32 v241, v241, v19
    v_mfma_f32_16x16x32_bf16 v[188:191], v[44:47], a[60:63], v[188:191]
    v_add_f32 v241, v241, v20
    s_waitcnt lgkmcnt(0)
    v_mfma_f32_16x16x32_bf16 v[160:163], v[48:51], a[64:67], v[160:163]
    ds_read_b64_tr_b16 v[32:33], v14 offset:36864
    v_add_f32 v241, v241, v21
    v_cvt_pk_bf16_f32 v128, v128, v129
    v_mfma_f32_16x16x32_bf16 v[168:171], v[48:51], a[68:71], v[168:171]
    ds_read_b64_tr_b16 v[34:35], v14 offset:37376
    v_cvt_pk_bf16_f32 v129, v130, v131
    v_mfma_f32_16x16x32_bf16 v[164:167], v[52:55], a[64:67], v[164:167]
    ds_read_b64_tr_b16 v[36:37], v15 offset:36864
    v_cvt_pk_bf16_f32 v130, v132, v133
    v_cvt_pk_bf16_f32 v131, v134, v135
    v_mfma_f32_16x16x32_bf16 v[172:175], v[52:55], a[68:71], v[172:175]
    ds_read_b64_tr_b16 v[38:39], v15 offset:37376
    v_cvt_pk_bf16_f32 v132, v136, v137
    v_mfma_f32_16x16x32_bf16 v[176:179], v[56:59], a[64:67], v[176:179]
    ds_read_b64_tr_b16 v[40:41], v16 offset:36864
    v_cvt_pk_bf16_f32 v133, v138, v139
    v_cvt_pk_bf16_f32 v134, v140, v141
    v_mfma_f32_16x16x32_bf16 v[184:187], v[56:59], a[68:71], v[184:187]
    ds_read_b64_tr_b16 v[42:43], v16 offset:37376
    v_cvt_pk_bf16_f32 v135, v142, v143
    v_mfma_f32_16x16x32_bf16 v[180:183], v[60:63], a[64:67], v[180:183]
    ds_read_b64_tr_b16 v[44:45], v17 offset:36864
    v_mfma_f32_16x16x32_bf16 v[188:191], v[60:63], a[68:71], v[188:191]
    ds_read_b64_tr_b16 v[46:47], v17 offset:37376
    v_mfma_f32_16x16x32_bf16 v[224:227], v[96:99], v[128:131], 0
    ds_read_b64_tr_b16 v[48:49], v14 offset:40960
    v_mfma_f32_16x16x32_bf16 v[228:231], v[100:103], v[128:131], 0
    ds_read_b64_tr_b16 v[50:51], v14 offset:41472
    v_mfma_f32_16x16x32_bf16 v[232:235], v[96:99], v[132:135], 0
    ds_read_b64_tr_b16 v[52:53], v15 offset:40960
    v_mul_f32 v10, s37, v112
    v_mul_f32 v11, s37, v113
    v_mfma_f32_16x16x32_bf16 v[236:239], v[100:103], v[132:135], 0
    ds_read_b64_tr_b16 v[54:55], v15 offset:41472
    v_mul_f32 v12, s37, v114
    v_mul_f32 v13, s37, v115
    s_waitcnt lgkmcnt(4)
    v_mfma_f32_16x16x32_bf16 v[160:163], v[32:35], a[72:75], v[160:163]
    ds_read_b64_tr_b16 v[56:57], v16 offset:40960
    v_mul_f32 v18, s37, v116
    v_mul_f32 v19, s37, v117
    v_mfma_f32_16x16x32_bf16 v[168:171], v[32:35], a[76:79], v[168:171]
    ds_read_b64_tr_b16 v[58:59], v16 offset:41472
    v_mul_f32 v20, s37, v118
    v_mul_f32 v21, s37, v119
    v_mfma_f32_16x16x32_bf16 v[164:167], v[36:39], a[72:75], v[164:167]
    ds_read_b64_tr_b16 v[60:61], v17 offset:40960
    v_exp_f32 v10, v10 clamp
    v_mfma_f32_16x16x32_bf16 v[172:175], v[36:39], a[76:79], v[172:175]
    ds_read_b64_tr_b16 v[62:63], v17 offset:41472
    v_exp_f32 v11, v11 clamp
    v_mfma_f32_16x16x32_bf16 v[176:179], v[40:43], a[72:75], v[176:179]
    ds_read_b64_tr_b16 v[32:33], v14 offset:45056
    v_exp_f32 v12, v12 clamp
    v_mfma_f32_16x16x32_bf16 v[184:187], v[40:43], a[76:79], v[184:187]
    ds_read_b64_tr_b16 v[34:35], v14 offset:45568
    v_exp_f32 v13, v13 clamp
    v_mfma_f32_16x16x32_bf16 v[180:183], v[44:47], a[72:75], v[180:183]
    ds_read_b64_tr_b16 v[36:37], v15 offset:45056
    v_exp_f32 v18, v18 clamp
    v_exp_f32 v19, v19 clamp
    v_mfma_f32_16x16x32_bf16 v[188:191], v[44:47], a[76:79], v[188:191]
    ds_read_b64_tr_b16 v[38:39], v15 offset:45568
    global_load_lds_dwordx4 v3, s[8:9] offset:1024
    s_waitcnt lgkmcnt(4)
    v_mfma_f32_16x16x32_bf16 v[160:163], v[48:51], a[80:83], v[160:163]
    ds_read_b64_tr_b16 v[40:41], v16 offset:45056
    v_exp_f32 v20, v20 clamp
    v_mfma_f32_16x16x32_bf16 v[168:171], v[48:51], a[84:87], v[168:171]
    ds_read_b64_tr_b16 v[42:43], v16 offset:45568
    v_exp_f32 v21, v21 clamp
    v_mfma_f32_16x16x32_bf16 v[164:167], v[52:55], a[80:83], v[164:167]
    ds_read_b64_tr_b16 v[44:45], v17 offset:45056
    v_max_f32 v112, s38, v112
    v_max_f32 v113, s38, v113
    v_mfma_f32_16x16x32_bf16 v[172:175], v[52:55], a[84:87], v[172:175]
    ds_read_b64_tr_b16 v[46:47], v17 offset:45568
    v_max_f32 v114, s38, v114
    v_max_f32 v115, s38, v115
    v_mfma_f32_16x16x32_bf16 v[176:179], v[56:59], a[80:83], v[176:179]
    ds_read_b64_tr_b16 v[48:49], v14 offset:49152
    v_max_f32 v116, s38, v116
    v_max_f32 v117, s38, v117
    v_max_f32 v118, s38, v118
    v_mfma_f32_16x16x32_bf16 v[184:187], v[56:59], a[84:87], v[184:187]
    ds_read_b64_tr_b16 v[50:51], v14 offset:49664
    v_max_f32 v119, s38, v119
    global_load_lds_dwordx4 v4, s[8:9] offset:2048
    v_mfma_f32_16x16x32_bf16 v[180:183], v[60:63], a[80:83], v[180:183]
    ds_read_b64_tr_b16 v[52:53], v15 offset:49152
    v_add_f32 v10, v10, v112
    v_add_f32 v11, v11, v113
    v_mfma_f32_16x16x32_bf16 v[188:191], v[60:63], a[84:87], v[188:191]
    ds_read_b64_tr_b16 v[54:55], v15 offset:49664
    v_add_f32 v12, v12, v114
    v_add_f32 v13, v13, v115
    s_waitcnt lgkmcnt(4)
    v_mfma_f32_16x16x32_bf16 v[160:163], v[32:35], a[88:91], v[160:163]
    ds_read_b64_tr_b16 v[56:57], v16 offset:49152
    v_add_f32 v18, v18, v116
    v_add_f32 v19, v19, v117
    v_add_f32 v20, v20, v118
    v_add_f32 v21, v21, v119
    v_mfma_f32_16x16x32_bf16 v[168:171], v[32:35], a[92:95], v[168:171]
    ds_read_b64_tr_b16 v[58:59], v16 offset:49664
    global_load_lds_dwordx4 v5, s[8:9] offset:3072
    s_add_u32 m0, s39, 4096
    v_mfma_f32_16x16x32_bf16 v[164:167], v[36:39], a[88:91], v[164:167]
    ds_read_b64_tr_b16 v[60:61], v17 offset:49152
    v_cvt_pk_bf16_f32 v112, v10, v11
    v_cvt_pk_bf16_f32 v113, v12, v13
    v_mfma_f32_16x16x32_bf16 v[172:175], v[36:39], a[92:95], v[172:175]
    ds_read_b64_tr_b16 v[62:63], v17 offset:49664
    v_cvt_pk_bf16_f32 v114, v18, v19
    v_cvt_pk_bf16_f32 v115, v20, v21
    v_mfma_f32_16x16x32_bf16 v[176:179], v[40:43], a[88:91], v[176:179]
    ds_read_b64_tr_b16 v[32:33], v14 offset:53248
    v_add_f32 v242, v10, v11
    v_add_f32 v242, v242, v12
    v_mfma_f32_16x16x32_bf16 v[184:187], v[40:43], a[92:95], v[184:187]
    ds_read_b64_tr_b16 v[34:35], v14 offset:53760
    v_add_f32 v242, v242, v13
    v_add_f32 v242, v242, v18
    v_mfma_f32_16x16x32_bf16 v[180:183], v[44:47], a[88:91], v[180:183]
    ds_read_b64_tr_b16 v[36:37], v15 offset:53248
    v_add_f32 v242, v242, v19
    v_add_f32 v242, v242, v20
    v_mfma_f32_16x16x32_bf16 v[188:191], v[44:47], a[92:95], v[188:191]
    ds_read_b64_tr_b16 v[38:39], v15 offset:53760
    v_add_f32 v242, v242, v21
    v_mul_f32 v10, s37, v120
    s_waitcnt lgkmcnt(4)
    v_mfma_f32_16x16x32_bf16 v[160:163], v[48:51], a[96:99], v[160:163]
    ds_read_b64_tr_b16 v[40:41], v16 offset:53248
    v_mul_f32 v11, s37, v121
    v_mul_f32 v12, s37, v122
    v_mul_f32 v13, s37, v123
    v_mfma_f32_16x16x32_bf16 v[168:171], v[48:51], a[100:103], v[168:171]
    ds_read_b64_tr_b16 v[42:43], v16 offset:53760
    v_mul_f32 v18, s37, v124
    global_load_lds_dwordx4 v6, s[8:9] offset:0
    v_mfma_f32_16x16x32_bf16 v[164:167], v[52:55], a[96:99], v[164:167]
    ds_read_b64_tr_b16 v[44:45], v17 offset:53248
    v_mul_f32 v19, s37, v125
    v_mul_f32 v20, s37, v126
    v_mul_f32 v21, s37, v127
    v_mfma_f32_16x16x32_bf16 v[172:175], v[52:55], a[100:103], v[172:175]
    ds_read_b64_tr_b16 v[46:47], v17 offset:53760
    v_exp_f32 v10, v10 clamp
    v_mfma_f32_16x16x32_bf16 v[176:179], v[56:59], a[96:99], v[176:179]
    ds_read_b64_tr_b16 v[48:49], v14 offset:57344
    v_exp_f32 v11, v11 clamp
    v_mfma_f32_16x16x32_bf16 v[184:187], v[56:59], a[100:103], v[184:187]
    ds_read_b64_tr_b16 v[50:51], v14 offset:57856
    v_mfma_f32_16x16x32_bf16 v[180:183], v[60:63], a[96:99], v[180:183]
    ds_read_b64_tr_b16 v[52:53], v15 offset:57344
    v_exp_f32 v12, v12 clamp
    v_exp_f32 v13, v13 clamp
    v_mfma_f32_16x16x32_bf16 v[188:191], v[60:63], a[100:103], v[188:191]
    ds_read_b64_tr_b16 v[54:55], v15 offset:57856
    global_load_lds_dwordx4 v7, s[8:9] offset:1024
    s_waitcnt lgkmcnt(4)
    v_mfma_f32_16x16x32_bf16 v[160:163], v[32:35], a[104:107], v[160:163]
    ds_read_b64_tr_b16 v[56:57], v16 offset:57344
    v_exp_f32 v18, v18 clamp
    v_mfma_f32_16x16x32_bf16 v[168:171], v[32:35], a[108:111], v[168:171]
    ds_read_b64_tr_b16 v[58:59], v16 offset:57856
    v_exp_f32 v19, v19 clamp
    v_mfma_f32_16x16x32_bf16 v[164:167], v[36:39], a[104:107], v[164:167]
    ds_read_b64_tr_b16 v[60:61], v17 offset:57344
    v_exp_f32 v20, v20 clamp
    v_exp_f32 v21, v21 clamp
    v_mfma_f32_16x16x32_bf16 v[172:175], v[36:39], a[108:111], v[172:175]
    ds_read_b64_tr_b16 v[62:63], v17 offset:57856
    global_load_lds_dwordx4 v8, s[8:9] offset:2048
    v_mfma_f32_16x16x32_bf16 v[176:179], v[40:43], a[104:107], v[176:179]
    ds_read_b64_tr_b16 v[32:33], v14 offset:61440
    v_max_f32 v120, s38, v120
    v_max_f32 v121, s38, v121
    v_mfma_f32_16x16x32_bf16 v[184:187], v[40:43], a[108:111], v[184:187]
    ds_read_b64_tr_b16 v[34:35], v14 offset:61952
    v_max_f32 v122, s38, v122
    v_max_f32 v123, s38, v123
    v_mfma_f32_16x16x32_bf16 v[180:183], v[44:47], a[104:107], v[180:183]
    ds_read_b64_tr_b16 v[36:37], v15 offset:61440
    v_max_f32 v124, s38, v124
    v_max_f32 v125, s38, v125
    v_mfma_f32_16x16x32_bf16 v[188:191], v[44:47], a[108:111], v[188:191]
    ds_read_b64_tr_b16 v[38:39], v15 offset:61952
    v_max_f32 v126, s38, v126
    v_max_f32 v127, s38, v127
    s_waitcnt lgkmcnt(4)
    v_mfma_f32_16x16x32_bf16 v[160:163], v[48:51], a[112:115], v[160:163]
    ds_read_b64_tr_b16 v[40:41], v16 offset:61440
    v_add_f32 v10, v10, v120
    v_add_f32 v11, v11, v121
    v_add_f32 v12, v12, v122
    v_mfma_f32_16x16x32_bf16 v[168:171], v[48:51], a[116:119], v[168:171]
    ds_read_b64_tr_b16 v[42:43], v16 offset:61952
    v_add_f32 v13, v13, v123
    global_load_lds_dwordx4 v9, s[8:9] offset:3072
    v_mfma_f32_16x16x32_bf16 v[164:167], v[52:55], a[112:115], v[164:167]
    ds_read_b64_tr_b16 v[44:45], v17 offset:61440
    v_add_f32 v18, v18, v124
    v_add_f32 v19, v19, v125
    v_mfma_f32_16x16x32_bf16 v[172:175], v[52:55], a[116:119], v[172:175]
    ds_read_b64_tr_b16 v[46:47], v17 offset:61952
    v_add_f32 v20, v20, v126
    v_add_f32 v21, v21, v127
    v_mfma_f32_16x16x32_bf16 v[176:179], v[56:59], a[112:115], v[176:179]
    v_cvt_pk_bf16_f32 v116, v10, v11
    v_cvt_pk_bf16_f32 v117, v12, v13
    v_mfma_f32_16x16x32_bf16 v[184:187], v[56:59], a[116:119], v[184:187]
    v_cvt_pk_bf16_f32 v118, v18, v19
    v_cvt_pk_bf16_f32 v119, v20, v21
    v_mfma_f32_16x16x32_bf16 v[180:183], v[60:63], a[112:115], v[180:183]
    v_add_f32 v243, v10, v11
    v_add_f32 v243, v243, v12
    v_mfma_f32_16x16x32_bf16 v[188:191], v[60:63], a[116:119], v[188:191]
    v_add_f32 v243, v243, v13
    v_add_f32 v243, v243, v18
    s_waitcnt lgkmcnt(0)
    v_mfma_f32_16x16x32_bf16 v[160:163], v[32:35], a[120:123], v[160:163]
    v_add_u32 v14, 65536, v14
    v_add_u32 v15, 65536, v15
    v_add_u32 v16, 65536, v16
    v_add_u32 v17, 65536, v17
    v_mfma_f32_16x16x32_bf16 v[168:171], v[32:35], a[124:127], v[168:171]
    s_waitcnt vmcnt(23)
    s_barrier
    s_getpc_b64 vcc
L_ct3:
    s_min_u32 s32, s82, L_end-L_ct3
    v_mov_b32 v0, s32
    global_load_dword v22, v0, vcc
    s_mov_b32 s20, s88
    s_mov_b32 s21, s89
    s_mov_b32 s22, 7340032
    s_add_u32 s32, s83, 0
    buffer_load_dword v22, v25, s[20:23], s32 offen
    ds_read_b64_tr_b16 v[48:49], v14 offset:0
    ds_read_b64_tr_b16 v[50:51], v14 offset:512
    ds_read_b64_tr_b16 v[52:53], v15 offset:0
    ds_read_b64_tr_b16 v[54:55], v15 offset:512
    v_add_f32 v243, v243, v19
    v_add_f32 v243, v243, v20
    v_add_f32 v243, v243, v21
    v_cvt_pk_bf16_f32 v144, v144, v145
    v_mfma_f32_16x16x32_bf16 v[164:167], v[36:39], a[120:123], v[164:167]
    ds_read_b64_tr_b16 v[56:57], v16 offset:0
    ds_read_b64_tr_b16 v[58:59], v16 offset:512
    v_cvt_pk_bf16_f32 v145, v146, v147
    v_cvt_pk_bf16_f32 v146, v148, v149
    v_mfma_f32_16x16x32_bf16 v[172:175], v[36:39], a[124:127], v[172:175]
    ds_read_b64_tr_b16 v[60:61], v17 offset:0
    ds_read_b64_tr_b16 v[62:63], v17 offset:512
    v_cvt_pk_bf16_f32 v147, v150, v151
    v_cvt_pk_bf16_f32 v148, v152, v153
    v_mfma_f32_16x16x32_bf16 v[176:179], v[40:43], a[120:123], v[176:179]
    v_cvt_pk_bf16_f32 v149, v154, v155
    v_cvt_pk_bf16_f32 v150, v156, v157
    v_cvt_pk_bf16_f32 v151, v158, v159
    v_add_f32 v240, v240, v242
    v_add_f32 v241, v241, v243
    s_lshl_b32 s32, s30, 4
    s_add_u32 s32, s32, s29
    v_permlane16_swap_b32 v240, v241
    v_add_f32 v240, v240, v241
    v_mov_b32 v241, v240
    s_lshl_b32 s32, s32, 2
    s_add_u32 s32, s32, s28
    v_permlane32_swap_b32 v240, v241
    s_lshl_b32 s32, s32, 7
    v_mfma_f32_16x16x32_bf16 v[184:187], v[40:43], a[124:127], v[184:187]
    s_add_u32 s32, s32, 20447232
    v_add_f32 v220, v240, v241
    v_bfe_u32 v221, v1, 2, 7
    buffer_store_dword v220, v221, s[12:15], s32 offen sc1
    s_add_u32 m0, s39, 32768
    s_add_u32 s34, s3, 4
    s_and_b32 s34, s34, 15
    s_mul_i32 s34, s34, 458752
    s_add_u32 s34, s34, 128
    s_add_u32 s8, s44, s34
    s_addc_u32 s9, s45, 0
    global_load_lds_dwordx4 v2, s[8:9] offset:0
    v_mfma_f32_16x16x32_bf16 v[180:183], v[44:47], a[120:123], v[180:183]
    v_mfma_f32_16x16x32_bf16 v[188:191], v[44:47], a[124:127], v[188:191]
    s_waitcnt lgkmcnt(0)
    v_mfma_f32_16x16x32_bf16 v[160:163], v[48:51], a[128:131], v[160:163]
    ds_read_b64_tr_b16 v[32:33], v14 offset:4096
    v_mfma_f32_16x16x32_bf16 v[168:171], v[48:51], a[132:135], v[168:171]
    ds_read_b64_tr_b16 v[34:35], v14 offset:4608
    v_mfma_f32_16x16x32_bf16 v[164:167], v[52:55], a[128:131], v[164:167]
    ds_read_b64_tr_b16 v[36:37], v15 offset:4096
    v_mfma_f32_16x16x32_bf16 v[172:175], v[52:55], a[132:135], v[172:175]
    ds_read_b64_tr_b16 v[38:39], v15 offset:4608
    v_mfma_f32_16x16x32_bf16 v[176:179], v[56:59], a[128:131], v[176:179]
    ds_read_b64_tr_b16 v[40:41], v16 offset:4096
    v_mfma_f32_16x16x32_bf16 v[184:187], v[56:59], a[132:135], v[184:187]
    ds_read_b64_tr_b16 v[42:43], v16 offset:4608
    v_mfma_f32_16x16x32_bf16 v[180:183], v[60:63], a[128:131], v[180:183]
    ds_read_b64_tr_b16 v[44:45], v17 offset:4096
    v_mfma_f32_16x16x32_bf16 v[188:191], v[60:63], a[132:135], v[188:191]
    ds_read_b64_tr_b16 v[46:47], v17 offset:4608
    v_mfma_f32_16x16x32_bf16 v[224:227], v[112:115], v[144:147], v[224:227]
    ds_read_b64_tr_b16 v[48:49], v14 offset:8192
    v_mfma_f32_16x16x32_bf16 v[228:231], v[116:119], v[144:147], v[228:231]
    ds_read_b64_tr_b16 v[50:51], v14 offset:8704
    v_mfma_f32_16x16x32_bf16 v[232:235], v[112:115], v[148:151], v[232:235]
    ds_read_b64_tr_b16 v[52:53], v15 offset:8192
    v_mfma_f32_16x16x32_bf16 v[236:239], v[116:119], v[148:151], v[236:239]
    ds_read_b64_tr_b16 v[54:55], v15 offset:8704
    s_waitcnt vmcnt(12)
    v_mov_b32 v216, 0
    v_mov_b32 v217, 0
    s_waitcnt lgkmcnt(4)
    v_mfma_f32_16x16x32_bf16 v[160:163], v[32:35], a[136:139], v[160:163]
    ds_read_b64_tr_b16 v[56:57], v16 offset:8192
    v_dot2_f32_bf16 v216, v192, v208, v216
    v_mfma_f32_16x16x32_bf16 v[168:171], v[32:35], a[140:143], v[168:171]
    ds_read_b64_tr_b16 v[58:59], v16 offset:8704
    v_mfma_f32_16x16x32_bf16 v[164:167], v[36:39], a[136:139], v[164:167]
    ds_read_b64_tr_b16 v[60:61], v17 offset:8192
    v_dot2_f32_bf16 v217, v200, v208, v217
    v_mfma_f32_16x16x32_bf16 v[172:175], v[36:39], a[140:143], v[172:175]
    ds_read_b64_tr_b16 v[62:63], v17 offset:8704
    v_dot2_f32_bf16 v216, v193, v209, v216
    v_mfma_f32_16x16x32_bf16 v[176:179], v[40:43], a[136:139], v[176:179]
    ds_read_b64_tr_b16 v[32:33], v14 offset:12288
    v_dot2_f32_bf16 v217, v201, v209, v217
    v_mfma_f32_16x16x32_bf16 v[184:187], v[40:43], a[140:143], v[184:187]
    ds_read_b64_tr_b16 v[34:35], v14 offset:12800
    v_mfma_f32_16x16x32_bf16 v[180:183], v[44:47], a[136:139], v[180:183]
    ds_read_b64_tr_b16 v[36:37], v15 offset:12288
    s_lshl_b32 s32, s28, 12
    s_add_u32 s32, s32, 131072
    v_add_u32 v222, s32, v1
    v_mfma_f32_16x16x32_bf16 v[188:191], v[44:47], a[140:143], v[188:191]
    ds_read_b64_tr_b16 v[38:39], v15 offset:12800
    v_dot2_f32_bf16 v216, v194, v210, v216
    global_load_lds_dwordx4 v3, s[8:9] offset:1024
    s_waitcnt lgkmcnt(4)
    v_mfma_f32_16x16x32_bf16 v[160:163], v[48:51], a[144:147], v[160:163]
    ds_read_b64_tr_b16 v[40:41], v16 offset:12288
    v_dot2_f32_bf16 v217, v202, v210, v217
    v_mfma_f32_16x16x32_bf16 v[168:171], v[48:51], a[148:151], v[168:171]
    ds_read_b64_tr_b16 v[42:43], v16 offset:12800
    v_mfma_f32_16x16x32_bf16 v[164:167], v[52:55], a[144:147], v[164:167]
    ds_read_b64_tr_b16 v[44:45], v17 offset:12288
    v_dot2_f32_bf16 v216, v195, v211, v216
    v_mfma_f32_16x16x32_bf16 v[172:175], v[52:55], a[148:151], v[172:175]
    ds_read_b64_tr_b16 v[46:47], v17 offset:12800
    v_mfma_f32_16x16x32_bf16 v[176:179], v[56:59], a[144:147], v[176:179]
    ds_read_b64_tr_b16 v[48:49], v14 offset:16384
    v_dot2_f32_bf16 v217, v203, v211, v217
    v_dot2_f32_bf16 v216, v196, v212, v216
    v_mfma_f32_16x16x32_bf16 v[184:187], v[56:59], a[148:151], v[184:187]
    ds_read_b64_tr_b16 v[50:51], v14 offset:16896
    global_load_lds_dwordx4 v4, s[8:9] offset:2048
    v_mfma_f32_16x16x32_bf16 v[180:183], v[60:63], a[144:147], v[180:183]
    ds_read_b64_tr_b16 v[52:53], v15 offset:16384
    v_dot2_f32_bf16 v217, v204, v212, v217
    v_mfma_f32_16x16x32_bf16 v[188:191], v[60:63], a[148:151], v[188:191]
    ds_read_b64_tr_b16 v[54:55], v15 offset:16896
    s_waitcnt lgkmcnt(4)
    v_mfma_f32_16x16x32_bf16 v[160:163], v[32:35], a[152:155], v[160:163]
    ds_read_b64_tr_b16 v[56:57], v16 offset:16384
    v_mfma_f32_16x16x32_bf16 v[168:171], v[32:35], a[156:159], v[168:171]
    ds_read_b64_tr_b16 v[58:59], v16 offset:16896
    ds_write_b128 v222, v[224:227] offset:0
    v_dot2_f32_bf16 v216, v197, v213, v216
    global_load_lds_dwordx4 v5, s[8:9] offset:3072
    s_add_u32 m0, s39, 36864
    v_mfma_f32_16x16x32_bf16 v[164:167], v[36:39], a[152:155], v[164:167]
    ds_read_b64_tr_b16 v[60:61], v17 offset:16384
    v_dot2_f32_bf16 v217, v205, v213, v217
    v_mfma_f32_16x16x32_bf16 v[172:175], v[36:39], a[156:159], v[172:175]
    ds_read_b64_tr_b16 v[62:63], v17 offset:16896
    v_mfma_f32_16x16x32_bf16 v[176:179], v[40:43], a[152:155], v[176:179]
    ds_read_b64_tr_b16 v[32:33], v14 offset:20480
    v_dot2_f32_bf16 v216, v198, v214, v216
    v_mfma_f32_16x16x32_bf16 v[184:187], v[40:43], a[156:159], v[184:187]
    ds_read_b64_tr_b16 v[34:35], v14 offset:20992
    v_mfma_f32_16x16x32_bf16 v[180:183], v[44:47], a[152:155], v[180:183]
    ds_read_b64_tr_b16 v[36:37], v15 offset:20480
    v_dot2_f32_bf16 v217, v206, v214, v217
    v_mfma_f32_16x16x32_bf16 v[188:191], v[44:47], a[156:159], v[188:191]
    ds_read_b64_tr_b16 v[38:39], v15 offset:20992
    v_dot2_f32_bf16 v216, v199, v215, v216
    s_waitcnt lgkmcnt(4)
    v_mfma_f32_16x16x32_bf16 v[160:163], v[48:51], a[160:163], v[160:163]
    ds_read_b64_tr_b16 v[40:41], v16 offset:20480
    v_mfma_f32_16x16x32_bf16 v[168:171], v[48:51], a[164:167], v[168:171]
    ds_read_b64_tr_b16 v[42:43], v16 offset:20992
    ds_write_b128 v222, v[228:231] offset:1024
    v_dot2_f32_bf16 v217, v207, v215, v217
    global_load_lds_dwordx4 v6, s[8:9] offset:0
    v_mfma_f32_16x16x32_bf16 v[164:167], v[52:55], a[160:163], v[164:167]
    ds_read_b64_tr_b16 v[44:45], v17 offset:20480
    v_cmp_eq_u32 vcc, 1008, v1
    v_mov_b32 v218, 2147483648
    s_lshl_b32 s36, s36, 3
    v_mfma_f32_16x16x32_bf16 v[172:175], v[52:55], a[164:167], v[172:175]
    ds_read_b64_tr_b16 v[46:47], v17 offset:20992
    v_cndmask_b32 v218, v218, 0, vcc
    s_add_u32 s36, s36, 19922944
    v_mfma_f32_16x16x32_bf16 v[176:179], v[56:59], a[160:163], v[176:179]
    ds_read_b64_tr_b16 v[48:49], v14 offset:24576
    v_mfma_f32_16x16x32_bf16 v[184:187], v[56:59], a[164:167], v[184:187]
    ds_read_b64_tr_b16 v[50:51], v14 offset:25088
    v_mfma_f32_16x16x32_bf16 v[180:183], v[60:63], a[160:163], v[180:183]
    ds_read_b64_tr_b16 v[52:53], v15 offset:24576
    v_mfma_f32_16x16x32_bf16 v[188:191], v[60:63], a[164:167], v[188:191]
    ds_read_b64_tr_b16 v[54:55], v15 offset:25088
    ds_write_b128 v222, v[232:235] offset:2048
    v_add_f32_dpp v216, v216, v216 row_shr:1 row_mask:0xf bank_mask:0xf bound_ctrl:0
    v_add_f32_dpp v217, v217, v217 row_shr:1 row_mask:0xf bank_mask:0xf bound_ctrl:0
    s_nop 0
    global_load_lds_dwordx4 v7, s[8:9] offset:1024
    s_waitcnt lgkmcnt(5)
    v_mfma_f32_16x16x32_bf16 v[160:163], v[32:35], a[168:171], v[160:163]
    ds_read_b64_tr_b16 v[56:57], v16 offset:24576
    v_add_f32_dpp v216, v216, v216 row_shr:2 row_mask:0xf bank_mask:0xf bound_ctrl:0
    v_add_f32_dpp v217, v217, v217 row_shr:2 row_mask:0xf bank_mask:0xf bound_ctrl:0
    v_mfma_f32_16x16x32_bf16 v[168:171], v[32:35], a[172:175], v[168:171]
    ds_read_b64_tr_b16 v[58:59], v16 offset:25088
    s_nop 0
    v_mfma_f32_16x16x32_bf16 v[164:167], v[36:39], a[168:171], v[164:167]
    ds_read_b64_tr_b16 v[60:61], v17 offset:24576
    s_lshl_b32 s32, s29, 4
    v_mov_b32 v156, s32
    s_lshl_b32 s32, s30, 4
    v_writelane_b32 v156, s32, 1
    v_mfma_f32_16x16x32_bf16 v[172:175], v[36:39], a[172:175], v[172:175]
    ds_read_b64_tr_b16 v[62:63], v17 offset:25088
    s_xor_b32 s32, s32, 64
    v_writelane_b32 v156, s32, 2
    global_load_lds_dwordx4 v8, s[8:9] offset:2048
    v_mfma_f32_16x16x32_bf16 v[176:179], v[40:43], a[168:171], v[176:179]
    ds_read_b64_tr_b16 v[32:33], v14 offset:28672
    v_add_f32_dpp v216, v216, v216 row_shr:4 row_mask:0xf bank_mask:0xf bound_ctrl:0
    v_add_f32_dpp v217, v217, v217 row_shr:4 row_mask:0xf bank_mask:0xf bound_ctrl:0
    s_nop 0
    s_and_b32 s32, s1, 512
    v_mfma_f32_16x16x32_bf16 v[184:187], v[40:43], a[172:175], v[184:187]
    ds_read_b64_tr_b16 v[34:35], v14 offset:29184
    v_cmp_gt_u32 vcc, s32, v1
    v_mov_b32 v157, 2147483648
    s_nop 0
    v_cndmask_b32 v156, v157, v156, vcc
    v_mfma_f32_16x16x32_bf16 v[180:183], v[44:47], a[168:171], v[180:183]
    ds_read_b64_tr_b16 v[36:37], v15 offset:28672
    v_mfma_f32_16x16x32_bf16 v[188:191], v[44:47], a[172:175], v[188:191]
    ds_read_b64_tr_b16 v[38:39], v15 offset:29184
    ds_write_b128 v222, v[236:239] offset:3072
    v_add_f32_dpp v216, v216, v216 row_shr:8 row_mask:0xf bank_mask:0xf bound_ctrl:0
    v_add_f32_dpp v217, v217, v217 row_shr:8 row_mask:0xf bank_mask:0xf bound_ctrl:0
    s_nop 0
    s_waitcnt lgkmcnt(5)
    v_mfma_f32_16x16x32_bf16 v[160:163], v[48:51], a[176:179], v[160:163]
    ds_read_b64_tr_b16 v[40:41], v16 offset:28672
    v_add_f32_dpp v216, v216, v216 row_bcast:15 row_mask:0xa bank_mask:0xf
    v_add_f32_dpp v217, v217, v217 row_bcast:15 row_mask:0xa bank_mask:0xf
    s_nop 0
    v_mfma_f32_16x16x32_bf16 v[168:171], v[48:51], a[180:183], v[168:171]
    ds_read_b64_tr_b16 v[42:43], v16 offset:29184
    global_load_lds_dwordx4 v9, s[8:9] offset:3072
    v_mfma_f32_16x16x32_bf16 v[164:167], v[52:55], a[176:179], v[164:167]
    ds_read_b64_tr_b16 v[44:45], v17 offset:28672
    v_add_f32_dpp v216, v216, v216 row_bcast:31 row_mask:0xc bank_mask:0xf
    v_add_f32_dpp v217, v217, v217 row_bcast:31 row_mask:0xc bank_mask:0xf
    v_mfma_f32_16x16x32_bf16 v[172:175], v[52:55], a[180:183], v[172:175]
    ds_read_b64_tr_b16 v[46:47], v17 offset:29184
    s_nop 0
    v_mfma_f32_16x16x32_bf16 v[176:179], v[56:59], a[176:179], v[176:179]
    v_mfma_f32_16x16x32_bf16 v[184:187], v[56:59], a[180:183], v[184:187]
    v_mfma_f32_16x16x32_bf16 v[180:183], v[60:63], a[176:179], v[180:183]
    buffer_store_dwordx2 v[216:217], v218, s[12:15], s36 offen sc1
    v_mfma_f32_16x16x32_bf16 v[188:191], v[60:63], a[180:183], v[188:191]
    s_waitcnt lgkmcnt(0)
    v_mfma_f32_16x16x32_bf16 v[160:163], v[32:35], a[184:187], v[160:163]
    v_mfma_f32_16x16x32_bf16 v[168:171], v[32:35], a[188:191], v[168:171]
    s_barrier
    s_add_u32 s32, s83, 2048
    buffer_load_dword v22, v25, s[20:23], s32 offen
    buffer_load_dword v157, v156, s[24:27], 0 offen sc1
    ds_read_b64_tr_b16 v[48:49], v14 offset:32768
    ds_read_b64_tr_b16 v[50:51], v14 offset:33280
    ds_read_b64_tr_b16 v[52:53], v15 offset:32768
    ds_read_b64_tr_b16 v[54:55], v15 offset:33280
    s_and_b32 s32, s28, 1
    s_lshl_b32 s32, s32, 1
    s_lshr_b32 s48, s28, 1
    s_add_u32 s32, s32, s48
    s_lshl_b32 s48, s32, 11
    s_add_u32 s48, s48, 131072
    v_add_u32 v222, s48, v1
    s_lshl_b32 s36, s30, 2
    s_add_u32 s36, s36, s32
    s_lshl_b32 s36, s36, 5
    s_add_u32 s36, s36, s29
    s_lshl_b32 s36, s36, 10
    s_add_u32 s36, s36, 20971520
    v_mfma_f32_16x16x32_bf16 v[164:167], v[36:39], a[184:187], v[164:167]
    ds_read_b64_tr_b16 v[56:57], v16 offset:32768
    ds_read_b64_tr_b16 v[58:59], v16 offset:33280
    v_mfma_f32_16x16x32_bf16 v[172:175], v[36:39], a[188:191], v[172:175]
    ds_read_b64_tr_b16 v[60:61], v17 offset:32768
    ds_read_b64_tr_b16 v[62:63], v17 offset:33280
    v_mfma_f32_16x16x32_bf16 v[176:179], v[40:43], a[184:187], v[176:179]
    ds_read_b64_tr_b16 v[32:33], v14 offset:36864
    s_add_u32 m0, s39, 65536
    s_add_u32 s34, s3, 8
    s_and_b32 s34, s34, 15
    s_mul_i32 s34, s34, 458752
    s_add_u32 s34, s34, 128
    v_mfma_f32_16x16x32_bf16 v[184:187], v[40:43], a[188:191], v[184:187]
    ds_read_b64_tr_b16 v[34:35], v14 offset:37376
    s_add_u32 s8, s44, s34
    s_addc_u32 s9, s45, 0
    global_load_lds_dwordx4 v2, s[8:9] offset:0
    v_mfma_f32_16x16x32_bf16 v[180:183], v[44:47], a[184:187], v[180:183]
    ds_read_b64_tr_b16 v[36:37], v15 offset:36864
    v_mfma_f32_16x16x32_bf16 v[188:191], v[44:47], a[188:191], v[188:191]
    ds_read_b64_tr_b16 v[38:39], v15 offset:37376
    s_waitcnt lgkmcnt(4)
    v_mfma_f32_16x16x32_bf16 v[160:163], v[48:51], a[192:195], v[160:163]
    ds_read_b64_tr_b16 v[40:41], v16 offset:36864
    v_mfma_f32_16x16x32_bf16 v[168:171], v[48:51], a[196:199], v[168:171]
    ds_read_b64_tr_b16 v[42:43], v16 offset:37376
    ds_read_b128 v[96:99], v222 offset:0
    ds_read_b128 v[100:103], v222 offset:1024
    v_mfma_f32_16x16x32_bf16 v[164:167], v[52:55], a[192:195], v[164:167]
    ds_read_b64_tr_b16 v[44:45], v17 offset:36864
    v_mfma_f32_16x16x32_bf16 v[172:175], v[52:55], a[196:199], v[172:175]
    ds_read_b64_tr_b16 v[46:47], v17 offset:37376
    ds_read_b128 v[104:107], v222 offset:8192
    ds_read_b128 v[108:111], v222 offset:9216
    v_mfma_f32_16x16x32_bf16 v[176:179], v[56:59], a[192:195], v[176:179]
    ds_read_b64_tr_b16 v[48:49], v14 offset:40960
    v_mul_f32 v10, s37, v64
    v_mfma_f32_16x16x32_bf16 v[184:187], v[56:59], a[196:199], v[184:187]
    ds_read_b64_tr_b16 v[50:51], v14 offset:41472
    v_mul_f32 v11, s37, v65
    v_mfma_f32_16x16x32_bf16 v[180:183], v[60:63], a[192:195], v[180:183]
    ds_read_b64_tr_b16 v[52:53], v15 offset:40960
    v_mul_f32 v12, s37, v66
    v_mul_f32 v13, s37, v67
    v_mfma_f32_16x16x32_bf16 v[188:191], v[60:63], a[196:199], v[188:191]
    ds_read_b64_tr_b16 v[54:55], v15 offset:41472
    v_mul_f32 v18, s37, v68
    s_waitcnt lgkmcnt(6)
    v_mfma_f32_16x16x32_bf16 v[160:163], v[32:35], a[200:203], v[160:163]
    ds_read_b64_tr_b16 v[56:57], v16 offset:40960
    v_mul_f32 v19, s37, v69
    v_mul_f32 v20, s37, v70
    v_mfma_f32_16x16x32_bf16 v[168:171], v[32:35], a[204:207], v[168:171]
    ds_read_b64_tr_b16 v[58:59], v16 offset:41472
    v_mul_f32 v21, s37, v71
    s_waitcnt lgkmcnt(6)
    v_mfma_f32_16x16x32_bf16 v[164:167], v[36:39], a[200:203], v[164:167]
    ds_read_b64_tr_b16 v[60:61], v17 offset:40960
    v_add_f32 v96, v96, v104
    v_add_f32 v97, v97, v105
    v_mfma_f32_16x16x32_bf16 v[172:175], v[36:39], a[204:207], v[172:175]
    ds_read_b64_tr_b16 v[62:63], v17 offset:41472
    v_add_f32 v98, v98, v106
    v_mfma_f32_16x16x32_bf16 v[176:179], v[40:43], a[200:203], v[176:179]
    ds_read_b64_tr_b16 v[32:33], v14 offset:45056
    v_add_f32 v99, v99, v107
    v_mfma_f32_16x16x32_bf16 v[184:187], v[40:43], a[204:207], v[184:187]
    ds_read_b64_tr_b16 v[34:35], v14 offset:45568
    buffer_store_dwordx4 v[96:99], v1, s[12:15], s36 offen sc1
    v_mfma_f32_16x16x32_bf16 v[180:183], v[44:47], a[200:203], v[180:183]
    ds_read_b64_tr_b16 v[36:37], v15 offset:45056
    v_add_f32 v100, v100, v108
    v_add_f32 v101, v101, v109
    v_mfma_f32_16x16x32_bf16 v[188:191], v[44:47], a[204:207], v[188:191]
    ds_read_b64_tr_b16 v[38:39], v15 offset:45568
    v_add_f32 v102, v102, v110
    s_waitcnt lgkmcnt(4)
    v_mfma_f32_16x16x32_bf16 v[160:163], v[48:51], a[208:211], v[160:163]
    ds_read_b64_tr_b16 v[40:41], v16 offset:45056
    v_add_f32 v103, v103, v111
    s_add_u32 s36, s36, 16384
    buffer_store_dwordx4 v[100:103], v1, s[12:15], s36 offen sc1
    v_mfma_f32_16x16x32_bf16 v[168:171], v[48:51], a[212:215], v[168:171]
    ds_read_b64_tr_b16 v[42:43], v16 offset:45568
    global_load_lds_dwordx4 v3, s[8:9] offset:1024
    v_mfma_f32_16x16x32_bf16 v[164:167], v[52:55], a[208:211], v[164:167]
    ds_read_b64_tr_b16 v[44:45], v17 offset:45056
    v_exp_f32 v10, v10 clamp
    v_mfma_f32_16x16x32_bf16 v[172:175], v[52:55], a[212:215], v[172:175]
    ds_read_b64_tr_b16 v[46:47], v17 offset:45568
    v_exp_f32 v11, v11 clamp
    v_mfma_f32_16x16x32_bf16 v[176:179], v[56:59], a[208:211], v[176:179]
    ds_read_b64_tr_b16 v[48:49], v14 offset:49152
    v_exp_f32 v12, v12 clamp
    v_mfma_f32_16x16x32_bf16 v[184:187], v[56:59], a[212:215], v[184:187]
    ds_read_b64_tr_b16 v[50:51], v14 offset:49664
    v_mfma_f32_16x16x32_bf16 v[180:183], v[60:63], a[208:211], v[180:183]
    ds_read_b64_tr_b16 v[52:53], v15 offset:49152
    v_exp_f32 v13, v13 clamp
    v_exp_f32 v18, v18 clamp
    v_mfma_f32_16x16x32_bf16 v[188:191], v[60:63], a[212:215], v[188:191]
    ds_read_b64_tr_b16 v[54:55], v15 offset:49664
    global_load_lds_dwordx4 v4, s[8:9] offset:2048
    s_waitcnt lgkmcnt(4)
    v_mfma_f32_16x16x32_bf16 v[160:163], v[32:35], a[216:219], v[160:163]
    ds_read_b64_tr_b16 v[56:57], v16 offset:49152
    v_exp_f32 v19, v19 clamp
    v_mfma_f32_16x16x32_bf16 v[168:171], v[32:35], a[220:223], v[168:171]
    ds_read_b64_tr_b16 v[58:59], v16 offset:49664
    v_exp_f32 v20, v20 clamp
    v_mfma_f32_16x16x32_bf16 v[164:167], v[36:39], a[216:219], v[164:167]
    ds_read_b64_tr_b16 v[60:61], v17 offset:49152
    v_exp_f32 v21, v21 clamp
    v_mfma_f32_16x16x32_bf16 v[172:175], v[36:39], a[220:223], v[172:175]
    ds_read_b64_tr_b16 v[62:63], v17 offset:49664
    global_load_lds_dwordx4 v5, s[8:9] offset:3072
    s_add_u32 m0, s39, 69632
    v_mfma_f32_16x16x32_bf16 v[176:179], v[40:43], a[216:219], v[176:179]
    ds_read_b64_tr_b16 v[32:33], v14 offset:53248
    v_max_f32 v64, s38, v64
    v_max_f32 v65, s38, v65
    v_mfma_f32_16x16x32_bf16 v[184:187], v[40:43], a[220:223], v[184:187]
    ds_read_b64_tr_b16 v[34:35], v14 offset:53760
    v_max_f32 v66, s38, v66
    v_mfma_f32_16x16x32_bf16 v[180:183], v[44:47], a[216:219], v[180:183]
    ds_read_b64_tr_b16 v[36:37], v15 offset:53248
    v_max_f32 v67, s38, v67
    v_max_f32 v68, s38, v68
    v_mfma_f32_16x16x32_bf16 v[188:191], v[44:47], a[220:223], v[188:191]
    ds_read_b64_tr_b16 v[38:39], v15 offset:53760
    v_max_f32 v69, s38, v69
    s_waitcnt lgkmcnt(4)
    v_mfma_f32_16x16x32_bf16 v[160:163], v[48:51], a[224:227], v[160:163]
    ds_read_b64_tr_b16 v[40:41], v16 offset:53248
    v_max_f32 v70, s38, v70
    v_max_f32 v71, s38, v71
    v_mfma_f32_16x16x32_bf16 v[168:171], v[48:51], a[228:231], v[168:171]
    ds_read_b64_tr_b16 v[42:43], v16 offset:53760
    v_add_f32 v10, v10, v64
    v_mfma_f32_16x16x32_bf16 v[164:167], v[52:55], a[224:227], v[164:167]
    ds_read_b64_tr_b16 v[44:45], v17 offset:53248
    v_add_f32 v11, v11, v65
    v_add_f32 v12, v12, v66
    v_add_f32 v13, v13, v67
    v_mfma_f32_16x16x32_bf16 v[172:175], v[52:55], a[228:231], v[172:175]
    ds_read_b64_tr_b16 v[46:47], v17 offset:53760
    v_add_f32 v18, v18, v68
    global_load_lds_dwordx4 v6, s[8:9] offset:0
    v_mfma_f32_16x16x32_bf16 v[176:179], v[56:59], a[224:227], v[176:179]
    ds_read_b64_tr_b16 v[48:49], v14 offset:57344
    v_add_f32 v19, v19, v69
    v_add_f32 v20, v20, v70
    v_mfma_f32_16x16x32_bf16 v[184:187], v[56:59], a[228:231], v[184:187]
    ds_read_b64_tr_b16 v[50:51], v14 offset:57856
    v_add_f32 v21, v21, v71
    v_mfma_f32_16x16x32_bf16 v[180:183], v[60:63], a[224:227], v[180:183]
    ds_read_b64_tr_b16 v[52:53], v15 offset:57344
    v_cvt_pk_bf16_f32 v64, v10, v11
    v_cvt_pk_bf16_f32 v65, v12, v13
    v_cvt_pk_bf16_f32 v66, v18, v19
    v_mfma_f32_16x16x32_bf16 v[188:191], v[60:63], a[228:231], v[188:191]
    ds_read_b64_tr_b16 v[54:55], v15 offset:57856
    global_load_lds_dwordx4 v7, s[8:9] offset:1024
    s_waitcnt lgkmcnt(4)
    v_mfma_f32_16x16x32_bf16 v[160:163], v[32:35], a[232:235], v[160:163]
    ds_read_b64_tr_b16 v[56:57], v16 offset:57344
    v_cvt_pk_bf16_f32 v67, v20, v21
    v_mul_f32 v10, s37, v72
    v_mfma_f32_16x16x32_bf16 v[168:171], v[32:35], a[236:239], v[168:171]
    ds_read_b64_tr_b16 v[58:59], v16 offset:57856
    v_mul_f32 v11, s37, v73
    v_mfma_f32_16x16x32_bf16 v[164:167], v[36:39], a[232:235], v[164:167]
    ds_read_b64_tr_b16 v[60:61], v17 offset:57344
    v_mul_f32 v12, s37, v74
    v_mul_f32 v13, s37, v75
    v_mfma_f32_16x16x32_bf16 v[172:175], v[36:39], a[236:239], v[172:175]
    ds_read_b64_tr_b16 v[62:63], v17 offset:57856
    v_mul_f32 v18, s37, v76
    v_mul_f32 v19, s37, v77
    v_mfma_f32_16x16x32_bf16 v[176:179], v[40:43], a[232:235], v[176:179]
    ds_read_b64_tr_b16 v[32:33], v14 offset:61440
    v_mul_f32 v20, s37, v78
    v_mul_f32 v21, s37, v79
    v_exp_f32 v10, v10 clamp
    v_mfma_f32_16x16x32_bf16 v[184:187], v[40:43], a[236:239], v[184:187]
    ds_read_b64_tr_b16 v[34:35], v14 offset:61952
    global_load_lds_dwordx4 v8, s[8:9] offset:2048
    v_mfma_f32_16x16x32_bf16 v[180:183], v[44:47], a[232:235], v[180:183]
    ds_read_b64_tr_b16 v[36:37], v15 offset:61440
    v_exp_f32 v11, v11 clamp
    v_mfma_f32_16x16x32_bf16 v[188:191], v[44:47], a[236:239], v[188:191]
    ds_read_b64_tr_b16 v[38:39], v15 offset:61952
    s_waitcnt lgkmcnt(4)
    v_mfma_f32_16x16x32_bf16 v[160:163], v[48:51], a[240:243], v[160:163]
    ds_read_b64_tr_b16 v[40:41], v16 offset:61440
    v_exp_f32 v12, v12 clamp
    v_exp_f32 v13, v13 clamp
    v_mfma_f32_16x16x32_bf16 v[168:171], v[48:51], a[244:247], v[168:171]
    ds_read_b64_tr_b16 v[42:43], v16 offset:61952
    global_load_lds_dwordx4 v9, s[8:9] offset:3072
    v_mfma_f32_16x16x32_bf16 v[164:167], v[52:55], a[240:243], v[164:167]
    ds_read_b64_tr_b16 v[44:45], v17 offset:61440
    v_exp_f32 v18, v18 clamp
    v_mfma_f32_16x16x32_bf16 v[172:175], v[52:55], a[244:247], v[172:175]
    ds_read_b64_tr_b16 v[46:47], v17 offset:61952
    v_exp_f32 v19, v19 clamp
    v_mfma_f32_16x16x32_bf16 v[176:179], v[56:59], a[240:243], v[176:179]
    v_exp_f32 v20, v20 clamp
    v_mfma_f32_16x16x32_bf16 v[184:187], v[56:59], a[244:247], v[184:187]
    v_mfma_f32_16x16x32_bf16 v[180:183], v[60:63], a[240:243], v[180:183]
    v_exp_f32 v21, v21 clamp
    v_mfma_f32_16x16x32_bf16 v[188:191], v[60:63], a[244:247], v[188:191]
    v_max_f32 v72, s38, v72
    s_waitcnt lgkmcnt(0)
    v_mfma_f32_16x16x32_bf16 v[160:163], v[32:35], a[248:251], v[160:163]
    v_add_u32 v14, 4294901760, v14
    v_add_u32 v15, 4294901760, v15
    v_add_u32 v16, 4294901760, v16
    v_add_u32 v17, 4294901760, v17
    s_waitcnt vmcnt(10)
    v_cmp_gt_u32 vcc, 1, v157
    s_nop 0
    s_and_b32 s32, vcc_lo, s1
    s_cbranch_scc1 L_poll_1
L_poll_1_ok:
    v_mfma_f32_16x16x32_bf16 v[168:171], v[32:35], a[252:255], v[168:171]
    s_barrier
    s_add_u32 s32, s83, 4096
    buffer_load_dword v22, v25, s[20:23], s32 offen
    v_mov_b32 v48, 0
    v_mov_b32 v49, 0
    v_mov_b32 v50, v26
    v_mov_b32 v51, 0
    v_mov_b32 v52, 0
    v_mov_b32 v53, 0
    v_lshlrev_b32 v54, 16, v26
    v_mov_b32 v55, 0
    v_max_f32 v73, s38, v73
    v_max_f32 v74, s38, v74
    v_max_f32 v75, s38, v75
    v_mfma_f32_16x16x32_bf16 v[164:167], v[36:39], a[248:251], v[164:167]
    v_mov_b32 v56, 0
    v_mov_b32 v57, 0
    v_mov_b32 v58, 0
    v_mov_b32 v59, v26
    v_mov_b32 v60, 0
    v_mov_b32 v61, 0
    v_mfma_f32_16x16x32_bf16 v[172:175], v[36:39], a[252:255], v[172:175]
    v_mov_b32 v62, 0
    v_lshlrev_b32 v63, 16, v26
    v_max_f32 v76, s38, v76
    v_max_f32 v77, s38, v77
    v_max_f32 v78, s38, v78
    v_max_f32 v79, s38, v79
    v_mfma_f32_16x16x32_bf16 v[176:179], v[40:43], a[248:251], v[176:179]
    ds_read_b64_tr_b16 v[32:33], v14 offset:0
    v_add_f32 v10, v10, v72
    v_add_f32 v11, v11, v73
    v_add_f32 v12, v12, v74
    s_add_u32 m0, s39, 98304
    s_add_u32 s34, s3, 12
    s_and_b32 s34, s34, 15
    v_mfma_f32_16x16x32_bf16 v[184:187], v[40:43], a[252:255], v[184:187]
    ds_read_b64_tr_b16 v[34:35], v14 offset:512
    s_mul_i32 s34, s34, 458752
    s_add_u32 s34, s34, 128
    s_add_u32 s8, s44, s34
    s_addc_u32 s9, s45, 0
    global_load_lds_dwordx4 v2, s[8:9] offset:0
    v_mfma_f32_16x16x32_bf16 v[180:183], v[44:47], a[248:251], v[180:183]
    ds_read_b64_tr_b16 v[36:37], v15 offset:0
    v_add_f32 v13, v13, v75
    v_add_f32 v18, v18, v76
    v_mfma_f32_16x16x32_bf16 v[188:191], v[44:47], a[252:255], v[188:191]
    ds_read_b64_tr_b16 v[38:39], v15 offset:512
    v_add_f32 v19, v19, v77
    v_mfma_f32_16x16x32_bf16 v[192:195], v[28:31], v[48:51], 0
    ds_read_b64_tr_b16 v[40:41], v16 offset:0
    v_add_f32 v20, v20, v78
    v_add_f32 v21, v21, v79
    v_mfma_f32_16x16x32_bf16 v[200:203], v[28:31], v[48:51], 0
    ds_read_b64_tr_b16 v[42:43], v16 offset:512
    v_cvt_pk_bf16_f32 v68, v10, v11
    v_mfma_f32_16x16x32_bf16 v[196:199], v[28:31], v[52:55], 0
    ds_read_b64_tr_b16 v[44:45], v17 offset:0
    v_cvt_pk_bf16_f32 v69, v12, v13
    v_cvt_pk_bf16_f32 v70, v18, v19
    v_mfma_f32_16x16x32_bf16 v[204:207], v[28:31], v[52:55], 0
    ds_read_b64_tr_b16 v[46:47], v17 offset:512
    v_cvt_pk_bf16_f32 v71, v20, v21
    v_mfma_f32_16x16x32_bf16 v[208:211], v[28:31], v[56:59], 0
    ds_read_b64_tr_b16 v[48:49], v14 offset:4096
    s_lshr_b32 s46, s30, 3
    s_lshl_b32 s46, s46, 5
    s_and_b32 s32, s30, 7
    s_add_u32 s46, s46, s32
    v_mfma_f32_16x16x32_bf16 v[216:219], v[28:31], v[56:59], 0
    ds_read_b64_tr_b16 v[50:51], v14 offset:4608
    s_lshl_b32 s46, s46, 12
    s_add_u32 s46, s46, s47
    s_add_u32 s4, s98, s46
    s_addc_u32 s5, s99, 0
    v_mfma_f32_16x16x32_bf16 v[212:215], v[28:31], v[60:63], 0
    ds_read_b64_tr_b16 v[52:53], v15 offset:4096
    v_mfma_f32_16x16x32_bf16 v[220:223], v[28:31], v[60:63], 0
    ds_read_b64_tr_b16 v[54:55], v15 offset:4608
    s_waitcnt lgkmcnt(4)
    v_mfma_f32_16x16x32_bf16 v[192:195], v[32:35], a[0:3], v[192:195]
    ds_read_b64_tr_b16 v[56:57], v16 offset:4096
    v_mul_f32 v10, v160, v160
    v_mul_f32 v11, v161, v161
    v_mfma_f32_16x16x32_bf16 v[200:203], v[32:35], a[4:7], v[200:203]
    ds_read_b64_tr_b16 v[58:59], v16 offset:4608
    v_mul_f32 v12, v162, v162
    v_mul_f32 v13, v163, v163
    v_mfma_f32_16x16x32_bf16 v[196:199], v[36:39], a[0:3], v[196:199]
    ds_read_b64_tr_b16 v[60:61], v17 offset:4096
    v_mul_f32 v18, v164, v164
    v_mul_f32 v19, v165, v165
    v_mfma_f32_16x16x32_bf16 v[204:207], v[36:39], a[4:7], v[204:207]
    ds_read_b64_tr_b16 v[62:63], v17 offset:4608
    v_mul_f32 v20, v166, v166
    v_mfma_f32_16x16x32_bf16 v[208:211], v[40:43], a[0:3], v[208:211]
    ds_read_b64_tr_b16 v[32:33], v14 offset:8192
    v_mul_f32 v21, v167, v167
    v_fma_f32 v10, v10, s42, v23
    v_mfma_f32_16x16x32_bf16 v[216:219], v[40:43], a[4:7], v[216:219]
    ds_read_b64_tr_b16 v[34:35], v14 offset:8704
    v_fma_f32 v11, v11, s42, v23
    v_mfma_f32_16x16x32_bf16 v[212:215], v[44:47], a[0:3], v[212:215]
    ds_read_b64_tr_b16 v[36:37], v15 offset:8192
    v_fma_f32 v12, v12, s42, v23
    v_fma_f32 v13, v13, s42, v23
    v_mfma_f32_16x16x32_bf16 v[220:223], v[44:47], a[4:7], v[220:223]
    ds_read_b64_tr_b16 v[38:39], v15 offset:8704
    v_fma_f32 v18, v18, s42, v23
    s_waitcnt lgkmcnt(4)
    v_mfma_f32_16x16x32_bf16 v[192:195], v[48:51], a[8:11], v[192:195]
    ds_read_b64_tr_b16 v[40:41], v16 offset:8192
    v_fma_f32 v19, v19, s42, v23
    v_fma_f32 v20, v20, s42, v23
    v_mfma_f32_16x16x32_bf16 v[200:203], v[48:51], a[12:15], v[200:203]
    ds_read_b64_tr_b16 v[42:43], v16 offset:8704
    v_fma_f32 v21, v21, s42, v23
    v_mfma_f32_16x16x32_bf16 v[196:199], v[52:55], a[8:11], v[196:199]
    ds_read_b64_tr_b16 v[44:45], v17 offset:8192
    v_mul_f32 v10, v160, v10
    v_mul_f32 v11, v161, v11
    v_mfma_f32_16x16x32_bf16 v[204:207], v[52:55], a[12:15], v[204:207]
    ds_read_b64_tr_b16 v[46:47], v17 offset:8704
    v_mul_f32 v12, v162, v12
    v_mfma_f32_16x16x32_bf16 v[208:211], v[56:59], a[8:11], v[208:211]
    ds_read_b64_tr_b16 v[48:49], v14 offset:12288
    v_mul_f32 v13, v163, v13
    v_mul_f32 v18, v164, v18
    v_mul_f32 v19, v165, v19
    v_mfma_f32_16x16x32_bf16 v[216:219], v[56:59], a[12:15], v[216:219]
    ds_read_b64_tr_b16 v[50:51], v14 offset:12800
    global_load_lds_dwordx4 v3, s[8:9] offset:1024
    v_mfma_f32_16x16x32_bf16 v[212:215], v[60:63], a[8:11], v[212:215]
    ds_read_b64_tr_b16 v[52:53], v15 offset:12288
    v_mul_f32 v20, v166, v20
    v_mul_f32 v21, v167, v21
    v_mfma_f32_16x16x32_bf16 v[220:223], v[60:63], a[12:15], v[220:223]
    ds_read_b64_tr_b16 v[54:55], v15 offset:12800
    v_exp_f32 v10, v10
    s_waitcnt lgkmcnt(4)
    v_mfma_f32_16x16x32_bf16 v[192:195], v[32:35], a[16:19], v[192:195]
    ds_read_b64_tr_b16 v[56:57], v16 offset:12288
    v_exp_f32 v11, v11
    v_mfma_f32_16x16x32_bf16 v[200:203], v[32:35], a[20:23], v[200:203]
    ds_read_b64_tr_b16 v[58:59], v16 offset:12800
    v_mfma_f32_16x16x32_bf16 v[196:199], v[36:39], a[16:19], v[196:199]
    ds_read_b64_tr_b16 v[60:61], v17 offset:12288
    v_exp_f32 v12, v12
    v_exp_f32 v13, v13
    v_mfma_f32_16x16x32_bf16 v[204:207], v[36:39], a[20:23], v[204:207]
    ds_read_b64_tr_b16 v[62:63], v17 offset:12800
    global_load_lds_dwordx4 v4, s[8:9] offset:2048
    v_mfma_f32_16x16x32_bf16 v[208:211], v[40:43], a[16:19], v[208:211]
    ds_read_b64_tr_b16 v[32:33], v14 offset:16384
    v_exp_f32 v18, v18
    v_mfma_f32_16x16x32_bf16 v[216:219], v[40:43], a[20:23], v[216:219]
    ds_read_b64_tr_b16 v[34:35], v14 offset:16896
    v_mfma_f32_16x16x32_bf16 v[212:215], v[44:47], a[16:19], v[212:215]
    ds_read_b64_tr_b16 v[36:37], v15 offset:16384
    v_exp_f32 v19, v19
    v_exp_f32 v20, v20
    v_mfma_f32_16x16x32_bf16 v[220:223], v[44:47], a[20:23], v[220:223]
    ds_read_b64_tr_b16 v[38:39], v15 offset:16896
    global_load_lds_dwordx4 v5, s[8:9] offset:3072
    s_add_u32 m0, s39, 102400
    s_waitcnt lgkmcnt(4)
    v_mfma_f32_16x16x32_bf16 v[192:195], v[48:51], a[24:27], v[192:195]
    ds_read_b64_tr_b16 v[40:41], v16 offset:16384
    v_exp_f32 v21, v21
    v_mfma_f32_16x16x32_bf16 v[200:203], v[48:51], a[28:31], v[200:203]
    ds_read_b64_tr_b16 v[42:43], v16 offset:16896
    v_mfma_f32_16x16x32_bf16 v[196:199], v[52:55], a[24:27], v[196:199]
    ds_read_b64_tr_b16 v[44:45], v17 offset:16384
    v_add_f32 v10, 1.0, v10
    v_add_f32 v11, 1.0, v11
    v_mfma_f32_16x16x32_bf16 v[204:207], v[52:55], a[28:31], v[204:207]
    ds_read_b64_tr_b16 v[46:47], v17 offset:16896
    v_add_f32 v12, 1.0, v12
    v_mfma_f32_16x16x32_bf16 v[208:211], v[56:59], a[24:27], v[208:211]
    ds_read_b64_tr_b16 v[48:49], v14 offset:20480
    v_add_f32 v13, 1.0, v13
    v_add_f32 v18, 1.0, v18
    v_mfma_f32_16x16x32_bf16 v[216:219], v[56:59], a[28:31], v[216:219]
    ds_read_b64_tr_b16 v[50:51], v14 offset:20992
    v_add_f32 v19, 1.0, v19
    v_add_f32 v20, 1.0, v20
    v_mfma_f32_16x16x32_bf16 v[212:215], v[60:63], a[24:27], v[212:215]
    ds_read_b64_tr_b16 v[52:53], v15 offset:20480
    v_add_f32 v21, 1.0, v21
    v_mfma_f32_16x16x32_bf16 v[220:223], v[60:63], a[28:31], v[220:223]
    ds_read_b64_tr_b16 v[54:55], v15 offset:20992
    v_rcp_f32 v10, v10
    s_waitcnt lgkmcnt(4)
    v_mfma_f32_16x16x32_bf16 v[192:195], v[32:35], a[32:35], v[192:195]
    ds_read_b64_tr_b16 v[56:57], v16 offset:20480
    v_rcp_f32 v11, v11
    v_rcp_f32 v12, v12
    v_mfma_f32_16x16x32_bf16 v[200:203], v[32:35], a[36:39], v[200:203]
    ds_read_b64_tr_b16 v[58:59], v16 offset:20992
    global_load_lds_dwordx4 v6, s[8:9] offset:0
    v_mfma_f32_16x16x32_bf16 v[196:199], v[36:39], a[32:35], v[196:199]
    ds_read_b64_tr_b16 v[60:61], v17 offset:20480
    v_rcp_f32 v13, v13
    v_mfma_f32_16x16x32_bf16 v[204:207], v[36:39], a[36:39], v[204:207]
    ds_read_b64_tr_b16 v[62:63], v17 offset:20992
    v_mfma_f32_16x16x32_bf16 v[208:211], v[40:43], a[32:35], v[208:211]
    ds_read_b64_tr_b16 v[32:33], v14 offset:24576
    v_rcp_f32 v18, v18
    v_rcp_f32 v19, v19
    v_mfma_f32_16x16x32_bf16 v[216:219], v[40:43], a[36:39], v[216:219]
    ds_read_b64_tr_b16 v[34:35], v14 offset:25088
    global_load_lds_dwordx4 v7, s[8:9] offset:1024
    v_mfma_f32_16x16x32_bf16 v[212:215], v[44:47], a[32:35], v[212:215]
    ds_read_b64_tr_b16 v[36:37], v15 offset:24576
    v_rcp_f32 v20, v20
    v_mfma_f32_16x16x32_bf16 v[220:223], v[44:47], a[36:39], v[220:223]
    ds_read_b64_tr_b16 v[38:39], v15 offset:25088
    s_waitcnt lgkmcnt(4)
    v_mfma_f32_16x16x32_bf16 v[192:195], v[48:51], a[40:43], v[192:195]
    ds_read_b64_tr_b16 v[40:41], v16 offset:24576
    v_rcp_f32 v21, v21
    v_mfma_f32_16x16x32_bf16 v[200:203], v[48:51], a[44:47], v[200:203]
    ds_read_b64_tr_b16 v[42:43], v16 offset:25088
    v_mul_f32 v10, v160, v10
    v_mfma_f32_16x16x32_bf16 v[196:199], v[52:55], a[40:43], v[196:199]
    ds_read_b64_tr_b16 v[44:45], v17 offset:24576
    v_mul_f32 v11, v161, v11
    v_mul_f32 v12, v162, v12
    v_mul_f32 v13, v163, v13
    v_mfma_f32_16x16x32_bf16 v[204:207], v[52:55], a[44:47], v[204:207]
    ds_read_b64_tr_b16 v[46:47], v17 offset:25088
    global_load_lds_dwordx4 v8, s[8:9] offset:2048
    v_mfma_f32_16x16x32_bf16 v[208:211], v[56:59], a[40:43], v[208:211]
    ds_read_b64_tr_b16 v[48:49], v14 offset:28672
    v_mul_f32 v18, v164, v18
    v_mul_f32 v19, v165, v19
    v_mfma_f32_16x16x32_bf16 v[216:219], v[56:59], a[44:47], v[216:219]
    ds_read_b64_tr_b16 v[50:51], v14 offset:29184
    v_mul_f32 v20, v166, v20
    v_mfma_f32_16x16x32_bf16 v[212:215], v[60:63], a[40:43], v[212:215]
    ds_read_b64_tr_b16 v[52:53], v15 offset:28672
    v_mul_f32 v21, v167, v21
    v_cvt_pk_bf16_f32 v160, v10, v11
    v_mfma_f32_16x16x32_bf16 v[220:223], v[60:63], a[44:47], v[220:223]
    ds_read_b64_tr_b16 v[54:55], v15 offset:29184
    v_cvt_pk_bf16_f32 v161, v12, v13
    s_waitcnt lgkmcnt(4)
    v_mfma_f32_16x16x32_bf16 v[192:195], v[32:35], a[48:51], v[192:195]
    ds_read_b64_tr_b16 v[56:57], v16 offset:28672
    v_cvt_pk_bf16_f32 v162, v18, v19
    v_cvt_pk_bf16_f32 v163, v20, v21
    s_add_u32 s6, s4, 0
    s_addc_u32 s7, s5, 0
    v_mfma_f32_16x16x32_bf16 v[200:203], v[32:35], a[52:55], v[200:203]
    ds_read_b64_tr_b16 v[58:59], v16 offset:29184
    global_store_dwordx4 v1, v[160:163], s[6:7] offset:0 sc1
    global_load_lds_dwordx4 v9, s[8:9] offset:3072
    v_mfma_f32_16x16x32_bf16 v[196:199], v[36:39], a[48:51], v[196:199]
    ds_read_b64_tr_b16 v[60:61], v17 offset:28672
    v_mfma_f32_16x16x32_bf16 v[204:207], v[36:39], a[52:55], v[204:207]
    ds_read_b64_tr_b16 v[62:63], v17 offset:29184
    v_mfma_f32_16x16x32_bf16 v[208:211], v[40:43], a[48:51], v[208:211]
    v_mul_f32 v10, v168, v168
    v_mul_f32 v11, v169, v169
    v_mfma_f32_16x16x32_bf16 v[216:219], v[40:43], a[52:55], v[216:219]
    v_mul_f32 v12, v170, v170
    v_mfma_f32_16x16x32_bf16 v[212:215], v[44:47], a[48:51], v[212:215]
    v_mul_f32 v13, v171, v171
    v_mul_f32 v18, v172, v172
    v_mfma_f32_16x16x32_bf16 v[220:223], v[44:47], a[52:55], v[220:223]
    v_mul_f32 v19, v173, v173
    s_waitcnt lgkmcnt(0)
    v_mfma_f32_16x16x32_bf16 v[192:195], v[48:51], a[56:59], v[192:195]
    v_mfma_f32_16x16x32_bf16 v[200:203], v[48:51], a[60:63], v[200:203]
    s_waitcnt vmcnt(17)
    s_barrier
    v_mov_b32 v0, 1
    buffer_store_dword v0, v27, s[12:15], s43 offen sc1
    ds_read_b64_tr_b16 v[32:33], v14 offset:32768
    ds_read_b64_tr_b16 v[34:35], v14 offset:33280
    ds_read_b64_tr_b16 v[36:37], v15 offset:32768
    ds_read_b64_tr_b16 v[38:39], v15 offset:33280
    v_mul_f32 v20, v174, v174
    v_mul_f32 v21, v175, v175
    v_fma_f32 v10, v10, s42, v23
    v_mfma_f32_16x16x32_bf16 v[196:199], v[52:55], a[56:59], v[196:199]
    ds_read_b64_tr_b16 v[40:41], v16 offset:32768
    ds_read_b64_tr_b16 v[42:43], v16 offset:33280
    v_fma_f32 v11, v11, s42, v23
    v_fma_f32 v12, v12, s42, v23
    v_mfma_f32_16x16x32_bf16 v[204:207], v[52:55], a[60:63], v[204:207]
    ds_read_b64_tr_b16 v[44:45], v17 offset:32768
    ds_read_b64_tr_b16 v[46:47], v17 offset:33280
    v_fma_f32 v13, v13, s42, v23
    v_fma_f32 v18, v18, s42, v23
    v_mfma_f32_16x16x32_bf16 v[208:211], v[56:59], a[56:59], v[208:211]
    ds_read_b64_tr_b16 v[48:49], v14 offset:36864
    v_fma_f32 v19, v19, s42, v23
    v_fma_f32 v20, v20, s42, v23
    v_fma_f32 v21, v21, s42, v23
    s_add_u32 m0, s39, 0
    s_add_u32 s34, s3, 0
    s_and_b32 s34, s34, 15
    v_mfma_f32_16x16x32_bf16 v[216:219], v[56:59], a[60:63], v[216:219]
    ds_read_b64_tr_b16 v[50:51], v14 offset:37376
    s_mul_i32 s34, s34, 458752
    s_add_u32 s34, s34, 256
    s_add_u32 s8, s44, s34
    s_addc_u32 s9, s45, 0
    global_load_lds_dwordx4 v2, s[8:9] offset:0
    v_mfma_f32_16x16x32_bf16 v[212:215], v[60:63], a[56:59], v[212:215]
    ds_read_b64_tr_b16 v[52:53], v15 offset:36864
    v_mul_f32 v10, v168, v10
    v_mul_f32 v11, v169, v11
    v_mfma_f32_16x16x32_bf16 v[220:223], v[60:63], a[60:63], v[220:223]
    ds_read_b64_tr_b16 v[54:55], v15 offset:37376
    v_mul_f32 v12, v170, v12
    s_waitcnt lgkmcnt(4)
    v_mfma_f32_16x16x32_bf16 v[192:195], v[32:35], a[64:67], v[192:195]
    ds_read_b64_tr_b16 v[56:57], v16 offset:36864
    v_mul_f32 v13, v171, v13
    v_mul_f32 v18, v172, v18
    v_mfma_f32_16x16x32_bf16 v[200:203], v[32:35], a[68:71], v[200:203]
    ds_read_b64_tr_b16 v[58:59], v16 offset:37376
    v_mul_f32 v19, v173, v19
    v_mfma_f32_16x16x32_bf16 v[196:199], v[36:39], a[64:67], v[196:199]
    ds_read_b64_tr_b16 v[60:61], v17 offset:36864
    v_mul_f32 v20, v174, v20
    v_mul_f32 v21, v175, v21
    v_mfma_f32_16x16x32_bf16 v[204:207], v[36:39], a[68:71], v[204:207]
    ds_read_b64_tr_b16 v[62:63], v17 offset:37376
    v_exp_f32 v10, v10
    v_mfma_f32_16x16x32_bf16 v[208:211], v[40:43], a[64:67], v[208:211]
    ds_read_b64_tr_b16 v[32:33], v14 offset:40960
    v_exp_f32 v11, v11
    v_mfma_f32_16x16x32_bf16 v[216:219], v[40:43], a[68:71], v[216:219]
    ds_read_b64_tr_b16 v[34:35], v14 offset:41472
    v_mfma_f32_16x16x32_bf16 v[212:215], v[44:47], a[64:67], v[212:215]
    ds_read_b64_tr_b16 v[36:37], v15 offset:40960
    v_exp_f32 v12, v12
    v_mfma_f32_16x16x32_bf16 v[220:223], v[44:47], a[68:71], v[220:223]
    ds_read_b64_tr_b16 v[38:39], v15 offset:41472
    v_exp_f32 v13, v13
    s_waitcnt lgkmcnt(4)
    v_mfma_f32_16x16x32_bf16 v[192:195], v[48:51], a[72:75], v[192:195]
    ds_read_b64_tr_b16 v[40:41], v16 offset:40960
    v_exp_f32 v18, v18
    v_mfma_f32_16x16x32_bf16 v[200:203], v[48:51], a[76:79], v[200:203]
    ds_read_b64_tr_b16 v[42:43], v16 offset:41472
    v_mfma_f32_16x16x32_bf16 v[196:199], v[52:55], a[72:75], v[196:199]
    ds_read_b64_tr_b16 v[44:45], v17 offset:40960
    v_exp_f32 v19, v19
    v_mfma_f32_16x16x32_bf16 v[204:207], v[52:55], a[76:79], v[204:207]
    ds_read_b64_tr_b16 v[46:47], v17 offset:41472
    v_exp_f32 v20, v20
    v_mfma_f32_16x16x32_bf16 v[208:211], v[56:59], a[72:75], v[208:211]
    ds_read_b64_tr_b16 v[48:49], v14 offset:45056
    v_exp_f32 v21, v21
    v_mfma_f32_16x16x32_bf16 v[216:219], v[56:59], a[76:79], v[216:219]
    ds_read_b64_tr_b16 v[50:51], v14 offset:45568
    v_mfma_f32_16x16x32_bf16 v[212:215], v[60:63], a[72:75], v[212:215]
    ds_read_b64_tr_b16 v[52:53], v15 offset:45056
    v_add_f32 v10, 1.0, v10
    v_add_f32 v11, 1.0, v11
    v_mfma_f32_16x16x32_bf16 v[220:223], v[60:63], a[76:79], v[220:223]
    ds_read_b64_tr_b16 v[54:55], v15 offset:45568
    v_add_f32 v12, 1.0, v12
    s_waitcnt lgkmcnt(4)
    v_mfma_f32_16x16x32_bf16 v[192:195], v[32:35], a[80:83], v[192:195]
    ds_read_b64_tr_b16 v[56:57], v16 offset:45056
    v_add_f32 v13, 1.0, v13
    v_add_f32 v18, 1.0, v18
    v_add_f32 v19, 1.0, v19
    v_mfma_f32_16x16x32_bf16 v[200:203], v[32:35], a[84:87], v[200:203]
    ds_read_b64_tr_b16 v[58:59], v16 offset:45568
    global_load_lds_dwordx4 v3, s[8:9] offset:1024
    v_mfma_f32_16x16x32_bf16 v[196:199], v[36:39], a[80:83], v[196:199]
    ds_read_b64_tr_b16 v[60:61], v17 offset:45056
    v_add_f32 v20, 1.0, v20
    v_add_f32 v21, 1.0, v21
    v_mfma_f32_16x16x32_bf16 v[204:207], v[36:39], a[84:87], v[204:207]
    ds_read_b64_tr_b16 v[62:63], v17 offset:45568
    v_rcp_f32 v10, v10
    v_mfma_f32_16x16x32_bf16 v[208:211], v[40:43], a[80:83], v[208:211]
    ds_read_b64_tr_b16 v[32:33], v14 offset:49152
    v_rcp_f32 v11, v11
    v_mfma_f32_16x16x32_bf16 v[216:219], v[40:43], a[84:87], v[216:219]
    ds_read_b64_tr_b16 v[34:35], v14 offset:49664
    v_mfma_f32_16x16x32_bf16 v[212:215], v[44:47], a[80:83], v[212:215]
    ds_read_b64_tr_b16 v[36:37], v15 offset:49152
    v_rcp_f32 v12, v12
    v_rcp_f32 v13, v13
    v_mfma_f32_16x16x32_bf16 v[220:223], v[44:47], a[84:87], v[220:223]
    ds_read_b64_tr_b16 v[38:39], v15 offset:49664
    global_load_lds_dwordx4 v4, s[8:9] offset:2048
    s_waitcnt lgkmcnt(4)
    v_mfma_f32_16x16x32_bf16 v[192:195], v[48:51], a[88:91], v[192:195]
    ds_read_b64_tr_b16 v[40:41], v16 offset:49152
    v_rcp_f32 v18, v18
    v_mfma_f32_16x16x32_bf16 v[200:203], v[48:51], a[92:95], v[200:203]
    ds_read_b64_tr_b16 v[42:43], v16 offset:49664
    v_rcp_f32 v19, v19
    v_mfma_f32_16x16x32_bf16 v[196:199], v[52:55], a[88:91], v[196:199]
    ds_read_b64_tr_b16 v[44:45], v17 offset:49152
    v_rcp_f32 v20, v20
    v_mfma_f32_16x16x32_bf16 v[204:207], v[52:55], a[92:95], v[204:207]
    ds_read_b64_tr_b16 v[46:47], v17 offset:49664
    global_load_lds_dwordx4 v5, s[8:9] offset:3072
    s_add_u32 m0, s39, 4096
    v_mfma_f32_16x16x32_bf16 v[208:211], v[56:59], a[88:91], v[208:211]
    ds_read_b64_tr_b16 v[48:49], v14 offset:53248
    v_rcp_f32 v21, v21
    v_mfma_f32_16x16x32_bf16 v[216:219], v[56:59], a[92:95], v[216:219]
    ds_read_b64_tr_b16 v[50:51], v14 offset:53760
    v_mul_f32 v10, v168, v10
    v_mfma_f32_16x16x32_bf16 v[212:215], v[60:63], a[88:91], v[212:215]
    ds_read_b64_tr_b16 v[52:53], v15 offset:53248
    v_mul_f32 v11, v169, v11
    v_mul_f32 v12, v170, v12
    v_mfma_f32_16x16x32_bf16 v[220:223], v[60:63], a[92:95], v[220:223]
    ds_read_b64_tr_b16 v[54:55], v15 offset:53760
    v_mul_f32 v13, v171, v13
    s_waitcnt lgkmcnt(4)
    v_mfma_f32_16x16x32_bf16 v[192:195], v[32:35], a[96:99], v[192:195]
    ds_read_b64_tr_b16 v[56:57], v16 offset:53248
    v_mul_f32 v18, v172, v18
    v_mul_f32 v19, v173, v19
    v_mfma_f32_16x16x32_bf16 v[200:203], v[32:35], a[100:103], v[200:203]
    ds_read_b64_tr_b16 v[58:59], v16 offset:53760
    v_mul_f32 v20, v174, v20
    v_mfma_f32_16x16x32_bf16 v[196:199], v[36:39], a[96:99], v[196:199]
    ds_read_b64_tr_b16 v[60:61], v17 offset:53248
    v_mul_f32 v21, v175, v21
    v_cvt_pk_bf16_f32 v164, v10, v11
    v_cvt_pk_bf16_f32 v165, v12, v13
    v_mfma_f32_16x16x32_bf16 v[204:207], v[36:39], a[100:103], v[204:207]
    ds_read_b64_tr_b16 v[62:63], v17 offset:53760
    global_load_lds_dwordx4 v6, s[8:9] offset:0
    v_mfma_f32_16x16x32_bf16 v[208:211], v[40:43], a[96:99], v[208:211]
    ds_read_b64_tr_b16 v[32:33], v14 offset:57344
    v_cvt_pk_bf16_f32 v166, v18, v19
    v_cvt_pk_bf16_f32 v167, v20, v21
    v_mfma_f32_16x16x32_bf16 v[216:219], v[40:43], a[100:103], v[216:219]
    ds_read_b64_tr_b16 v[34:35], v14 offset:57856
    global_store_dwordx4 v1, v[164:167], s[6:7] offset:1024 sc1
    v_mfma_f32_16x16x32_bf16 v[212:215], v[44:47], a[96:99], v[212:215]
    ds_read_b64_tr_b16 v[36:37], v15 offset:57344
    v_mul_f32 v10, v176, v176
    v_mul_f32 v11, v177, v177
    v_mfma_f32_16x16x32_bf16 v[220:223], v[44:47], a[100:103], v[220:223]
    ds_read_b64_tr_b16 v[38:39], v15 offset:57856
    global_load_lds_dwordx4 v7, s[8:9] offset:1024
    s_waitcnt lgkmcnt(4)
    v_mfma_f32_16x16x32_bf16 v[192:195], v[48:51], a[104:107], v[192:195]
    ds_read_b64_tr_b16 v[40:41], v16 offset:57344
    v_mul_f32 v12, v178, v178
    v_mul_f32 v13, v179, v179
    v_mfma_f32_16x16x32_bf16 v[200:203], v[48:51], a[108:111], v[200:203]
    ds_read_b64_tr_b16 v[42:43], v16 offset:57856
    v_mul_f32 v18, v180, v180
    v_mfma_f32_16x16x32_bf16 v[196:199], v[52:55], a[104:107], v[196:199]
    ds_read_b64_tr_b16 v[44:45], v17 offset:57344
    v_mul_f32 v19, v181, v181
    v_mul_f32 v20, v182, v182
    v_mfma_f32_16x16x32_bf16 v[204:207], v[52:55], a[108:111], v[204:207]
    ds_read_b64_tr_b16 v[46:47], v17 offset:57856
    v_mul_f32 v21, v183, v183
    v_mfma_f32_16x16x32_bf16 v[208:211], v[56:59], a[104:107], v[208:211]
    ds_read_b64_tr_b16 v[48:49], v14 offset:61440
    v_fma_f32 v10, v10, s42, v23
    v_fma_f32 v11, v11, s42, v23
    v_fma_f32 v12, v12, s42, v23
    v_mfma_f32_16x16x32_bf16 v[216:219], v[56:59], a[108:111], v[216:219]
    ds_read_b64_tr_b16 v[50:51], v14 offset:61952
    global_load_lds_dwordx4 v8, s[8:9] offset:2048
    v_mfma_f32_16x16x32_bf16 v[212:215], v[60:63], a[104:107], v[212:215]
    ds_read_b64_tr_b16 v[52:53], v15 offset:61440
    v_fma_f32 v13, v13, s42, v23
    v_fma_f32 v18, v18, s42, v23
    v_mfma_f32_16x16x32_bf16 v[220:223], v[60:63], a[108:111], v[220:223]
    ds_read_b64_tr_b16 v[54:55], v15 offset:61952
    v_fma_f32 v19, v19, s42, v23
    s_waitcnt lgkmcnt(4)
    v_mfma_f32_16x16x32_bf16 v[192:195], v[32:35], a[112:115], v[192:195]
    ds_read_b64_tr_b16 v[56:57], v16 offset:61440
    v_fma_f32 v20, v20, s42, v23
    v_fma_f32 v21, v21, s42, v23
    v_mul_f32 v10, v176, v10
    v_mfma_f32_16x16x32_bf16 v[200:203], v[32:35], a[116:119], v[200:203]
    ds_read_b64_tr_b16 v[58:59], v16 offset:61952
    global_load_lds_dwordx4 v9, s[8:9] offset:3072
    v_mfma_f32_16x16x32_bf16 v[196:199], v[36:39], a[112:115], v[196:199]
    ds_read_b64_tr_b16 v[60:61], v17 offset:61440
    v_mul_f32 v11, v177, v11
    v_mul_f32 v12, v178, v12
    v_mfma_f32_16x16x32_bf16 v[204:207], v[36:39], a[116:119], v[204:207]
    ds_read_b64_tr_b16 v[62:63], v17 offset:61952
    v_mul_f32 v13, v179, v13
    v_mfma_f32_16x16x32_bf16 v[208:211], v[40:43], a[112:115], v[208:211]
    v_mul_f32 v18, v180, v18
    v_mul_f32 v19, v181, v19
    v_mfma_f32_16x16x32_bf16 v[216:219], v[40:43], a[116:119], v[216:219]
    v_mul_f32 v20, v182, v20
    v_mul_f32 v21, v183, v21
    v_mfma_f32_16x16x32_bf16 v[212:215], v[44:47], a[112:115], v[212:215]
    v_exp_f32 v10, v10
    v_mfma_f32_16x16x32_bf16 v[220:223], v[44:47], a[116:119], v[220:223]
    v_exp_f32 v11, v11
    s_waitcnt lgkmcnt(0)
    v_mfma_f32_16x16x32_bf16 v[192:195], v[48:51], a[120:123], v[192:195]
    v_add_u32 v14, 65536, v14
    v_add_u32 v15, 65536, v15
    v_add_u32 v16, 65536, v16
    v_add_u32 v17, 65536, v17
    v_mfma_f32_16x16x32_bf16 v[200:203], v[48:51], a[124:127], v[200:203]
    s_waitcnt vmcnt(20)
    s_barrier
    s_getpc_b64 vcc
L_ct4:
    s_min_u32 s32, s82, L_end-L_ct4
    v_mov_b32 v0, s32
    global_load_dword v22, v0, vcc
    ds_read_b64_tr_b16 v[32:33], v14 offset:0
    ds_read_b64_tr_b16 v[34:35], v14 offset:512
    ds_read_b64_tr_b16 v[36:37], v15 offset:0
    ds_read_b64_tr_b16 v[38:39], v15 offset:512
    v_exp_f32 v12, v12
    v_mfma_f32_16x16x32_bf16 v[196:199], v[52:55], a[120:123], v[196:199]
    ds_read_b64_tr_b16 v[40:41], v16 offset:0
    ds_read_b64_tr_b16 v[42:43], v16 offset:512
    v_exp_f32 v13, v13
    v_mfma_f32_16x16x32_bf16 v[204:207], v[52:55], a[124:127], v[204:207]
    ds_read_b64_tr_b16 v[44:45], v17 offset:0
    ds_read_b64_tr_b16 v[46:47], v17 offset:512
    v_exp_f32 v18, v18
    v_mfma_f32_16x16x32_bf16 v[208:211], v[56:59], a[120:123], v[208:211]
    ds_read_b64_tr_b16 v[48:49], v14 offset:4096
    v_exp_f32 v19, v19
    s_add_u32 m0, s39, 32768
    s_add_u32 s34, s3, 4
    s_and_b32 s34, s34, 15
    s_mul_i32 s34, s34, 458752
    v_mfma_f32_16x16x32_bf16 v[216:219], v[56:59], a[124:127], v[216:219]
    ds_read_b64_tr_b16 v[50:51], v14 offset:4608
    s_add_u32 s34, s34, 256
    s_add_u32 s8, s44, s34
    s_addc_u32 s9, s45, 0
    global_load_lds_dwordx4 v2, s[8:9] offset:0
    v_mfma_f32_16x16x32_bf16 v[212:215], v[60:63], a[120:123], v[212:215]
    ds_read_b64_tr_b16 v[52:53], v15 offset:4096
    v_exp_f32 v20, v20
    v_mfma_f32_16x16x32_bf16 v[220:223], v[60:63], a[124:127], v[220:223]
    ds_read_b64_tr_b16 v[54:55], v15 offset:4608
    v_exp_f32 v21, v21
    s_waitcnt lgkmcnt(4)
    v_mfma_f32_16x16x32_bf16 v[192:195], v[32:35], a[128:131], v[192:195]
    ds_read_b64_tr_b16 v[56:57], v16 offset:4096
    v_add_f32 v10, 1.0, v10
    v_mfma_f32_16x16x32_bf16 v[200:203], v[32:35], a[132:135], v[200:203]
    ds_read_b64_tr_b16 v[58:59], v16 offset:4608
    v_add_f32 v11, 1.0, v11
    v_mfma_f32_16x16x32_bf16 v[196:199], v[36:39], a[128:131], v[196:199]
    ds_read_b64_tr_b16 v[60:61], v17 offset:4096
    v_add_f32 v12, 1.0, v12
    v_add_f32 v13, 1.0, v13
    v_mfma_f32_16x16x32_bf16 v[204:207], v[36:39], a[132:135], v[204:207]
    ds_read_b64_tr_b16 v[62:63], v17 offset:4608
    v_add_f32 v18, 1.0, v18
    v_mfma_f32_16x16x32_bf16 v[208:211], v[40:43], a[128:131], v[208:211]
    ds_read_b64_tr_b16 v[32:33], v14 offset:8192
    v_add_f32 v19, 1.0, v19
    v_add_f32 v20, 1.0, v20
    v_mfma_f32_16x16x32_bf16 v[216:219], v[40:43], a[132:135], v[216:219]
    ds_read_b64_tr_b16 v[34:35], v14 offset:8704
    v_add_f32 v21, 1.0, v21
    v_mfma_f32_16x16x32_bf16 v[212:215], v[44:47], a[128:131], v[212:215]
    ds_read_b64_tr_b16 v[36:37], v15 offset:8192
    v_rcp_f32 v10, v10
    v_mfma_f32_16x16x32_bf16 v[220:223], v[44:47], a[132:135], v[220:223]
    ds_read_b64_tr_b16 v[38:39], v15 offset:8704
    v_rcp_f32 v11, v11
    s_waitcnt lgkmcnt(4)
    v_mfma_f32_16x16x32_bf16 v[192:195], v[48:51], a[136:139], v[192:195]
    ds_read_b64_tr_b16 v[40:41], v16 offset:8192
    v_rcp_f32 v12, v12
    v_mfma_f32_16x16x32_bf16 v[200:203], v[48:51], a[140:143], v[200:203]
    ds_read_b64_tr_b16 v[42:43], v16 offset:8704
    v_mfma_f32_16x16x32_bf16 v[196:199], v[52:55], a[136:139], v[196:199]
    ds_read_b64_tr_b16 v[44:45], v17 offset:8192
    v_and_b32 v26, 0x300, v1
    v_cmp_eq_u32 vcc, 0x100, v26
    v_mov_b32 v26, 0x3f80
    s_nop 0
    v_cndmask_b32 v26, 0, v26, vcc
    v_mfma_f32_16x16x32_bf16 v[204:207], v[52:55], a[140:143], v[204:207]
    ds_read_b64_tr_b16 v[46:47], v17 offset:8704
    v_rcp_f32 v13, v13
    v_rcp_f32 v18, v18
    v_mfma_f32_16x16x32_bf16 v[208:211], v[56:59], a[136:139], v[208:211]
    ds_read_b64_tr_b16 v[48:49], v14 offset:12288
    v_rcp_f32 v19, v19
    v_mfma_f32_16x16x32_bf16 v[216:219], v[56:59], a[140:143], v[216:219]
    ds_read_b64_tr_b16 v[50:51], v14 offset:12800
    v_mfma_f32_16x16x32_bf16 v[212:215], v[60:63], a[136:139], v[212:215]
    ds_read_b64_tr_b16 v[52:53], v15 offset:12288
    v_rcp_f32 v20, v20
    v_mfma_f32_16x16x32_bf16 v[220:223], v[60:63], a[140:143], v[220:223]
    ds_read_b64_tr_b16 v[54:55], v15 offset:12800
    v_rcp_f32 v21, v21
    s_waitcnt lgkmcnt(4)
    v_mfma_f32_16x16x32_bf16 v[192:195], v[32:35], a[144:147], v[192:195]
    ds_read_b64_tr_b16 v[56:57], v16 offset:12288
    v_mul_f32 v10, v176, v10
    v_mul_f32 v11, v177, v11
    v_mul_f32 v12, v178, v12
    v_mfma_f32_16x16x32_bf16 v[200:203], v[32:35], a[148:151], v[200:203]
    ds_read_b64_tr_b16 v[58:59], v16 offset:12800
    global_load_lds_dwordx4 v3, s[8:9] offset:1024
    v_mfma_f32_16x16x32_bf16 v[196:199], v[36:39], a[144:147], v[196:199]
    ds_read_b64_tr_b16 v[60:61], v17 offset:12288
    v_mul_f32 v13, v179, v13
    v_mul_f32 v18, v180, v18
    v_mfma_f32_16x16x32_bf16 v[204:207], v[36:39], a[148:151], v[204:207]
    ds_read_b64_tr_b16 v[62:63], v17 offset:12800
    v_mul_f32 v19, v181, v19
    v_mfma_f32_16x16x32_bf16 v[208:211], v[40:43], a[144:147], v[208:211]
    ds_read_b64_tr_b16 v[32:33], v14 offset:16384
    v_mul_f32 v20, v182, v20
    v_mul_f32 v21, v183, v21
    v_mfma_f32_16x16x32_bf16 v[216:219], v[40:43], a[148:151], v[216:219]
    ds_read_b64_tr_b16 v[34:35], v14 offset:16896
    v_cvt_pk_bf16_f32 v176, v10, v11
    v_mfma_f32_16x16x32_bf16 v[212:215], v[44:47], a[144:147], v[212:215]
    ds_read_b64_tr_b16 v[36:37], v15 offset:16384
    v_cvt_pk_bf16_f32 v177, v12, v13
    v_cvt_pk_bf16_f32 v178, v18, v19
    v_cvt_pk_bf16_f32 v179, v20, v21
    v_mfma_f32_16x16x32_bf16 v[220:223], v[44:47], a[148:151], v[220:223]
    ds_read_b64_tr_b16 v[38:39], v15 offset:16896
    global_load_lds_dwordx4 v4, s[8:9] offset:2048
    s_waitcnt lgkmcnt(4)
    v_mfma_f32_16x16x32_bf16 v[192:195], v[48:51], a[152:155], v[192:195]
    ds_read_b64_tr_b16 v[40:41], v16 offset:16384
    global_store_dwordx4 v1, v[176:179], s[6:7] offset:2048 sc1
    v_mfma_f32_16x16x32_bf16 v[200:203], v[48:51], a[156:159], v[200:203]
    ds_read_b64_tr_b16 v[42:43], v16 offset:16896
    v_mul_f32 v10, v184, v184
    v_mfma_f32_16x16x32_bf16 v[196:199], v[52:55], a[152:155], v[196:199]
    ds_read_b64_tr_b16 v[44:45], v17 offset:16384
    v_mul_f32 v11, v185, v185
    v_mul_f32 v12, v186, v186
    v_mul_f32 v13, v187, v187
    v_mfma_f32_16x16x32_bf16 v[204:207], v[52:55], a[156:159], v[204:207]
    ds_read_b64_tr_b16 v[46:47], v17 offset:16896
    global_load_lds_dwordx4 v5, s[8:9] offset:3072
    s_add_u32 m0, s39, 36864
    v_mfma_f32_16x16x32_bf16 v[208:211], v[56:59], a[152:155], v[208:211]
    ds_read_b64_tr_b16 v[48:49], v14 offset:20480
    v_mul_f32 v18, v188, v188
    v_mul_f32 v19, v189, v189
    v_mfma_f32_16x16x32_bf16 v[216:219], v[56:59], a[156:159], v[216:219]
    ds_read_b64_tr_b16 v[50:51], v14 offset:20992
    v_mul_f32 v20, v190, v190
    v_mfma_f32_16x16x32_bf16 v[212:215], v[60:63], a[152:155], v[212:215]
    ds_read_b64_tr_b16 v[52:53], v15 offset:20480
    v_mul_f32 v21, v191, v191
    v_fma_f32 v10, v10, s42, v23
    v_mfma_f32_16x16x32_bf16 v[220:223], v[60:63], a[156:159], v[220:223]
    ds_read_b64_tr_b16 v[54:55], v15 offset:20992
    v_fma_f32 v11, v11, s42, v23
    s_waitcnt lgkmcnt(4)
    v_mfma_f32_16x16x32_bf16 v[192:195], v[32:35], a[160:163], v[192:195]
    ds_read_b64_tr_b16 v[56:57], v16 offset:20480
    v_fma_f32 v12, v12, s42, v23
    v_fma_f32 v13, v13, s42, v23
    v_mfma_f32_16x16x32_bf16 v[200:203], v[32:35], a[164:167], v[200:203]
    ds_read_b64_tr_b16 v[58:59], v16 offset:20992
    v_fma_f32 v18, v18, s42, v23
    v_mfma_f32_16x16x32_bf16 v[196:199], v[36:39], a[160:163], v[196:199]
    ds_read_b64_tr_b16 v[60:61], v17 offset:20480
    v_fma_f32 v19, v19, s42, v23
    v_fma_f32 v20, v20, s42, v23
    v_fma_f32 v21, v21, s42, v23
    v_mfma_f32_16x16x32_bf16 v[204:207], v[36:39], a[164:167], v[204:207]
    ds_read_b64_tr_b16 v[62:63], v17 offset:20992
    global_load_lds_dwordx4 v6, s[8:9] offset:0
    v_mfma_f32_16x16x32_bf16 v[208:211], v[40:43], a[160:163], v[208:211]
    ds_read_b64_tr_b16 v[32:33], v14 offset:24576
    v_mul_f32 v10, v184, v10
    v_mul_f32 v11, v185, v11
    v_mfma_f32_16x16x32_bf16 v[216:219], v[40:43], a[164:167], v[216:219]
    ds_read_b64_tr_b16 v[34:35], v14 offset:25088
    v_mul_f32 v12, v186, v12
    v_mfma_f32_16x16x32_bf16 v[212:215], v[44:47], a[160:163], v[212:215]
    ds_read_b64_tr_b16 v[36:37], v15 offset:24576
    v_mul_f32 v13, v187, v13
    v_mul_f32 v18, v188, v18
    v_mul_f32 v19, v189, v19
    v_mfma_f32_16x16x32_bf16 v[220:223], v[44:47], a[164:167], v[220:223]
    ds_read_b64_tr_b16 v[38:39], v15 offset:25088
    global_load_lds_dwordx4 v7, s[8:9] offset:1024
    s_waitcnt lgkmcnt(4)
    v_mfma_f32_16x16x32_bf16 v[192:195], v[48:51], a[168:171], v[192:195]
    ds_read_b64_tr_b16 v[40:41], v16 offset:24576
    v_mul_f32 v20, v190, v20
    v_mul_f32 v21, v191, v21
    v_mfma_f32_16x16x32_bf16 v[200:203], v[48:51], a[172:175], v[200:203]
    ds_read_b64_tr_b16 v[42:43], v16 offset:25088
    v_exp_f32 v10, v10
    v_mfma_f32_16x16x32_bf16 v[196:199], v[52:55], a[168:171], v[196:199]
    ds_read_b64_tr_b16 v[44:45], v17 offset:24576
    v_exp_f32 v11, v11
    v_and_b32 v158, 0xf0, v1
    v_lshlrev_b32 v158, 3, v158
    v_bfe_u32 v159, v1, 8, 1
    v_mfma_f32_16x16x32_bf16 v[204:207], v[52:55], a[172:175], v[204:207]
    ds_read_b64_tr_b16 v[46:47], v17 offset:25088
    v_mul_u32_u24 v159, 4, v159
    v_xor_b32 v159, s30, v159
    v_lshl_add_u32 v158, v159, 11, v158
    s_mov_b32 s35, 20217856
    v_mfma_f32_16x16x32_bf16 v[208:211], v[56:59], a[168:171], v[208:211]
    ds_read_b64_tr_b16 v[48:49], v14 offset:28672
    v_exp_f32 v12, v12
    v_exp_f32 v13, v13
    s_and_b32 s32, s1, 512
    v_cmp_gt_u32 vcc, s32, v1
    v_mfma_f32_16x16x32_bf16 v[216:219], v[56:59], a[172:175], v[216:219]
    ds_read_b64_tr_b16 v[50:51], v14 offset:29184
    v_mov_b32 v159, 2147483648
    s_nop 0
    v_cndmask_b32 v158, v159, v158, vcc
    global_load_lds_dwordx4 v8, s[8:9] offset:2048
    v_mfma_f32_16x16x32_bf16 v[212:215], v[60:63], a[168:171], v[212:215]
    ds_read_b64_tr_b16 v[52:53], v15 offset:28672
    v_exp_f32 v18, v18
    v_mfma_f32_16x16x32_bf16 v[220:223], v[60:63], a[172:175], v[220:223]
    ds_read_b64_tr_b16 v[54:55], v15 offset:29184
    v_exp_f32 v19, v19
    s_waitcnt lgkmcnt(4)
    v_mfma_f32_16x16x32_bf16 v[192:195], v[32:35], a[176:179], v[192:195]
    ds_read_b64_tr_b16 v[56:57], v16 offset:28672
    v_exp_f32 v20, v20
    v_mfma_f32_16x16x32_bf16 v[200:203], v[32:35], a[180:183], v[200:203]
    ds_read_b64_tr_b16 v[58:59], v16 offset:29184
    global_load_lds_dwordx4 v9, s[8:9] offset:3072
    v_mfma_f32_16x16x32_bf16 v[196:199], v[36:39], a[176:179], v[196:199]
    ds_read_b64_tr_b16 v[60:61], v17 offset:28672
    v_exp_f32 v21, v21
    v_mfma_f32_16x16x32_bf16 v[204:207], v[36:39], a[180:183], v[204:207]
    ds_read_b64_tr_b16 v[62:63], v17 offset:29184
    v_add_f32 v10, 1.0, v10
    v_mfma_f32_16x16x32_bf16 v[208:211], v[40:43], a[176:179], v[208:211]
    v_add_f32 v11, 1.0, v11
    v_add_f32 v12, 1.0, v12
    v_mfma_f32_16x16x32_bf16 v[216:219], v[40:43], a[180:183], v[216:219]
    v_add_f32 v13, 1.0, v13
    v_mfma_f32_16x16x32_bf16 v[212:215], v[44:47], a[176:179], v[212:215]
    v_add_f32 v18, 1.0, v18
    v_add_f32 v19, 1.0, v19
    v_mfma_f32_16x16x32_bf16 v[220:223], v[44:47], a[180:183], v[220:223]
    v_add_f32 v20, 1.0, v20
    s_waitcnt lgkmcnt(0)
    v_mfma_f32_16x16x32_bf16 v[192:195], v[48:51], a[184:187], v[192:195]
    v_mfma_f32_16x16x32_bf16 v[200:203], v[48:51], a[188:191], v[200:203]
    s_waitcnt vmcnt(20)
    s_barrier
    s_add_u32 s32, s83, 5120
    buffer_load_dword v22, v25, s[20:23], s32 offen
    buffer_load_dword v159, v158, s[12:15], s35 offen sc1
    ds_read_b64_tr_b16 v[32:33], v14 offset:32768
    ds_read_b64_tr_b16 v[34:35], v14 offset:33280
    ds_read_b64_tr_b16 v[36:37], v15 offset:32768
    ds_read_b64_tr_b16 v[38:39], v15 offset:33280
    v_add_f32 v21, 1.0, v21
    v_rcp_f32 v10, v10
    v_mfma_f32_16x16x32_bf16 v[196:199], v[52:55], a[184:187], v[196:199]
    ds_read_b64_tr_b16 v[40:41], v16 offset:32768
    ds_read_b64_tr_b16 v[42:43], v16 offset:33280
    v_rcp_f32 v11, v11
    v_mfma_f32_16x16x32_bf16 v[204:207], v[52:55], a[188:191], v[204:207]
    ds_read_b64_tr_b16 v[44:45], v17 offset:32768
    ds_read_b64_tr_b16 v[46:47], v17 offset:33280
    v_rcp_f32 v12, v12
    v_mfma_f32_16x16x32_bf16 v[208:211], v[56:59], a[184:187], v[208:211]
    ds_read_b64_tr_b16 v[48:49], v14 offset:36864
    v_rcp_f32 v13, v13
    s_add_u32 m0, s39, 65536
    s_add_u32 s34, s3, 8
    s_and_b32 s34, s34, 15
    s_mul_i32 s34, s34, 458752
    v_mfma_f32_16x16x32_bf16 v[216:219], v[56:59], a[188:191], v[216:219]
    ds_read_b64_tr_b16 v[50:51], v14 offset:37376
    s_add_u32 s34, s34, 256
    s_add_u32 s8, s44, s34
    s_addc_u32 s9, s45, 0
    global_load_lds_dwordx4 v2, s[8:9] offset:0
    v_mfma_f32_16x16x32_bf16 v[212:215], v[60:63], a[184:187], v[212:215]
    ds_read_b64_tr_b16 v[52:53], v15 offset:36864
    v_rcp_f32 v18, v18
    v_mfma_f32_16x16x32_bf16 v[220:223], v[60:63], a[188:191], v[220:223]
    ds_read_b64_tr_b16 v[54:55], v15 offset:37376
    v_rcp_f32 v19, v19
    s_waitcnt lgkmcnt(4)
    v_mfma_f32_16x16x32_bf16 v[192:195], v[32:35], a[192:195], v[192:195]
    ds_read_b64_tr_b16 v[56:57], v16 offset:36864
    v_rcp_f32 v20, v20
    v_mfma_f32_16x16x32_bf16 v[200:203], v[32:35], a[196:199], v[200:203]
    ds_read_b64_tr_b16 v[58:59], v16 offset:37376
    v_mfma_f32_16x16x32_bf16 v[196:199], v[36:39], a[192:195], v[196:199]
    ds_read_b64_tr_b16 v[60:61], v17 offset:36864
    v_rcp_f32 v21, v21
    v_mfma_f32_16x16x32_bf16 v[204:207], v[36:39], a[196:199], v[204:207]
    ds_read_b64_tr_b16 v[62:63], v17 offset:37376
    v_mul_f32 v10, v184, v10
    v_mfma_f32_16x16x32_bf16 v[208:211], v[40:43], a[192:195], v[208:211]
    ds_read_b64_tr_b16 v[32:33], v14 offset:40960
    v_mul_f32 v11, v185, v11
    v_mul_f32 v12, v186, v12
    v_mfma_f32_16x16x32_bf16 v[216:219], v[40:43], a[196:199], v[216:219]
    ds_read_b64_tr_b16 v[34:35], v14 offset:41472
    v_mul_f32 v13, v187, v13
    v_mfma_f32_16x16x32_bf16 v[212:215], v[44:47], a[192:195], v[212:215]
    ds_read_b64_tr_b16 v[36:37], v15 offset:40960
    v_mul_f32 v18, v188, v18
    v_mul_f32 v19, v189, v19
    v_mfma_f32_16x16x32_bf16 v[220:223], v[44:47], a[196:199], v[220:223]
    ds_read_b64_tr_b16 v[38:39], v15 offset:41472
    v_mul_f32 v20, v190, v20
    s_waitcnt lgkmcnt(4)
    v_mfma_f32_16x16x32_bf16 v[192:195], v[48:51], a[200:203], v[192:195]
    ds_read_b64_tr_b16 v[40:41], v16 offset:40960
    v_mul_f32 v21, v191, v21
    v_cvt_pk_bf16_f32 v180, v10, v11
    v_mfma_f32_16x16x32_bf16 v[200:203], v[48:51], a[204:207], v[200:203]
    ds_read_b64_tr_b16 v[42:43], v16 offset:41472
    v_cvt_pk_bf16_f32 v181, v12, v13
    v_mfma_f32_16x16x32_bf16 v[196:199], v[52:55], a[200:203], v[196:199]
    ds_read_b64_tr_b16 v[44:45], v17 offset:40960
    v_cvt_pk_bf16_f32 v182, v18, v19
    v_cvt_pk_bf16_f32 v183, v20, v21
    v_mfma_f32_16x16x32_bf16 v[204:207], v[52:55], a[204:207], v[204:207]
    ds_read_b64_tr_b16 v[46:47], v17 offset:41472
    global_store_dwordx4 v1, v[180:183], s[6:7] offset:3072 sc1
    v_mfma_f32_16x16x32_bf16 v[208:211], v[56:59], a[200:203], v[208:211]
    ds_read_b64_tr_b16 v[48:49], v14 offset:45056
    v_mul_f32 v10, s37, v80
    v_mul_f32 v11, s37, v81
    v_mfma_f32_16x16x32_bf16 v[216:219], v[56:59], a[204:207], v[216:219]
    ds_read_b64_tr_b16 v[50:51], v14 offset:45568
    v_mul_f32 v12, s37, v82
    v_mfma_f32_16x16x32_bf16 v[212:215], v[60:63], a[200:203], v[212:215]
    ds_read_b64_tr_b16 v[52:53], v15 offset:45056
    v_mul_f32 v13, s37, v83
    v_mul_f32 v18, s37, v84
    v_mfma_f32_16x16x32_bf16 v[220:223], v[60:63], a[204:207], v[220:223]
    ds_read_b64_tr_b16 v[54:55], v15 offset:45568
    v_mul_f32 v19, s37, v85
    s_waitcnt lgkmcnt(4)
    v_mfma_f32_16x16x32_bf16 v[192:195], v[32:35], a[208:211], v[192:195]
    ds_read_b64_tr_b16 v[56:57], v16 offset:45056
    v_mul_f32 v20, s37, v86
    v_mul_f32 v21, s37, v87
    v_exp_f32 v10, v10 clamp
    v_mfma_f32_16x16x32_bf16 v[200:203], v[32:35], a[212:215], v[200:203]
    ds_read_b64_tr_b16 v[58:59], v16 offset:45568
    global_load_lds_dwordx4 v3, s[8:9] offset:1024
    v_mfma_f32_16x16x32_bf16 v[196:199], v[36:39], a[208:211], v[196:199]
    ds_read_b64_tr_b16 v[60:61], v17 offset:45056
    v_exp_f32 v11, v11 clamp
    v_mfma_f32_16x16x32_bf16 v[204:207], v[36:39], a[212:215], v[204:207]
    ds_read_b64_tr_b16 v[62:63], v17 offset:45568
    v_mfma_f32_16x16x32_bf16 v[208:211], v[40:43], a[208:211], v[208:211]
    ds_read_b64_tr_b16 v[32:33], v14 offset:49152
    v_exp_f32 v12, v12 clamp
    v_mfma_f32_16x16x32_bf16 v[216:219], v[40:43], a[212:215], v[216:219]
    ds_read_b64_tr_b16 v[34:35], v14 offset:49664
    v_exp_f32 v13, v13 clamp
    v_mfma_f32_16x16x32_bf16 v[212:215], v[44:47], a[208:211], v[212:215]
    ds_read_b64_tr_b16 v[36:37], v15 offset:49152
    v_exp_f32 v18, v18 clamp
    v_mfma_f32_16x16x32_bf16 v[220:223], v[44:47], a[212:215], v[220:223]
    ds_read_b64_tr_b16 v[38:39], v15 offset:49664
    global_load_lds_dwordx4 v4, s[8:9] offset:2048
    s_waitcnt lgkmcnt(4)
    v_mfma_f32_16x16x32_bf16 v[192:195], v[48:51], a[216:219], v[192:195]
    ds_read_b64_tr_b16 v[40:41], v16 offset:49152
    v_exp_f32 v19, v19 clamp
    v_mfma_f32_16x16x32_bf16 v[200:203], v[48:51], a[220:223], v[200:203]
    ds_read_b64_tr_b16 v[42:43], v16 offset:49664
    v_exp_f32 v20, v20 clamp
    v_mfma_f32_16x16x32_bf16 v[196:199], v[52:55], a[216:219], v[196:199]
    ds_read_b64_tr_b16 v[44:45], v17 offset:49152
    v_exp_f32 v21, v21 clamp
    v_mfma_f32_16x16x32_bf16 v[204:207], v[52:55], a[220:223], v[204:207]
    ds_read_b64_tr_b16 v[46:47], v17 offset:49664
    global_load_lds_dwordx4 v5, s[8:9] offset:3072
    s_add_u32 m0, s39, 69632
    v_mfma_f32_16x16x32_bf16 v[208:211], v[56:59], a[216:219], v[208:211]
    ds_read_b64_tr_b16 v[48:49], v14 offset:53248
    v_max_f32 v80, s38, v80
    v_max_f32 v81, s38, v81
    v_mfma_f32_16x16x32_bf16 v[216:219], v[56:59], a[220:223], v[216:219]
    ds_read_b64_tr_b16 v[50:51], v14 offset:53760
    v_max_f32 v82, s38, v82
    v_mfma_f32_16x16x32_bf16 v[212:215], v[60:63], a[216:219], v[212:215]
    ds_read_b64_tr_b16 v[52:53], v15 offset:53248
    v_max_f32 v83, s38, v83
    v_max_f32 v84, s38, v84
    v_mfma_f32_16x16x32_bf16 v[220:223], v[60:63], a[220:223], v[220:223]
    ds_read_b64_tr_b16 v[54:55], v15 offset:53760
    v_max_f32 v85, s38, v85
    s_waitcnt lgkmcnt(4)
    v_mfma_f32_16x16x32_bf16 v[192:195], v[32:35], a[224:227], v[192:195]
    ds_read_b64_tr_b16 v[56:57], v16 offset:53248
    v_max_f32 v86, s38, v86
    v_max_f32 v87, s38, v87
    v_mfma_f32_16x16x32_bf16 v[200:203], v[32:35], a[228:231], v[200:203]
    ds_read_b64_tr_b16 v[58:59], v16 offset:53760
    v_add_f32 v10, v10, v80
    v_mfma_f32_16x16x32_bf16 v[196:199], v[36:39], a[224:227], v[196:199]
    ds_read_b64_tr_b16 v[60:61], v17 offset:53248
    v_add_f32 v11, v11, v81
    v_add_f32 v12, v12, v82
    v_add_f32 v13, v13, v83
    v_mfma_f32_16x16x32_bf16 v[204:207], v[36:39], a[228:231], v[204:207]
    ds_read_b64_tr_b16 v[62:63], v17 offset:53760
    global_load_lds_dwordx4 v6, s[8:9] offset:0
    v_mfma_f32_16x16x32_bf16 v[208:211], v[40:43], a[224:227], v[208:211]
    ds_read_b64_tr_b16 v[32:33], v14 offset:57344
    v_add_f32 v18, v18, v84
    v_add_f32 v19, v19, v85
    v_mfma_f32_16x16x32_bf16 v[216:219], v[40:43], a[228:231], v[216:219]
    ds_read_b64_tr_b16 v[34:35], v14 offset:57856
    v_add_f32 v20, v20, v86
    v_mfma_f32_16x16x32_bf16 v[212:215], v[44:47], a[224:227], v[212:215]
    ds_read_b64_tr_b16 v[36:37], v15 offset:57344
    v_add_f32 v21, v21, v87
    v_cvt_pk_bf16_f32 v80, v10, v11
    v_cvt_pk_bf16_f32 v81, v12, v13
    v_mfma_f32_16x16x32_bf16 v[220:223], v[44:47], a[228:231], v[220:223]
    ds_read_b64_tr_b16 v[38:39], v15 offset:57856
    global_load_lds_dwordx4 v7, s[8:9] offset:1024
    s_waitcnt lgkmcnt(4)
    v_mfma_f32_16x16x32_bf16 v[192:195], v[48:51], a[232:235], v[192:195]
    ds_read_b64_tr_b16 v[40:41], v16 offset:57344
    v_cvt_pk_bf16_f32 v82, v18, v19
    v_cvt_pk_bf16_f32 v83, v20, v21
    v_mfma_f32_16x16x32_bf16 v[200:203], v[48:51], a[236:239], v[200:203]
    ds_read_b64_tr_b16 v[42:43], v16 offset:57856
    v_mul_f32 v10, s37, v88
    v_mul_f32 v11, s37, v89
    v_mfma_f32_16x16x32_bf16 v[196:199], v[52:55], a[232:235], v[196:199]
    ds_read_b64_tr_b16 v[44:45], v17 offset:57344
    v_mul_f32 v12, s37, v90
    v_mul_f32 v13, s37, v91
    v_mfma_f32_16x16x32_bf16 v[204:207], v[52:55], a[236:239], v[204:207]
    ds_read_b64_tr_b16 v[46:47], v17 offset:57856
    v_mul_f32 v18, s37, v92
    v_mfma_f32_16x16x32_bf16 v[208:211], v[56:59], a[232:235], v[208:211]
    ds_read_b64_tr_b16 v[48:49], v14 offset:61440
    v_mul_f32 v19, s37, v93
    v_mul_f32 v20, s37, v94
    v_mul_f32 v21, s37, v95
    v_mfma_f32_16x16x32_bf16 v[216:219], v[56:59], a[236:239], v[216:219]
    ds_read_b64_tr_b16 v[50:51], v14 offset:61952
    global_load_lds_dwordx4 v8, s[8:9] offset:2048
    v_mfma_f32_16x16x32_bf16 v[212:215], v[60:63], a[232:235], v[212:215]
    ds_read_b64_tr_b16 v[52:53], v15 offset:61440
    v_exp_f32 v10, v10 clamp
    v_mfma_f32_16x16x32_bf16 v[220:223], v[60:63], a[236:239], v[220:223]
    ds_read_b64_tr_b16 v[54:55], v15 offset:61952
    v_exp_f32 v11, v11 clamp
    s_waitcnt lgkmcnt(4)
    v_mfma_f32_16x16x32_bf16 v[192:195], v[32:35], a[240:243], v[192:195]
    ds_read_b64_tr_b16 v[56:57], v16 offset:61440
    v_exp_f32 v12, v12 clamp
    v_mfma_f32_16x16x32_bf16 v[200:203], v[32:35], a[244:247], v[200:203]
    ds_read_b64_tr_b16 v[58:59], v16 offset:61952
    global_load_lds_dwordx4 v9, s[8:9] offset:3072
    v_mfma_f32_16x16x32_bf16 v[196:199], v[36:39], a[240:243], v[196:199]
    ds_read_b64_tr_b16 v[60:61], v17 offset:61440
    v_exp_f32 v13, v13 clamp
    v_mfma_f32_16x16x32_bf16 v[204:207], v[36:39], a[244:247], v[204:207]
    ds_read_b64_tr_b16 v[62:63], v17 offset:61952
    v_exp_f32 v18, v18 clamp
    v_mfma_f32_16x16x32_bf16 v[208:211], v[40:43], a[240:243], v[208:211]
    v_exp_f32 v19, v19 clamp
    v_mfma_f32_16x16x32_bf16 v[216:219], v[40:43], a[244:247], v[216:219]
    v_mfma_f32_16x16x32_bf16 v[212:215], v[44:47], a[240:243], v[212:215]
    v_exp_f32 v20, v20 clamp
    v_mfma_f32_16x16x32_bf16 v[220:223], v[44:47], a[244:247], v[220:223]
    v_exp_f32 v21, v21 clamp
    s_waitcnt lgkmcnt(0)
    v_mfma_f32_16x16x32_bf16 v[192:195], v[48:51], a[248:251], v[192:195]
    v_add_u32 v14, 4294901760, v14
    v_add_u32 v15, 4294901760, v15
    v_add_u32 v16, 4294901760, v16
    v_add_u32 v17, 4294901760, v17
    s_waitcnt vmcnt(9)
    v_cmp_gt_u32 vcc, 1, v159
    s_nop 0
    s_and_b32 s32, vcc_lo, s1
    s_cbranch_scc1 L_poll_2
L_poll_2_ok:
    v_mfma_f32_16x16x32_bf16 v[200:203], v[48:51], a[252:255], v[200:203]
    s_barrier
    s_mov_b32 s20, s80
    s_mov_b32 s21, s81
    s_mov_b32 s22, 2097152
    s_lshl_b32 s32, s2, 2
    s_add_u32 s32, s32, s28
    s_lshl_b32 s32, s32, 11
    buffer_load_dword v22, v25, s[20:23], s32 offen
    v_mov_b32 v32, v26
    v_mov_b32 v33, 0
    v_mov_b32 v34, 0
    v_mov_b32 v35, 0
    v_lshlrev_b32 v36, 16, v26
    v_mov_b32 v37, 0
    v_mov_b32 v38, 0
    v_mov_b32 v39, 0
    v_max_f32 v88, s38, v88
    v_max_f32 v89, s38, v89
    v_and_b32 v112, 512, v1
    v_add_u32 v112, v112, v1
    s_lshl_b32 s36, s30, 3
    s_lshr_b32 s32, s29, 1
    s_add_u32 s36, s36, s32
    s_lshl_b32 s36, s36, 2
    v_mfma_f32_16x16x32_bf16 v[196:199], v[52:55], a[248:251], v[196:199]
    v_mov_b32 v40, 0
    v_mov_b32 v41, v26
    v_mov_b32 v42, 0
    v_mov_b32 v43, 0
    v_mov_b32 v44, 0
    v_lshlrev_b32 v45, 16, v26
    v_mov_b32 v46, 0
    v_mov_b32 v47, 0
    v_max_f32 v90, s38, v90
    v_mfma_f32_16x16x32_bf16 v[204:207], v[52:55], a[252:255], v[204:207]
    v_max_f32 v91, s38, v91
    v_max_f32 v92, s38, v92
    s_add_u32 s36, s36, s28
    s_lshl_b32 s36, s36, 3
    s_and_b32 s32, s29, 1
    s_add_u32 s36, s36, s32
    s_lshl_b32 s36, s36, 9
    s_add_u32 s36, s36, 20971520
    v_mfma_f32_16x16x32_bf16 v[208:211], v[56:59], a[248:251], v[208:211]
    ds_read_b64_tr_b16 v[48:49], v14 offset:0
    v_max_f32 v93, s38, v93
    v_max_f32 v94, s38, v94
    v_max_f32 v95, s38, v95
    buffer_load_dwordx4 v[96:99], v112, s[12:15], s36 offen offset:0 sc1
    v_mfma_f32_16x16x32_bf16 v[216:219], v[56:59], a[252:255], v[216:219]
    ds_read_b64_tr_b16 v[50:51], v14 offset:512
    buffer_load_dwordx4 v[100:103], v112, s[12:15], s36 offen offset:2048 sc1
    v_lshlrev_b32 v238, 2, v1
    v_and_b32 v238, 0xf00, v238
    v_and_b32 v239, 48, v1
    v_add_u32 v238, v238, v239
    v_mfma_f32_16x16x32_bf16 v[212:215], v[60:63], a[248:251], v[212:215]
    ds_read_b64_tr_b16 v[52:53], v15 offset:0
    v_add_f32 v10, v10, v88
    v_add_f32 v11, v11, v89
    v_add_f32 v12, v12, v90
    s_xor_b32 s36, s30, 4
    v_mfma_f32_16x16x32_bf16 v[220:223], v[60:63], a[252:255], v[220:223]
    ds_read_b64_tr_b16 v[54:55], v15 offset:512
    s_lshl_b32 s36, s36, 13
    s_lshl_b32 s32, s28, 6
    s_add_u32 s36, s36, s32
    s_add_u32 s36, s36, 20447232
    v_mfma_f32_16x16x32_bf16 v[160:163], v[28:31], v[32:35], 0
    ds_read_b64_tr_b16 v[56:57], v16 offset:0
    v_add_f32 v13, v13, v91
    v_add_f32 v18, v18, v92
    v_add_f32 v19, v19, v93
    buffer_load_dwordx4 v[224:227], v238, s[12:15], s36 offen sc1
    v_mfma_f32_16x16x32_bf16 v[168:171], v[28:31], v[32:35], 0
    ds_read_b64_tr_b16 v[58:59], v16 offset:512
    s_add_u32 s36, s36, 4096
    buffer_load_dwordx4 v[228:231], v238, s[12:15], s36 offen sc1
    v_mfma_f32_16x16x32_bf16 v[164:167], v[28:31], v[36:39], 0
    ds_read_b64_tr_b16 v[60:61], v17 offset:0
    v_add_f32 v20, v20, v94
    v_add_f32 v21, v21, v95
    v_mfma_f32_16x16x32_bf16 v[172:175], v[28:31], v[36:39], 0
    ds_read_b64_tr_b16 v[62:63], v17 offset:512
    v_cvt_pk_bf16_f32 v84, v10, v11
    v_mfma_f32_16x16x32_bf16 v[176:179], v[28:31], v[40:43], 0
    ds_read_b64_tr_b16 v[32:33], v14 offset:4096
    v_cvt_pk_bf16_f32 v85, v12, v13
    v_cvt_pk_bf16_f32 v86, v18, v19
    v_cvt_pk_bf16_f32 v87, v20, v21
    s_add_u32 m0, s39, 98304
    s_add_u32 s34, s3, 12
    s_and_b32 s34, s34, 15
    v_mfma_f32_16x16x32_bf16 v[184:187], v[28:31], v[40:43], 0
    ds_read_b64_tr_b16 v[34:35], v14 offset:4608
    s_mul_i32 s34, s34, 458752
    s_add_u32 s34, s34, 256
    s_add_u32 s8, s44, s34
    s_addc_u32 s9, s45, 0
    global_load_lds_dwordx4 v2, s[8:9] offset:0
    v_mfma_f32_16x16x32_bf16 v[180:183], v[28:31], v[44:47], 0
    ds_read_b64_tr_b16 v[36:37], v15 offset:4096
    v_mfma_f32_16x16x32_bf16 v[188:191], v[28:31], v[44:47], 0
    ds_read_b64_tr_b16 v[38:39], v15 offset:4608
    s_waitcnt lgkmcnt(4)
    v_mfma_f32_16x16x32_bf16 v[160:163], v[48:51], a[0:3], v[160:163]
    ds_read_b64_tr_b16 v[40:41], v16 offset:4096
    v_mul_f32 v10, v192, v192
    v_mul_f32 v11, v193, v193
    v_mfma_f32_16x16x32_bf16 v[168:171], v[48:51], a[4:7], v[168:171]
    ds_read_b64_tr_b16 v[42:43], v16 offset:4608
    v_mul_f32 v12, v194, v194
    v_mfma_f32_16x16x32_bf16 v[164:167], v[52:55], a[0:3], v[164:167]
    ds_read_b64_tr_b16 v[44:45], v17 offset:4096
    v_mul_f32 v13, v195, v195
    v_mfma_f32_16x16x32_bf16 v[172:175], v[52:55], a[4:7], v[172:175]
    ds_read_b64_tr_b16 v[46:47], v17 offset:4608
    v_mul_f32 v18, v196, v196
    v_mfma_f32_16x16x32_bf16 v[176:179], v[56:59], a[0:3], v[176:179]
    ds_read_b64_tr_b16 v[48:49], v14 offset:8192
    v_mul_f32 v19, v197, v197
    v_mul_f32 v20, v198, v198
    v_mfma_f32_16x16x32_bf16 v[184:187], v[56:59], a[4:7], v[184:187]
    ds_read_b64_tr_b16 v[50:51], v14 offset:8704
    v_mul_f32 v21, v199, v199
    v_mfma_f32_16x16x32_bf16 v[180:183], v[60:63], a[0:3], v[180:183]
    ds_read_b64_tr_b16 v[52:53], v15 offset:8192
    v_fma_f32 v10, v10, s42, v23
    v_mfma_f32_16x16x32_bf16 v[188:191], v[60:63], a[4:7], v[188:191]
    ds_read_b64_tr_b16 v[54:55], v15 offset:8704
    v_fma_f32 v11, v11, s42, v23
    s_waitcnt lgkmcnt(4)
    v_mfma_f32_16x16x32_bf16 v[160:163], v[32:35], a[8:11], v[160:163]
    ds_read_b64_tr_b16 v[56:57], v16 offset:8192
    v_fma_f32 v12, v12, s42, v23
    v_mfma_f32_16x16x32_bf16 v[168:171], v[32:35], a[12:15], v[168:171]
    ds_read_b64_tr_b16 v[58:59], v16 offset:8704
    v_fma_f32 v13, v13, s42, v23
    v_mfma_f32_16x16x32_bf16 v[164:167], v[36:39], a[8:11], v[164:167]
    ds_read_b64_tr_b16 v[60:61], v17 offset:8192
    v_fma_f32 v18, v18, s42, v23
    v_fma_f32 v19, v19, s42, v23
    v_mfma_f32_16x16x32_bf16 v[172:175], v[36:39], a[12:15], v[172:175]
    ds_read_b64_tr_b16 v[62:63], v17 offset:8704
    v_fma_f32 v20, v20, s42, v23
    v_mfma_f32_16x16x32_bf16 v[176:179], v[40:43], a[8:11], v[176:179]
    ds_read_b64_tr_b16 v[32:33], v14 offset:12288
    v_fma_f32 v21, v21, s42, v23
    v_mfma_f32_16x16x32_bf16 v[184:187], v[40:43], a[12:15], v[184:187]
    ds_read_b64_tr_b16 v[34:35], v14 offset:12800
    v_mul_f32 v10, v192, v10
    v_mfma_f32_16x16x32_bf16 v[180:183], v[44:47], a[8:11], v[180:183]
    ds_read_b64_tr_b16 v[36:37], v15 offset:12288
    v_mul_f32 v11, v193, v11
    v_mul_f32 v12, v194, v12
    v_mfma_f32_16x16x32_bf16 v[188:191], v[44:47], a[12:15], v[188:191]
    ds_read_b64_tr_b16 v[38:39], v15 offset:12800
    v_mul_f32 v13, v195, v13
    s_waitcnt lgkmcnt(4)
    v_mfma_f32_16x16x32_bf16 v[160:163], v[48:51], a[16:19], v[160:163]
    ds_read_b64_tr_b16 v[40:41], v16 offset:12288
    v_mul_f32 v18, v196, v18
    v_mul_f32 v19, v197, v19
    v_mfma_f32_16x16x32_bf16 v[168:171], v[48:51], a[20:23], v[168:171]
    ds_read_b64_tr_b16 v[42:43], v16 offset:12800
    global_load_lds_dwordx4 v3, s[8:9] offset:1024
    v_mfma_f32_16x16x32_bf16 v[164:167], v[52:55], a[16:19], v[164:167]
    ds_read_b64_tr_b16 v[44:45], v17 offset:12288
    v_mul_f32 v20, v198, v20
    v_mfma_f32_16x16x32_bf16 v[172:175], v[52:55], a[20:23], v[172:175]
    ds_read_b64_tr_b16 v[46:47], v17 offset:12800
    v_mul_f32 v21, v199, v21
    v_mfma_f32_16x16x32_bf16 v[176:179], v[56:59], a[16:19], v[176:179]
    ds_read_b64_tr_b16 v[48:49], v14 offset:16384
    v_exp_f32 v10, v10
    v_mfma_f32_16x16x32_bf16 v[184:187], v[56:59], a[20:23], v[184:187]
    ds_read_b64_tr_b16 v[50:51], v14 offset:16896
    v_exp_f32 v11, v11
    v_mfma_f32_16x16x32_bf16 v[180:183], v[60:63], a[16:19], v[180:183]
    ds_read_b64_tr_b16 v[52:53], v15 offset:16384
    v_exp_f32 v12, v12
    v_mfma_f32_16x16x32_bf16 v[188:191], v[60:63], a[20:23], v[188:191]
    ds_read_b64_tr_b16 v[54:55], v15 offset:16896
    global_load_lds_dwordx4 v4, s[8:9] offset:2048
    s_waitcnt lgkmcnt(4)
    v_mfma_f32_16x16x32_bf16 v[160:163], v[32:35], a[24:27], v[160:163]
    ds_read_b64_tr_b16 v[56:57], v16 offset:16384
    v_exp_f32 v13, v13
    v_mfma_f32_16x16x32_bf16 v[168:171], v[32:35], a[28:31], v[168:171]
    ds_read_b64_tr_b16 v[58:59], v16 offset:16896
    v_mfma_f32_16x16x32_bf16 v[164:167], v[36:39], a[24:27], v[164:167]
    ds_read_b64_tr_b16 v[60:61], v17 offset:16384
    v_exp_f32 v18, v18
    v_mfma_f32_16x16x32_bf16 v[172:175], v[36:39], a[28:31], v[172:175]
    ds_read_b64_tr_b16 v[62:63], v17 offset:16896
    global_load_lds_dwordx4 v5, s[8:9] offset:3072
    s_add_u32 m0, s39, 102400
    v_mfma_f32_16x16x32_bf16 v[176:179], v[40:43], a[24:27], v[176:179]
    ds_read_b64_tr_b16 v[32:33], v14 offset:20480
    v_exp_f32 v19, v19
    v_mfma_f32_16x16x32_bf16 v[184:187], v[40:43], a[28:31], v[184:187]
    ds_read_b64_tr_b16 v[34:35], v14 offset:20992
    v_mfma_f32_16x16x32_bf16 v[180:183], v[44:47], a[24:27], v[180:183]
    ds_read_b64_tr_b16 v[36:37], v15 offset:20480
    v_exp_f32 v20, v20
    v_mfma_f32_16x16x32_bf16 v[188:191], v[44:47], a[28:31], v[188:191]
    ds_read_b64_tr_b16 v[38:39], v15 offset:20992
    v_exp_f32 v21, v21
    s_waitcnt lgkmcnt(4)
    v_mfma_f32_16x16x32_bf16 v[160:163], v[48:51], a[32:35], v[160:163]
    ds_read_b64_tr_b16 v[40:41], v16 offset:20480
    v_add_f32 v10, 1.0, v10
    v_mfma_f32_16x16x32_bf16 v[168:171], v[48:51], a[36:39], v[168:171]
    ds_read_b64_tr_b16 v[42:43], v16 offset:20992
    v_mfma_f32_16x16x32_bf16 v[164:167], v[52:55], a[32:35], v[164:167]
    ds_read_b64_tr_b16 v[44:45], v17 offset:20480
    v_add_f32 v11, 1.0, v11
    v_add_f32 v12, 1.0, v12
    v_add_f32 v13, 1.0, v13
    v_mfma_f32_16x16x32_bf16 v[172:175], v[52:55], a[36:39], v[172:175]
    ds_read_b64_tr_b16 v[46:47], v17 offset:20992
    global_load_lds_dwordx4 v6, s[8:9] offset:0
    v_mfma_f32_16x16x32_bf16 v[176:179], v[56:59], a[32:35], v[176:179]
    ds_read_b64_tr_b16 v[48:49], v14 offset:24576
    v_add_f32 v18, 1.0, v18
    v_mfma_f32_16x16x32_bf16 v[184:187], v[56:59], a[36:39], v[184:187]
    ds_read_b64_tr_b16 v[50:51], v14 offset:25088
    v_add_f32 v19, 1.0, v19
    v_mfma_f32_16x16x32_bf16 v[180:183], v[60:63], a[32:35], v[180:183]
    ds_read_b64_tr_b16 v[52:53], v15 offset:24576
    v_add_f32 v20, 1.0, v20
    v_add_f32 v21, 1.0, v21
    v_mfma_f32_16x16x32_bf16 v[188:191], v[60:63], a[36:39], v[188:191]
    ds_read_b64_tr_b16 v[54:55], v15 offset:25088
    global_load_lds_dwordx4 v7, s[8:9] offset:1024
    s_waitcnt lgkmcnt(4)
    v_mfma_f32_16x16x32_bf16 v[160:163], v[32:35], a[40:43], v[160:163]
    ds_read_b64_tr_b16 v[56:57], v16 offset:24576
    v_rcp_f32 v10, v10
    v_rcp_f32 v11, v11
    v_mfma_f32_16x16x32_bf16 v[168:171], v[32:35], a[44:47], v[168:171]
    ds_read_b64_tr_b16 v[58:59], v16 offset:25088
    s_waitcnt vmcnt(8)
    v_add_f32 v96, v96, v100
    v_mfma_f32_16x16x32_bf16 v[164:167], v[36:39], a[40:43], v[164:167]
    ds_read_b64_tr_b16 v[60:61], v17 offset:24576
    v_rcp_f32 v12, v12
    v_mfma_f32_16x16x32_bf16 v[172:175], v[36:39], a[44:47], v[172:175]
    ds_read_b64_tr_b16 v[62:63], v17 offset:25088
    v_add_f32 v97, v97, v101
    v_add_f32 v98, v98, v102
    v_mfma_f32_16x16x32_bf16 v[176:179], v[40:43], a[40:43], v[176:179]
    ds_read_b64_tr_b16 v[32:33], v14 offset:28672
    v_rcp_f32 v13, v13
    v_add_f32 v99, v99, v103
    s_lshl_b32 s32, s28, 9
    s_add_u32 s32, s32, 139264
    v_mfma_f32_16x16x32_bf16 v[184:187], v[40:43], a[44:47], v[184:187]
    ds_read_b64_tr_b16 v[34:35], v14 offset:29184
    v_lshrrev_b32 v113, 1, v1
    v_add_u32 v112, s32, v113
    global_load_lds_dwordx4 v8, s[8:9] offset:2048
    v_mfma_f32_16x16x32_bf16 v[180:183], v[44:47], a[40:43], v[180:183]
    ds_read_b64_tr_b16 v[36:37], v15 offset:28672
    v_rcp_f32 v18, v18
    v_mfma_f32_16x16x32_bf16 v[188:191], v[44:47], a[44:47], v[188:191]
    ds_read_b64_tr_b16 v[38:39], v15 offset:29184
    s_waitcnt lgkmcnt(4)
    v_mfma_f32_16x16x32_bf16 v[160:163], v[48:51], a[48:51], v[160:163]
    ds_read_b64_tr_b16 v[40:41], v16 offset:28672
    v_rcp_f32 v19, v19
    v_permlane32_swap_b32 v96, v97
    v_mfma_f32_16x16x32_bf16 v[168:171], v[48:51], a[52:55], v[168:171]
    ds_read_b64_tr_b16 v[42:43], v16 offset:29184
    v_permlane32_swap_b32 v98, v99
    global_load_lds_dwordx4 v9, s[8:9] offset:3072
    v_mfma_f32_16x16x32_bf16 v[164:167], v[52:55], a[48:51], v[164:167]
    ds_read_b64_tr_b16 v[44:45], v17 offset:28672
    v_rcp_f32 v20, v20
    v_rcp_f32 v21, v21
    v_mfma_f32_16x16x32_bf16 v[172:175], v[52:55], a[52:55], v[172:175]
    ds_read_b64_tr_b16 v[46:47], v17 offset:29184
    v_add_f32 v96, v96, v97
    v_add_f32 v97, v98, v99
    v_mfma_f32_16x16x32_bf16 v[176:179], v[56:59], a[48:51], v[176:179]
    v_mul_f32 v10, v192, v10
    v_mfma_f32_16x16x32_bf16 v[184:187], v[56:59], a[52:55], v[184:187]
    ds_write_b64 v112, v[96:97]
    v_mfma_f32_16x16x32_bf16 v[180:183], v[60:63], a[48:51], v[180:183]
    v_mul_f32 v11, v193, v11
    v_mul_f32 v12, v194, v12
    v_mfma_f32_16x16x32_bf16 v[188:191], v[60:63], a[52:55], v[188:191]
    v_mul_f32 v13, v195, v13
    v_add_u32 v113, 139264, v113
    s_waitcnt lgkmcnt(1)
    v_mfma_f32_16x16x32_bf16 v[160:163], v[32:35], a[56:59], v[160:163]
    v_mfma_f32_16x16x32_bf16 v[168:171], v[32:35], a[60:63], v[168:171]
    s_waitcnt lgkmcnt(0)
    s_barrier
    v_mov_b32 v0, 1
    buffer_store_dword v0, v27, s[12:15], s49 offen sc1
    ds_read_b64_tr_b16 v[48:49], v14 offset:32768
    ds_read_b64_tr_b16 v[50:51], v14 offset:33280
    ds_read_b64_tr_b16 v[52:53], v15 offset:32768
    ds_read_b64_tr_b16 v[54:55], v15 offset:33280
    v_mul_f32 v18, v196, v18
    v_mul_f32 v19, v197, v19
    v_mfma_f32_16x16x32_bf16 v[164:167], v[36:39], a[56:59], v[164:167]
    ds_read_b64_tr_b16 v[56:57], v16 offset:32768
    ds_read_b64_tr_b16 v[58:59], v16 offset:33280
    v_mul_f32 v20, v198, v20
    v_mul_f32 v21, v199, v21
    v_mfma_f32_16x16x32_bf16 v[172:175], v[36:39], a[60:63], v[172:175]
    ds_read_b64_tr_b16 v[60:61], v17 offset:32768
    ds_read_b64_tr_b16 v[62:63], v17 offset:33280
    ds_read_b64 v[104:105], v113 offset:0
    ds_read_b64 v[106:107], v113 offset:512
    v_mfma_f32_16x16x32_bf16 v[176:179], v[40:43], a[56:59], v[176:179]
    ds_read_b64_tr_b16 v[32:33], v14 offset:36864
    v_cvt_pk_bf16_f32 v192, v10, v11
    v_cvt_pk_bf16_f32 v193, v12, v13
    v_cvt_pk_bf16_f32 v194, v18, v19
    v_mfma_f32_16x16x32_bf16 v[184:187], v[40:43], a[60:63], v[184:187]
    ds_read_b64_tr_b16 v[34:35], v14 offset:37376
    ds_read_b64 v[108:109], v113 offset:1024
    ds_read_b64 v[110:111], v113 offset:1536
    v_lshrrev_b32 v2, 6, v1
    v_mul_u32_u24 v2, 7168, v2
    v_lshrrev_b32 v3, 4, v1
    v_and_b32 v3, 32, v3
    v_mfma_f32_16x16x32_bf16 v[180:183], v[44:47], a[56:59], v[180:183]
    ds_read_b64_tr_b16 v[36:37], v15 offset:36864
    v_cvt_pk_bf16_f32 v195, v20, v21
    s_add_u32 s6, s4, 32768
    s_addc_u32 s7, s5, 0
    global_store_dwordx4 v1, v[192:195], s[6:7] offset:0 sc1
    v_and_b32 v112, 496, v1
    v_lshrrev_b32 v113, 7, v1
    v_mfma_f32_16x16x32_bf16 v[188:191], v[44:47], a[60:63], v[188:191]
    ds_read_b64_tr_b16 v[38:39], v15 offset:37376
    v_and_b32 v113, 4, v113
    v_add_u32 v112, v112, v113
    v_and_b32 v4, 48, v1
    v_xor_b32 v3, v3, v4
    v_add_u32 v2, v2, v3
    s_waitcnt lgkmcnt(8)
    v_mfma_f32_16x16x32_bf16 v[160:163], v[48:51], a[64:67], v[160:163]
    ds_read_b64_tr_b16 v[40:41], v16 offset:36864
    s_lshl_b32 s36, s30, 2
    s_lshr_b32 s32, s29, 2
    s_add_u32 s36, s36, s32
    s_lshl_b32 s36, s36, 1
    s_and_b32 s32, s29, 1
    v_mfma_f32_16x16x32_bf16 v[168:171], v[48:51], a[68:71], v[168:171]
    ds_read_b64_tr_b16 v[42:43], v16 offset:37376
    s_add_u32 s36, s36, s32
    s_add_u32 s3, s3, s28
    s_lshl_b32 s40, s30, 6
    s_add_u32 s40, s40, 6144
    v_mfma_f32_16x16x32_bf16 v[164:167], v[52:55], a[64:67], v[164:167]
    ds_read_b64_tr_b16 v[44:45], v17 offset:36864
    v_mul_f32 v10, v200, v200
    v_mul_f32 v11, v201, v201
    s_lshl_b32 s36, s36, 9
    s_and_b32 s32, s29, 2
    s_lshl_b32 s32, s32, 2
    s_add_u32 s36, s36, s32
    s_add_u32 s36, s36, 20316160
    v_mfma_f32_16x16x32_bf16 v[172:175], v[52:55], a[68:71], v[172:175]
    ds_read_b64_tr_b16 v[46:47], v17 offset:37376
    s_cmp_eq_u32 s28, 0
    s_cselect_b32 s36, s36, 2147483648
    s_add_u32 s44, s84, s40
    s_addc_u32 s45, s85, 0
    v_mov_b32 v3, v2
    v_add_u32 v9, 340992, v3
    v_mfma_f32_16x16x32_bf16 v[176:179], v[56:59], a[64:67], v[176:179]
    ds_read_b64_tr_b16 v[48:49], v14 offset:40960
    v_mul_f32 v12, v202, v202
    v_mul_f32 v13, v203, v203
    v_add_u32 v8, 227328, v2
    v_mfma_f32_16x16x32_bf16 v[184:187], v[56:59], a[68:71], v[184:187]
    ds_read_b64_tr_b16 v[50:51], v14 offset:41472
    v_add_u32 v7, 113664, v3
    v_add_u32 v6, 0, v2
    v_mfma_f32_16x16x32_bf16 v[180:183], v[60:63], a[64:67], v[180:183]
    ds_read_b64_tr_b16 v[52:53], v15 offset:40960
    v_mul_f32 v18, v204, v204
    v_mul_f32 v19, v205, v205
    v_mul_f32 v20, v206, v206
    v_mfma_f32_16x16x32_bf16 v[188:191], v[60:63], a[68:71], v[188:191]
    ds_read_b64_tr_b16 v[54:55], v15 offset:41472
    s_waitcnt lgkmcnt(10)
    v_add_u32 v5, 340992, v3
    v_add_u32 v4, 227328, v2
    v_add_u32 v3, 113664, v3
    v_mfma_f32_16x16x32_bf16 v[160:163], v[32:35], a[72:75], v[160:163]
    ds_read_b64_tr_b16 v[56:57], v16 offset:40960
    v_mul_f32 v21, v207, v207
    v_fma_f32 v10, v10, s42, v23
    v_add_f32 v104, v104, v106
    v_add_f32 v105, v105, v107
    v_add_f32 v108, v108, v110
    v_add_f32 v109, v109, v111
    s_add_u32 m0, s39, 0
    v_mfma_f32_16x16x32_bf16 v[168:171], v[32:35], a[76:79], v[168:171]
    ds_read_b64_tr_b16 v[58:59], v16 offset:41472
    s_add_u32 s34, s3, 0
    s_and_b32 s34, s34, 15
    s_mul_i32 s34, s34, 458752
    s_add_u32 s8, s44, s34
    s_addc_u32 s9, s45, 0
    global_load_lds_dwordx4 v2, s[8:9] offset:0
    s_waitcnt lgkmcnt(4)
    v_mfma_f32_16x16x32_bf16 v[164:167], v[36:39], a[72:75], v[164:167]
    ds_read_b64_tr_b16 v[60:61], v17 offset:40960
    v_fma_f32 v11, v11, s42, v23
    v_fma_f32 v12, v12, s42, v23
    v_fma_f32 v13, v13, s42, v23
    v_add_f32 v104, v104, v108
    v_mfma_f32_16x16x32_bf16 v[172:175], v[36:39], a[76:79], v[172:175]
    ds_read_b64_tr_b16 v[62:63], v17 offset:41472
    v_add_f32 v105, v105, v109
    s_nop 1
    v_permlane32_swap_b32 v104, v105
    v_mfma_f32_16x16x32_bf16 v[176:179], v[40:43], a[72:75], v[176:179]
    ds_read_b64_tr_b16 v[32:33], v14 offset:45056
    v_fma_f32 v18, v18, s42, v23
    v_fma_f32 v19, v19, s42, v23
    v_cvt_pk_bf16_f32 v104, v104, v105
    v_mfma_f32_16x16x32_bf16 v[184:187], v[40:43], a[76:79], v[184:187]
    ds_read_b64_tr_b16 v[34:35], v14 offset:45568
    buffer_store_dword v104, v112, s[12:15], s36 offen sc1
    v_mfma_f32_16x16x32_bf16 v[180:183], v[44:47], a[72:75], v[180:183]
    ds_read_b64_tr_b16 v[36:37], v15 offset:45056
    v_fma_f32 v20, v20, s42, v23
    v_mfma_f32_16x16x32_bf16 v[188:191], v[44:47], a[76:79], v[188:191]
    ds_read_b64_tr_b16 v[38:39], v15 offset:45568
    v_fma_f32 v21, v21, s42, v23
    v_mfma_f32_16x16x32_bf16 v[160:163], v[48:51], a[80:83], v[160:163]
    ds_read_b64_tr_b16 v[40:41], v16 offset:45056
    v_mul_f32 v10, v200, v10
    v_mul_f32 v11, v201, v11
    v_mfma_f32_16x16x32_bf16 v[168:171], v[48:51], a[84:87], v[168:171]
    ds_read_b64_tr_b16 v[42:43], v16 offset:45568
    v_mul_f32 v12, v202, v12
    s_waitcnt lgkmcnt(4)
    v_mfma_f32_16x16x32_bf16 v[164:167], v[52:55], a[80:83], v[164:167]
    ds_read_b64_tr_b16 v[44:45], v17 offset:45056
    v_mul_f32 v13, v203, v13
    v_mfma_f32_16x16x32_bf16 v[172:175], v[52:55], a[84:87], v[172:175]
    ds_read_b64_tr_b16 v[46:47], v17 offset:45568
    v_mul_f32 v18, v204, v18
    v_mfma_f32_16x16x32_bf16 v[176:179], v[56:59], a[80:83], v[176:179]
    ds_read_b64_tr_b16 v[48:49], v14 offset:49152
    v_mul_f32 v19, v205, v19
    v_mul_f32 v20, v206, v20
    v_mul_f32 v21, v207, v21
    v_mfma_f32_16x16x32_bf16 v[184:187], v[56:59], a[84:87], v[184:187]
    ds_read_b64_tr_b16 v[50:51], v14 offset:49664
    global_load_lds_dwordx4 v3, s[8:9] offset:1024
    v_mfma_f32_16x16x32_bf16 v[180:183], v[60:63], a[80:83], v[180:183]
    ds_read_b64_tr_b16 v[52:53], v15 offset:49152
    v_exp_f32 v10, v10
    v_mfma_f32_16x16x32_bf16 v[188:191], v[60:63], a[84:87], v[188:191]
    ds_read_b64_tr_b16 v[54:55], v15 offset:49664
    v_mfma_f32_16x16x32_bf16 v[160:163], v[32:35], a[88:91], v[160:163]
    ds_read_b64_tr_b16 v[56:57], v16 offset:49152
    v_exp_f32 v11, v11
    v_mfma_f32_16x16x32_bf16 v[168:171], v[32:35], a[92:95], v[168:171]
    ds_read_b64_tr_b16 v[58:59], v16 offset:49664
    s_waitcnt vmcnt(13)
    v_add_f32 v224, v224, v228
    global_load_lds_dwordx4 v4, s[8:9] offset:2048
    s_waitcnt lgkmcnt(4)
    v_mfma_f32_16x16x32_bf16 v[164:167], v[36:39], a[88:91], v[164:167]
    ds_read_b64_tr_b16 v[60:61], v17 offset:49152
    v_exp_f32 v12, v12
    v_exp_f32 v13, v13
    v_mfma_f32_16x16x32_bf16 v[172:175], v[36:39], a[92:95], v[172:175]
    ds_read_b64_tr_b16 v[62:63], v17 offset:49664
    v_add_f32 v225, v225, v229
    global_load_lds_dwordx4 v5, s[8:9] offset:3072
    v_mfma_f32_16x16x32_bf16 v[176:179], v[40:43], a[88:91], v[176:179]
    ds_read_b64_tr_b16 v[32:33], v14 offset:53248
    v_exp_f32 v18, v18
    v_mfma_f32_16x16x32_bf16 v[184:187], v[40:43], a[92:95], v[184:187]
    ds_read_b64_tr_b16 v[34:35], v14 offset:53760
    v_add_f32 v226, v226, v230
    v_mfma_f32_16x16x32_bf16 v[180:183], v[44:47], a[88:91], v[180:183]
    ds_read_b64_tr_b16 v[36:37], v15 offset:53248
    v_exp_f32 v19, v19
    v_add_f32 v227, v227, v231
    s_add_u32 m0, s39, 4096
    s_add_u32 s34, s3, 1
    s_and_b32 s34, s34, 15
    v_mfma_f32_16x16x32_bf16 v[188:191], v[44:47], a[92:95], v[188:191]
    ds_read_b64_tr_b16 v[38:39], v15 offset:53760
    s_mul_i32 s34, s34, 458752
    s_add_u32 s8, s44, s34
    s_addc_u32 s9, s45, 0
    global_load_lds_dwordx4 v6, s[8:9] offset:0
    v_mfma_f32_16x16x32_bf16 v[160:163], v[48:51], a[96:99], v[160:163]
    ds_read_b64_tr_b16 v[40:41], v16 offset:53248
    v_exp_f32 v20, v20
    v_mfma_f32_16x16x32_bf16 v[168:171], v[48:51], a[100:103], v[168:171]
    ds_read_b64_tr_b16 v[42:43], v16 offset:53760
    v_add_f32_dpp v224, v224, v224 row_ror:4 row_mask:0xf bank_mask:0xf
    s_waitcnt lgkmcnt(4)
    v_mfma_f32_16x16x32_bf16 v[164:167], v[52:55], a[96:99], v[164:167]
    ds_read_b64_tr_b16 v[44:45], v17 offset:53248
    v_exp_f32 v21, v21
    v_mfma_f32_16x16x32_bf16 v[172:175], v[52:55], a[100:103], v[172:175]
    ds_read_b64_tr_b16 v[46:47], v17 offset:53760
    v_add_f32_dpp v225, v225, v225 row_ror:4 row_mask:0xf bank_mask:0xf
    v_add_f32_dpp v226, v226, v226 row_ror:4 row_mask:0xf bank_mask:0xf
    v_mfma_f32_16x16x32_bf16 v[176:179], v[56:59], a[96:99], v[176:179]
    ds_read_b64_tr_b16 v[48:49], v14 offset:57344
    v_add_f32 v10, 1.0, v10
    v_add_f32 v11, 1.0, v11
    v_mfma_f32_16x16x32_bf16 v[184:187], v[56:59], a[100:103], v[184:187]
    ds_read_b64_tr_b16 v[50:51], v14 offset:57856
    v_add_f32 v12, 1.0, v12
    v_add_f32_dpp v227, v227, v227 row_ror:4 row_mask:0xf bank_mask:0xf
    v_mfma_f32_16x16x32_bf16 v[180:183], v[60:63], a[96:99], v[180:183]
    ds_read_b64_tr_b16 v[52:53], v15 offset:57344
    v_add_f32 v13, 1.0, v13
    v_add_f32 v18, 1.0, v18
    v_mfma_f32_16x16x32_bf16 v[188:191], v[60:63], a[100:103], v[188:191]
    ds_read_b64_tr_b16 v[54:55], v15 offset:57856
    v_add_f32_dpp v224, v224, v224 row_ror:8 row_mask:0xf bank_mask:0xf
    v_mfma_f32_16x16x32_bf16 v[160:163], v[32:35], a[104:107], v[160:163]
    ds_read_b64_tr_b16 v[56:57], v16 offset:57344
    v_add_f32 v19, 1.0, v19
    v_add_f32 v20, 1.0, v20
    v_mfma_f32_16x16x32_bf16 v[168:171], v[32:35], a[108:111], v[168:171]
    ds_read_b64_tr_b16 v[58:59], v16 offset:57856
    v_add_f32 v21, 1.0, v21
    v_add_f32_dpp v225, v225, v225 row_ror:8 row_mask:0xf bank_mask:0xf
    s_waitcnt lgkmcnt(4)
    v_mfma_f32_16x16x32_bf16 v[164:167], v[36:39], a[104:107], v[164:167]
    ds_read_b64_tr_b16 v[60:61], v17 offset:57344
    v_rcp_f32 v10, v10
    v_mfma_f32_16x16x32_bf16 v[172:175], v[36:39], a[108:111], v[172:175]
    ds_read_b64_tr_b16 v[62:63], v17 offset:57856
    v_add_f32_dpp v226, v226, v226 row_ror:8 row_mask:0xf bank_mask:0xf
    v_mfma_f32_16x16x32_bf16 v[176:179], v[40:43], a[104:107], v[176:179]
    ds_read_b64_tr_b16 v[32:33], v14 offset:61440
    v_rcp_f32 v11, v11
    v_add_f32_dpp v227, v227, v227 row_ror:8 row_mask:0xf bank_mask:0xf
    v_mfma_f32_16x16x32_bf16 v[184:187], v[40:43], a[108:111], v[184:187]
    ds_read_b64_tr_b16 v[34:35], v14 offset:61952
    v_mov_b32 v228, v224
    global_load_lds_dwordx4 v7, s[8:9] offset:1024
    v_mfma_f32_16x16x32_bf16 v[180:183], v[44:47], a[104:107], v[180:183]
    ds_read_b64_tr_b16 v[36:37], v15 offset:61440
    v_rcp_f32 v12, v12
    v_rcp_f32 v13, v13
    v_mfma_f32_16x16x32_bf16 v[188:191], v[44:47], a[108:111], v[188:191]
    ds_read_b64_tr_b16 v[38:39], v15 offset:61952
    v_mov_b32 v229, v225
    global_load_lds_dwordx4 v8, s[8:9] offset:2048
    v_mfma_f32_16x16x32_bf16 v[160:163], v[48:51], a[112:115], v[160:163]
    ds_read_b64_tr_b16 v[40:41], v16 offset:61440
    v_rcp_f32 v18, v18
    v_mfma_f32_16x16x32_bf16 v[168:171], v[48:51], a[116:119], v[168:171]
    ds_read_b64_tr_b16 v[42:43], v16 offset:61952
    v_mov_b32 v230, v226
    s_waitcnt lgkmcnt(4)
    v_mfma_f32_16x16x32_bf16 v[164:167], v[52:55], a[112:115], v[164:167]
    ds_read_b64_tr_b16 v[44:45], v17 offset:61440
    v_rcp_f32 v19, v19
    v_mov_b32 v231, v227
    v_mfma_f32_16x16x32_bf16 v[172:175], v[52:55], a[116:119], v[172:175]
    ds_read_b64_tr_b16 v[46:47], v17 offset:61952
    global_load_lds_dwordx4 v9, s[8:9] offset:3072
    v_mfma_f32_16x16x32_bf16 v[176:179], v[56:59], a[112:115], v[176:179]
    v_rcp_f32 v20, v20
    v_mfma_f32_16x16x32_bf16 v[184:187], v[56:59], a[116:119], v[184:187]
    v_permlane16_swap_b32 v224, v228
    v_mfma_f32_16x16x32_bf16 v[180:183], v[60:63], a[112:115], v[180:183]
    v_rcp_f32 v21, v21
    v_mfma_f32_16x16x32_bf16 v[188:191], v[60:63], a[116:119], v[188:191]
    v_permlane16_swap_b32 v225, v229
    v_permlane16_swap_b32 v226, v230
    v_mfma_f32_16x16x32_bf16 v[160:163], v[32:35], a[120:123], v[160:163]
    v_add_u32 v14, 65536, v14
    v_add_u32 v15, 65536, v15
    v_add_u32 v16, 65536, v16
    v_add_u32 v17, 65536, v17
    v_mfma_f32_16x16x32_bf16 v[168:171], v[32:35], a[124:127], v[168:171]
    s_waitcnt lgkmcnt(0)
    s_barrier
    s_getpc_b64 vcc
L_ct5:
    s_min_u32 s32, s82, L_end-L_ct5
    v_mov_b32 v0, s32
    global_load_dword v22, v0, vcc
    ds_read_b64_tr_b16 v[48:49], v14 offset:0
    ds_read_b64_tr_b16 v[50:51], v14 offset:512
    ds_read_b64_tr_b16 v[52:53], v15 offset:0
    ds_read_b64_tr_b16 v[54:55], v15 offset:512
    v_mul_f32 v10, v200, v10
    v_mul_f32 v11, v201, v11
    v_mul_f32 v12, v202, v12
    v_permlane16_swap_b32 v227, v231
    v_mfma_f32_16x16x32_bf16 v[164:167], v[36:39], a[120:123], v[164:167]
    ds_read_b64_tr_b16 v[56:57], v16 offset:0
    ds_read_b64_tr_b16 v[58:59], v16 offset:512
    v_mul_f32 v13, v203, v13
    v_mul_f32 v18, v204, v18
    v_mfma_f32_16x16x32_bf16 v[172:175], v[36:39], a[124:127], v[172:175]
    ds_read_b64_tr_b16 v[60:61], v17 offset:0
    ds_read_b64_tr_b16 v[62:63], v17 offset:512
    v_add_f32 v224, v224, v228
    v_mfma_f32_16x16x32_bf16 v[176:179], v[40:43], a[120:123], v[176:179]
    ds_read_b64_tr_b16 v[32:33], v14 offset:4096
    v_mul_f32 v19, v205, v19
    v_mul_f32 v20, v206, v20
    v_mul_f32 v21, v207, v21
    v_add_f32 v225, v225, v229
    s_add_u32 m0, s39, 32768
    s_add_u32 s34, s3, 8
    v_mfma_f32_16x16x32_bf16 v[184:187], v[40:43], a[124:127], v[184:187]
    ds_read_b64_tr_b16 v[34:35], v14 offset:4608
    s_and_b32 s34, s34, 15
    s_mul_i32 s34, s34, 458752
    s_add_u32 s8, s44, s34
    s_addc_u32 s9, s45, 0
    global_load_lds_dwordx4 v2, s[8:9] offset:0
    v_mfma_f32_16x16x32_bf16 v[180:183], v[44:47], a[120:123], v[180:183]
    ds_read_b64_tr_b16 v[36:37], v15 offset:4096
    v_cvt_pk_bf16_f32 v196, v10, v11
    v_cvt_pk_bf16_f32 v197, v12, v13
    v_mfma_f32_16x16x32_bf16 v[188:191], v[44:47], a[124:127], v[188:191]
    ds_read_b64_tr_b16 v[38:39], v15 offset:4608
    v_add_f32 v226, v226, v230
    s_waitcnt lgkmcnt(4)
    v_mfma_f32_16x16x32_bf16 v[160:163], v[48:51], a[128:131], v[160:163]
    ds_read_b64_tr_b16 v[40:41], v16 offset:4096
    v_cvt_pk_bf16_f32 v198, v18, v19
    v_cvt_pk_bf16_f32 v199, v20, v21
    v_mfma_f32_16x16x32_bf16 v[168:171], v[48:51], a[132:135], v[168:171]
    ds_read_b64_tr_b16 v[42:43], v16 offset:4608
    v_add_f32 v227, v227, v231
    v_mov_b32 v228, v224
    v_mfma_f32_16x16x32_bf16 v[164:167], v[52:55], a[128:131], v[164:167]
    ds_read_b64_tr_b16 v[44:45], v17 offset:4096
    global_store_dwordx4 v1, v[196:199], s[6:7] offset:1024 sc1
    v_mul_f32 v10, v208, v208
    v_mfma_f32_16x16x32_bf16 v[172:175], v[52:55], a[132:135], v[172:175]
    ds_read_b64_tr_b16 v[46:47], v17 offset:4608
    v_mov_b32 v229, v225
    v_mfma_f32_16x16x32_bf16 v[176:179], v[56:59], a[128:131], v[176:179]
    ds_read_b64_tr_b16 v[48:49], v14 offset:8192
    v_mul_f32 v11, v209, v209
    v_mul_f32 v12, v210, v210
    v_mfma_f32_16x16x32_bf16 v[184:187], v[56:59], a[132:135], v[184:187]
    ds_read_b64_tr_b16 v[50:51], v14 offset:8704
    v_mov_b32 v230, v226
    v_mfma_f32_16x16x32_bf16 v[180:183], v[60:63], a[128:131], v[180:183]
    ds_read_b64_tr_b16 v[52:53], v15 offset:8192
    v_mul_f32 v13, v211, v211
    v_mul_f32 v18, v212, v212
    v_mfma_f32_16x16x32_bf16 v[188:191], v[60:63], a[132:135], v[188:191]
    ds_read_b64_tr_b16 v[54:55], v15 offset:8704
    v_mov_b32 v231, v227
    s_waitcnt lgkmcnt(4)
    v_mfma_f32_16x16x32_bf16 v[160:163], v[32:35], a[136:139], v[160:163]
    ds_read_b64_tr_b16 v[56:57], v16 offset:8192
    v_mul_f32 v19, v213, v213
    v_mul_f32 v20, v214, v214
    v_mfma_f32_16x16x32_bf16 v[168:171], v[32:35], a[140:143], v[168:171]
    ds_read_b64_tr_b16 v[58:59], v16 offset:8704
    v_mul_f32 v21, v215, v215
    v_permlane32_swap_b32 v224, v228
    v_mfma_f32_16x16x32_bf16 v[164:167], v[36:39], a[136:139], v[164:167]
    ds_read_b64_tr_b16 v[60:61], v17 offset:8192
    v_fma_f32 v10, v10, s42, v23
    v_fma_f32 v11, v11, s42, v23
    v_mfma_f32_16x16x32_bf16 v[172:175], v[36:39], a[140:143], v[172:175]
    ds_read_b64_tr_b16 v[62:63], v17 offset:8704
    v_permlane32_swap_b32 v225, v229
    v_permlane32_swap_b32 v226, v230
    v_mfma_f32_16x16x32_bf16 v[176:179], v[40:43], a[136:139], v[176:179]
    ds_read_b64_tr_b16 v[32:33], v14 offset:12288
    v_fma_f32 v12, v12, s42, v23
    v_fma_f32 v13, v13, s42, v23
    v_fma_f32 v18, v18, s42, v23
    v_mfma_f32_16x16x32_bf16 v[184:187], v[40:43], a[140:143], v[184:187]
    ds_read_b64_tr_b16 v[34:35], v14 offset:12800
    v_permlane32_swap_b32 v227, v231
    global_load_lds_dwordx4 v3, s[8:9] offset:1024
    v_mfma_f32_16x16x32_bf16 v[180:183], v[44:47], a[136:139], v[180:183]
    ds_read_b64_tr_b16 v[36:37], v15 offset:12288
    v_fma_f32 v19, v19, s42, v23
    v_fma_f32 v20, v20, s42, v23
    v_mfma_f32_16x16x32_bf16 v[188:191], v[44:47], a[140:143], v[188:191]
    ds_read_b64_tr_b16 v[38:39], v15 offset:12800
    v_add_f32 v224, v224, v228
    s_waitcnt lgkmcnt(4)
    v_mfma_f32_16x16x32_bf16 v[160:163], v[48:51], a[144:147], v[160:163]
    ds_read_b64_tr_b16 v[40:41], v16 offset:12288
    v_fma_f32 v21, v21, s42, v23
    v_mul_f32 v10, v208, v10
    v_add_f32 v225, v225, v229
    v_mfma_f32_16x16x32_bf16 v[168:171], v[48:51], a[148:151], v[168:171]
    ds_read_b64_tr_b16 v[42:43], v16 offset:12800
    global_load_lds_dwordx4 v4, s[8:9] offset:2048
    v_mfma_f32_16x16x32_bf16 v[164:167], v[52:55], a[144:147], v[164:167]
    ds_read_b64_tr_b16 v[44:45], v17 offset:12288
    v_mul_f32 v11, v209, v11
    v_mul_f32 v12, v210, v12
    v_mfma_f32_16x16x32_bf16 v[172:175], v[52:55], a[148:151], v[172:175]
    ds_read_b64_tr_b16 v[46:47], v17 offset:12800
    v_mul_f32 v13, v211, v13
    v_add_f32 v226, v226, v230
    v_mfma_f32_16x16x32_bf16 v[176:179], v[56:59], a[144:147], v[176:179]
    ds_read_b64_tr_b16 v[48:49], v14 offset:16384
    v_mul_f32 v18, v212, v18
    v_mul_f32 v19, v213, v19
    v_add_f32 v227, v227, v231
    v_cvt_pk_bf16_f32 v224, v224, v225
    v_mfma_f32_16x16x32_bf16 v[184:187], v[56:59], a[148:151], v[184:187]
    ds_read_b64_tr_b16 v[50:51], v14 offset:16896
    v_cvt_pk_bf16_f32 v225, v226, v227
    v_and_b32 v228, 48, v1
    global_load_lds_dwordx4 v5, s[8:9] offset:3072
    v_mfma_f32_16x16x32_bf16 v[180:183], v[60:63], a[144:147], v[180:183]
    ds_read_b64_tr_b16 v[52:53], v15 offset:16384
    v_mul_f32 v20, v214, v20
    v_mul_f32 v21, v215, v21
    v_mfma_f32_16x16x32_bf16 v[188:191], v[60:63], a[148:151], v[188:191]
    ds_read_b64_tr_b16 v[54:55], v15 offset:16896
    v_exp_f32 v10, v10
    s_waitcnt lgkmcnt(4)
    v_mfma_f32_16x16x32_bf16 v[160:163], v[32:35], a[152:155], v[160:163]
    ds_read_b64_tr_b16 v[56:57], v16 offset:16384
    v_exp_f32 v11, v11
    s_add_u32 m0, s39, 36864
    s_add_u32 s34, s3, 9
    s_and_b32 s34, s34, 15
    v_mfma_f32_16x16x32_bf16 v[168:171], v[32:35], a[156:159], v[168:171]
    ds_read_b64_tr_b16 v[58:59], v16 offset:16896
    s_mul_i32 s34, s34, 458752
    s_add_u32 s8, s44, s34
    s_addc_u32 s9, s45, 0
    global_load_lds_dwordx4 v6, s[8:9] offset:0
    v_mfma_f32_16x16x32_bf16 v[164:167], v[36:39], a[152:155], v[164:167]
    ds_read_b64_tr_b16 v[60:61], v17 offset:16384
    v_exp_f32 v12, v12
    s_lshr_b32 s32, s28, 1
    s_lshl_b32 s32, s32, 3
    s_and_b32 s48, s28, 1
    v_mfma_f32_16x16x32_bf16 v[172:175], v[36:39], a[156:159], v[172:175]
    ds_read_b64_tr_b16 v[62:63], v17 offset:16896
    s_add_u32 s32, s32, s48
    s_lshl_b32 s32, s32, 3
    s_add_u32 s32, s32, 135168
    v_add_u32 v228, s32, v228
    v_mfma_f32_16x16x32_bf16 v[176:179], v[40:43], a[152:155], v[176:179]
    ds_read_b64_tr_b16 v[32:33], v14 offset:20480
    v_exp_f32 v13, v13
    v_mfma_f32_16x16x32_bf16 v[184:187], v[40:43], a[156:159], v[184:187]
    ds_read_b64_tr_b16 v[34:35], v14 offset:20992
    v_mfma_f32_16x16x32_bf16 v[180:183], v[44:47], a[152:155], v[180:183]
    ds_read_b64_tr_b16 v[36:37], v15 offset:20480
    v_exp_f32 v18, v18
    v_and_b32 v25, 0xf0, v1
    v_mfma_f32_16x16x32_bf16 v[188:191], v[44:47], a[156:159], v[188:191]
    ds_read_b64_tr_b16 v[38:39], v15 offset:20992
    v_lshlrev_b32 v25, 3, v25
    s_and_b32 s40, s49, 0xfffff800
    s_waitcnt lgkmcnt(4)
    v_mfma_f32_16x16x32_bf16 v[160:163], v[48:51], a[160:163], v[160:163]
    ds_read_b64_tr_b16 v[40:41], v16 offset:20480
    v_exp_f32 v19, v19
    v_exp_f32 v20, v20
    s_and_b32 s32, s1, 512
    v_mfma_f32_16x16x32_bf16 v[168:171], v[48:51], a[164:167], v[168:171]
    ds_read_b64_tr_b16 v[42:43], v16 offset:20992
    v_cmp_gt_u32 vcc, s32, v1
    v_mov_b32 v24, 2147483648
    s_nop 0
    v_cndmask_b32 v25, v24, v25, vcc
    v_mfma_f32_16x16x32_bf16 v[164:167], v[52:55], a[160:163], v[164:167]
    ds_read_b64_tr_b16 v[44:45], v17 offset:20480
    v_exp_f32 v21, v21
    v_mfma_f32_16x16x32_bf16 v[172:175], v[52:55], a[164:167], v[172:175]
    ds_read_b64_tr_b16 v[46:47], v17 offset:20992
    v_mfma_f32_16x16x32_bf16 v[176:179], v[56:59], a[160:163], v[176:179]
    ds_read_b64_tr_b16 v[48:49], v14 offset:24576
    v_add_f32 v10, 1.0, v10
    v_mfma_f32_16x16x32_bf16 v[184:187], v[56:59], a[164:167], v[184:187]
    ds_read_b64_tr_b16 v[50:51], v14 offset:25088
    v_mfma_f32_16x16x32_bf16 v[180:183], v[60:63], a[160:163], v[180:183]
    ds_read_b64_tr_b16 v[52:53], v15 offset:24576
    v_add_f32 v11, 1.0, v11
    v_add_f32 v12, 1.0, v12
    v_add_f32 v13, 1.0, v13
    v_mfma_f32_16x16x32_bf16 v[188:191], v[60:63], a[164:167], v[188:191]
    ds_read_b64_tr_b16 v[54:55], v15 offset:25088
    ds_write_b64 v228, v[224:225]
    s_waitcnt lgkmcnt(5)
    v_mfma_f32_16x16x32_bf16 v[160:163], v[32:35], a[168:171], v[160:163]
    ds_read_b64_tr_b16 v[56:57], v16 offset:24576
    v_add_f32 v18, 1.0, v18
    v_add_f32 v19, 1.0, v19
    v_mfma_f32_16x16x32_bf16 v[168:171], v[32:35], a[172:175], v[168:171]
    ds_read_b64_tr_b16 v[58:59], v16 offset:25088
    global_load_lds_dwordx4 v7, s[8:9] offset:1024
    v_mfma_f32_16x16x32_bf16 v[164:167], v[36:39], a[168:171], v[164:167]
    ds_read_b64_tr_b16 v[60:61], v17 offset:24576
    v_add_f32 v20, 1.0, v20
    v_add_f32 v21, 1.0, v21
    v_mfma_f32_16x16x32_bf16 v[172:175], v[36:39], a[172:175], v[172:175]
    ds_read_b64_tr_b16 v[62:63], v17 offset:25088
    v_rcp_f32 v10, v10
    v_mfma_f32_16x16x32_bf16 v[176:179], v[40:43], a[168:171], v[176:179]
    ds_read_b64_tr_b16 v[32:33], v14 offset:28672
    v_rcp_f32 v11, v11
    v_mfma_f32_16x16x32_bf16 v[184:187], v[40:43], a[172:175], v[184:187]
    ds_read_b64_tr_b16 v[34:35], v14 offset:29184
    global_load_lds_dwordx4 v8, s[8:9] offset:2048
    v_mfma_f32_16x16x32_bf16 v[180:183], v[44:47], a[168:171], v[180:183]
    ds_read_b64_tr_b16 v[36:37], v15 offset:28672
    v_rcp_f32 v12, v12
    v_mfma_f32_16x16x32_bf16 v[188:191], v[44:47], a[172:175], v[188:191]
    ds_read_b64_tr_b16 v[38:39], v15 offset:29184
    s_waitcnt lgkmcnt(4)
    v_mfma_f32_16x16x32_bf16 v[160:163], v[48:51], a[176:179], v[160:163]
    ds_read_b64_tr_b16 v[40:41], v16 offset:28672
    v_rcp_f32 v13, v13
    v_mfma_f32_16x16x32_bf16 v[168:171], v[48:51], a[180:183], v[168:171]
    ds_read_b64_tr_b16 v[42:43], v16 offset:29184
    global_load_lds_dwordx4 v9, s[8:9] offset:3072
    v_mfma_f32_16x16x32_bf16 v[164:167], v[52:55], a[176:179], v[164:167]
    ds_read_b64_tr_b16 v[44:45], v17 offset:28672
    v_rcp_f32 v18, v18
    v_mfma_f32_16x16x32_bf16 v[172:175], v[52:55], a[180:183], v[172:175]
    ds_read_b64_tr_b16 v[46:47], v17 offset:29184
    v_mfma_f32_16x16x32_bf16 v[176:179], v[56:59], a[176:179], v[176:179]
    v_rcp_f32 v19, v19
    v_mfma_f32_16x16x32_bf16 v[184:187], v[56:59], a[180:183], v[184:187]
    v_rcp_f32 v20, v20
    v_mfma_f32_16x16x32_bf16 v[180:183], v[60:63], a[176:179], v[180:183]
    v_rcp_f32 v21, v21
    v_mfma_f32_16x16x32_bf16 v[188:191], v[60:63], a[180:183], v[188:191]
    s_waitcnt lgkmcnt(0)
    v_mfma_f32_16x16x32_bf16 v[160:163], v[32:35], a[184:187], v[160:163]
    v_mfma_f32_16x16x32_bf16 v[168:171], v[32:35], a[188:191], v[168:171]
    s_waitcnt vmcnt(21)
    s_barrier
    buffer_load_dword v24, v25, s[12:15], s40 offen sc1
    ds_read_b64_tr_b16 v[48:49], v14 offset:32768
    ds_read_b64_tr_b16 v[50:51], v14 offset:33280
    ds_read_b64_tr_b16 v[52:53], v15 offset:32768
    ds_read_b64_tr_b16 v[54:55], v15 offset:33280
    v_mul_f32 v10, v208, v10
    v_mfma_f32_16x16x32_bf16 v[164:167], v[36:39], a[184:187], v[164:167]
    ds_read_b64_tr_b16 v[56:57], v16 offset:32768
    ds_read_b64_tr_b16 v[58:59], v16 offset:33280
    v_mul_f32 v11, v209, v11
    v_mul_f32 v12, v210, v12
    v_mfma_f32_16x16x32_bf16 v[172:175], v[36:39], a[188:191], v[172:175]
    ds_read_b64_tr_b16 v[60:61], v17 offset:32768
    ds_read_b64_tr_b16 v[62:63], v17 offset:33280
    v_mul_f32 v13, v211, v13
    v_mfma_f32_16x16x32_bf16 v[176:179], v[40:43], a[184:187], v[176:179]
    ds_read_b64_tr_b16 v[32:33], v14 offset:36864
    v_mul_f32 v18, v212, v18
    v_mul_f32 v19, v213, v19
    v_bfe_u32 v2, v1, 7, 2
    v_lshlrev_b32 v2, 11, v2
    v_mfma_f32_16x16x32_bf16 v[184:187], v[40:43], a[188:191], v[184:187]
    ds_read_b64_tr_b16 v[34:35], v14 offset:37376
    v_lshrrev_b32 v3, 3, v1
    v_and_b32 v3, 32, v3
    v_and_b32 v4, 112, v1
    v_xor_b32 v3, v3, v4
    v_mfma_f32_16x16x32_bf16 v[180:183], v[44:47], a[184:187], v[180:183]
    ds_read_b64_tr_b16 v[36:37], v15 offset:36864
    v_lshrrev_b32 v236, 1, v1
    v_mul_f32 v20, v214, v20
    v_mul_f32 v21, v215, v21
    v_cvt_pk_bf16_f32 v208, v10, v11
    v_add_u32 v2, v2, v3
    v_mfma_f32_16x16x32_bf16 v[188:191], v[44:47], a[188:191], v[188:191]
    ds_read_b64_tr_b16 v[38:39], v15 offset:37376
    v_lshrrev_b32 v3, 9, v1
    v_xor_b32 v3, s31, v3
    v_lshl_add_u32 v2, v3, 7, v2
    s_lshr_b32 s32, s0, 1
    s_lshl_b32 s32, s32, 8
    s_waitcnt lgkmcnt(4)
    v_mfma_f32_16x16x32_bf16 v[160:163], v[48:51], a[192:195], v[160:163]
    ds_read_b64_tr_b16 v[40:41], v16 offset:36864
    v_and_b32 v236, 24, v236
    v_cvt_pk_bf16_f32 v209, v12, v13
    v_cvt_pk_bf16_f32 v210, v18, v19
    v_add_u32 v2, s32, v2
    s_lshr_b32 s34, s28, 1
    v_mfma_f32_16x16x32_bf16 v[168:171], v[48:51], a[196:199], v[168:171]
    ds_read_b64_tr_b16 v[42:43], v16 offset:37376
    s_lshl_b32 s32, s31, 3
    s_add_u32 s34, s34, s32
    s_mul_i32 s34, s34, 393216
    s_and_b32 s32, s28, 1
    v_mfma_f32_16x16x32_bf16 v[164:167], v[52:55], a[192:195], v[164:167]
    ds_read_b64_tr_b16 v[44:45], v17 offset:36864
    v_and_b32 v237, 0xc0, v1
    v_cvt_pk_bf16_f32 v211, v20, v21
    global_store_dwordx4 v1, v[208:211], s[6:7] offset:2048 sc1
    s_lshl_b32 s32, s32, 16
    s_add_u32 s34, s34, s32
    v_mfma_f32_16x16x32_bf16 v[172:175], v[52:55], a[196:199], v[172:175]
    ds_read_b64_tr_b16 v[46:47], v17 offset:37376
    s_add_u32 s44, s88, s34
    s_addc_u32 s45, s89, 0
    s_add_u32 s32, s41, 4096
    s_add_u32 s16, s98, s32
    s_addc_u32 s17, s99, 0
    v_mfma_f32_16x16x32_bf16 v[176:179], v[56:59], a[192:195], v[176:179]
    ds_read_b64_tr_b16 v[48:49], v14 offset:40960
    v_mul_f32 v10, v216, v216
    v_mul_f32 v11, v217, v217
    s_add_u32 s32, s47, 266240
    s_add_u32 s18, s98, s32
    v_mfma_f32_16x16x32_bf16 v[184:187], v[56:59], a[196:199], v[184:187]
    ds_read_b64_tr_b16 v[50:51], v14 offset:41472
    s_addc_u32 s19, s99, 0
    v_xor_b32 v3, 64, v2
    v_add_u32 v9, 54272, v3
    v_mfma_f32_16x16x32_bf16 v[180:183], v[60:63], a[192:195], v[180:183]
    ds_read_b64_tr_b16 v[52:53], v15 offset:40960
    v_add_u32 v236, v236, v237
    v_mul_f32 v12, v218, v218
    v_mul_f32 v13, v219, v219
    v_add_u32 v8, 47104, v2
    v_add_u32 v7, 39936, v3
    v_mfma_f32_16x16x32_bf16 v[188:191], v[60:63], a[196:199], v[188:191]
    ds_read_b64_tr_b16 v[54:55], v15 offset:41472
    v_add_u32 v6, 32768, v2
    v_add_u32 v5, 21504, v3
    v_add_u32 v4, 14336, v2
    v_add_u32 v3, 7168, v3
    s_waitcnt lgkmcnt(4)
    v_mfma_f32_16x16x32_bf16 v[160:163], v[32:35], a[200:203], v[160:163]
    ds_read_b64_tr_b16 v[56:57], v16 offset:40960
    v_lshrrev_b32 v237, 8, v1
    v_mul_f32 v18, v220, v220
    v_mul_f32 v19, v221, v221
    v_mul_f32 v20, v222, v222
    s_add_u32 m0, s39, 65536
    v_mfma_f32_16x16x32_bf16 v[168:171], v[32:35], a[204:207], v[168:171]
    ds_read_b64_tr_b16 v[58:59], v16 offset:41472
    s_add_u32 s8, s44, 0
    s_addc_u32 s9, s45, 0
    global_load_lds_dwordx4 v2, s[8:9] offset:0
    v_mfma_f32_16x16x32_bf16 v[164:167], v[36:39], a[200:203], v[164:167]
    ds_read_b64_tr_b16 v[60:61], v17 offset:40960
    v_mul_f32 v21, v223, v223
    v_mfma_f32_16x16x32_bf16 v[172:175], v[36:39], a[204:207], v[172:175]
    ds_read_b64_tr_b16 v[62:63], v17 offset:41472
    v_fma_f32 v10, v10, s42, v23
    v_mfma_f32_16x16x32_bf16 v[176:179], v[40:43], a[200:203], v[176:179]
    ds_read_b64_tr_b16 v[32:33], v14 offset:45056
    v_lshl_add_u32 v236, v237, 9, v236
    v_fma_f32 v11, v11, s42, v23
    v_mfma_f32_16x16x32_bf16 v[184:187], v[40:43], a[204:207], v[184:187]
    ds_read_b64_tr_b16 v[34:35], v14 offset:45568
    v_fma_f32 v12, v12, s42, v23
    v_mfma_f32_16x16x32_bf16 v[180:183], v[44:47], a[200:203], v[180:183]
    ds_read_b64_tr_b16 v[36:37], v15 offset:45056
    v_and_b32 v237, 1, v237
    v_fma_f32 v13, v13, s42, v23
    v_mfma_f32_16x16x32_bf16 v[188:191], v[44:47], a[204:207], v[188:191]
    ds_read_b64_tr_b16 v[38:39], v15 offset:45568
    v_fma_f32 v18, v18, s42, v23
    v_fma_f32 v19, v19, s42, v23
    s_waitcnt lgkmcnt(4)
    v_mfma_f32_16x16x32_bf16 v[160:163], v[48:51], a[208:211], v[160:163]
    ds_read_b64_tr_b16 v[40:41], v16 offset:45056
    v_fma_f32 v20, v20, s42, v23
    v_mfma_f32_16x16x32_bf16 v[168:171], v[48:51], a[212:215], v[168:171]
    ds_read_b64_tr_b16 v[42:43], v16 offset:45568
    v_fma_f32 v21, v21, s42, v23
    v_mfma_f32_16x16x32_bf16 v[164:167], v[52:55], a[208:211], v[164:167]
    ds_read_b64_tr_b16 v[44:45], v17 offset:45056
    v_lshl_add_u32 v236, v237, 5, v236
    v_mul_f32 v10, v216, v10
    v_mul_f32 v11, v217, v11
    v_mfma_f32_16x16x32_bf16 v[172:175], v[52:55], a[212:215], v[172:175]
    ds_read_b64_tr_b16 v[46:47], v17 offset:45568
    v_mul_f32 v12, v218, v12
    global_load_lds_dwordx4 v3, s[8:9] offset:1024
    v_mfma_f32_16x16x32_bf16 v[176:179], v[56:59], a[208:211], v[176:179]
    ds_read_b64_tr_b16 v[48:49], v14 offset:49152
    v_xor_b32 v237, 32, v236
    v_mul_f32 v13, v219, v13
    v_mfma_f32_16x16x32_bf16 v[184:187], v[56:59], a[212:215], v[184:187]
    ds_read_b64_tr_b16 v[50:51], v14 offset:49664
    v_mul_f32 v18, v220, v18
    v_mfma_f32_16x16x32_bf16 v[180:183], v[60:63], a[208:211], v[180:183]
    ds_read_b64_tr_b16 v[52:53], v15 offset:49152
    v_mul_f32 v19, v221, v19
    v_mfma_f32_16x16x32_bf16 v[188:191], v[60:63], a[212:215], v[188:191]
    ds_read_b64_tr_b16 v[54:55], v15 offset:49664
    v_mul_f32 v20, v222, v20
    s_waitcnt lgkmcnt(4)
    v_mfma_f32_16x16x32_bf16 v[160:163], v[32:35], a[216:219], v[160:163]
    ds_read_b64_tr_b16 v[56:57], v16 offset:49152
    v_mul_f32 v21, v223, v21
    v_exp_f32 v10, v10
    v_mfma_f32_16x16x32_bf16 v[168:171], v[32:35], a[220:223], v[168:171]
    ds_read_b64_tr_b16 v[58:59], v16 offset:49664
    global_load_lds_dwordx4 v4, s[8:9] offset:2048
    v_mfma_f32_16x16x32_bf16 v[164:167], v[36:39], a[216:219], v[164:167]
    ds_read_b64_tr_b16 v[60:61], v17 offset:49152
    v_exp_f32 v11, v11
    v_mfma_f32_16x16x32_bf16 v[172:175], v[36:39], a[220:223], v[172:175]
    ds_read_b64_tr_b16 v[62:63], v17 offset:49664
    v_mfma_f32_16x16x32_bf16 v[176:179], v[40:43], a[216:219], v[176:179]
    ds_read_b64_tr_b16 v[32:33], v14 offset:53248
    v_exp_f32 v12, v12
    v_exp_f32 v13, v13
    v_mfma_f32_16x16x32_bf16 v[184:187], v[40:43], a[220:223], v[184:187]
    ds_read_b64_tr_b16 v[34:35], v14 offset:53760
    global_load_lds_dwordx4 v5, s[8:9] offset:3072
    s_add_u32 m0, s39, 69632
    v_mfma_f32_16x16x32_bf16 v[180:183], v[44:47], a[216:219], v[180:183]
    ds_read_b64_tr_b16 v[36:37], v15 offset:53248
    v_exp_f32 v18, v18
    v_mfma_f32_16x16x32_bf16 v[188:191], v[44:47], a[220:223], v[188:191]
    ds_read_b64_tr_b16 v[38:39], v15 offset:53760
    s_waitcnt lgkmcnt(4)
    v_mfma_f32_16x16x32_bf16 v[160:163], v[48:51], a[224:227], v[160:163]
    ds_read_b64_tr_b16 v[40:41], v16 offset:53248
    v_exp_f32 v19, v19
    v_mfma_f32_16x16x32_bf16 v[168:171], v[48:51], a[228:231], v[168:171]
    ds_read_b64_tr_b16 v[42:43], v16 offset:53760
    v_mfma_f32_16x16x32_bf16 v[164:167], v[52:55], a[224:227], v[164:167]
    ds_read_b64_tr_b16 v[44:45], v17 offset:53248
    v_exp_f32 v20, v20
    v_mfma_f32_16x16x32_bf16 v[172:175], v[52:55], a[228:231], v[172:175]
    ds_read_b64_tr_b16 v[46:47], v17 offset:53760
    global_load_lds_dwordx4 v6, s[8:9] offset:0
    v_mfma_f32_16x16x32_bf16 v[176:179], v[56:59], a[224:227], v[176:179]
    ds_read_b64_tr_b16 v[48:49], v14 offset:57344
    v_exp_f32 v21, v21
    v_mfma_f32_16x16x32_bf16 v[184:187], v[56:59], a[228:231], v[184:187]
    ds_read_b64_tr_b16 v[50:51], v14 offset:57856
    v_mfma_f32_16x16x32_bf16 v[180:183], v[60:63], a[224:227], v[180:183]
    ds_read_b64_tr_b16 v[52:53], v15 offset:57344
    v_add_f32 v10, 1.0, v10
    v_add_f32 v11, 1.0, v11
    v_mfma_f32_16x16x32_bf16 v[188:191], v[60:63], a[228:231], v[188:191]
    ds_read_b64_tr_b16 v[54:55], v15 offset:57856
    v_add_f32 v12, 1.0, v12
    s_waitcnt lgkmcnt(4)
    v_mfma_f32_16x16x32_bf16 v[160:163], v[32:35], a[232:235], v[160:163]
    ds_read_b64_tr_b16 v[56:57], v16 offset:57344
    v_add_f32 v13, 1.0, v13
    v_add_f32 v18, 1.0, v18
    v_mfma_f32_16x16x32_bf16 v[168:171], v[32:35], a[236:239], v[168:171]
    ds_read_b64_tr_b16 v[58:59], v16 offset:57856
    global_load_lds_dwordx4 v7, s[8:9] offset:1024
    v_mfma_f32_16x16x32_bf16 v[164:167], v[36:39], a[232:235], v[164:167]
    ds_read_b64_tr_b16 v[60:61], v17 offset:57344
    v_add_f32 v19, 1.0, v19
    v_mfma_f32_16x16x32_bf16 v[172:175], v[36:39], a[236:239], v[172:175]
    ds_read_b64_tr_b16 v[62:63], v17 offset:57856
    v_add_f32 v20, 1.0, v20
    v_mfma_f32_16x16x32_bf16 v[176:179], v[40:43], a[232:235], v[176:179]
    ds_read_b64_tr_b16 v[32:33], v14 offset:61440
    v_add_f32 v21, 1.0, v21
    v_rcp_f32 v10, v10
    v_mfma_f32_16x16x32_bf16 v[184:187], v[40:43], a[236:239], v[184:187]
    ds_read_b64_tr_b16 v[34:35], v14 offset:61952
    global_load_lds_dwordx4 v8, s[8:9] offset:2048
    v_mfma_f32_16x16x32_bf16 v[180:183], v[44:47], a[232:235], v[180:183]
    ds_read_b64_tr_b16 v[36:37], v15 offset:61440
    v_rcp_f32 v11, v11
    v_mfma_f32_16x16x32_bf16 v[188:191], v[44:47], a[236:239], v[188:191]
    ds_read_b64_tr_b16 v[38:39], v15 offset:61952
    s_waitcnt lgkmcnt(4)
    v_mfma_f32_16x16x32_bf16 v[160:163], v[48:51], a[240:243], v[160:163]
    ds_read_b64_tr_b16 v[40:41], v16 offset:61440
    v_rcp_f32 v12, v12
    v_rcp_f32 v13, v13
    v_mfma_f32_16x16x32_bf16 v[168:171], v[48:51], a[244:247], v[168:171]
    ds_read_b64_tr_b16 v[42:43], v16 offset:61952
    global_load_lds_dwordx4 v9, s[8:9] offset:3072
    v_mfma_f32_16x16x32_bf16 v[164:167], v[52:55], a[240:243], v[164:167]
    ds_read_b64_tr_b16 v[44:45], v17 offset:61440
    v_rcp_f32 v18, v18
    v_mfma_f32_16x16x32_bf16 v[172:175], v[52:55], a[244:247], v[172:175]
    ds_read_b64_tr_b16 v[46:47], v17 offset:61952
    v_mfma_f32_16x16x32_bf16 v[176:179], v[56:59], a[240:243], v[176:179]
    v_rcp_f32 v19, v19
    v_mfma_f32_16x16x32_bf16 v[184:187], v[56:59], a[244:247], v[184:187]
    v_mfma_f32_16x16x32_bf16 v[180:183], v[60:63], a[240:243], v[180:183]
    v_rcp_f32 v20, v20
    v_mfma_f32_16x16x32_bf16 v[188:191], v[60:63], a[244:247], v[188:191]
    s_waitcnt lgkmcnt(0)
    v_mfma_f32_16x16x32_bf16 v[160:163], v[32:35], a[248:251], v[160:163]
    s_waitcnt vmcnt(9)
    v_cmp_gt_u32 vcc, 1, v24
    s_nop 0
    s_and_b32 s32, vcc_lo, s1
    s_cbranch_scc1 L_poll_3
L_poll_3_ok:
    v_mfma_f32_16x16x32_bf16 v[168:171], v[32:35], a[252:255], v[168:171]
    s_barrier
    v_mov_b32 v0, 2
    buffer_store_dword v0, v27, s[12:15], s43 offen sc1
    s_mov_b32 s20, s90
    s_mov_b32 s21, s91
    s_mov_b32 s22, 2048
    v_and_b32 v202, 0xf0, v1
    v_lshrrev_b32 v202, 3, v202
    s_lshl_b32 s32, s0, 7
    buffer_load_ushort v198, v202, s[20:23], s32 offen offset:0
    buffer_load_ushort v199, v202, s[20:23], s32 offen offset:32
    buffer_load_ushort v200, v202, s[20:23], s32 offen offset:64
    buffer_load_ushort v201, v202, s[20:23], s32 offen offset:96
    v_mov_b32 v48, 0
    v_mov_b32 v49, 0
    v_mov_b32 v50, v26
    v_mov_b32 v51, 0
    v_mov_b32 v52, 0
    v_mov_b32 v53, 0
    v_lshlrev_b32 v54, 16, v26
    v_mov_b32 v55, 0
    v_rcp_f32 v21, v21
    v_mfma_f32_16x16x32_bf16 v[164:167], v[36:39], a[248:251], v[164:167]
    ds_read_b64_tr_b16 v[56:57], v236 offset:0
    ds_read_b64_tr_b16 v[58:59], v236 offset:256
    v_mul_f32 v10, v216, v10
    v_mul_f32 v11, v217, v11
    v_mfma_f32_16x16x32_bf16 v[172:175], v[36:39], a[252:255], v[172:175]
    ds_read_b64_tr_b16 v[60:61], v237 offset:0
    ds_read_b64_tr_b16 v[62:63], v237 offset:256
    v_mul_f32 v12, v218, v12
    v_mfma_f32_16x16x32_bf16 v[176:179], v[40:43], a[248:251], v[176:179]
    ds_read_b64_tr_b16 v[32:33], v236 offset:2048
    v_mul_f32 v13, v219, v13
    v_mul_f32 v18, v220, v18
    s_add_u32 m0, s39, 98304
    s_add_u32 s8, s44, 786432
    v_mfma_f32_16x16x32_bf16 v[184:187], v[40:43], a[252:255], v[184:187]
    ds_read_b64_tr_b16 v[34:35], v236 offset:2304
    s_addc_u32 s9, s45, 0
    global_load_lds_dwordx4 v2, s[8:9] offset:0
    v_mfma_f32_16x16x32_bf16 v[180:183], v[44:47], a[248:251], v[180:183]
    ds_read_b64_tr_b16 v[36:37], v237 offset:2048
    v_mul_f32 v19, v221, v19
    v_mfma_f32_16x16x32_bf16 v[188:191], v[44:47], a[252:255], v[188:191]
    ds_read_b64_tr_b16 v[38:39], v237 offset:2304
    v_mul_f32 v20, v222, v20
    v_mfma_f32_16x16x32_bf16 v[240:243], v[28:31], v[48:51], 0
    ds_read_b64_tr_b16 v[40:41], v236 offset:4096
    v_mul_f32 v21, v223, v21
    v_cvt_pk_bf16_f32 v212, v10, v11
    v_mfma_f32_16x16x32_bf16 v[248:251], v[28:31], v[48:51], 0
    ds_read_b64_tr_b16 v[42:43], v236 offset:4352
    v_cvt_pk_bf16_f32 v213, v12, v13
    v_mfma_f32_16x16x32_bf16 v[244:247], v[28:31], v[52:55], 0
    ds_read_b64_tr_b16 v[44:45], v237 offset:4096
    v_cvt_pk_bf16_f32 v214, v18, v19
    v_mfma_f32_16x16x32_bf16 v[252:255], v[28:31], v[52:55], 0
    ds_read_b64_tr_b16 v[46:47], v237 offset:4352
    v_cvt_pk_bf16_f32 v215, v20, v21
    s_waitcnt lgkmcnt(4)
    v_mfma_f32_16x16x32_bf16 v[240:243], v[56:59], a[0:3], v[240:243]
    ds_read_b64_tr_b16 v[48:49], v236 offset:6144
    global_store_dwordx4 v1, v[212:215], s[6:7] offset:3072 sc1
    v_lshrrev_b32 v239, 4, v1
    v_and_b32 v239, 48, v239
    s_and_b32 s32, s28, 1
    v_mfma_f32_16x16x32_bf16 v[248:251], v[56:59], a[4:7], v[248:251]
    ds_read_b64_tr_b16 v[50:51], v236 offset:6400
    s_lshl_b32 s32, s32, 6
    s_add_u32 s32, s32, 135168
    v_add_u32 v239, s32, v239
    v_mfma_f32_16x16x32_bf16 v[244:247], v[60:63], a[0:3], v[244:247]
    ds_read_b64_tr_b16 v[52:53], v237 offset:6144
    v_mfma_f32_16x16x32_bf16 v[252:255], v[60:63], a[4:7], v[252:255]
    ds_read_b64_tr_b16 v[54:55], v237 offset:6400
    v_mfma_f32_16x16x32_bf16 v[240:243], v[32:35], a[8:11], v[240:243]
    ds_read_b64_tr_b16 v[56:57], v236 offset:8192
    v_mul_f32 v10, v160, v160
    v_mul_f32 v11, v161, v161
    v_mfma_f32_16x16x32_bf16 v[248:251], v[32:35], a[12:15], v[248:251]
    ds_read_b64_tr_b16 v[58:59], v236 offset:8448
    v_mul_f32 v12, v162, v162
    v_mul_f32 v13, v163, v163
    v_mfma_f32_16x16x32_bf16 v[244:247], v[36:39], a[8:11], v[244:247]
    ds_read_b64_tr_b16 v[60:61], v237 offset:8192
    v_mfma_f32_16x16x32_bf16 v[252:255], v[36:39], a[12:15], v[252:255]
    ds_read_b64_tr_b16 v[62:63], v237 offset:8448
    ds_read_b128 v[224:227], v239
    v_mul_f32 v18, v164, v164
    v_mul_f32 v19, v165, v165
    v_mul_f32 v20, v166, v166
    global_load_lds_dwordx4 v3, s[8:9] offset:1024
    s_waitcnt lgkmcnt(5)
    v_mfma_f32_16x16x32_bf16 v[240:243], v[40:43], a[16:19], v[240:243]
    ds_read_b64_tr_b16 v[32:33], v236 offset:10240
    v_mul_f32 v21, v167, v167
    v_fma_f32 v10, v10, s42, v23
    v_mfma_f32_16x16x32_bf16 v[248:251], v[40:43], a[20:23], v[248:251]
    ds_read_b64_tr_b16 v[34:35], v236 offset:10496
    v_fma_f32 v11, v11, s42, v23
    v_fma_f32 v12, v12, s42, v23
    v_mfma_f32_16x16x32_bf16 v[244:247], v[44:47], a[16:19], v[244:247]
    ds_read_b64_tr_b16 v[36:37], v237 offset:10240
    v_fma_f32 v13, v13, s42, v23
    v_fma_f32 v18, v18, s42, v23
    v_mfma_f32_16x16x32_bf16 v[252:255], v[44:47], a[20:23], v[252:255]
    ds_read_b64_tr_b16 v[38:39], v237 offset:10496
    v_fma_f32 v19, v19, s42, v23
    v_mfma_f32_16x16x32_bf16 v[240:243], v[48:51], a[24:27], v[240:243]
    ds_read_b64_tr_b16 v[40:41], v236 offset:12288
    v_fma_f32 v20, v20, s42, v23
    v_fma_f32 v21, v21, s42, v23
    v_mul_f32 v10, v160, v10
    v_mfma_f32_16x16x32_bf16 v[248:251], v[48:51], a[28:31], v[248:251]
    ds_read_b64_tr_b16 v[42:43], v236 offset:12544
    global_load_lds_dwordx4 v4, s[8:9] offset:2048
    v_mfma_f32_16x16x32_bf16 v[244:247], v[52:55], a[24:27], v[244:247]
    ds_read_b64_tr_b16 v[44:45], v237 offset:12288
    v_mul_f32 v11, v161, v11
    v_mul_f32 v12, v162, v12
    v_mfma_f32_16x16x32_bf16 v[252:255], v[52:55], a[28:31], v[252:255]
    ds_read_b64_tr_b16 v[46:47], v237 offset:12544
    v_mul_f32 v13, v163, v13
    v_mul_f32 v18, v164, v18
    s_waitcnt lgkmcnt(4)
    v_mfma_f32_16x16x32_bf16 v[240:243], v[56:59], a[32:35], v[240:243]
    ds_read_b64_tr_b16 v[48:49], v236 offset:14336
    v_mul_f32 v19, v165, v19
    v_mul_f32 v20, v166, v20
    v_mfma_f32_16x16x32_bf16 v[248:251], v[56:59], a[36:39], v[248:251]
    ds_read_b64_tr_b16 v[50:51], v236 offset:14592
    v_mul_f32 v21, v167, v21
    v_mfma_f32_16x16x32_bf16 v[244:247], v[60:63], a[32:35], v[244:247]
    ds_read_b64_tr_b16 v[52:53], v237 offset:14336
    v_exp_f32 v10, v10
    v_exp_f32 v11, v11
    v_mfma_f32_16x16x32_bf16 v[252:255], v[60:63], a[36:39], v[252:255]
    ds_read_b64_tr_b16 v[54:55], v237 offset:14592
    global_load_lds_dwordx4 v5, s[8:9] offset:3072
    s_add_u32 m0, s39, 102400
    v_mfma_f32_16x16x32_bf16 v[240:243], v[32:35], a[40:43], v[240:243]
    ds_read_b64_tr_b16 v[56:57], v236 offset:16384
    v_exp_f32 v12, v12
    v_mfma_f32_16x16x32_bf16 v[248:251], v[32:35], a[44:47], v[248:251]
    ds_read_b64_tr_b16 v[58:59], v236 offset:16640
    v_exp_f32 v13, v13
    v_mfma_f32_16x16x32_bf16 v[244:247], v[36:39], a[40:43], v[244:247]
    ds_read_b64_tr_b16 v[60:61], v237 offset:16384
    v_exp_f32 v18, v18
    v_mfma_f32_16x16x32_bf16 v[252:255], v[36:39], a[44:47], v[252:255]
    ds_read_b64_tr_b16 v[62:63], v237 offset:16640
    s_waitcnt lgkmcnt(4)
    v_mfma_f32_16x16x32_bf16 v[240:243], v[40:43], a[48:51], v[240:243]
    ds_read_b64_tr_b16 v[32:33], v236 offset:18432
    v_exp_f32 v19, v19
    v_mfma_f32_16x16x32_bf16 v[248:251], v[40:43], a[52:55], v[248:251]
    ds_read_b64_tr_b16 v[34:35], v236 offset:18688
    v_exp_f32 v20, v20
    v_mfma_f32_16x16x32_bf16 v[244:247], v[44:47], a[48:51], v[244:247]
    ds_read_b64_tr_b16 v[36:37], v237 offset:18432
    v_exp_f32 v21, v21
    v_mfma_f32_16x16x32_bf16 v[252:255], v[44:47], a[52:55], v[252:255]
    ds_read_b64_tr_b16 v[38:39], v237 offset:18688
    v_add_f32 v10, 1.0, v10
    v_mfma_f32_16x16x32_bf16 v[240:243], v[48:51], a[56:59], v[240:243]
    ds_read_b64_tr_b16 v[40:41], v236 offset:20480
    v_add_f32 v11, 1.0, v11
    v_add_f32 v12, 1.0, v12
    v_add_f32 v13, 1.0, v13
    v_mfma_f32_16x16x32_bf16 v[248:251], v[48:51], a[60:63], v[248:251]
    ds_read_b64_tr_b16 v[42:43], v236 offset:20736
    global_load_lds_dwordx4 v6, s[8:9] offset:0
    v_mfma_f32_16x16x32_bf16 v[244:247], v[52:55], a[56:59], v[244:247]
    ds_read_b64_tr_b16 v[44:45], v237 offset:20480
    v_add_f32 v18, 1.0, v18
    v_add_f32 v19, 1.0, v19
    v_mfma_f32_16x16x32_bf16 v[252:255], v[52:55], a[60:63], v[252:255]
    ds_read_b64_tr_b16 v[46:47], v237 offset:20736
    v_add_f32 v20, 1.0, v20
    s_waitcnt lgkmcnt(4)
    v_mfma_f32_16x16x32_bf16 v[240:243], v[56:59], a[64:67], v[240:243]
    ds_read_b64_tr_b16 v[48:49], v236 offset:22528
    v_add_f32 v21, 1.0, v21
    v_rcp_f32 v10, v10
    v_rcp_f32 v11, v11
    v_mfma_f32_16x16x32_bf16 v[248:251], v[56:59], a[68:71], v[248:251]
    ds_read_b64_tr_b16 v[50:51], v236 offset:22784
    s_add_u32 s10, s16, 0
    s_addc_u32 s11, s17, 0
    global_load_dwordx4 a[0:3], v1, s[10:11] offset:-4096 sc1
    v_mfma_f32_16x16x32_bf16 v[244:247], v[60:63], a[64:67], v[244:247]
    ds_read_b64_tr_b16 v[52:53], v237 offset:22528
    v_rcp_f32 v12, v12
    v_mfma_f32_16x16x32_bf16 v[252:255], v[60:63], a[68:71], v[252:255]
    ds_read_b64_tr_b16 v[54:55], v237 offset:22784
    global_load_lds_dwordx4 v7, s[8:9] offset:1024
    v_mfma_f32_16x16x32_bf16 v[240:243], v[32:35], a[72:75], v[240:243]
    ds_read_b64_tr_b16 v[56:57], v236 offset:24576
    v_rcp_f32 v13, v13
    v_mfma_f32_16x16x32_bf16 v[248:251], v[32:35], a[76:79], v[248:251]
    ds_read_b64_tr_b16 v[58:59], v236 offset:24832
    v_rcp_f32 v18, v18
    v_mfma_f32_16x16x32_bf16 v[244:247], v[36:39], a[72:75], v[244:247]
    ds_read_b64_tr_b16 v[60:61], v237 offset:24576
    v_rcp_f32 v19, v19
    v_mfma_f32_16x16x32_bf16 v[252:255], v[36:39], a[76:79], v[252:255]
    ds_read_b64_tr_b16 v[62:63], v237 offset:24832
    v_rcp_f32 v20, v20
    global_load_dwordx4 a[4:7], v1, s[10:11] offset:-3072 sc1
    s_waitcnt lgkmcnt(4)
    v_mfma_f32_16x16x32_bf16 v[240:243], v[40:43], a[80:83], v[240:243]
    ds_read_b64_tr_b16 v[32:33], v236 offset:26624
    v_rcp_f32 v21, v21
    global_load_dwordx4 a[8:11], v1, s[10:11] offset:-2048 sc1
    v_mfma_f32_16x16x32_bf16 v[248:251], v[40:43], a[84:87], v[248:251]
    ds_read_b64_tr_b16 v[34:35], v236 offset:26880
    global_load_lds_dwordx4 v8, s[8:9] offset:2048
    v_mfma_f32_16x16x32_bf16 v[244:247], v[44:47], a[80:83], v[244:247]
    ds_read_b64_tr_b16 v[36:37], v237 offset:26624
    v_mul_f32 v10, v160, v10
    v_mul_f32 v11, v161, v11
    v_mfma_f32_16x16x32_bf16 v[252:255], v[44:47], a[84:87], v[252:255]
    ds_read_b64_tr_b16 v[38:39], v237 offset:26880
    v_mul_f32 v12, v162, v12
    v_mfma_f32_16x16x32_bf16 v[240:243], v[48:51], a[88:91], v[240:243]
    ds_read_b64_tr_b16 v[40:41], v236 offset:28672
    v_mul_f32 v13, v163, v13
    v_mul_f32 v18, v164, v18
    v_mul_f32 v19, v165, v19
    v_mfma_f32_16x16x32_bf16 v[248:251], v[48:51], a[92:95], v[248:251]
    ds_read_b64_tr_b16 v[42:43], v236 offset:28928
    v_mul_f32 v20, v166, v20
    global_load_dwordx4 a[12:15], v1, s[10:11] offset:-1024 sc1
    v_mfma_f32_16x16x32_bf16 v[244:247], v[52:55], a[88:91], v[244:247]
    ds_read_b64_tr_b16 v[44:45], v237 offset:28672
    v_mul_f32 v21, v167, v21
    v_cvt_pk_bf16_f32 v160, v10, v11
    v_cvt_pk_bf16_f32 v161, v12, v13
    v_mfma_f32_16x16x32_bf16 v[252:255], v[52:55], a[92:95], v[252:255]
    ds_read_b64_tr_b16 v[46:47], v237 offset:28928
    global_load_dwordx4 a[16:19], v1, s[10:11] offset:0 sc1
    global_load_lds_dwordx4 v9, s[8:9] offset:3072
    s_waitcnt lgkmcnt(4)
    v_mfma_f32_16x16x32_bf16 v[240:243], v[56:59], a[96:99], v[240:243]
    ds_read_b64_tr_b16 v[48:49], v236 offset:30720
    v_cvt_pk_bf16_f32 v162, v18, v19
    v_cvt_pk_bf16_f32 v163, v20, v21
    s_add_u32 s6, s4, 65536
    v_mfma_f32_16x16x32_bf16 v[248:251], v[56:59], a[100:103], v[248:251]
    ds_read_b64_tr_b16 v[50:51], v236 offset:30976
    s_addc_u32 s7, s5, 0
    global_store_dwordx4 v1, v[160:163], s[6:7] offset:0 sc1
    v_mfma_f32_16x16x32_bf16 v[244:247], v[60:63], a[96:99], v[244:247]
    ds_read_b64_tr_b16 v[52:53], v237 offset:30720
    v_mul_f32 v10, v168, v168
    v_mfma_f32_16x16x32_bf16 v[252:255], v[60:63], a[100:103], v[252:255]
    ds_read_b64_tr_b16 v[54:55], v237 offset:30976
    global_load_dwordx4 a[20:23], v1, s[10:11] offset:1024 sc1
    v_mfma_f32_16x16x32_bf16 v[240:243], v[32:35], a[104:107], v[240:243]
    v_mul_f32 v11, v169, v169
    v_mul_f32 v12, v170, v170
    v_mfma_f32_16x16x32_bf16 v[248:251], v[32:35], a[108:111], v[248:251]
    v_mul_f32 v13, v171, v171
    global_load_dwordx4 a[24:27], v1, s[10:11] offset:2048 sc1
    v_mfma_f32_16x16x32_bf16 v[244:247], v[36:39], a[104:107], v[244:247]
    v_mul_f32 v18, v172, v172
    v_mul_f32 v19, v173, v173
    v_mfma_f32_16x16x32_bf16 v[252:255], v[36:39], a[108:111], v[252:255]
    v_mul_f32 v20, v174, v174
    s_waitcnt lgkmcnt(0)
    v_mfma_f32_16x16x32_bf16 v[240:243], v[40:43], a[112:115], v[240:243]
    v_mfma_f32_16x16x32_bf16 v[248:251], v[40:43], a[116:119], v[248:251]
    s_waitcnt vmcnt(15)
    s_barrier
    v_mov_b32 v0, 2
    buffer_store_dword v0, v27, s[12:15], s49 offen sc1
    ds_read_b64_tr_b16 v[56:57], v236 offset:32768
    ds_read_b64_tr_b16 v[58:59], v236 offset:33024
    ds_read_b64_tr_b16 v[60:61], v237 offset:32768
    ds_read_b64_tr_b16 v[62:63], v237 offset:33024
    v_mul_f32 v21, v175, v175
    v_fma_f32 v10, v10, s42, v23
    v_fma_f32 v11, v11, s42, v23
    v_fma_f32 v12, v12, s42, v23
    global_load_dwordx4 a[28:31], v1, s[10:11] offset:3072 sc1
    v_mfma_f32_16x16x32_bf16 v[244:247], v[44:47], a[112:115], v[244:247]
    ds_read_b64_tr_b16 v[32:33], v236 offset:34816
    ds_read_b64_tr_b16 v[34:35], v236 offset:35072
    v_fma_f32 v13, v13, s42, v23
    v_fma_f32 v18, v18, s42, v23
    v_mfma_f32_16x16x32_bf16 v[252:255], v[44:47], a[116:119], v[252:255]
    ds_read_b64_tr_b16 v[36:37], v237 offset:34816
    ds_read_b64_tr_b16 v[38:39], v237 offset:35072
    v_fma_f32 v19, v19, s42, v23
    v_mfma_f32_16x16x32_bf16 v[240:243], v[48:51], a[120:123], v[240:243]
    ds_read_b64_tr_b16 v[40:41], v236 offset:36864
    v_fma_f32 v20, v20, s42, v23
    v_fma_f32 v21, v21, s42, v23
    v_mul_f32 v10, v168, v10
    s_add_u32 m0, s39, 0
    v_mfma_f32_16x16x32_bf16 v[248:251], v[48:51], a[124:127], v[248:251]
    ds_read_b64_tr_b16 v[42:43], v236 offset:37120
    s_add_u32 s8, s44, 1572864
    s_addc_u32 s9, s45, 0
    global_load_lds_dwordx4 v2, s[8:9] offset:0
    v_mfma_f32_16x16x32_bf16 v[244:247], v[52:55], a[120:123], v[244:247]
    ds_read_b64_tr_b16 v[44:45], v237 offset:36864
    s_and_b32 s35, s43, 0xfffff800
    s_xor_b32 s35, s35, 8192
    s_sub_u32 s32, s35, s40
    v_bfe_u32 v196, v1, 8, 1
    v_mul_lo_u32 v196, v196, s32
    v_mfma_f32_16x16x32_bf16 v[252:255], v[52:55], a[124:127], v[252:255]
    ds_read_b64_tr_b16 v[46:47], v237 offset:37120
    v_add_u32 v196, v196, v25
    v_mul_f32 v11, v169, v11
    v_mul_f32 v12, v170, v12
    v_mul_f32 v13, v171, v13
    v_mul_f32 v18, v172, v18
    s_waitcnt lgkmcnt(4)
    v_mfma_f32_16x16x32_bf16 v[240:243], v[56:59], a[128:131], v[240:243]
    ds_read_b64_tr_b16 v[48:49], v236 offset:38912
    v_mul_f32 v19, v173, v19
    v_mul_f32 v20, v174, v20
    v_mul_f32 v21, v175, v21
    v_mfma_f32_16x16x32_bf16 v[248:251], v[56:59], a[132:135], v[248:251]
    ds_read_b64_tr_b16 v[50:51], v236 offset:39168
    s_add_u32 s10, s16, 8192
    s_addc_u32 s11, s17, 0
    global_load_dwordx4 a[32:35], v1, s[10:11] offset:-4096 sc1
    v_mfma_f32_16x16x32_bf16 v[244:247], v[60:63], a[128:131], v[244:247]
    ds_read_b64_tr_b16 v[52:53], v237 offset:38912
    v_exp_f32 v10, v10
    v_mfma_f32_16x16x32_bf16 v[252:255], v[60:63], a[132:135], v[252:255]
    ds_read_b64_tr_b16 v[54:55], v237 offset:39168
    v_exp_f32 v11, v11
    v_mfma_f32_16x16x32_bf16 v[240:243], v[32:35], a[136:139], v[240:243]
    ds_read_b64_tr_b16 v[56:57], v236 offset:40960
    v_exp_f32 v12, v12
    v_mfma_f32_16x16x32_bf16 v[248:251], v[32:35], a[140:143], v[248:251]
    ds_read_b64_tr_b16 v[58:59], v236 offset:41216
    v_exp_f32 v13, v13
    v_mfma_f32_16x16x32_bf16 v[244:247], v[36:39], a[136:139], v[244:247]
    ds_read_b64_tr_b16 v[60:61], v237 offset:40960
    v_exp_f32 v18, v18
    v_mfma_f32_16x16x32_bf16 v[252:255], v[36:39], a[140:143], v[252:255]
    ds_read_b64_tr_b16 v[62:63], v237 offset:41216
    s_waitcnt lgkmcnt(4)
    v_mfma_f32_16x16x32_bf16 v[240:243], v[40:43], a[144:147], v[240:243]
    ds_read_b64_tr_b16 v[32:33], v236 offset:43008
    v_exp_f32 v19, v19
    v_mfma_f32_16x16x32_bf16 v[248:251], v[40:43], a[148:151], v[248:251]
    ds_read_b64_tr_b16 v[34:35], v236 offset:43264
    v_exp_f32 v20, v20
    v_mfma_f32_16x16x32_bf16 v[244:247], v[44:47], a[144:147], v[244:247]
    ds_read_b64_tr_b16 v[36:37], v237 offset:43008
    v_exp_f32 v21, v21
    v_add_f32 v10, 1.0, v10
    v_mfma_f32_16x16x32_bf16 v[252:255], v[44:47], a[148:151], v[252:255]
    ds_read_b64_tr_b16 v[38:39], v237 offset:43264
    global_load_lds_dwordx4 v3, s[8:9] offset:1024
    v_mfma_f32_16x16x32_bf16 v[240:243], v[48:51], a[152:155], v[240:243]
    ds_read_b64_tr_b16 v[40:41], v236 offset:45056
    v_add_f32 v11, 1.0, v11
    v_add_f32 v12, 1.0, v12
    v_mfma_f32_16x16x32_bf16 v[248:251], v[48:51], a[156:159], v[248:251]
    ds_read_b64_tr_b16 v[42:43], v236 offset:45312
    v_add_f32 v13, 1.0, v13
    global_load_dwordx4 a[36:39], v1, s[10:11] offset:-3072 sc1
    v_mfma_f32_16x16x32_bf16 v[244:247], v[52:55], a[152:155], v[244:247]
    ds_read_b64_tr_b16 v[44:45], v237 offset:45056
    v_add_f32 v18, 1.0, v18
    v_add_f32 v19, 1.0, v19
    v_mfma_f32_16x16x32_bf16 v[252:255], v[52:55], a[156:159], v[252:255]
    ds_read_b64_tr_b16 v[46:47], v237 offset:45312
    v_add_f32 v20, 1.0, v20
    s_waitcnt lgkmcnt(4)
    v_mfma_f32_16x16x32_bf16 v[240:243], v[56:59], a[160:163], v[240:243]
    ds_read_b64_tr_b16 v[48:49], v236 offset:47104
    v_add_f32 v21, 1.0, v21
    v_rcp_f32 v10, v10
    v_mfma_f32_16x16x32_bf16 v[248:251], v[56:59], a[164:167], v[248:251]
    ds_read_b64_tr_b16 v[50:51], v236 offset:47360
    v_rcp_f32 v11, v11
    global_load_lds_dwordx4 v4, s[8:9] offset:2048
    v_mfma_f32_16x16x32_bf16 v[244:247], v[60:63], a[160:163], v[244:247]
    ds_read_b64_tr_b16 v[52:53], v237 offset:47104
    v_rcp_f32 v12, v12
    v_mfma_f32_16x16x32_bf16 v[252:255], v[60:63], a[164:167], v[252:255]
    ds_read_b64_tr_b16 v[54:55], v237 offset:47360
    global_load_dwordx4 a[40:43], v1, s[10:11] offset:-2048 sc1
    v_mfma_f32_16x16x32_bf16 v[240:243], v[32:35], a[168:171], v[240:243]
    ds_read_b64_tr_b16 v[56:57], v236 offset:49152
    v_rcp_f32 v13, v13
    v_mfma_f32_16x16x32_bf16 v[248:251], v[32:35], a[172:175], v[248:251]
    ds_read_b64_tr_b16 v[58:59], v236 offset:49408
    v_rcp_f32 v18, v18
    v_mfma_f32_16x16x32_bf16 v[244:247], v[36:39], a[168:171], v[244:247]
    ds_read_b64_tr_b16 v[60:61], v237 offset:49152
    v_rcp_f32 v19, v19
    v_rcp_f32 v20, v20
    v_mfma_f32_16x16x32_bf16 v[252:255], v[36:39], a[172:175], v[252:255]
    ds_read_b64_tr_b16 v[62:63], v237 offset:49408
    global_load_lds_dwordx4 v5, s[8:9] offset:3072
    s_add_u32 m0, s39, 4096
    s_waitcnt lgkmcnt(4)
    v_mfma_f32_16x16x32_bf16 v[240:243], v[40:43], a[176:179], v[240:243]
    ds_read_b64_tr_b16 v[32:33], v236 offset:51200
    v_rcp_f32 v21, v21
    v_mfma_f32_16x16x32_bf16 v[248:251], v[40:43], a[180:183], v[248:251]
    ds_read_b64_tr_b16 v[34:35], v236 offset:51456
    global_load_dwordx4 a[44:47], v1, s[10:11] offset:-1024 sc1
    v_mfma_f32_16x16x32_bf16 v[244:247], v[44:47], a[176:179], v[244:247]
    ds_read_b64_tr_b16 v[36:37], v237 offset:51200
    v_mul_f32 v10, v168, v10
    v_mul_f32 v11, v169, v11
    v_mfma_f32_16x16x32_bf16 v[252:255], v[44:47], a[180:183], v[252:255]
    ds_read_b64_tr_b16 v[38:39], v237 offset:51456
    v_mul_f32 v12, v170, v12
    v_mfma_f32_16x16x32_bf16 v[240:243], v[48:51], a[184:187], v[240:243]
    ds_read_b64_tr_b16 v[40:41], v236 offset:53248
    v_mul_f32 v13, v171, v13
    v_mul_f32 v18, v172, v18
    v_mfma_f32_16x16x32_bf16 v[248:251], v[48:51], a[188:191], v[248:251]
    ds_read_b64_tr_b16 v[42:43], v236 offset:53504
    v_mul_f32 v19, v173, v19
    v_mul_f32 v20, v174, v20
    v_mfma_f32_16x16x32_bf16 v[244:247], v[52:55], a[184:187], v[244:247]
    ds_read_b64_tr_b16 v[44:45], v237 offset:53248
    v_mul_f32 v21, v175, v21
    v_cvt_pk_bf16_f32 v164, v10, v11
    v_cvt_pk_bf16_f32 v165, v12, v13
    v_mfma_f32_16x16x32_bf16 v[252:255], v[52:55], a[188:191], v[252:255]
    ds_read_b64_tr_b16 v[46:47], v237 offset:53504
    global_load_dwordx4 a[48:51], v1, s[10:11] offset:0 sc1
    global_load_lds_dwordx4 v6, s[8:9] offset:0
    s_waitcnt lgkmcnt(4)
    v_mfma_f32_16x16x32_bf16 v[240:243], v[56:59], a[192:195], v[240:243]
    ds_read_b64_tr_b16 v[48:49], v236 offset:55296
    v_cvt_pk_bf16_f32 v166, v18, v19
    v_cvt_pk_bf16_f32 v167, v20, v21
    v_mfma_f32_16x16x32_bf16 v[248:251], v[56:59], a[196:199], v[248:251]
    ds_read_b64_tr_b16 v[50:51], v236 offset:55552
    global_store_dwordx4 v1, v[164:167], s[6:7] offset:1024 sc1
    v_mfma_f32_16x16x32_bf16 v[244:247], v[60:63], a[192:195], v[244:247]
    ds_read_b64_tr_b16 v[52:53], v237 offset:55296
    v_mul_f32 v10, v176, v176
    v_mul_f32 v11, v177, v177
    v_mfma_f32_16x16x32_bf16 v[252:255], v[60:63], a[196:199], v[252:255]
    ds_read_b64_tr_b16 v[54:55], v237 offset:55552
    v_mul_f32 v12, v178, v178
    v_mfma_f32_16x16x32_bf16 v[240:243], v[32:35], a[200:203], v[240:243]
    ds_read_b64_tr_b16 v[56:57], v236 offset:57344
    v_mul_f32 v13, v179, v179
    v_mul_f32 v18, v180, v180
    v_mul_f32 v19, v181, v181
    v_mfma_f32_16x16x32_bf16 v[248:251], v[32:35], a[204:207], v[248:251]
    ds_read_b64_tr_b16 v[58:59], v236 offset:57600
    global_load_dwordx4 a[52:55], v1, s[10:11] offset:1024 sc1
    global_load_lds_dwordx4 v7, s[8:9] offset:1024
    v_mfma_f32_16x16x32_bf16 v[244:247], v[36:39], a[200:203], v[244:247]
    ds_read_b64_tr_b16 v[60:61], v237 offset:57344
    v_lshl_or_b32 v28, v199, 16, v198
    v_lshl_or_b32 v29, v201, 16, v200
    v_mul_f32 v20, v182, v182
    v_mfma_f32_16x16x32_bf16 v[252:255], v[36:39], a[204:207], v[252:255]
    ds_read_b64_tr_b16 v[62:63], v237 offset:57600
    v_mul_f32 v21, v183, v183
    v_fma_f32 v10, v10, s42, v23
    v_fma_f32 v11, v11, s42, v23
    s_waitcnt lgkmcnt(4)
    v_mfma_f32_16x16x32_bf16 v[240:243], v[40:43], a[208:211], v[240:243]
    ds_read_b64_tr_b16 v[32:33], v236 offset:59392
    v_fma_f32 v12, v12, s42, v23
    v_fma_f32 v13, v13, s42, v23
    v_mfma_f32_16x16x32_bf16 v[248:251], v[40:43], a[212:215], v[248:251]
    ds_read_b64_tr_b16 v[34:35], v236 offset:59648
    v_fma_f32 v18, v18, s42, v23
    v_mfma_f32_16x16x32_bf16 v[244:247], v[44:47], a[208:211], v[244:247]
    ds_read_b64_tr_b16 v[36:37], v237 offset:59392
    v_fma_f32 v19, v19, s42, v23
    v_fma_f32 v20, v20, s42, v23
    v_fma_f32 v21, v21, s42, v23
    v_mfma_f32_16x16x32_bf16 v[252:255], v[44:47], a[212:215], v[252:255]
    ds_read_b64_tr_b16 v[38:39], v237 offset:59648
    global_load_dwordx4 a[56:59], v1, s[10:11] offset:2048 sc1
    global_load_lds_dwordx4 v8, s[8:9] offset:2048
    v_mfma_f32_16x16x32_bf16 v[240:243], v[48:51], a[216:219], v[240:243]
    ds_read_b64_tr_b16 v[40:41], v236 offset:61440
    v_mul_f32 v10, v176, v10
    v_mul_f32 v11, v177, v11
    v_mfma_f32_16x16x32_bf16 v[248:251], v[48:51], a[220:223], v[248:251]
    ds_read_b64_tr_b16 v[42:43], v236 offset:61696
    v_mul_f32 v12, v178, v12
    v_mul_f32 v13, v179, v13
    v_mfma_f32_16x16x32_bf16 v[244:247], v[52:55], a[216:219], v[244:247]
    ds_read_b64_tr_b16 v[44:45], v237 offset:61440
    v_mul_f32 v18, v180, v18
    v_mul_f32 v19, v181, v19
    v_mfma_f32_16x16x32_bf16 v[252:255], v[52:55], a[220:223], v[252:255]
    ds_read_b64_tr_b16 v[46:47], v237 offset:61696
    v_mul_f32 v20, v182, v20
    s_waitcnt lgkmcnt(4)
    v_mfma_f32_16x16x32_bf16 v[240:243], v[56:59], a[224:227], v[240:243]
    ds_read_b64_tr_b16 v[48:49], v236 offset:63488
    v_mul_f32 v21, v183, v21
    v_exp_f32 v10, v10
    v_mfma_f32_16x16x32_bf16 v[248:251], v[56:59], a[228:231], v[248:251]
    ds_read_b64_tr_b16 v[50:51], v236 offset:63744
    global_load_dwordx4 a[60:63], v1, s[10:11] offset:3072 sc1
    global_load_lds_dwordx4 v9, s[8:9] offset:3072
    v_mfma_f32_16x16x32_bf16 v[244:247], v[60:63], a[224:227], v[244:247]
    ds_read_b64_tr_b16 v[52:53], v237 offset:63488
    v_exp_f32 v11, v11
    v_mfma_f32_16x16x32_bf16 v[252:255], v[60:63], a[228:231], v[252:255]
    ds_read_b64_tr_b16 v[54:55], v237 offset:63744
    v_exp_f32 v12, v12
    v_mfma_f32_16x16x32_bf16 v[240:243], v[32:35], a[232:235], v[240:243]
    v_exp_f32 v13, v13
    v_mfma_f32_16x16x32_bf16 v[248:251], v[32:35], a[236:239], v[248:251]
    v_exp_f32 v18, v18
    v_mfma_f32_16x16x32_bf16 v[244:247], v[36:39], a[232:235], v[244:247]
    v_exp_f32 v19, v19
    v_mfma_f32_16x16x32_bf16 v[252:255], v[36:39], a[236:239], v[252:255]
    s_waitcnt lgkmcnt(0)
    v_mfma_f32_16x16x32_bf16 v[240:243], v[40:43], a[240:243], v[240:243]
    v_mfma_f32_16x16x32_bf16 v[248:251], v[40:43], a[244:247], v[248:251]
    s_waitcnt vmcnt(17)
    s_barrier
    v_mov_b32 v56, v26
    v_mov_b32 v57, 0
    v_mov_b32 v58, 0
    v_mov_b32 v59, 0
    v_lshlrev_b32 v60, 16, v26
    v_mov_b32 v61, 0
    v_mov_b32 v62, 0
    v_mov_b32 v63, 0
    v_exp_f32 v20, v20
    v_exp_f32 v21, v21
    v_mfma_f32_16x16x32_bf16 v[244:247], v[44:47], a[240:243], v[244:247]
    v_mov_b32 v32, 0
    v_mov_b32 v33, v26
    v_mov_b32 v34, 0
    v_mov_b32 v35, 0
    v_mov_b32 v36, 0
    v_lshlrev_b32 v37, 16, v26
    v_mov_b32 v38, 0
    v_mfma_f32_16x16x32_bf16 v[252:255], v[44:47], a[244:247], v[252:255]
    v_mov_b32 v39, 0
    v_add_f32 v10, 1.0, v10
    v_add_f32 v11, 1.0, v11
    v_add_f32 v12, 1.0, v12
    s_add_u32 s10, s16, 16384
    s_addc_u32 s11, s17, 0
    global_load_dwordx4 a[64:67], v1, s[10:11] offset:-4096 sc1
    v_mfma_f32_16x16x32_bf16 v[240:243], v[48:51], a[248:251], v[240:243]
    ds_read_b64_tr_b16 v[40:41], v14 offset:0
    v_add_f32 v13, 1.0, v13
    v_add_f32 v18, 1.0, v18
    v_add_f32 v19, 1.0, v19
    s_add_u32 m0, s39, 32768
    v_mfma_f32_16x16x32_bf16 v[248:251], v[48:51], a[252:255], v[248:251]
    ds_read_b64_tr_b16 v[42:43], v14 offset:4096
    s_add_u32 s8, s44, 2359296
    s_addc_u32 s9, s45, 0
    global_load_lds_dwordx4 v2, s[8:9] offset:0
    v_mfma_f32_16x16x32_bf16 v[244:247], v[52:55], a[248:251], v[244:247]
    ds_read_b64_tr_b16 v[44:45], v15 offset:0
    v_add_f32 v20, 1.0, v20
    v_add_f32 v21, 1.0, v21
    v_mfma_f32_16x16x32_bf16 v[252:255], v[52:55], a[252:255], v[252:255]
    ds_read_b64_tr_b16 v[46:47], v15 offset:4096
    v_rcp_f32 v10, v10
    v_mfma_f32_16x16x32_bf16 v[96:99], v[28:31], v[56:59], 0
    ds_read_b64_tr_b16 v[48:49], v16 offset:0
    v_rcp_f32 v11, v11
    v_mfma_f32_16x16x32_bf16 v[104:107], v[28:31], v[56:59], 0
    ds_read_b64_tr_b16 v[50:51], v16 offset:4096
    v_rcp_f32 v12, v12
    v_mfma_f32_16x16x32_bf16 v[100:103], v[28:31], v[60:63], 0
    ds_read_b64_tr_b16 v[52:53], v17 offset:0
    v_rcp_f32 v13, v13
    v_mfma_f32_16x16x32_bf16 v[108:111], v[28:31], v[60:63], 0
    ds_read_b64_tr_b16 v[54:55], v17 offset:4096
    v_mfma_f32_16x16x32_bf16 v[112:115], v[28:31], v[32:35], 0
    ds_read_b64_tr_b16 v[56:57], v14 offset:512
    v_rcp_f32 v18, v18
    v_mfma_f32_16x16x32_bf16 v[120:123], v[28:31], v[32:35], 0
    ds_read_b64_tr_b16 v[58:59], v14 offset:4608
    v_rcp_f32 v19, v19
    v_mfma_f32_16x16x32_bf16 v[116:119], v[28:31], v[36:39], 0
    ds_read_b64_tr_b16 v[60:61], v15 offset:512
    v_rcp_f32 v20, v20
    v_mfma_f32_16x16x32_bf16 v[124:127], v[28:31], v[36:39], 0
    ds_read_b64_tr_b16 v[62:63], v15 offset:4608
    v_rcp_f32 v21, v21
    s_waitcnt lgkmcnt(4)
    v_mfma_f32_16x16x32_bf16 v[96:99], v[40:43], a[0:3], v[96:99]
    ds_read_b64_tr_b16 v[32:33], v16 offset:512
    v_mul_f32 v10, v176, v10
    v_mul_f32 v11, v177, v11
    v_mfma_f32_16x16x32_bf16 v[104:107], v[40:43], a[4:7], v[104:107]
    ds_read_b64_tr_b16 v[34:35], v16 offset:4608
    global_load_dwordx4 a[68:71], v1, s[10:11] offset:-3072 sc1
    v_mfma_f32_16x16x32_bf16 v[100:103], v[44:47], a[0:3], v[100:103]
    ds_read_b64_tr_b16 v[36:37], v17 offset:512
    v_mul_f32 v12, v178, v12
    v_mul_f32 v13, v179, v13
    v_mfma_f32_16x16x32_bf16 v[108:111], v[44:47], a[4:7], v[108:111]
    ds_read_b64_tr_b16 v[38:39], v17 offset:4608
    v_mul_f32 v18, v180, v18
    v_mul_f32 v19, v181, v19
    v_mfma_f32_16x16x32_bf16 v[112:115], v[48:51], a[0:3], v[112:115]
    ds_read_b64_tr_b16 v[40:41], v14 offset:8192
    v_mul_f32 v20, v182, v20
    v_mul_f32 v21, v183, v21
    v_cvt_pk_bf16_f32 v176, v10, v11
    v_mfma_f32_16x16x32_bf16 v[120:123], v[48:51], a[4:7], v[120:123]
    ds_read_b64_tr_b16 v[42:43], v14 offset:12288
    global_load_lds_dwordx4 v3, s[8:9] offset:1024
    v_mfma_f32_16x16x32_bf16 v[116:119], v[52:55], a[0:3], v[116:119]
    ds_read_b64_tr_b16 v[44:45], v15 offset:8192
    v_cvt_pk_bf16_f32 v177, v12, v13
    v_cvt_pk_bf16_f32 v178, v18, v19
    v_mfma_f32_16x16x32_bf16 v[124:127], v[52:55], a[4:7], v[124:127]
    ds_read_b64_tr_b16 v[46:47], v15 offset:12288
    v_cvt_pk_bf16_f32 v179, v20, v21
    s_waitcnt lgkmcnt(4)
    v_mfma_f32_16x16x32_bf16 v[128:131], v[56:59], a[0:3], 0
    ds_read_b64_tr_b16 v[48:49], v16 offset:8192
    global_store_dwordx4 v1, v[176:179], s[6:7] offset:2048 sc1
    v_mul_f32 v10, v184, v184
    v_mfma_f32_16x16x32_bf16 v[136:139], v[56:59], a[4:7], 0
    ds_read_b64_tr_b16 v[50:51], v16 offset:12288
    v_mul_f32 v11, v185, v185
    global_load_dwordx4 a[72:75], v1, s[10:11] offset:-2048 sc1
    v_mfma_f32_16x16x32_bf16 v[132:135], v[60:63], a[0:3], 0
    ds_read_b64_tr_b16 v[52:53], v17 offset:8192
    v_mul_f32 v12, v186, v186
    v_mul_f32 v13, v187, v187
    v_mul_f32 v18, v188, v188
    v_mfma_f32_16x16x32_bf16 v[140:143], v[60:63], a[4:7], 0
    ds_read_b64_tr_b16 v[54:55], v17 offset:12288
    global_load_lds_dwordx4 v4, s[8:9] offset:2048
    v_mfma_f32_16x16x32_bf16 v[144:147], v[32:35], a[0:3], 0
    ds_read_b64_tr_b16 v[56:57], v14 offset:8704
    v_mul_f32 v19, v189, v189
    v_mul_f32 v20, v190, v190
    v_mfma_f32_16x16x32_bf16 v[152:155], v[32:35], a[4:7], 0
    ds_read_b64_tr_b16 v[58:59], v14 offset:12800
    v_mul_f32 v21, v191, v191
    v_mfma_f32_16x16x32_bf16 v[148:151], v[36:39], a[0:3], 0
    ds_read_b64_tr_b16 v[60:61], v15 offset:8704
    v_fma_f32 v10, v10, s42, v23
    v_fma_f32 v11, v11, s42, v23
    v_mfma_f32_16x16x32_bf16 v[156:159], v[36:39], a[4:7], 0
    ds_read_b64_tr_b16 v[62:63], v15 offset:12800
    v_fma_f32 v12, v12, s42, v23
    v_fma_f32 v13, v13, s42, v23
    s_waitcnt lgkmcnt(4)
    v_mfma_f32_16x16x32_bf16 v[96:99], v[40:43], a[8:11], v[96:99]
    ds_read_b64_tr_b16 v[32:33], v16 offset:8704
    v_fma_f32 v18, v18, s42, v23
    v_fma_f32 v19, v19, s42, v23
    v_fma_f32 v20, v20, s42, v23
    global_load_dwordx4 a[76:79], v1, s[10:11] offset:-1024 sc1
    v_mfma_f32_16x16x32_bf16 v[104:107], v[40:43], a[12:15], v[104:107]
    ds_read_b64_tr_b16 v[34:35], v16 offset:12800
    global_load_lds_dwordx4 v5, s[8:9] offset:3072
    s_add_u32 m0, s39, 36864
    v_mfma_f32_16x16x32_bf16 v[100:103], v[44:47], a[8:11], v[100:103]
    ds_read_b64_tr_b16 v[36:37], v17 offset:8704
    v_fma_f32 v21, v21, s42, v23
    v_mul_f32 v10, v184, v10
    v_mfma_f32_16x16x32_bf16 v[108:111], v[44:47], a[12:15], v[108:111]
    ds_read_b64_tr_b16 v[38:39], v17 offset:12800
    v_mul_f32 v11, v185, v11
    v_mfma_f32_16x16x32_bf16 v[112:115], v[48:51], a[8:11], v[112:115]
    ds_read_b64_tr_b16 v[40:41], v14 offset:16384
    v_mul_f32 v12, v186, v12
    v_mul_f32 v13, v187, v13
    v_mfma_f32_16x16x32_bf16 v[120:123], v[48:51], a[12:15], v[120:123]
    ds_read_b64_tr_b16 v[42:43], v14 offset:20480
    v_mul_f32 v18, v188, v18
    v_mul_f32 v19, v189, v19
    v_mfma_f32_16x16x32_bf16 v[116:119], v[52:55], a[8:11], v[116:119]
    ds_read_b64_tr_b16 v[44:45], v15 offset:16384
    v_mul_f32 v20, v190, v20
    v_mul_f32 v21, v191, v21
    v_mfma_f32_16x16x32_bf16 v[124:127], v[52:55], a[12:15], v[124:127]
    ds_read_b64_tr_b16 v[46:47], v15 offset:20480
    v_exp_f32 v10, v10
    global_load_dwordx4 a[80:83], v1, s[10:11] offset:0 sc1
    s_waitcnt lgkmcnt(4)
    v_mfma_f32_16x16x32_bf16 v[128:131], v[56:59], a[8:11], v[128:131]
    ds_read_b64_tr_b16 v[48:49], v16 offset:16384
    v_exp_f32 v11, v11
    v_mfma_f32_16x16x32_bf16 v[136:139], v[56:59], a[12:15], v[136:139]
    ds_read_b64_tr_b16 v[50:51], v16 offset:20480
    v_mfma_f32_16x16x32_bf16 v[132:135], v[60:63], a[8:11], v[132:135]
    ds_read_b64_tr_b16 v[52:53], v17 offset:16384
    v_exp_f32 v12, v12
    v_exp_f32 v13, v13
    v_mfma_f32_16x16x32_bf16 v[140:143], v[60:63], a[12:15], v[140:143]
    ds_read_b64_tr_b16 v[54:55], v17 offset:20480
    global_load_lds_dwordx4 v6, s[8:9] offset:0
    v_mfma_f32_16x16x32_bf16 v[144:147], v[32:35], a[8:11], v[144:147]
    ds_read_b64_tr_b16 v[56:57], v14 offset:16896
    v_exp_f32 v18, v18
    v_mfma_f32_16x16x32_bf16 v[152:155], v[32:35], a[12:15], v[152:155]
    ds_read_b64_tr_b16 v[58:59], v14 offset:20992
    v_exp_f32 v19, v19
    v_mfma_f32_16x16x32_bf16 v[148:151], v[36:39], a[8:11], v[148:151]
    ds_read_b64_tr_b16 v[60:61], v15 offset:16896
    v_exp_f32 v20, v20
    v_mfma_f32_16x16x32_bf16 v[156:159], v[36:39], a[12:15], v[156:159]
    ds_read_b64_tr_b16 v[62:63], v15 offset:20992
    global_load_dwordx4 a[84:87], v1, s[10:11] offset:1024 sc1
    s_waitcnt lgkmcnt(4)
    v_mfma_f32_16x16x32_bf16 v[96:99], v[40:43], a[16:19], v[96:99]
    ds_read_b64_tr_b16 v[32:33], v16 offset:16896
    v_exp_f32 v21, v21
    v_mfma_f32_16x16x32_bf16 v[104:107], v[40:43], a[20:23], v[104:107]
    ds_read_b64_tr_b16 v[34:35], v16 offset:20992
    v_add_f32 v10, 1.0, v10
    v_add_f32 v11, 1.0, v11
    v_mfma_f32_16x16x32_bf16 v[100:103], v[44:47], a[16:19], v[100:103]
    ds_read_b64_tr_b16 v[36:37], v17 offset:16896
    v_add_f32 v12, 1.0, v12
    v_add_f32 v13, 1.0, v13
    v_add_f32 v18, 1.0, v18
    v_mfma_f32_16x16x32_bf16 v[108:111], v[44:47], a[20:23], v[108:111]
    ds_read_b64_tr_b16 v[38:39], v17 offset:20992
    global_load_lds_dwordx4 v7, s[8:9] offset:1024
    v_mfma_f32_16x16x32_bf16 v[112:115], v[48:51], a[16:19], v[112:115]
    ds_read_b64_tr_b16 v[40:41], v14 offset:24576
    v_add_f32 v19, 1.0, v19
    v_add_f32 v20, 1.0, v20
    v_mfma_f32_16x16x32_bf16 v[120:123], v[48:51], a[20:23], v[120:123]
    ds_read_b64_tr_b16 v[42:43], v14 offset:28672
    v_add_f32 v21, 1.0, v21
    v_mfma_f32_16x16x32_bf16 v[116:119], v[52:55], a[16:19], v[116:119]
    ds_read_b64_tr_b16 v[44:45], v15 offset:24576
    v_rcp_f32 v10, v10
    v_mfma_f32_16x16x32_bf16 v[124:127], v[52:55], a[20:23], v[124:127]
    ds_read_b64_tr_b16 v[46:47], v15 offset:28672
    v_rcp_f32 v11, v11
    global_load_dwordx4 a[88:91], v1, s[10:11] offset:2048 sc1
    s_waitcnt lgkmcnt(4)
    v_mfma_f32_16x16x32_bf16 v[128:131], v[56:59], a[16:19], v[128:131]
    ds_read_b64_tr_b16 v[48:49], v16 offset:24576
    v_rcp_f32 v12, v12
    v_rcp_f32 v13, v13
    v_mfma_f32_16x16x32_bf16 v[136:139], v[56:59], a[20:23], v[136:139]
    ds_read_b64_tr_b16 v[50:51], v16 offset:28672
    global_load_lds_dwordx4 v8, s[8:9] offset:2048
    v_mfma_f32_16x16x32_bf16 v[132:135], v[60:63], a[16:19], v[132:135]
    ds_read_b64_tr_b16 v[52:53], v17 offset:24576
    v_rcp_f32 v18, v18
    v_mfma_f32_16x16x32_bf16 v[140:143], v[60:63], a[20:23], v[140:143]
    ds_read_b64_tr_b16 v[54:55], v17 offset:28672
    v_mfma_f32_16x16x32_bf16 v[144:147], v[32:35], a[16:19], v[144:147]
    ds_read_b64_tr_b16 v[56:57], v14 offset:25088
    v_rcp_f32 v19, v19
    v_mfma_f32_16x16x32_bf16 v[152:155], v[32:35], a[20:23], v[152:155]
    ds_read_b64_tr_b16 v[58:59], v14 offset:29184
    v_rcp_f32 v20, v20
    v_mfma_f32_16x16x32_bf16 v[148:151], v[36:39], a[16:19], v[148:151]
    ds_read_b64_tr_b16 v[60:61], v15 offset:25088
    v_rcp_f32 v21, v21
    v_mul_f32 v10, v184, v10
    v_mfma_f32_16x16x32_bf16 v[156:159], v[36:39], a[20:23], v[156:159]
    ds_read_b64_tr_b16 v[62:63], v15 offset:29184
    global_load_dwordx4 a[92:95], v1, s[10:11] offset:3072 sc1
    global_load_lds_dwordx4 v9, s[8:9] offset:3072
    s_waitcnt lgkmcnt(4)
    v_mfma_f32_16x16x32_bf16 v[96:99], v[40:43], a[24:27], v[96:99]
    ds_read_b64_tr_b16 v[32:33], v16 offset:25088
    v_mul_f32 v11, v185, v11
    v_mul_f32 v12, v186, v12
    v_mfma_f32_16x16x32_bf16 v[104:107], v[40:43], a[28:31], v[104:107]
    ds_read_b64_tr_b16 v[34:35], v16 offset:29184
    v_mul_f32 v13, v187, v13
    v_mfma_f32_16x16x32_bf16 v[100:103], v[44:47], a[24:27], v[100:103]
    ds_read_b64_tr_b16 v[36:37], v17 offset:25088
    v_mul_f32 v18, v188, v18
    v_mul_f32 v19, v189, v19
    v_mfma_f32_16x16x32_bf16 v[108:111], v[44:47], a[28:31], v[108:111]
    ds_read_b64_tr_b16 v[38:39], v17 offset:29184
    v_mul_f32 v20, v190, v20
    v_mul_f32 v21, v191, v21
    v_mfma_f32_16x16x32_bf16 v[112:115], v[48:51], a[24:27], v[112:115]
    v_cvt_pk_bf16_f32 v180, v10, v11
    v_cvt_pk_bf16_f32 v181, v12, v13
    v_mfma_f32_16x16x32_bf16 v[120:123], v[48:51], a[28:31], v[120:123]
    v_cvt_pk_bf16_f32 v182, v18, v19
    v_mfma_f32_16x16x32_bf16 v[116:119], v[52:55], a[24:27], v[116:119]
    v_cvt_pk_bf16_f32 v183, v20, v21
    v_mfma_f32_16x16x32_bf16 v[124:127], v[52:55], a[28:31], v[124:127]
    global_store_dwordx4 v1, v[180:183], s[6:7] offset:3072 sc1
    s_waitcnt lgkmcnt(0)
    v_mfma_f32_16x16x32_bf16 v[128:131], v[56:59], a[24:27], v[128:131]
    v_mfma_f32_16x16x32_bf16 v[136:139], v[56:59], a[28:31], v[136:139]
    s_waitcnt vmcnt(19)
    s_barrier
    s_getpc_b64 vcc
L_ct6:
    s_min_u32 s32, s82, L_end-L_ct6
    v_mov_b32 v0, s32
    global_load_dword v22, v0, vcc
    buffer_load_dword v197, v196, s[12:15], s40 offen sc1
    ds_read_b64_tr_b16 v[40:41], v14 offset:32768
    ds_read_b64_tr_b16 v[42:43], v14 offset:36864
    ds_read_b64_tr_b16 v[44:45], v15 offset:32768
    ds_read_b64_tr_b16 v[46:47], v15 offset:36864
    v_mul_f32 v10, v240, v240
    v_mul_f32 v11, v241, v241
    v_mul_f32 v12, v242, v242
    v_mfma_f32_16x16x32_bf16 v[132:135], v[60:63], a[24:27], v[132:135]
    ds_read_b64_tr_b16 v[48:49], v16 offset:32768
    ds_read_b64_tr_b16 v[50:51], v16 offset:36864
    v_mul_f32 v13, v243, v243
    v_mul_f32 v18, v244, v244
    s_add_u32 s10, s16, 24576
    v_mfma_f32_16x16x32_bf16 v[140:143], v[60:63], a[28:31], v[140:143]
    ds_read_b64_tr_b16 v[52:53], v17 offset:32768
    ds_read_b64_tr_b16 v[54:55], v17 offset:36864
    s_addc_u32 s11, s17, 0
    global_load_dwordx4 a[96:99], v1, s[10:11] offset:-4096 sc1
    v_mfma_f32_16x16x32_bf16 v[144:147], v[32:35], a[24:27], v[144:147]
    ds_read_b64_tr_b16 v[56:57], v14 offset:33280
    v_mul_f32 v19, v245, v245
    v_mul_f32 v20, v246, v246
    v_mul_f32 v21, v247, v247
    s_add_u32 m0, s39, 65536
    v_mfma_f32_16x16x32_bf16 v[152:155], v[32:35], a[28:31], v[152:155]
    ds_read_b64_tr_b16 v[58:59], v14 offset:37376
    s_add_u32 s8, s44, 131072
    s_addc_u32 s9, s45, 0
    global_load_lds_dwordx4 v2, s[8:9] offset:0
    v_mfma_f32_16x16x32_bf16 v[148:151], v[36:39], a[24:27], v[148:151]
    ds_read_b64_tr_b16 v[60:61], v15 offset:33280
    v_fma_f32 v10, v10, s42, v23
    v_mfma_f32_16x16x32_bf16 v[156:159], v[36:39], a[28:31], v[156:159]
    ds_read_b64_tr_b16 v[62:63], v15 offset:37376
    v_fma_f32 v11, v11, s42, v23
    s_waitcnt lgkmcnt(4)
    v_mfma_f32_16x16x32_bf16 v[96:99], v[40:43], a[32:35], v[96:99]
    ds_read_b64_tr_b16 v[32:33], v16 offset:33280
    v_fma_f32 v12, v12, s42, v23
    v_fma_f32 v13, v13, s42, v23
    v_mfma_f32_16x16x32_bf16 v[104:107], v[40:43], a[36:39], v[104:107]
    ds_read_b64_tr_b16 v[34:35], v16 offset:37376
    v_fma_f32 v18, v18, s42, v23
    v_mfma_f32_16x16x32_bf16 v[100:103], v[44:47], a[32:35], v[100:103]
    ds_read_b64_tr_b16 v[36:37], v17 offset:33280
    v_fma_f32 v19, v19, s42, v23
    v_mfma_f32_16x16x32_bf16 v[108:111], v[44:47], a[36:39], v[108:111]
    ds_read_b64_tr_b16 v[38:39], v17 offset:37376
    v_fma_f32 v20, v20, s42, v23
    v_mfma_f32_16x16x32_bf16 v[112:115], v[48:51], a[32:35], v[112:115]
    ds_read_b64_tr_b16 v[40:41], v14 offset:40960
    v_fma_f32 v21, v21, s42, v23
    v_mul_f32 v10, v240, v10
    v_mfma_f32_16x16x32_bf16 v[120:123], v[48:51], a[36:39], v[120:123]
    ds_read_b64_tr_b16 v[42:43], v14 offset:45056
    v_mul_f32 v11, v241, v11
    v_mfma_f32_16x16x32_bf16 v[116:119], v[52:55], a[32:35], v[116:119]
    ds_read_b64_tr_b16 v[44:45], v15 offset:40960
    v_mul_f32 v12, v242, v12
    v_mul_f32 v13, v243, v13
    v_mfma_f32_16x16x32_bf16 v[124:127], v[52:55], a[36:39], v[124:127]
    ds_read_b64_tr_b16 v[46:47], v15 offset:45056
    global_load_dwordx4 a[100:103], v1, s[10:11] offset:-3072 sc1
    s_waitcnt lgkmcnt(4)
    v_mfma_f32_16x16x32_bf16 v[128:131], v[56:59], a[32:35], v[128:131]
    ds_read_b64_tr_b16 v[48:49], v16 offset:40960
    v_mul_f32 v18, v244, v18
    v_mul_f32 v19, v245, v19
    v_mfma_f32_16x16x32_bf16 v[136:139], v[56:59], a[36:39], v[136:139]
    ds_read_b64_tr_b16 v[50:51], v16 offset:45056
    v_mul_f32 v20, v246, v20
    v_mfma_f32_16x16x32_bf16 v[132:135], v[60:63], a[32:35], v[132:135]
    ds_read_b64_tr_b16 v[52:53], v17 offset:40960
    v_mul_f32 v21, v247, v21
    v_exp_f32 v10, v10
    v_mfma_f32_16x16x32_bf16 v[140:143], v[60:63], a[36:39], v[140:143]
    ds_read_b64_tr_b16 v[54:55], v17 offset:45056
    global_load_lds_dwordx4 v3, s[8:9] offset:1024
    v_mfma_f32_16x16x32_bf16 v[144:147], v[32:35], a[32:35], v[144:147]
    ds_read_b64_tr_b16 v[56:57], v14 offset:41472
    v_exp_f32 v11, v11
    v_mfma_f32_16x16x32_bf16 v[152:155], v[32:35], a[36:39], v[152:155]
    ds_read_b64_tr_b16 v[58:59], v14 offset:45568
    v_mfma_f32_16x16x32_bf16 v[148:151], v[36:39], a[32:35], v[148:151]
    ds_read_b64_tr_b16 v[60:61], v15 offset:41472
    v_exp_f32 v12, v12
    v_mfma_f32_16x16x32_bf16 v[156:159], v[36:39], a[36:39], v[156:159]
    ds_read_b64_tr_b16 v[62:63], v15 offset:45568
    global_load_dwordx4 a[104:107], v1, s[10:11] offset:-2048 sc1
    s_waitcnt lgkmcnt(4)
    v_mfma_f32_16x16x32_bf16 v[96:99], v[40:43], a[40:43], v[96:99]
    ds_read_b64_tr_b16 v[32:33], v16 offset:41472
    v_exp_f32 v13, v13
    v_exp_f32 v18, v18
    v_mfma_f32_16x16x32_bf16 v[104:107], v[40:43], a[44:47], v[104:107]
    ds_read_b64_tr_b16 v[34:35], v16 offset:45568
    global_load_lds_dwordx4 v4, s[8:9] offset:2048
    v_mfma_f32_16x16x32_bf16 v[100:103], v[44:47], a[40:43], v[100:103]
    ds_read_b64_tr_b16 v[36:37], v17 offset:41472
    v_exp_f32 v19, v19
    v_mfma_f32_16x16x32_bf16 v[108:111], v[44:47], a[44:47], v[108:111]
    ds_read_b64_tr_b16 v[38:39], v17 offset:45568
    v_mfma_f32_16x16x32_bf16 v[112:115], v[48:51], a[40:43], v[112:115]
    ds_read_b64_tr_b16 v[40:41], v14 offset:49152
    v_exp_f32 v20, v20
    v_mfma_f32_16x16x32_bf16 v[120:123], v[48:51], a[44:47], v[120:123]
    ds_read_b64_tr_b16 v[42:43], v14 offset:53248
    global_load_dwordx4 a[108:111], v1, s[10:11] offset:-1024 sc1
    v_mfma_f32_16x16x32_bf16 v[116:119], v[52:55], a[40:43], v[116:119]
    ds_read_b64_tr_b16 v[44:45], v15 offset:49152
    v_exp_f32 v21, v21
    v_mfma_f32_16x16x32_bf16 v[124:127], v[52:55], a[44:47], v[124:127]
    ds_read_b64_tr_b16 v[46:47], v15 offset:53248
    global_load_lds_dwordx4 v5, s[8:9] offset:3072
    s_add_u32 m0, s39, 69632
    s_waitcnt lgkmcnt(4)
    v_mfma_f32_16x16x32_bf16 v[128:131], v[56:59], a[40:43], v[128:131]
    ds_read_b64_tr_b16 v[48:49], v16 offset:49152
    v_add_f32 v10, 1.0, v10
    v_add_f32 v11, 1.0, v11
    v_mfma_f32_16x16x32_bf16 v[136:139], v[56:59], a[44:47], v[136:139]
    ds_read_b64_tr_b16 v[50:51], v16 offset:53248
    v_add_f32 v12, 1.0, v12
    v_mfma_f32_16x16x32_bf16 v[132:135], v[60:63], a[40:43], v[132:135]
    ds_read_b64_tr_b16 v[52:53], v17 offset:49152
    v_add_f32 v13, 1.0, v13
    v_add_f32 v18, 1.0, v18
    v_mfma_f32_16x16x32_bf16 v[140:143], v[60:63], a[44:47], v[140:143]
    ds_read_b64_tr_b16 v[54:55], v17 offset:53248
    global_load_dwordx4 a[112:115], v1, s[10:11] offset:0 sc1
    v_mfma_f32_16x16x32_bf16 v[144:147], v[32:35], a[40:43], v[144:147]
    ds_read_b64_tr_b16 v[56:57], v14 offset:49664
    v_add_f32 v19, 1.0, v19
    v_add_f32 v20, 1.0, v20
    v_mfma_f32_16x16x32_bf16 v[152:155], v[32:35], a[44:47], v[152:155]
    ds_read_b64_tr_b16 v[58:59], v14 offset:53760
    v_add_f32 v21, 1.0, v21
    v_mfma_f32_16x16x32_bf16 v[148:151], v[36:39], a[40:43], v[148:151]
    ds_read_b64_tr_b16 v[60:61], v15 offset:49664
    v_rcp_f32 v10, v10
    v_mfma_f32_16x16x32_bf16 v[156:159], v[36:39], a[44:47], v[156:159]
    ds_read_b64_tr_b16 v[62:63], v15 offset:53760
    global_load_lds_dwordx4 v6, s[8:9] offset:0
    s_waitcnt lgkmcnt(4)
    v_mfma_f32_16x16x32_bf16 v[96:99], v[40:43], a[48:51], v[96:99]
    ds_read_b64_tr_b16 v[32:33], v16 offset:49664
    v_rcp_f32 v11, v11
    v_mfma_f32_16x16x32_bf16 v[104:107], v[40:43], a[52:55], v[104:107]
    ds_read_b64_tr_b16 v[34:35], v16 offset:53760
    v_rcp_f32 v12, v12
    v_mfma_f32_16x16x32_bf16 v[100:103], v[44:47], a[48:51], v[100:103]
    ds_read_b64_tr_b16 v[36:37], v17 offset:49664
    v_rcp_f32 v13, v13
    v_mfma_f32_16x16x32_bf16 v[108:111], v[44:47], a[52:55], v[108:111]
    ds_read_b64_tr_b16 v[38:39], v17 offset:53760
    global_load_dwordx4 a[116:119], v1, s[10:11] offset:1024 sc1
    v_mfma_f32_16x16x32_bf16 v[112:115], v[48:51], a[48:51], v[112:115]
    ds_read_b64_tr_b16 v[40:41], v14 offset:57344
    v_rcp_f32 v18, v18
    v_mfma_f32_16x16x32_bf16 v[120:123], v[48:51], a[52:55], v[120:123]
    ds_read_b64_tr_b16 v[42:43], v14 offset:61440
    global_load_lds_dwordx4 v7, s[8:9] offset:1024
    v_mfma_f32_16x16x32_bf16 v[116:119], v[52:55], a[48:51], v[116:119]
    ds_read_b64_tr_b16 v[44:45], v15 offset:57344
    v_rcp_f32 v19, v19
    v_mfma_f32_16x16x32_bf16 v[124:127], v[52:55], a[52:55], v[124:127]
    ds_read_b64_tr_b16 v[46:47], v15 offset:61440
    s_waitcnt lgkmcnt(4)
    v_mfma_f32_16x16x32_bf16 v[128:131], v[56:59], a[48:51], v[128:131]
    ds_read_b64_tr_b16 v[48:49], v16 offset:57344
    v_rcp_f32 v20, v20
    v_mfma_f32_16x16x32_bf16 v[136:139], v[56:59], a[52:55], v[136:139]
    ds_read_b64_tr_b16 v[50:51], v16 offset:61440
    v_rcp_f32 v21, v21
    global_load_dwordx4 a[120:123], v1, s[10:11] offset:2048 sc1
    v_mfma_f32_16x16x32_bf16 v[132:135], v[60:63], a[48:51], v[132:135]
    ds_read_b64_tr_b16 v[52:53], v17 offset:57344
    v_mul_f32 v10, v240, v10
    v_mfma_f32_16x16x32_bf16 v[140:143], v[60:63], a[52:55], v[140:143]
    ds_read_b64_tr_b16 v[54:55], v17 offset:61440
    global_load_lds_dwordx4 v8, s[8:9] offset:2048
    v_mfma_f32_16x16x32_bf16 v[144:147], v[32:35], a[48:51], v[144:147]
    ds_read_b64_tr_b16 v[56:57], v14 offset:57856
    v_mul_f32 v11, v241, v11
    v_mul_f32 v12, v242, v12
    v_mfma_f32_16x16x32_bf16 v[152:155], v[32:35], a[52:55], v[152:155]
    ds_read_b64_tr_b16 v[58:59], v14 offset:61952
    v_mul_f32 v13, v243, v13
    v_mfma_f32_16x16x32_bf16 v[148:151], v[36:39], a[48:51], v[148:151]
    ds_read_b64_tr_b16 v[60:61], v15 offset:57856
    v_mul_f32 v18, v244, v18
    v_mul_f32 v19, v245, v19
    v_mfma_f32_16x16x32_bf16 v[156:159], v[36:39], a[52:55], v[156:159]
    ds_read_b64_tr_b16 v[62:63], v15 offset:61952
    global_load_dwordx4 a[124:127], v1, s[10:11] offset:3072 sc1
    s_waitcnt lgkmcnt(4)
    v_mfma_f32_16x16x32_bf16 v[96:99], v[40:43], a[56:59], v[96:99]
    ds_read_b64_tr_b16 v[32:33], v16 offset:57856
    v_mul_f32 v20, v246, v20
    v_mul_f32 v21, v247, v21
    v_cvt_pk_bf16_f32 v240, v10, v11
    v_mfma_f32_16x16x32_bf16 v[104:107], v[40:43], a[60:63], v[104:107]
    ds_read_b64_tr_b16 v[34:35], v16 offset:61952
    global_load_lds_dwordx4 v9, s[8:9] offset:3072
    v_mfma_f32_16x16x32_bf16 v[100:103], v[44:47], a[56:59], v[100:103]
    ds_read_b64_tr_b16 v[36:37], v17 offset:57856
    v_cvt_pk_bf16_f32 v241, v12, v13
    v_mfma_f32_16x16x32_bf16 v[108:111], v[44:47], a[60:63], v[108:111]
    ds_read_b64_tr_b16 v[38:39], v17 offset:61952
    v_cvt_pk_bf16_f32 v242, v18, v19
    v_mfma_f32_16x16x32_bf16 v[112:115], v[48:51], a[56:59], v[112:115]
    v_cvt_pk_bf16_f32 v243, v20, v21
    s_lshl_b32 s33, s30, 11
    s_add_u32 s6, s18, s33
    v_mfma_f32_16x16x32_bf16 v[120:123], v[48:51], a[60:63], v[120:123]
    s_addc_u32 s7, s19, 0
    global_store_dwordx4 v1, v[240:243], s[6:7] offset:-4096 sc1
    v_mfma_f32_16x16x32_bf16 v[116:119], v[52:55], a[56:59], v[116:119]
    v_mfma_f32_16x16x32_bf16 v[124:127], v[52:55], a[60:63], v[124:127]
    s_waitcnt lgkmcnt(0)
    v_mfma_f32_16x16x32_bf16 v[128:131], v[56:59], a[56:59], v[128:131]
    v_add_u32 v14, 4294901760, v14
    v_add_u32 v15, 4294901760, v15
    v_add_u32 v16, 4294901760, v16
    v_add_u32 v17, 4294901760, v17
    s_waitcnt vmcnt(17)
    v_cmp_gt_u32 vcc, 2, v197
    s_nop 0
    s_and_b32 s32, vcc_lo, s1
    s_cbranch_scc1 L_poll_4
L_poll_4_ok:
    v_mfma_f32_16x16x32_bf16 v[136:139], v[56:59], a[60:63], v[136:139]
    s_barrier
    s_and_b32 s32, s28, 1
    s_xor_b32 s35, s30, 4
    s_lshl_b32 s35, s35, 1
    s_add_u32 s35, s35, s32
    s_lshl_b32 s35, s35, 11
    s_add_u32 s35, s35, 20316160
    buffer_load_dwordx4 v[72:75], v1, s[12:15], s35 offen offset:0 sc1
    buffer_load_dwordx4 v[76:79], v1, s[12:15], s35 offen offset:1024 sc1
    ds_read_b64_tr_b16 v[40:41], v14 offset:0
    ds_read_b64_tr_b16 v[42:43], v14 offset:4096
    ds_read_b64_tr_b16 v[44:45], v15 offset:0
    ds_read_b64_tr_b16 v[46:47], v15 offset:4096
    v_mul_f32 v10, v248, v248
    v_mfma_f32_16x16x32_bf16 v[132:135], v[60:63], a[56:59], v[132:135]
    ds_read_b64_tr_b16 v[48:49], v16 offset:0
    ds_read_b64_tr_b16 v[50:51], v16 offset:4096
    v_mul_f32 v11, v249, v249
    v_mul_f32 v12, v250, v250
    v_mul_f32 v13, v251, v251
    v_mfma_f32_16x16x32_bf16 v[140:143], v[60:63], a[60:63], v[140:143]
    ds_read_b64_tr_b16 v[52:53], v17 offset:0
    ds_read_b64_tr_b16 v[54:55], v17 offset:4096
    s_add_u32 s10, s16, 32768
    s_addc_u32 s11, s17, 0
    global_load_dwordx4 a[128:131], v1, s[10:11] offset:-4096 sc1
    v_mfma_f32_16x16x32_bf16 v[144:147], v[32:35], a[56:59], v[144:147]
    ds_read_b64_tr_b16 v[56:57], v14 offset:512
    v_mul_f32 v18, v252, v252
    v_mul_f32 v19, v253, v253
    s_add_u32 m0, s39, 98304
    s_add_u32 s8, s44, 917504
    v_mfma_f32_16x16x32_bf16 v[152:155], v[32:35], a[60:63], v[152:155]
    ds_read_b64_tr_b16 v[58:59], v14 offset:4608
    s_addc_u32 s9, s45, 0
    global_load_lds_dwordx4 v2, s[8:9] offset:0
    v_mfma_f32_16x16x32_bf16 v[148:151], v[36:39], a[56:59], v[148:151]
    ds_read_b64_tr_b16 v[60:61], v15 offset:512
    v_mul_f32 v20, v254, v254
    v_mul_f32 v21, v255, v255
    v_mfma_f32_16x16x32_bf16 v[156:159], v[36:39], a[60:63], v[156:159]
    ds_read_b64_tr_b16 v[62:63], v15 offset:4608
    v_fma_f32 v10, v10, s42, v23
    s_waitcnt lgkmcnt(4)
    v_mfma_f32_16x16x32_bf16 v[96:99], v[40:43], a[64:67], v[96:99]
    ds_read_b64_tr_b16 v[32:33], v16 offset:512
    v_fma_f32 v11, v11, s42, v23
    v_mfma_f32_16x16x32_bf16 v[104:107], v[40:43], a[68:71], v[104:107]
    ds_read_b64_tr_b16 v[34:35], v16 offset:4608
    v_fma_f32 v12, v12, s42, v23
    v_mfma_f32_16x16x32_bf16 v[100:103], v[44:47], a[64:67], v[100:103]
    ds_read_b64_tr_b16 v[36:37], v17 offset:512
    v_fma_f32 v13, v13, s42, v23
    v_fma_f32 v18, v18, s42, v23
    v_mfma_f32_16x16x32_bf16 v[108:111], v[44:47], a[68:71], v[108:111]
    ds_read_b64_tr_b16 v[38:39], v17 offset:4608
    v_fma_f32 v19, v19, s42, v23
    v_mfma_f32_16x16x32_bf16 v[112:115], v[48:51], a[64:67], v[112:115]
    ds_read_b64_tr_b16 v[40:41], v14 offset:8192
    v_fma_f32 v20, v20, s42, v23
    v_mfma_f32_16x16x32_bf16 v[120:123], v[48:51], a[68:71], v[120:123]
    ds_read_b64_tr_b16 v[42:43], v14 offset:12288
    v_fma_f32 v21, v21, s42, v23
    v_mfma_f32_16x16x32_bf16 v[116:119], v[52:55], a[64:67], v[116:119]
    ds_read_b64_tr_b16 v[44:45], v15 offset:8192
    v_mul_f32 v10, v248, v10
    v_mul_f32 v11, v249, v11
    v_mfma_f32_16x16x32_bf16 v[124:127], v[52:55], a[68:71], v[124:127]
    ds_read_b64_tr_b16 v[46:47], v15 offset:12288
    v_mul_f32 v12, v250, v12
    global_load_dwordx4 a[132:135], v1, s[10:11] offset:-3072 sc1
    s_waitcnt lgkmcnt(4)
    v_mfma_f32_16x16x32_bf16 v[128:131], v[56:59], a[64:67], v[128:131]
    ds_read_b64_tr_b16 v[48:49], v16 offset:8192
    v_mul_f32 v13, v251, v13
    v_mfma_f32_16x16x32_bf16 v[136:139], v[56:59], a[68:71], v[136:139]
    ds_read_b64_tr_b16 v[50:51], v16 offset:12288
    v_mul_f32 v18, v252, v18
    v_mfma_f32_16x16x32_bf16 v[132:135], v[60:63], a[64:67], v[132:135]
    ds_read_b64_tr_b16 v[52:53], v17 offset:8192
    v_mul_f32 v19, v253, v19
    v_mul_f32 v20, v254, v20
    v_mul_f32 v21, v255, v21
    v_mfma_f32_16x16x32_bf16 v[140:143], v[60:63], a[68:71], v[140:143]
    ds_read_b64_tr_b16 v[54:55], v17 offset:12288
    global_load_lds_dwordx4 v3, s[8:9] offset:1024
    v_mfma_f32_16x16x32_bf16 v[144:147], v[32:35], a[64:67], v[144:147]
    ds_read_b64_tr_b16 v[56:57], v14 offset:8704
    v_exp_f32 v10, v10
    v_mfma_f32_16x16x32_bf16 v[152:155], v[32:35], a[68:71], v[152:155]
    ds_read_b64_tr_b16 v[58:59], v14 offset:12800
    v_mfma_f32_16x16x32_bf16 v[148:151], v[36:39], a[64:67], v[148:151]
    ds_read_b64_tr_b16 v[60:61], v15 offset:8704
    v_exp_f32 v11, v11
    v_mfma_f32_16x16x32_bf16 v[156:159], v[36:39], a[68:71], v[156:159]
    ds_read_b64_tr_b16 v[62:63], v15 offset:12800
    v_exp_f32 v12, v12
    global_load_dwordx4 a[136:139], v1, s[10:11] offset:-2048 sc1
    s_waitcnt lgkmcnt(4)
    v_mfma_f32_16x16x32_bf16 v[96:99], v[40:43], a[72:75], v[96:99]
    ds_read_b64_tr_b16 v[32:33], v16 offset:8704
    v_exp_f32 v13, v13
    v_mfma_f32_16x16x32_bf16 v[104:107], v[40:43], a[76:79], v[104:107]
    ds_read_b64_tr_b16 v[34:35], v16 offset:12800
    global_load_lds_dwordx4 v4, s[8:9] offset:2048
    v_mfma_f32_16x16x32_bf16 v[100:103], v[44:47], a[72:75], v[100:103]
    ds_read_b64_tr_b16 v[36:37], v17 offset:8704
    v_exp_f32 v18, v18
    v_mfma_f32_16x16x32_bf16 v[108:111], v[44:47], a[76:79], v[108:111]
    ds_read_b64_tr_b16 v[38:39], v17 offset:12800
    v_mfma_f32_16x16x32_bf16 v[112:115], v[48:51], a[72:75], v[112:115]
    ds_read_b64_tr_b16 v[40:41], v14 offset:16384
    v_exp_f32 v19, v19
    v_mfma_f32_16x16x32_bf16 v[120:123], v[48:51], a[76:79], v[120:123]
    ds_read_b64_tr_b16 v[42:43], v14 offset:20480
    global_load_dwordx4 a[140:143], v1, s[10:11] offset:-1024 sc1
    v_mfma_f32_16x16x32_bf16 v[116:119], v[52:55], a[72:75], v[116:119]
    ds_read_b64_tr_b16 v[44:45], v15 offset:16384
    v_exp_f32 v20, v20
    v_exp_f32 v21, v21
    v_mfma_f32_16x16x32_bf16 v[124:127], v[52:55], a[76:79], v[124:127]
    ds_read_b64_tr_b16 v[46:47], v15 offset:20480
    global_load_lds_dwordx4 v5, s[8:9] offset:3072
    s_add_u32 m0, s39, 102400
    s_waitcnt lgkmcnt(4)
    v_mfma_f32_16x16x32_bf16 v[128:131], v[56:59], a[72:75], v[128:131]
    ds_read_b64_tr_b16 v[48:49], v16 offset:16384
    v_add_f32 v10, 1.0, v10
    v_mfma_f32_16x16x32_bf16 v[136:139], v[56:59], a[76:79], v[136:139]
    ds_read_b64_tr_b16 v[50:51], v16 offset:20480
    v_mfma_f32_16x16x32_bf16 v[132:135], v[60:63], a[72:75], v[132:135]
    ds_read_b64_tr_b16 v[52:53], v17 offset:16384
    v_add_f32 v11, 1.0, v11
    v_add_f32 v12, 1.0, v12
    v_mfma_f32_16x16x32_bf16 v[140:143], v[60:63], a[76:79], v[140:143]
    ds_read_b64_tr_b16 v[54:55], v17 offset:20480
    v_add_f32 v13, 1.0, v13
    global_load_dwordx4 a[144:147], v1, s[10:11] offset:0 sc1
    v_mfma_f32_16x16x32_bf16 v[144:147], v[32:35], a[72:75], v[144:147]
    ds_read_b64_tr_b16 v[56:57], v14 offset:16896
    v_add_f32 v18, 1.0, v18
    v_mfma_f32_16x16x32_bf16 v[152:155], v[32:35], a[76:79], v[152:155]
    ds_read_b64_tr_b16 v[58:59], v14 offset:20992
    v_add_f32 v19, 1.0, v19
    v_mfma_f32_16x16x32_bf16 v[148:151], v[36:39], a[72:75], v[148:151]
    ds_read_b64_tr_b16 v[60:61], v15 offset:16896
    v_add_f32 v20, 1.0, v20
    v_add_f32 v21, 1.0, v21
    v_rcp_f32 v10, v10
    v_mfma_f32_16x16x32_bf16 v[156:159], v[36:39], a[76:79], v[156:159]
    ds_read_b64_tr_b16 v[62:63], v15 offset:20992
    global_load_lds_dwordx4 v6, s[8:9] offset:0
    s_waitcnt lgkmcnt(4)
    v_mfma_f32_16x16x32_bf16 v[96:99], v[40:43], a[80:83], v[96:99]
    ds_read_b64_tr_b16 v[32:33], v16 offset:16896
    v_rcp_f32 v11, v11
    v_mfma_f32_16x16x32_bf16 v[104:107], v[40:43], a[84:87], v[104:107]
    ds_read_b64_tr_b16 v[34:35], v16 offset:20992
    v_mfma_f32_16x16x32_bf16 v[100:103], v[44:47], a[80:83], v[100:103]
    ds_read_b64_tr_b16 v[36:37], v17 offset:16896
    v_rcp_f32 v12, v12
    v_mfma_f32_16x16x32_bf16 v[108:111], v[44:47], a[84:87], v[108:111]
    ds_read_b64_tr_b16 v[38:39], v17 offset:20992
    global_load_dwordx4 a[148:151], v1, s[10:11] offset:1024 sc1
    v_mfma_f32_16x16x32_bf16 v[112:115], v[48:51], a[80:83], v[112:115]
    ds_read_b64_tr_b16 v[40:41], v14 offset:24576
    v_rcp_f32 v13, v13
    v_mfma_f32_16x16x32_bf16 v[120:123], v[48:51], a[84:87], v[120:123]
    ds_read_b64_tr_b16 v[42:43], v14 offset:28672
    global_load_lds_dwordx4 v7, s[8:9] offset:1024
    v_mfma_f32_16x16x32_bf16 v[116:119], v[52:55], a[80:83], v[116:119]
    ds_read_b64_tr_b16 v[44:45], v15 offset:24576
    v_rcp_f32 v18, v18
    v_mfma_f32_16x16x32_bf16 v[124:127], v[52:55], a[84:87], v[124:127]
    ds_read_b64_tr_b16 v[46:47], v15 offset:28672
    v_rcp_f32 v19, v19
    s_waitcnt lgkmcnt(4)
    v_mfma_f32_16x16x32_bf16 v[128:131], v[56:59], a[80:83], v[128:131]
    ds_read_b64_tr_b16 v[48:49], v16 offset:24576
    v_rcp_f32 v20, v20
    v_mfma_f32_16x16x32_bf16 v[136:139], v[56:59], a[84:87], v[136:139]
    ds_read_b64_tr_b16 v[50:51], v16 offset:28672
    global_load_dwordx4 a[152:155], v1, s[10:11] offset:2048 sc1
    v_mfma_f32_16x16x32_bf16 v[132:135], v[60:63], a[80:83], v[132:135]
    ds_read_b64_tr_b16 v[52:53], v17 offset:24576
    v_rcp_f32 v21, v21
    v_mfma_f32_16x16x32_bf16 v[140:143], v[60:63], a[84:87], v[140:143]
    ds_read_b64_tr_b16 v[54:55], v17 offset:28672
    global_load_lds_dwordx4 v8, s[8:9] offset:2048
    v_mfma_f32_16x16x32_bf16 v[144:147], v[32:35], a[80:83], v[144:147]
    ds_read_b64_tr_b16 v[56:57], v14 offset:25088
    v_mul_f32 v10, v248, v10
    v_mfma_f32_16x16x32_bf16 v[152:155], v[32:35], a[84:87], v[152:155]
    ds_read_b64_tr_b16 v[58:59], v14 offset:29184
    v_mul_f32 v11, v249, v11
    v_mfma_f32_16x16x32_bf16 v[148:151], v[36:39], a[80:83], v[148:151]
    ds_read_b64_tr_b16 v[60:61], v15 offset:25088
    v_mul_f32 v12, v250, v12
    v_mul_f32 v13, v251, v13
    v_mfma_f32_16x16x32_bf16 v[156:159], v[36:39], a[84:87], v[156:159]
    ds_read_b64_tr_b16 v[62:63], v15 offset:29184
    v_mul_f32 v18, v252, v18
    global_load_dwordx4 a[156:159], v1, s[10:11] offset:3072 sc1
    s_waitcnt lgkmcnt(4)
    v_mfma_f32_16x16x32_bf16 v[96:99], v[40:43], a[88:91], v[96:99]
    ds_read_b64_tr_b16 v[32:33], v16 offset:25088
    v_mul_f32 v19, v253, v19
    v_mul_f32 v20, v254, v20
    v_mfma_f32_16x16x32_bf16 v[104:107], v[40:43], a[92:95], v[104:107]
    ds_read_b64_tr_b16 v[34:35], v16 offset:29184
    global_load_lds_dwordx4 v9, s[8:9] offset:3072
    v_mfma_f32_16x16x32_bf16 v[100:103], v[44:47], a[88:91], v[100:103]
    ds_read_b64_tr_b16 v[36:37], v17 offset:25088
    v_mul_f32 v21, v255, v21
    v_cvt_pk_bf16_f32 v244, v10, v11
    v_mfma_f32_16x16x32_bf16 v[108:111], v[44:47], a[92:95], v[108:111]
    ds_read_b64_tr_b16 v[38:39], v17 offset:29184
    v_cvt_pk_bf16_f32 v245, v12, v13
    v_mfma_f32_16x16x32_bf16 v[112:115], v[48:51], a[88:91], v[112:115]
    v_cvt_pk_bf16_f32 v246, v18, v19
    v_mfma_f32_16x16x32_bf16 v[120:123], v[48:51], a[92:95], v[120:123]
    v_cvt_pk_bf16_f32 v247, v20, v21
    v_mfma_f32_16x16x32_bf16 v[116:119], v[52:55], a[88:91], v[116:119]
    global_store_dwordx4 v1, v[244:247], s[6:7] offset:-3072 sc1
    v_mfma_f32_16x16x32_bf16 v[124:127], v[52:55], a[92:95], v[124:127]
    s_waitcnt lgkmcnt(0)
    v_mfma_f32_16x16x32_bf16 v[128:131], v[56:59], a[88:91], v[128:131]
    v_mfma_f32_16x16x32_bf16 v[136:139], v[56:59], a[92:95], v[136:139]
    s_waitcnt vmcnt(21)
    s_barrier
    v_mov_b32 v0, 3
    buffer_store_dword v0, v27, s[12:15], s49 offen sc1
    ds_read_b64_tr_b16 v[40:41], v14 offset:32768
    ds_read_b64_tr_b16 v[42:43], v14 offset:36864
    ds_read_b64_tr_b16 v[44:45], v15 offset:32768
    ds_read_b64_tr_b16 v[46:47], v15 offset:36864
    v_mfma_f32_16x16x32_bf16 v[132:135], v[60:63], a[88:91], v[132:135]
    ds_read_b64_tr_b16 v[48:49], v16 offset:32768
    ds_read_b64_tr_b16 v[50:51], v16 offset:36864
    s_add_u32 s10, s16, 40960
    s_addc_u32 s11, s17, 0
    v_mfma_f32_16x16x32_bf16 v[140:143], v[60:63], a[92:95], v[140:143]
    ds_read_b64_tr_b16 v[52:53], v17 offset:32768
    ds_read_b64_tr_b16 v[54:55], v17 offset:36864
    global_load_dwordx4 a[160:163], v1, s[10:11] offset:-4096 sc1
    v_mfma_f32_16x16x32_bf16 v[144:147], v[32:35], a[88:91], v[144:147]
    ds_read_b64_tr_b16 v[56:57], v14 offset:33280
    s_add_u32 m0, s39, 0
    s_add_u32 s8, s44, 1703936
    s_addc_u32 s9, s45, 0
    v_mfma_f32_16x16x32_bf16 v[152:155], v[32:35], a[92:95], v[152:155]
    ds_read_b64_tr_b16 v[58:59], v14 offset:37376
    global_load_lds_dwordx4 v2, s[8:9] offset:0
    v_mfma_f32_16x16x32_bf16 v[148:151], v[36:39], a[88:91], v[148:151]
    ds_read_b64_tr_b16 v[60:61], v15 offset:33280
    v_mfma_f32_16x16x32_bf16 v[156:159], v[36:39], a[92:95], v[156:159]
    ds_read_b64_tr_b16 v[62:63], v15 offset:37376
    s_waitcnt lgkmcnt(4)
    v_mfma_f32_16x16x32_bf16 v[96:99], v[40:43], a[96:99], v[96:99]
    ds_read_b64_tr_b16 v[32:33], v16 offset:33280
    v_mfma_f32_16x16x32_bf16 v[104:107], v[40:43], a[100:103], v[104:107]
    ds_read_b64_tr_b16 v[34:35], v16 offset:37376
    v_mfma_f32_16x16x32_bf16 v[100:103], v[44:47], a[96:99], v[100:103]
    ds_read_b64_tr_b16 v[36:37], v17 offset:33280
    v_mfma_f32_16x16x32_bf16 v[108:111], v[44:47], a[100:103], v[108:111]
    ds_read_b64_tr_b16 v[38:39], v17 offset:37376
    v_mfma_f32_16x16x32_bf16 v[112:115], v[48:51], a[96:99], v[112:115]
    v_mfma_f32_16x16x32_bf16 v[120:123], v[48:51], a[100:103], v[120:123]
    v_mfma_f32_16x16x32_bf16 v[116:119], v[52:55], a[96:99], v[116:119]
    v_mfma_f32_16x16x32_bf16 v[124:127], v[52:55], a[100:103], v[124:127]
    s_waitcnt lgkmcnt(0)
    v_mfma_f32_16x16x32_bf16 v[128:131], v[56:59], a[96:99], v[128:131]
    global_load_dwordx4 a[164:167], v1, s[10:11] offset:-3072 sc1
    v_mfma_f32_16x16x32_bf16 v[136:139], v[56:59], a[100:103], v[136:139]
    v_mfma_f32_16x16x32_bf16 v[132:135], v[60:63], a[96:99], v[132:135]
    ds_read_b64_tr_b16 v[40:41], v14 offset:40960
    v_mfma_f32_16x16x32_bf16 v[140:143], v[60:63], a[100:103], v[140:143]
    ds_read_b64_tr_b16 v[42:43], v14 offset:45056
    v_mfma_f32_16x16x32_bf16 v[144:147], v[32:35], a[96:99], v[144:147]
    ds_read_b64_tr_b16 v[44:45], v15 offset:40960
    v_mfma_f32_16x16x32_bf16 v[152:155], v[32:35], a[100:103], v[152:155]
    ds_read_b64_tr_b16 v[46:47], v15 offset:45056
    global_load_lds_dwordx4 v3, s[8:9] offset:1024
    v_mfma_f32_16x16x32_bf16 v[148:151], v[36:39], a[96:99], v[148:151]
    ds_read_b64_tr_b16 v[48:49], v16 offset:40960
    v_mfma_f32_16x16x32_bf16 v[156:159], v[36:39], a[100:103], v[156:159]
    ds_read_b64_tr_b16 v[50:51], v16 offset:45056
    s_waitcnt vmcnt(22)
    v_mfma_f32_16x16x32_bf16 v[192:195], v[72:75], v[64:67], 0
    ds_read_b64_tr_b16 v[52:53], v17 offset:40960
    global_load_dwordx4 a[168:171], v1, s[10:11] offset:-2048 sc1
    v_mfma_f32_16x16x32_bf16 v[200:203], v[72:75], v[68:71], 0
    ds_read_b64_tr_b16 v[54:55], v17 offset:45056
    v_mfma_f32_16x16x32_bf16 v[196:199], v[76:79], v[64:67], 0
    ds_read_b64_tr_b16 v[56:57], v14 offset:41472
    v_mfma_f32_16x16x32_bf16 v[204:207], v[76:79], v[68:71], 0
    ds_read_b64_tr_b16 v[58:59], v14 offset:45568
    global_load_lds_dwordx4 v4, s[8:9] offset:2048
    v_mfma_f32_16x16x32_bf16 v[208:211], v[224:227], v[64:67], 0
    ds_read_b64_tr_b16 v[60:61], v15 offset:41472
    v_mfma_f32_16x16x32_bf16 v[212:215], v[224:227], v[68:71], 0
    ds_read_b64_tr_b16 v[62:63], v15 offset:45568
    s_waitcnt lgkmcnt(4)
    v_mfma_f32_16x16x32_bf16 v[96:99], v[40:43], a[104:107], v[96:99]
    ds_read_b64_tr_b16 v[32:33], v16 offset:41472
    global_load_dwordx4 a[172:175], v1, s[10:11] offset:-1024 sc1
    v_mfma_f32_16x16x32_bf16 v[104:107], v[40:43], a[108:111], v[104:107]
    ds_read_b64_tr_b16 v[34:35], v16 offset:45568
    v_mfma_f32_16x16x32_bf16 v[100:103], v[44:47], a[104:107], v[100:103]
    ds_read_b64_tr_b16 v[36:37], v17 offset:41472
    v_mfma_f32_16x16x32_bf16 v[108:111], v[44:47], a[108:111], v[108:111]
    ds_read_b64_tr_b16 v[38:39], v17 offset:45568
    global_load_lds_dwordx4 v5, s[8:9] offset:3072
    s_add_u32 m0, s39, 4096
    v_mfma_f32_16x16x32_bf16 v[112:115], v[48:51], a[104:107], v[112:115]
    ds_read_b64_tr_b16 v[40:41], v14 offset:49152
    v_mfma_f32_16x16x32_bf16 v[120:123], v[48:51], a[108:111], v[120:123]
    ds_read_b64_tr_b16 v[42:43], v14 offset:53248
    v_mfma_f32_16x16x32_bf16 v[116:119], v[52:55], a[104:107], v[116:119]
    ds_read_b64_tr_b16 v[44:45], v15 offset:49152
    v_add_f32 v29, 0x358637bd, v208
    v_mfma_f32_16x16x32_bf16 v[124:127], v[52:55], a[108:111], v[124:127]
    ds_read_b64_tr_b16 v[46:47], v15 offset:53248
    v_add_f32 v30, 0x358637bd, v212
    s_waitcnt lgkmcnt(4)
    v_mfma_f32_16x16x32_bf16 v[128:131], v[56:59], a[104:107], v[128:131]
    ds_read_b64_tr_b16 v[48:49], v16 offset:49152
    v_rcp_f32 v29, v29
    v_mfma_f32_16x16x32_bf16 v[136:139], v[56:59], a[108:111], v[136:139]
    ds_read_b64_tr_b16 v[50:51], v16 offset:53248
    global_load_dwordx4 a[176:179], v1, s[10:11] offset:0 sc1
    v_mfma_f32_16x16x32_bf16 v[132:135], v[60:63], a[104:107], v[132:135]
    ds_read_b64_tr_b16 v[52:53], v17 offset:49152
    v_rcp_f32 v30, v30
    v_mfma_f32_16x16x32_bf16 v[140:143], v[60:63], a[108:111], v[140:143]
    ds_read_b64_tr_b16 v[54:55], v17 offset:53248
    s_nop 0
    v_mfma_f32_16x16x32_bf16 v[144:147], v[32:35], a[104:107], v[144:147]
    ds_read_b64_tr_b16 v[56:57], v14 offset:49664
    v_mul_f32 v192, v29, v192
    v_mfma_f32_16x16x32_bf16 v[152:155], v[32:35], a[108:111], v[152:155]
    ds_read_b64_tr_b16 v[58:59], v14 offset:53760
    global_load_lds_dwordx4 v6, s[8:9] offset:0
    v_mfma_f32_16x16x32_bf16 v[148:151], v[36:39], a[104:107], v[148:151]
    ds_read_b64_tr_b16 v[60:61], v15 offset:49664
    v_mul_f32 v193, v29, v193
    v_mfma_f32_16x16x32_bf16 v[156:159], v[36:39], a[108:111], v[156:159]
    ds_read_b64_tr_b16 v[62:63], v15 offset:53760
    v_mul_f32 v194, v29, v194
    s_waitcnt lgkmcnt(4)
    v_mfma_f32_16x16x32_bf16 v[96:99], v[40:43], a[112:115], v[96:99]
    ds_read_b64_tr_b16 v[32:33], v16 offset:49664
    v_mul_f32 v195, v29, v195
    v_mul_f32 v196, v29, v196
    v_mfma_f32_16x16x32_bf16 v[104:107], v[40:43], a[116:119], v[104:107]
    ds_read_b64_tr_b16 v[34:35], v16 offset:53760
    global_load_dwordx4 a[180:183], v1, s[10:11] offset:1024 sc1
    v_mfma_f32_16x16x32_bf16 v[100:103], v[44:47], a[112:115], v[100:103]
    ds_read_b64_tr_b16 v[36:37], v17 offset:49664
    v_mul_f32 v197, v29, v197
    v_mul_f32 v198, v29, v198
    v_mfma_f32_16x16x32_bf16 v[108:111], v[44:47], a[116:119], v[108:111]
    ds_read_b64_tr_b16 v[38:39], v17 offset:53760
    global_load_lds_dwordx4 v7, s[8:9] offset:1024
    v_mfma_f32_16x16x32_bf16 v[112:115], v[48:51], a[112:115], v[112:115]
    ds_read_b64_tr_b16 v[40:41], v14 offset:57344
    v_mul_f32 v199, v29, v199
    v_mfma_f32_16x16x32_bf16 v[120:123], v[48:51], a[116:119], v[120:123]
    ds_read_b64_tr_b16 v[42:43], v14 offset:61440
    v_mul_f32 v200, v30, v200
    v_mfma_f32_16x16x32_bf16 v[116:119], v[52:55], a[112:115], v[116:119]
    ds_read_b64_tr_b16 v[44:45], v15 offset:57344
    v_mul_f32 v201, v30, v201
    v_mul_f32 v202, v30, v202
    v_mfma_f32_16x16x32_bf16 v[124:127], v[52:55], a[116:119], v[124:127]
    ds_read_b64_tr_b16 v[46:47], v15 offset:61440
    global_load_dwordx4 a[184:187], v1, s[10:11] offset:2048 sc1
    s_waitcnt lgkmcnt(4)
    v_mfma_f32_16x16x32_bf16 v[128:131], v[56:59], a[112:115], v[128:131]
    ds_read_b64_tr_b16 v[48:49], v16 offset:57344
    v_mul_f32 v203, v30, v203
    v_mul_f32 v204, v30, v204
    v_mfma_f32_16x16x32_bf16 v[136:139], v[56:59], a[116:119], v[136:139]
    ds_read_b64_tr_b16 v[50:51], v16 offset:61440
    global_load_lds_dwordx4 v8, s[8:9] offset:2048
    v_mfma_f32_16x16x32_bf16 v[132:135], v[60:63], a[112:115], v[132:135]
    ds_read_b64_tr_b16 v[52:53], v17 offset:57344
    v_mul_f32 v205, v30, v205
    v_mfma_f32_16x16x32_bf16 v[140:143], v[60:63], a[116:119], v[140:143]
    ds_read_b64_tr_b16 v[54:55], v17 offset:61440
    v_mul_f32 v206, v30, v206
    v_mfma_f32_16x16x32_bf16 v[144:147], v[32:35], a[112:115], v[144:147]
    ds_read_b64_tr_b16 v[56:57], v14 offset:57856
    v_mul_f32 v207, v30, v207
    v_mfma_f32_16x16x32_bf16 v[152:155], v[32:35], a[116:119], v[152:155]
    ds_read_b64_tr_b16 v[58:59], v14 offset:61952
    v_cvt_pk_bf16_f32 v192, v192, v193
    v_mfma_f32_16x16x32_bf16 v[148:151], v[36:39], a[112:115], v[148:151]
    ds_read_b64_tr_b16 v[60:61], v15 offset:57856
    v_cvt_pk_bf16_f32 v193, v194, v195
    v_cvt_pk_bf16_f32 v194, v196, v197
    global_load_dwordx4 a[188:191], v1, s[10:11] offset:3072 sc1
    v_mfma_f32_16x16x32_bf16 v[156:159], v[36:39], a[116:119], v[156:159]
    ds_read_b64_tr_b16 v[62:63], v15 offset:61952
    global_load_lds_dwordx4 v9, s[8:9] offset:3072
    s_waitcnt lgkmcnt(4)
    v_mfma_f32_16x16x32_bf16 v[96:99], v[40:43], a[120:123], v[96:99]
    ds_read_b64_tr_b16 v[32:33], v16 offset:57856
    v_cvt_pk_bf16_f32 v195, v198, v199
    v_mfma_f32_16x16x32_bf16 v[104:107], v[40:43], a[124:127], v[104:107]
    ds_read_b64_tr_b16 v[34:35], v16 offset:61952
    v_cvt_pk_bf16_f32 v196, v200, v201
    v_mfma_f32_16x16x32_bf16 v[100:103], v[44:47], a[120:123], v[100:103]
    ds_read_b64_tr_b16 v[36:37], v17 offset:57856
    v_cvt_pk_bf16_f32 v197, v202, v203
    v_mfma_f32_16x16x32_bf16 v[108:111], v[44:47], a[124:127], v[108:111]
    ds_read_b64_tr_b16 v[38:39], v17 offset:61952
    v_cvt_pk_bf16_f32 v198, v204, v205
    v_mfma_f32_16x16x32_bf16 v[112:115], v[48:51], a[120:123], v[112:115]
    v_cvt_pk_bf16_f32 v199, v206, v207
    s_and_b32 s32, s28, 1
    s_mul_i32 s32, s32, 2048
    s_add_u32 s35, s46, 98304
    s_add_u32 s35, s35, s32
    s_sub_u32 s35, s35, s46
    s_add_u32 s35, s35, s47
    s_xor_b32 s32, s30, 4
    v_mfma_f32_16x16x32_bf16 v[120:123], v[48:51], a[124:127], v[120:123]
    s_lshr_b32 s48, s32, 3
    s_lshl_b32 s48, s48, 5
    s_and_b32 s32, s32, 7
    s_add_u32 s32, s32, s48
    s_lshl_b32 s32, s32, 12
    s_add_u32 s35, s35, s32
    buffer_store_dwordx4 v[192:195], v1, s[12:15], s35 offen offset:0 sc1
    v_mfma_f32_16x16x32_bf16 v[116:119], v[52:55], a[120:123], v[116:119]
    v_mfma_f32_16x16x32_bf16 v[124:127], v[52:55], a[124:127], v[124:127]
    s_waitcnt lgkmcnt(0)
    v_mfma_f32_16x16x32_bf16 v[128:131], v[56:59], a[120:123], v[128:131]
    v_add_u32 v14, 65536, v14
    v_add_u32 v15, 65536, v15
    v_add_u32 v16, 65536, v16
    v_add_u32 v17, 65536, v17
    v_mfma_f32_16x16x32_bf16 v[136:139], v[56:59], a[124:127], v[136:139]
    s_waitcnt vmcnt(20)
    s_barrier
    ds_read_b64_tr_b16 v[40:41], v14 offset:0
    ds_read_b64_tr_b16 v[42:43], v14 offset:4096
    ds_read_b64_tr_b16 v[44:45], v15 offset:0
    ds_read_b64_tr_b16 v[46:47], v15 offset:4096
    v_mfma_f32_16x16x32_bf16 v[132:135], v[60:63], a[120:123], v[132:135]
    ds_read_b64_tr_b16 v[48:49], v16 offset:0
    ds_read_b64_tr_b16 v[50:51], v16 offset:4096
    s_add_u32 s10, s16, 49152
    s_addc_u32 s11, s17, 0
    v_mfma_f32_16x16x32_bf16 v[140:143], v[60:63], a[124:127], v[140:143]
    ds_read_b64_tr_b16 v[52:53], v17 offset:0
    ds_read_b64_tr_b16 v[54:55], v17 offset:4096
    global_load_dwordx4 a[192:195], v1, s[10:11] offset:-4096 sc1
    v_mfma_f32_16x16x32_bf16 v[144:147], v[32:35], a[120:123], v[144:147]
    ds_read_b64_tr_b16 v[56:57], v14 offset:512
    s_add_u32 m0, s39, 32768
    s_add_u32 s8, s44, 2490368
    s_addc_u32 s9, s45, 0
    v_mfma_f32_16x16x32_bf16 v[152:155], v[32:35], a[124:127], v[152:155]
    ds_read_b64_tr_b16 v[58:59], v14 offset:4608
    global_load_lds_dwordx4 v2, s[8:9] offset:0
    v_mfma_f32_16x16x32_bf16 v[148:151], v[36:39], a[120:123], v[148:151]
    ds_read_b64_tr_b16 v[60:61], v15 offset:512
    v_mfma_f32_16x16x32_bf16 v[156:159], v[36:39], a[124:127], v[156:159]
    ds_read_b64_tr_b16 v[62:63], v15 offset:4608
    s_waitcnt lgkmcnt(4)
    v_mfma_f32_16x16x32_bf16 v[96:99], v[40:43], a[128:131], v[96:99]
    ds_read_b64_tr_b16 v[32:33], v16 offset:512
    v_mfma_f32_16x16x32_bf16 v[104:107], v[40:43], a[132:135], v[104:107]
    ds_read_b64_tr_b16 v[34:35], v16 offset:4608
    v_mfma_f32_16x16x32_bf16 v[100:103], v[44:47], a[128:131], v[100:103]
    ds_read_b64_tr_b16 v[36:37], v17 offset:512
    v_mfma_f32_16x16x32_bf16 v[108:111], v[44:47], a[132:135], v[108:111]
    ds_read_b64_tr_b16 v[38:39], v17 offset:4608
    v_mfma_f32_16x16x32_bf16 v[112:115], v[48:51], a[128:131], v[112:115]
    buffer_store_dwordx4 v[196:199], v1, s[12:15], s35 offen offset:1024 sc1
    v_mfma_f32_16x16x32_bf16 v[120:123], v[48:51], a[132:135], v[120:123]
    v_mfma_f32_16x16x32_bf16 v[116:119], v[52:55], a[128:131], v[116:119]
    v_mfma_f32_16x16x32_bf16 v[124:127], v[52:55], a[132:135], v[124:127]
    s_waitcnt lgkmcnt(0)
    v_mfma_f32_16x16x32_bf16 v[128:131], v[56:59], a[128:131], v[128:131]
    global_load_dwordx4 a[196:199], v1, s[10:11] offset:-3072 sc1
    v_mfma_f32_16x16x32_bf16 v[136:139], v[56:59], a[132:135], v[136:139]
    v_mfma_f32_16x16x32_bf16 v[132:135], v[60:63], a[128:131], v[132:135]
    ds_read_b64_tr_b16 v[40:41], v14 offset:8192
    v_mfma_f32_16x16x32_bf16 v[140:143], v[60:63], a[132:135], v[140:143]
    ds_read_b64_tr_b16 v[42:43], v14 offset:12288
    v_mfma_f32_16x16x32_bf16 v[144:147], v[32:35], a[128:131], v[144:147]
    ds_read_b64_tr_b16 v[44:45], v15 offset:8192
    v_mfma_f32_16x16x32_bf16 v[152:155], v[32:35], a[132:135], v[152:155]
    ds_read_b64_tr_b16 v[46:47], v15 offset:12288
    global_load_lds_dwordx4 v3, s[8:9] offset:1024
    v_mfma_f32_16x16x32_bf16 v[148:151], v[36:39], a[128:131], v[148:151]
    ds_read_b64_tr_b16 v[48:49], v16 offset:8192
    v_mfma_f32_16x16x32_bf16 v[156:159], v[36:39], a[132:135], v[156:159]
    ds_read_b64_tr_b16 v[50:51], v16 offset:12288
    v_mfma_f32_16x16x32_bf16 v[192:195], v[72:75], v[80:83], 0
    ds_read_b64_tr_b16 v[52:53], v17 offset:8192
    global_load_dwordx4 a[200:203], v1, s[10:11] offset:-2048 sc1
    v_mfma_f32_16x16x32_bf16 v[200:203], v[72:75], v[84:87], 0
    ds_read_b64_tr_b16 v[54:55], v17 offset:12288
    v_mfma_f32_16x16x32_bf16 v[196:199], v[76:79], v[80:83], 0
    ds_read_b64_tr_b16 v[56:57], v14 offset:8704
    v_mfma_f32_16x16x32_bf16 v[204:207], v[76:79], v[84:87], 0
    ds_read_b64_tr_b16 v[58:59], v14 offset:12800
    global_load_lds_dwordx4 v4, s[8:9] offset:2048
    v_mfma_f32_16x16x32_bf16 v[208:211], v[224:227], v[80:83], 0
    ds_read_b64_tr_b16 v[60:61], v15 offset:8704
    v_mfma_f32_16x16x32_bf16 v[212:215], v[224:227], v[84:87], 0
    ds_read_b64_tr_b16 v[62:63], v15 offset:12800
    s_waitcnt lgkmcnt(4)
    v_mfma_f32_16x16x32_bf16 v[96:99], v[40:43], a[136:139], v[96:99]
    ds_read_b64_tr_b16 v[32:33], v16 offset:8704
    global_load_dwordx4 a[204:207], v1, s[10:11] offset:-1024 sc1
    v_mfma_f32_16x16x32_bf16 v[104:107], v[40:43], a[140:143], v[104:107]
    ds_read_b64_tr_b16 v[34:35], v16 offset:12800
    v_mfma_f32_16x16x32_bf16 v[100:103], v[44:47], a[136:139], v[100:103]
    ds_read_b64_tr_b16 v[36:37], v17 offset:8704
    v_mfma_f32_16x16x32_bf16 v[108:111], v[44:47], a[140:143], v[108:111]
    ds_read_b64_tr_b16 v[38:39], v17 offset:12800
    global_load_lds_dwordx4 v5, s[8:9] offset:3072
    s_add_u32 m0, s39, 36864
    v_mfma_f32_16x16x32_bf16 v[112:115], v[48:51], a[136:139], v[112:115]
    ds_read_b64_tr_b16 v[40:41], v14 offset:16384
    v_mfma_f32_16x16x32_bf16 v[120:123], v[48:51], a[140:143], v[120:123]
    ds_read_b64_tr_b16 v[42:43], v14 offset:20480
    v_mfma_f32_16x16x32_bf16 v[116:119], v[52:55], a[136:139], v[116:119]
    ds_read_b64_tr_b16 v[44:45], v15 offset:16384
    v_add_f32 v29, 0x358637bd, v208
    v_mfma_f32_16x16x32_bf16 v[124:127], v[52:55], a[140:143], v[124:127]
    ds_read_b64_tr_b16 v[46:47], v15 offset:20480
    v_add_f32 v30, 0x358637bd, v212
    s_waitcnt lgkmcnt(4)
    v_mfma_f32_16x16x32_bf16 v[128:131], v[56:59], a[136:139], v[128:131]
    ds_read_b64_tr_b16 v[48:49], v16 offset:16384
    v_rcp_f32 v29, v29
    v_mfma_f32_16x16x32_bf16 v[136:139], v[56:59], a[140:143], v[136:139]
    ds_read_b64_tr_b16 v[50:51], v16 offset:20480
    global_load_dwordx4 a[208:211], v1, s[10:11] offset:0 sc1
    v_mfma_f32_16x16x32_bf16 v[132:135], v[60:63], a[136:139], v[132:135]
    ds_read_b64_tr_b16 v[52:53], v17 offset:16384
    v_rcp_f32 v30, v30
    v_mfma_f32_16x16x32_bf16 v[140:143], v[60:63], a[140:143], v[140:143]
    ds_read_b64_tr_b16 v[54:55], v17 offset:20480
    s_nop 0
    v_mfma_f32_16x16x32_bf16 v[144:147], v[32:35], a[136:139], v[144:147]
    ds_read_b64_tr_b16 v[56:57], v14 offset:16896
    v_mul_f32 v192, v29, v192
    v_mfma_f32_16x16x32_bf16 v[152:155], v[32:35], a[140:143], v[152:155]
    ds_read_b64_tr_b16 v[58:59], v14 offset:20992
    global_load_lds_dwordx4 v6, s[8:9] offset:0
    v_mfma_f32_16x16x32_bf16 v[148:151], v[36:39], a[136:139], v[148:151]
    ds_read_b64_tr_b16 v[60:61], v15 offset:16896
    v_mul_f32 v193, v29, v193
    v_mfma_f32_16x16x32_bf16 v[156:159], v[36:39], a[140:143], v[156:159]
    ds_read_b64_tr_b16 v[62:63], v15 offset:20992
    v_mul_f32 v194, v29, v194
    s_waitcnt lgkmcnt(4)
    v_mfma_f32_16x16x32_bf16 v[96:99], v[40:43], a[144:147], v[96:99]
    ds_read_b64_tr_b16 v[32:33], v16 offset:16896
    v_mul_f32 v195, v29, v195
    v_mul_f32 v196, v29, v196
    v_mfma_f32_16x16x32_bf16 v[104:107], v[40:43], a[148:151], v[104:107]
    ds_read_b64_tr_b16 v[34:35], v16 offset:20992
    global_load_dwordx4 a[212:215], v1, s[10:11] offset:1024 sc1
    v_mfma_f32_16x16x32_bf16 v[100:103], v[44:47], a[144:147], v[100:103]
    ds_read_b64_tr_b16 v[36:37], v17 offset:16896
    v_mul_f32 v197, v29, v197
    v_mul_f32 v198, v29, v198
    v_mfma_f32_16x16x32_bf16 v[108:111], v[44:47], a[148:151], v[108:111]
    ds_read_b64_tr_b16 v[38:39], v17 offset:20992
    global_load_lds_dwordx4 v7, s[8:9] offset:1024
    v_mfma_f32_16x16x32_bf16 v[112:115], v[48:51], a[144:147], v[112:115]
    ds_read_b64_tr_b16 v[40:41], v14 offset:24576
    v_mul_f32 v199, v29, v199
    v_mfma_f32_16x16x32_bf16 v[120:123], v[48:51], a[148:151], v[120:123]
    ds_read_b64_tr_b16 v[42:43], v14 offset:28672
    v_mul_f32 v200, v30, v200
    v_mfma_f32_16x16x32_bf16 v[116:119], v[52:55], a[144:147], v[116:119]
    ds_read_b64_tr_b16 v[44:45], v15 offset:24576
    v_mul_f32 v201, v30, v201
    v_mul_f32 v202, v30, v202
    v_mfma_f32_16x16x32_bf16 v[124:127], v[52:55], a[148:151], v[124:127]
    ds_read_b64_tr_b16 v[46:47], v15 offset:28672
    global_load_dwordx4 a[216:219], v1, s[10:11] offset:2048 sc1
    s_waitcnt lgkmcnt(4)
    v_mfma_f32_16x16x32_bf16 v[128:131], v[56:59], a[144:147], v[128:131]
    ds_read_b64_tr_b16 v[48:49], v16 offset:24576
    v_mul_f32 v203, v30, v203
    v_mul_f32 v204, v30, v204
    v_mfma_f32_16x16x32_bf16 v[136:139], v[56:59], a[148:151], v[136:139]
    ds_read_b64_tr_b16 v[50:51], v16 offset:28672
    global_load_lds_dwordx4 v8, s[8:9] offset:2048
    v_mfma_f32_16x16x32_bf16 v[132:135], v[60:63], a[144:147], v[132:135]
    ds_read_b64_tr_b16 v[52:53], v17 offset:24576
    v_mul_f32 v205, v30, v205
    v_mfma_f32_16x16x32_bf16 v[140:143], v[60:63], a[148:151], v[140:143]
    ds_read_b64_tr_b16 v[54:55], v17 offset:28672
    v_mul_f32 v206, v30, v206
    v_mfma_f32_16x16x32_bf16 v[144:147], v[32:35], a[144:147], v[144:147]
    ds_read_b64_tr_b16 v[56:57], v14 offset:25088
    v_mul_f32 v207, v30, v207
    v_mfma_f32_16x16x32_bf16 v[152:155], v[32:35], a[148:151], v[152:155]
    ds_read_b64_tr_b16 v[58:59], v14 offset:29184
    v_cvt_pk_bf16_f32 v192, v192, v193
    v_mfma_f32_16x16x32_bf16 v[148:151], v[36:39], a[144:147], v[148:151]
    ds_read_b64_tr_b16 v[60:61], v15 offset:25088
    v_cvt_pk_bf16_f32 v193, v194, v195
    v_cvt_pk_bf16_f32 v194, v196, v197
    global_load_dwordx4 a[220:223], v1, s[10:11] offset:3072 sc1
    v_mfma_f32_16x16x32_bf16 v[156:159], v[36:39], a[148:151], v[156:159]
    ds_read_b64_tr_b16 v[62:63], v15 offset:29184
    global_load_lds_dwordx4 v9, s[8:9] offset:3072
    s_waitcnt lgkmcnt(4)
    v_mfma_f32_16x16x32_bf16 v[96:99], v[40:43], a[152:155], v[96:99]
    ds_read_b64_tr_b16 v[32:33], v16 offset:25088
    v_cvt_pk_bf16_f32 v195, v198, v199
    v_mfma_f32_16x16x32_bf16 v[104:107], v[40:43], a[156:159], v[104:107]
    ds_read_b64_tr_b16 v[34:35], v16 offset:29184
    v_cvt_pk_bf16_f32 v196, v200, v201
    v_mfma_f32_16x16x32_bf16 v[100:103], v[44:47], a[152:155], v[100:103]
    ds_read_b64_tr_b16 v[36:37], v17 offset:25088
    v_cvt_pk_bf16_f32 v197, v202, v203
    v_mfma_f32_16x16x32_bf16 v[108:111], v[44:47], a[156:159], v[108:111]
    ds_read_b64_tr_b16 v[38:39], v17 offset:29184
    v_cvt_pk_bf16_f32 v198, v204, v205
    v_mfma_f32_16x16x32_bf16 v[112:115], v[48:51], a[152:155], v[112:115]
    v_cvt_pk_bf16_f32 v199, v206, v207
    s_and_b32 s32, s28, 1
    s_mul_i32 s32, s32, 4294379520
    s_add_u32 s35, s46, 393216
    s_add_u32 s35, s35, s32
    s_sub_u32 s35, s35, s46
    s_add_u32 s35, s35, s47
    s_xor_b32 s32, s30, 4
    v_mfma_f32_16x16x32_bf16 v[120:123], v[48:51], a[156:159], v[120:123]
    s_lshr_b32 s48, s32, 3
    s_lshl_b32 s48, s48, 5
    s_and_b32 s32, s32, 7
    s_add_u32 s32, s32, s48
    s_lshl_b32 s32, s32, 12
    s_add_u32 s35, s35, s32
    buffer_store_dwordx4 v[192:195], v1, s[12:15], s35 offen offset:0 sc1
    v_mfma_f32_16x16x32_bf16 v[116:119], v[52:55], a[152:155], v[116:119]
    v_mfma_f32_16x16x32_bf16 v[124:127], v[52:55], a[156:159], v[124:127]
    s_waitcnt lgkmcnt(0)
    v_mfma_f32_16x16x32_bf16 v[128:131], v[56:59], a[152:155], v[128:131]
    v_mfma_f32_16x16x32_bf16 v[136:139], v[56:59], a[156:159], v[136:139]
    s_waitcnt vmcnt(20)
    s_barrier
    buffer_load_dword v24, v25, s[12:15], s40 offen sc1
    ds_read_b64_tr_b16 v[40:41], v14 offset:32768
    ds_read_b64_tr_b16 v[42:43], v14 offset:36864
    ds_read_b64_tr_b16 v[44:45], v15 offset:32768
    ds_read_b64_tr_b16 v[46:47], v15 offset:36864
    v_mfma_f32_16x16x32_bf16 v[132:135], v[60:63], a[152:155], v[132:135]
    ds_read_b64_tr_b16 v[48:49], v16 offset:32768
    ds_read_b64_tr_b16 v[50:51], v16 offset:36864
    s_add_u32 s10, s16, 57344
    s_addc_u32 s11, s17, 0
    v_mfma_f32_16x16x32_bf16 v[140:143], v[60:63], a[156:159], v[140:143]
    ds_read_b64_tr_b16 v[52:53], v17 offset:32768
    ds_read_b64_tr_b16 v[54:55], v17 offset:36864
    global_load_dwordx4 a[224:227], v1, s[10:11] offset:-4096 sc1
    v_mfma_f32_16x16x32_bf16 v[144:147], v[32:35], a[152:155], v[144:147]
    ds_read_b64_tr_b16 v[56:57], v14 offset:33280
    s_add_u32 m0, s39, 65536
    s_add_u32 s8, s44, 262144
    s_addc_u32 s9, s45, 0
    v_mfma_f32_16x16x32_bf16 v[152:155], v[32:35], a[156:159], v[152:155]
    ds_read_b64_tr_b16 v[58:59], v14 offset:37376
    global_load_lds_dwordx4 v2, s[8:9] offset:0
    v_mfma_f32_16x16x32_bf16 v[148:151], v[36:39], a[152:155], v[148:151]
    ds_read_b64_tr_b16 v[60:61], v15 offset:33280
    v_mfma_f32_16x16x32_bf16 v[156:159], v[36:39], a[156:159], v[156:159]
    ds_read_b64_tr_b16 v[62:63], v15 offset:37376
    s_waitcnt lgkmcnt(4)
    v_mfma_f32_16x16x32_bf16 v[96:99], v[40:43], a[160:163], v[96:99]
    ds_read_b64_tr_b16 v[32:33], v16 offset:33280
    v_mfma_f32_16x16x32_bf16 v[104:107], v[40:43], a[164:167], v[104:107]
    ds_read_b64_tr_b16 v[34:35], v16 offset:37376
    v_mfma_f32_16x16x32_bf16 v[100:103], v[44:47], a[160:163], v[100:103]
    ds_read_b64_tr_b16 v[36:37], v17 offset:33280
    v_mfma_f32_16x16x32_bf16 v[108:111], v[44:47], a[164:167], v[108:111]
    ds_read_b64_tr_b16 v[38:39], v17 offset:37376
    v_mfma_f32_16x16x32_bf16 v[112:115], v[48:51], a[160:163], v[112:115]
    ds_read_b64_tr_b16 v[40:41], v14 offset:40960
    buffer_store_dwordx4 v[196:199], v1, s[12:15], s35 offen offset:1024 sc1
    v_mfma_f32_16x16x32_bf16 v[120:123], v[48:51], a[164:167], v[120:123]
    ds_read_b64_tr_b16 v[42:43], v14 offset:45056
    v_mfma_f32_16x16x32_bf16 v[116:119], v[52:55], a[160:163], v[116:119]
    ds_read_b64_tr_b16 v[44:45], v15 offset:40960
    global_load_dwordx4 a[228:231], v1, s[10:11] offset:-3072 sc1
    v_mfma_f32_16x16x32_bf16 v[124:127], v[52:55], a[164:167], v[124:127]
    ds_read_b64_tr_b16 v[46:47], v15 offset:45056
    s_waitcnt lgkmcnt(4)
    v_mfma_f32_16x16x32_bf16 v[128:131], v[56:59], a[160:163], v[128:131]
    ds_read_b64_tr_b16 v[48:49], v16 offset:40960
    v_mfma_f32_16x16x32_bf16 v[136:139], v[56:59], a[164:167], v[136:139]
    ds_read_b64_tr_b16 v[50:51], v16 offset:45056
    v_mfma_f32_16x16x32_bf16 v[132:135], v[60:63], a[160:163], v[132:135]
    ds_read_b64_tr_b16 v[52:53], v17 offset:40960
    v_mfma_f32_16x16x32_bf16 v[140:143], v[60:63], a[164:167], v[140:143]
    ds_read_b64_tr_b16 v[54:55], v17 offset:45056
    global_load_lds_dwordx4 v3, s[8:9] offset:1024
    v_mfma_f32_16x16x32_bf16 v[144:147], v[32:35], a[160:163], v[144:147]
    ds_read_b64_tr_b16 v[56:57], v14 offset:41472
    v_mfma_f32_16x16x32_bf16 v[152:155], v[32:35], a[164:167], v[152:155]
    ds_read_b64_tr_b16 v[58:59], v14 offset:45568
    v_mfma_f32_16x16x32_bf16 v[148:151], v[36:39], a[160:163], v[148:151]
    ds_read_b64_tr_b16 v[60:61], v15 offset:41472
    global_load_dwordx4 a[232:235], v1, s[10:11] offset:-2048 sc1
    v_mfma_f32_16x16x32_bf16 v[156:159], v[36:39], a[164:167], v[156:159]
    ds_read_b64_tr_b16 v[62:63], v15 offset:45568
    s_waitcnt lgkmcnt(4)
    v_mfma_f32_16x16x32_bf16 v[96:99], v[40:43], a[168:171], v[96:99]
    ds_read_b64_tr_b16 v[32:33], v16 offset:41472
    v_mfma_f32_16x16x32_bf16 v[104:107], v[40:43], a[172:175], v[104:107]
    ds_read_b64_tr_b16 v[34:35], v16 offset:45568
    global_load_lds_dwordx4 v4, s[8:9] offset:2048
    v_mfma_f32_16x16x32_bf16 v[100:103], v[44:47], a[168:171], v[100:103]
    ds_read_b64_tr_b16 v[36:37], v17 offset:41472
    v_mfma_f32_16x16x32_bf16 v[108:111], v[44:47], a[172:175], v[108:111]
    ds_read_b64_tr_b16 v[38:39], v17 offset:45568
    v_mfma_f32_16x16x32_bf16 v[112:115], v[48:51], a[168:171], v[112:115]
    ds_read_b64_tr_b16 v[40:41], v14 offset:49152
    global_load_dwordx4 a[236:239], v1, s[10:11] offset:-1024 sc1
    v_mfma_f32_16x16x32_bf16 v[120:123], v[48:51], a[172:175], v[120:123]
    ds_read_b64_tr_b16 v[42:43], v14 offset:53248
    v_mfma_f32_16x16x32_bf16 v[116:119], v[52:55], a[168:171], v[116:119]
    ds_read_b64_tr_b16 v[44:45], v15 offset:49152
    v_mfma_f32_16x16x32_bf16 v[124:127], v[52:55], a[172:175], v[124:127]
    ds_read_b64_tr_b16 v[46:47], v15 offset:53248
    global_load_lds_dwordx4 v5, s[8:9] offset:3072
    s_add_u32 m0, s39, 69632
    s_waitcnt lgkmcnt(4)
    v_mfma_f32_16x16x32_bf16 v[128:131], v[56:59], a[168:171], v[128:131]
    ds_read_b64_tr_b16 v[48:49], v16 offset:49152
    v_mfma_f32_16x16x32_bf16 v[136:139], v[56:59], a[172:175], v[136:139]
    ds_read_b64_tr_b16 v[50:51], v16 offset:53248
    v_mfma_f32_16x16x32_bf16 v[132:135], v[60:63], a[168:171], v[132:135]
    ds_read_b64_tr_b16 v[52:53], v17 offset:49152
    global_load_dwordx4 a[240:243], v1, s[10:11] offset:0 sc1
    v_mfma_f32_16x16x32_bf16 v[140:143], v[60:63], a[172:175], v[140:143]
    ds_read_b64_tr_b16 v[54:55], v17 offset:53248
    v_mfma_f32_16x16x32_bf16 v[144:147], v[32:35], a[168:171], v[144:147]
    ds_read_b64_tr_b16 v[56:57], v14 offset:49664
    v_mfma_f32_16x16x32_bf16 v[152:155], v[32:35], a[172:175], v[152:155]
    ds_read_b64_tr_b16 v[58:59], v14 offset:53760
    v_mfma_f32_16x16x32_bf16 v[148:151], v[36:39], a[168:171], v[148:151]
    ds_read_b64_tr_b16 v[60:61], v15 offset:49664
    v_mfma_f32_16x16x32_bf16 v[156:159], v[36:39], a[172:175], v[156:159]
    ds_read_b64_tr_b16 v[62:63], v15 offset:53760
    global_load_lds_dwordx4 v6, s[8:9] offset:0
    s_waitcnt lgkmcnt(4)
    v_mfma_f32_16x16x32_bf16 v[96:99], v[40:43], a[176:179], v[96:99]
    ds_read_b64_tr_b16 v[32:33], v16 offset:49664
    v_mfma_f32_16x16x32_bf16 v[104:107], v[40:43], a[180:183], v[104:107]
    ds_read_b64_tr_b16 v[34:35], v16 offset:53760
    v_mfma_f32_16x16x32_bf16 v[100:103], v[44:47], a[176:179], v[100:103]
    ds_read_b64_tr_b16 v[36:37], v17 offset:49664
    global_load_dwordx4 a[244:247], v1, s[10:11] offset:1024 sc1
    v_mfma_f32_16x16x32_bf16 v[108:111], v[44:47], a[180:183], v[108:111]
    ds_read_b64_tr_b16 v[38:39], v17 offset:53760
    v_mfma_f32_16x16x32_bf16 v[112:115], v[48:51], a[176:179], v[112:115]
    ds_read_b64_tr_b16 v[40:41], v14 offset:57344
    v_mfma_f32_16x16x32_bf16 v[120:123], v[48:51], a[180:183], v[120:123]
    ds_read_b64_tr_b16 v[42:43], v14 offset:61440
    global_load_lds_dwordx4 v7, s[8:9] offset:1024
    v_mfma_f32_16x16x32_bf16 v[116:119], v[52:55], a[176:179], v[116:119]
    ds_read_b64_tr_b16 v[44:45], v15 offset:57344
    v_mfma_f32_16x16x32_bf16 v[124:127], v[52:55], a[180:183], v[124:127]
    ds_read_b64_tr_b16 v[46:47], v15 offset:61440
    s_waitcnt lgkmcnt(4)
    v_mfma_f32_16x16x32_bf16 v[128:131], v[56:59], a[176:179], v[128:131]
    ds_read_b64_tr_b16 v[48:49], v16 offset:57344
    global_load_dwordx4 a[248:251], v1, s[10:11] offset:2048 sc1
    v_mfma_f32_16x16x32_bf16 v[136:139], v[56:59], a[180:183], v[136:139]
    ds_read_b64_tr_b16 v[50:51], v16 offset:61440
    v_mfma_f32_16x16x32_bf16 v[132:135], v[60:63], a[176:179], v[132:135]
    ds_read_b64_tr_b16 v[52:53], v17 offset:57344
    v_mfma_f32_16x16x32_bf16 v[140:143], v[60:63], a[180:183], v[140:143]
    ds_read_b64_tr_b16 v[54:55], v17 offset:61440
    global_load_lds_dwordx4 v8, s[8:9] offset:2048
    v_mfma_f32_16x16x32_bf16 v[144:147], v[32:35], a[176:179], v[144:147]
    ds_read_b64_tr_b16 v[56:57], v14 offset:57856
    v_mfma_f32_16x16x32_bf16 v[152:155], v[32:35], a[180:183], v[152:155]
    ds_read_b64_tr_b16 v[58:59], v14 offset:61952
    v_mfma_f32_16x16x32_bf16 v[148:151], v[36:39], a[176:179], v[148:151]
    ds_read_b64_tr_b16 v[60:61], v15 offset:57856
    global_load_dwordx4 a[252:255], v1, s[10:11] offset:3072 sc1
    v_mfma_f32_16x16x32_bf16 v[156:159], v[36:39], a[180:183], v[156:159]
    ds_read_b64_tr_b16 v[62:63], v15 offset:61952
    s_waitcnt lgkmcnt(4)
    v_mfma_f32_16x16x32_bf16 v[96:99], v[40:43], a[184:187], v[96:99]
    ds_read_b64_tr_b16 v[32:33], v16 offset:57856
    v_mfma_f32_16x16x32_bf16 v[104:107], v[40:43], a[188:191], v[104:107]
    ds_read_b64_tr_b16 v[34:35], v16 offset:61952
    global_load_lds_dwordx4 v9, s[8:9] offset:3072
    v_mfma_f32_16x16x32_bf16 v[100:103], v[44:47], a[184:187], v[100:103]
    ds_read_b64_tr_b16 v[36:37], v17 offset:57856
    v_mfma_f32_16x16x32_bf16 v[108:111], v[44:47], a[188:191], v[108:111]
    ds_read_b64_tr_b16 v[38:39], v17 offset:61952
    v_mfma_f32_16x16x32_bf16 v[112:115], v[48:51], a[184:187], v[112:115]
    v_mfma_f32_16x16x32_bf16 v[120:123], v[48:51], a[188:191], v[120:123]
    v_mfma_f32_16x16x32_bf16 v[116:119], v[52:55], a[184:187], v[116:119]
    v_mfma_f32_16x16x32_bf16 v[124:127], v[52:55], a[188:191], v[124:127]
    s_waitcnt lgkmcnt(0)
    v_mfma_f32_16x16x32_bf16 v[128:131], v[56:59], a[184:187], v[128:131]
    v_add_u32 v14, 4294901760, v14
    v_add_u32 v15, 4294901760, v15
    v_add_u32 v16, 4294901760, v16
    v_add_u32 v17, 4294901760, v17
    s_waitcnt vmcnt(17)
    v_cmp_gt_u32 vcc, 3, v24
    s_nop 0
    s_and_b32 s32, vcc_lo, s1
    s_cbranch_scc1 L_poll_5
L_poll_5_ok:
    v_mfma_f32_16x16x32_bf16 v[136:139], v[56:59], a[188:191], v[136:139]
    s_barrier
    ds_read_b64_tr_b16 v[40:41], v14 offset:0
    ds_read_b64_tr_b16 v[42:43], v14 offset:4096
    ds_read_b64_tr_b16 v[44:45], v15 offset:0
    ds_read_b64_tr_b16 v[46:47], v15 offset:4096
    v_mfma_f32_16x16x32_bf16 v[132:135], v[60:63], a[184:187], v[132:135]
    ds_read_b64_tr_b16 v[48:49], v16 offset:0
    ds_read_b64_tr_b16 v[50:51], v16 offset:4096
    s_add_u32 s10, s16, 65536
    s_addc_u32 s11, s17, 0
    v_mfma_f32_16x16x32_bf16 v[140:143], v[60:63], a[188:191], v[140:143]
    ds_read_b64_tr_b16 v[52:53], v17 offset:0
    ds_read_b64_tr_b16 v[54:55], v17 offset:4096
    global_load_dwordx4 a[0:3], v1, s[10:11] offset:-4096 sc1
    v_mfma_f32_16x16x32_bf16 v[144:147], v[32:35], a[184:187], v[144:147]
    ds_read_b64_tr_b16 v[56:57], v14 offset:512
    s_add_u32 m0, s39, 98304
    s_add_u32 s8, s44, 1048576
    s_addc_u32 s9, s45, 0
    v_mfma_f32_16x16x32_bf16 v[152:155], v[32:35], a[188:191], v[152:155]
    ds_read_b64_tr_b16 v[58:59], v14 offset:4608
    global_load_lds_dwordx4 v2, s[8:9] offset:0
    v_mfma_f32_16x16x32_bf16 v[148:151], v[36:39], a[184:187], v[148:151]
    ds_read_b64_tr_b16 v[60:61], v15 offset:512
    v_mfma_f32_16x16x32_bf16 v[156:159], v[36:39], a[188:191], v[156:159]
    ds_read_b64_tr_b16 v[62:63], v15 offset:4608
    s_waitcnt lgkmcnt(4)
    v_mfma_f32_16x16x32_bf16 v[96:99], v[40:43], a[192:195], v[96:99]
    ds_read_b64_tr_b16 v[32:33], v16 offset:512
    v_mfma_f32_16x16x32_bf16 v[104:107], v[40:43], a[196:199], v[104:107]
    ds_read_b64_tr_b16 v[34:35], v16 offset:4608
    v_mfma_f32_16x16x32_bf16 v[100:103], v[44:47], a[192:195], v[100:103]
    ds_read_b64_tr_b16 v[36:37], v17 offset:512
    v_mfma_f32_16x16x32_bf16 v[108:111], v[44:47], a[196:199], v[108:111]
    ds_read_b64_tr_b16 v[38:39], v17 offset:4608
    v_mfma_f32_16x16x32_bf16 v[112:115], v[48:51], a[192:195], v[112:115]
    ds_read_b64_tr_b16 v[40:41], v14 offset:8192
    v_mfma_f32_16x16x32_bf16 v[120:123], v[48:51], a[196:199], v[120:123]
    ds_read_b64_tr_b16 v[42:43], v14 offset:12288
    v_mfma_f32_16x16x32_bf16 v[116:119], v[52:55], a[192:195], v[116:119]
    ds_read_b64_tr_b16 v[44:45], v15 offset:8192
    global_load_dwordx4 a[4:7], v1, s[10:11] offset:-3072 sc1
    v_mfma_f32_16x16x32_bf16 v[124:127], v[52:55], a[196:199], v[124:127]
    ds_read_b64_tr_b16 v[46:47], v15 offset:12288
    s_waitcnt lgkmcnt(4)
    v_mfma_f32_16x16x32_bf16 v[128:131], v[56:59], a[192:195], v[128:131]
    ds_read_b64_tr_b16 v[48:49], v16 offset:8192
    v_mfma_f32_16x16x32_bf16 v[136:139], v[56:59], a[196:199], v[136:139]
    ds_read_b64_tr_b16 v[50:51], v16 offset:12288
    v_mfma_f32_16x16x32_bf16 v[132:135], v[60:63], a[192:195], v[132:135]
    ds_read_b64_tr_b16 v[52:53], v17 offset:8192
    v_mfma_f32_16x16x32_bf16 v[140:143], v[60:63], a[196:199], v[140:143]
    ds_read_b64_tr_b16 v[54:55], v17 offset:12288
    global_load_lds_dwordx4 v3, s[8:9] offset:1024
    v_mfma_f32_16x16x32_bf16 v[144:147], v[32:35], a[192:195], v[144:147]
    ds_read_b64_tr_b16 v[56:57], v14 offset:8704
    v_mfma_f32_16x16x32_bf16 v[152:155], v[32:35], a[196:199], v[152:155]
    ds_read_b64_tr_b16 v[58:59], v14 offset:12800
    v_mfma_f32_16x16x32_bf16 v[148:151], v[36:39], a[192:195], v[148:151]
    ds_read_b64_tr_b16 v[60:61], v15 offset:8704
    global_load_dwordx4 a[8:11], v1, s[10:11] offset:-2048 sc1
    v_mfma_f32_16x16x32_bf16 v[156:159], v[36:39], a[196:199], v[156:159]
    ds_read_b64_tr_b16 v[62:63], v15 offset:12800
    s_waitcnt lgkmcnt(4)
    v_mfma_f32_16x16x32_bf16 v[96:99], v[40:43], a[200:203], v[96:99]
    ds_read_b64_tr_b16 v[32:33], v16 offset:8704
    v_mfma_f32_16x16x32_bf16 v[104:107], v[40:43], a[204:207], v[104:107]
    ds_read_b64_tr_b16 v[34:35], v16 offset:12800
    global_load_lds_dwordx4 v4, s[8:9] offset:2048
    v_mfma_f32_16x16x32_bf16 v[100:103], v[44:47], a[200:203], v[100:103]
    ds_read_b64_tr_b16 v[36:37], v17 offset:8704
    v_mfma_f32_16x16x32_bf16 v[108:111], v[44:47], a[204:207], v[108:111]
    ds_read_b64_tr_b16 v[38:39], v17 offset:12800
    v_mfma_f32_16x16x32_bf16 v[112:115], v[48:51], a[200:203], v[112:115]
    ds_read_b64_tr_b16 v[40:41], v14 offset:16384
    global_load_dwordx4 a[12:15], v1, s[10:11] offset:-1024 sc1
    v_mfma_f32_16x16x32_bf16 v[120:123], v[48:51], a[204:207], v[120:123]
    ds_read_b64_tr_b16 v[42:43], v14 offset:20480
    v_mfma_f32_16x16x32_bf16 v[116:119], v[52:55], a[200:203], v[116:119]
    ds_read_b64_tr_b16 v[44:45], v15 offset:16384
    v_mfma_f32_16x16x32_bf16 v[124:127], v[52:55], a[204:207], v[124:127]
    ds_read_b64_tr_b16 v[46:47], v15 offset:20480
    global_load_lds_dwordx4 v5, s[8:9] offset:3072
    s_add_u32 m0, s39, 102400
    s_waitcnt lgkmcnt(4)
    v_mfma_f32_16x16x32_bf16 v[128:131], v[56:59], a[200:203], v[128:131]
    ds_read_b64_tr_b16 v[48:49], v16 offset:16384
    v_mfma_f32_16x16x32_bf16 v[136:139], v[56:59], a[204:207], v[136:139]
    ds_read_b64_tr_b16 v[50:51], v16 offset:20480
    v_mfma_f32_16x16x32_bf16 v[132:135], v[60:63], a[200:203], v[132:135]
    ds_read_b64_tr_b16 v[52:53], v17 offset:16384
    global_load_dwordx4 a[16:19], v1, s[10:11] offset:0 sc1
    v_mfma_f32_16x16x32_bf16 v[140:143], v[60:63], a[204:207], v[140:143]
    ds_read_b64_tr_b16 v[54:55], v17 offset:20480
    v_mfma_f32_16x16x32_bf16 v[144:147], v[32:35], a[200:203], v[144:147]
    ds_read_b64_tr_b16 v[56:57], v14 offset:16896
    v_mfma_f32_16x16x32_bf16 v[152:155], v[32:35], a[204:207], v[152:155]
    ds_read_b64_tr_b16 v[58:59], v14 offset:20992
    v_mfma_f32_16x16x32_bf16 v[148:151], v[36:39], a[200:203], v[148:151]
    ds_read_b64_tr_b16 v[60:61], v15 offset:16896
    v_mfma_f32_16x16x32_bf16 v[156:159], v[36:39], a[204:207], v[156:159]
    ds_read_b64_tr_b16 v[62:63], v15 offset:20992
    global_load_lds_dwordx4 v6, s[8:9] offset:0
    s_waitcnt lgkmcnt(4)
    v_mfma_f32_16x16x32_bf16 v[96:99], v[40:43], a[208:211], v[96:99]
    ds_read_b64_tr_b16 v[32:33], v16 offset:16896
    v_mfma_f32_16x16x32_bf16 v[104:107], v[40:43], a[212:215], v[104:107]
    ds_read_b64_tr_b16 v[34:35], v16 offset:20992
    v_mfma_f32_16x16x32_bf16 v[100:103], v[44:47], a[208:211], v[100:103]
    ds_read_b64_tr_b16 v[36:37], v17 offset:16896
    global_load_dwordx4 a[20:23], v1, s[10:11] offset:1024 sc1
    v_mfma_f32_16x16x32_bf16 v[108:111], v[44:47], a[212:215], v[108:111]
    ds_read_b64_tr_b16 v[38:39], v17 offset:20992
    v_mfma_f32_16x16x32_bf16 v[112:115], v[48:51], a[208:211], v[112:115]
    ds_read_b64_tr_b16 v[40:41], v14 offset:24576
    v_mfma_f32_16x16x32_bf16 v[120:123], v[48:51], a[212:215], v[120:123]
    ds_read_b64_tr_b16 v[42:43], v14 offset:28672
    global_load_lds_dwordx4 v7, s[8:9] offset:1024
    v_mfma_f32_16x16x32_bf16 v[116:119], v[52:55], a[208:211], v[116:119]
    ds_read_b64_tr_b16 v[44:45], v15 offset:24576
    v_mfma_f32_16x16x32_bf16 v[124:127], v[52:55], a[212:215], v[124:127]
    ds_read_b64_tr_b16 v[46:47], v15 offset:28672
    s_waitcnt lgkmcnt(4)
    v_mfma_f32_16x16x32_bf16 v[128:131], v[56:59], a[208:211], v[128:131]
    ds_read_b64_tr_b16 v[48:49], v16 offset:24576
    global_load_dwordx4 a[24:27], v1, s[10:11] offset:2048 sc1
    v_mfma_f32_16x16x32_bf16 v[136:139], v[56:59], a[212:215], v[136:139]
    ds_read_b64_tr_b16 v[50:51], v16 offset:28672
    v_mfma_f32_16x16x32_bf16 v[132:135], v[60:63], a[208:211], v[132:135]
    ds_read_b64_tr_b16 v[52:53], v17 offset:24576
    v_mfma_f32_16x16x32_bf16 v[140:143], v[60:63], a[212:215], v[140:143]
    ds_read_b64_tr_b16 v[54:55], v17 offset:28672
    global_load_lds_dwordx4 v8, s[8:9] offset:2048
    v_mfma_f32_16x16x32_bf16 v[144:147], v[32:35], a[208:211], v[144:147]
    ds_read_b64_tr_b16 v[56:57], v14 offset:25088
    v_mfma_f32_16x16x32_bf16 v[152:155], v[32:35], a[212:215], v[152:155]
    ds_read_b64_tr_b16 v[58:59], v14 offset:29184
    v_mfma_f32_16x16x32_bf16 v[148:151], v[36:39], a[208:211], v[148:151]
    ds_read_b64_tr_b16 v[60:61], v15 offset:25088
    global_load_dwordx4 a[28:31], v1, s[10:11] offset:3072 sc1
    v_mfma_f32_16x16x32_bf16 v[156:159], v[36:39], a[212:215], v[156:159]
    ds_read_b64_tr_b16 v[62:63], v15 offset:29184
    s_waitcnt lgkmcnt(4)
    v_mfma_f32_16x16x32_bf16 v[96:99], v[40:43], a[216:219], v[96:99]
    ds_read_b64_tr_b16 v[32:33], v16 offset:25088
    v_mfma_f32_16x16x32_bf16 v[104:107], v[40:43], a[220:223], v[104:107]
    ds_read_b64_tr_b16 v[34:35], v16 offset:29184
    global_load_lds_dwordx4 v9, s[8:9] offset:3072
    v_mfma_f32_16x16x32_bf16 v[100:103], v[44:47], a[216:219], v[100:103]
    ds_read_b64_tr_b16 v[36:37], v17 offset:25088
    v_mfma_f32_16x16x32_bf16 v[108:111], v[44:47], a[220:223], v[108:111]
    ds_read_b64_tr_b16 v[38:39], v17 offset:29184
    v_mfma_f32_16x16x32_bf16 v[112:115], v[48:51], a[216:219], v[112:115]
    v_mfma_f32_16x16x32_bf16 v[120:123], v[48:51], a[220:223], v[120:123]
    v_mfma_f32_16x16x32_bf16 v[116:119], v[52:55], a[216:219], v[116:119]
    v_mfma_f32_16x16x32_bf16 v[124:127], v[52:55], a[220:223], v[124:127]
    s_waitcnt lgkmcnt(0)
    v_mfma_f32_16x16x32_bf16 v[128:131], v[56:59], a[216:219], v[128:131]
    v_mfma_f32_16x16x32_bf16 v[136:139], v[56:59], a[220:223], v[136:139]
    s_waitcnt vmcnt(17)
    s_barrier
    s_getpc_b64 vcc
L_ct7:
    s_min_u32 s32, s82, L_end-L_ct7
    v_mov_b32 v0, s32
    global_load_dword v22, v0, vcc
    v_mov_b32 v0, 4
    buffer_store_dword v0, v27, s[12:15], s49 offen sc1
    v_and_b32 v30, 0xf0, v1
    v_lshrrev_b32 v30, 2, v30
    s_lshl_b32 s32, s29, 2
    s_add_u32 s32, s32, s28
    s_lshl_b32 s32, s32, 7
    s_add_u32 s32, s32, 19922944
    buffer_load_dword v28, v30, s[12:15], s32 offen offset:0 sc1
    buffer_load_dword v29, v30, s[12:15], s32 offen offset:64 sc1
    ds_read_b64_tr_b16 v[40:41], v14 offset:32768
    ds_read_b64_tr_b16 v[42:43], v14 offset:36864
    ds_read_b64_tr_b16 v[44:45], v15 offset:32768
    ds_read_b64_tr_b16 v[46:47], v15 offset:36864
    v_mfma_f32_16x16x32_bf16 v[132:135], v[60:63], a[216:219], v[132:135]
    ds_read_b64_tr_b16 v[48:49], v16 offset:32768
    ds_read_b64_tr_b16 v[50:51], v16 offset:36864
    s_add_u32 s10, s16, 73728
    s_addc_u32 s11, s17, 0
    v_mfma_f32_16x16x32_bf16 v[140:143], v[60:63], a[220:223], v[140:143]
    ds_read_b64_tr_b16 v[52:53], v17 offset:32768
    ds_read_b64_tr_b16 v[54:55], v17 offset:36864
    global_load_dwordx4 a[32:35], v1, s[10:11] offset:-4096 sc1
    v_mfma_f32_16x16x32_bf16 v[144:147], v[32:35], a[216:219], v[144:147]
    ds_read_b64_tr_b16 v[56:57], v14 offset:33280
    s_add_u32 m0, s39, 0
    s_add_u32 s8, s44, 1835008
    s_addc_u32 s9, s45, 0
    v_mfma_f32_16x16x32_bf16 v[152:155], v[32:35], a[220:223], v[152:155]
    ds_read_b64_tr_b16 v[58:59], v14 offset:37376
    global_load_lds_dwordx4 v2, s[8:9] offset:0
    v_mfma_f32_16x16x32_bf16 v[148:151], v[36:39], a[216:219], v[148:151]
    ds_read_b64_tr_b16 v[60:61], v15 offset:33280
    v_mfma_f32_16x16x32_bf16 v[156:159], v[36:39], a[220:223], v[156:159]
    ds_read_b64_tr_b16 v[62:63], v15 offset:37376
    s_waitcnt lgkmcnt(4)
    v_mfma_f32_16x16x32_bf16 v[96:99], v[40:43], a[224:227], v[96:99]
    ds_read_b64_tr_b16 v[32:33], v16 offset:33280
    v_mfma_f32_16x16x32_bf16 v[104:107], v[40:43], a[228:231], v[104:107]
    ds_read_b64_tr_b16 v[34:35], v16 offset:37376
    v_mfma_f32_16x16x32_bf16 v[100:103], v[44:47], a[224:227], v[100:103]
    ds_read_b64_tr_b16 v[36:37], v17 offset:33280
    v_mfma_f32_16x16x32_bf16 v[108:111], v[44:47], a[228:231], v[108:111]
    ds_read_b64_tr_b16 v[38:39], v17 offset:37376
    v_mfma_f32_16x16x32_bf16 v[112:115], v[48:51], a[224:227], v[112:115]
    ds_read_b64_tr_b16 v[40:41], v14 offset:40960
    v_mfma_f32_16x16x32_bf16 v[120:123], v[48:51], a[228:231], v[120:123]
    ds_read_b64_tr_b16 v[42:43], v14 offset:45056
    v_mfma_f32_16x16x32_bf16 v[116:119], v[52:55], a[224:227], v[116:119]
    ds_read_b64_tr_b16 v[44:45], v15 offset:40960
    global_load_dwordx4 a[36:39], v1, s[10:11] offset:-3072 sc1
    v_mfma_f32_16x16x32_bf16 v[124:127], v[52:55], a[228:231], v[124:127]
    ds_read_b64_tr_b16 v[46:47], v15 offset:45056
    s_waitcnt lgkmcnt(4)
    v_mfma_f32_16x16x32_bf16 v[128:131], v[56:59], a[224:227], v[128:131]
    ds_read_b64_tr_b16 v[48:49], v16 offset:40960
    v_mfma_f32_16x16x32_bf16 v[136:139], v[56:59], a[228:231], v[136:139]
    ds_read_b64_tr_b16 v[50:51], v16 offset:45056
    v_mfma_f32_16x16x32_bf16 v[132:135], v[60:63], a[224:227], v[132:135]
    ds_read_b64_tr_b16 v[52:53], v17 offset:40960
    v_mfma_f32_16x16x32_bf16 v[140:143], v[60:63], a[228:231], v[140:143]
    ds_read_b64_tr_b16 v[54:55], v17 offset:45056
    global_load_lds_dwordx4 v3, s[8:9] offset:1024
    v_mfma_f32_16x16x32_bf16 v[144:147], v[32:35], a[224:227], v[144:147]
    ds_read_b64_tr_b16 v[56:57], v14 offset:41472
    v_mfma_f32_16x16x32_bf16 v[152:155], v[32:35], a[228:231], v[152:155]
    ds_read_b64_tr_b16 v[58:59], v14 offset:45568
    v_mfma_f32_16x16x32_bf16 v[148:151], v[36:39], a[224:227], v[148:151]
    ds_read_b64_tr_b16 v[60:61], v15 offset:41472
    global_load_dwordx4 a[40:43], v1, s[10:11] offset:-2048 sc1
    v_mfma_f32_16x16x32_bf16 v[156:159], v[36:39], a[228:231], v[156:159]
    ds_read_b64_tr_b16 v[62:63], v15 offset:45568
    s_waitcnt lgkmcnt(4)
    v_mfma_f32_16x16x32_bf16 v[96:99], v[40:43], a[232:235], v[96:99]
    ds_read_b64_tr_b16 v[32:33], v16 offset:41472
    v_mfma_f32_16x16x32_bf16 v[104:107], v[40:43], a[236:239], v[104:107]
    ds_read_b64_tr_b16 v[34:35], v16 offset:45568
    global_load_lds_dwordx4 v4, s[8:9] offset:2048
    v_mfma_f32_16x16x32_bf16 v[100:103], v[44:47], a[232:235], v[100:103]
    ds_read_b64_tr_b16 v[36:37], v17 offset:41472
    v_mfma_f32_16x16x32_bf16 v[108:111], v[44:47], a[236:239], v[108:111]
    ds_read_b64_tr_b16 v[38:39], v17 offset:45568
    v_mfma_f32_16x16x32_bf16 v[112:115], v[48:51], a[232:235], v[112:115]
    ds_read_b64_tr_b16 v[40:41], v14 offset:49152
    global_load_dwordx4 a[44:47], v1, s[10:11] offset:-1024 sc1
    v_mfma_f32_16x16x32_bf16 v[120:123], v[48:51], a[236:239], v[120:123]
    ds_read_b64_tr_b16 v[42:43], v14 offset:53248
    v_mfma_f32_16x16x32_bf16 v[116:119], v[52:55], a[232:235], v[116:119]
    ds_read_b64_tr_b16 v[44:45], v15 offset:49152
    v_mfma_f32_16x16x32_bf16 v[124:127], v[52:55], a[236:239], v[124:127]
    ds_read_b64_tr_b16 v[46:47], v15 offset:53248
    global_load_lds_dwordx4 v5, s[8:9] offset:3072
    s_add_u32 m0, s39, 4096
    s_waitcnt lgkmcnt(4)
    v_mfma_f32_16x16x32_bf16 v[128:131], v[56:59], a[232:235], v[128:131]
    ds_read_b64_tr_b16 v[48:49], v16 offset:49152
    v_mfma_f32_16x16x32_bf16 v[136:139], v[56:59], a[236:239], v[136:139]
    ds_read_b64_tr_b16 v[50:51], v16 offset:53248
    v_mfma_f32_16x16x32_bf16 v[132:135], v[60:63], a[232:235], v[132:135]
    ds_read_b64_tr_b16 v[52:53], v17 offset:49152
    global_load_dwordx4 a[48:51], v1, s[10:11] offset:0 sc1
    v_mfma_f32_16x16x32_bf16 v[140:143], v[60:63], a[236:239], v[140:143]
    ds_read_b64_tr_b16 v[54:55], v17 offset:53248
    v_mfma_f32_16x16x32_bf16 v[144:147], v[32:35], a[232:235], v[144:147]
    ds_read_b64_tr_b16 v[56:57], v14 offset:49664
    v_mfma_f32_16x16x32_bf16 v[152:155], v[32:35], a[236:239], v[152:155]
    ds_read_b64_tr_b16 v[58:59], v14 offset:53760
    v_mfma_f32_16x16x32_bf16 v[148:151], v[36:39], a[232:235], v[148:151]
    ds_read_b64_tr_b16 v[60:61], v15 offset:49664
    v_mfma_f32_16x16x32_bf16 v[156:159], v[36:39], a[236:239], v[156:159]
    ds_read_b64_tr_b16 v[62:63], v15 offset:53760
    global_load_lds_dwordx4 v6, s[8:9] offset:0
    s_waitcnt lgkmcnt(4)
    v_mfma_f32_16x16x32_bf16 v[96:99], v[40:43], a[240:243], v[96:99]
    ds_read_b64_tr_b16 v[32:33], v16 offset:49664
    v_mfma_f32_16x16x32_bf16 v[104:107], v[40:43], a[244:247], v[104:107]
    ds_read_b64_tr_b16 v[34:35], v16 offset:53760
    v_mfma_f32_16x16x32_bf16 v[100:103], v[44:47], a[240:243], v[100:103]
    ds_read_b64_tr_b16 v[36:37], v17 offset:49664
    global_load_dwordx4 a[52:55], v1, s[10:11] offset:1024 sc1
    v_mfma_f32_16x16x32_bf16 v[108:111], v[44:47], a[244:247], v[108:111]
    ds_read_b64_tr_b16 v[38:39], v17 offset:53760
    v_mfma_f32_16x16x32_bf16 v[112:115], v[48:51], a[240:243], v[112:115]
    ds_read_b64_tr_b16 v[40:41], v14 offset:57344
    v_mfma_f32_16x16x32_bf16 v[120:123], v[48:51], a[244:247], v[120:123]
    ds_read_b64_tr_b16 v[42:43], v14 offset:61440
    global_load_lds_dwordx4 v7, s[8:9] offset:1024
    v_mfma_f32_16x16x32_bf16 v[116:119], v[52:55], a[240:243], v[116:119]
    ds_read_b64_tr_b16 v[44:45], v15 offset:57344
    v_mfma_f32_16x16x32_bf16 v[124:127], v[52:55], a[244:247], v[124:127]
    ds_read_b64_tr_b16 v[46:47], v15 offset:61440
    s_waitcnt lgkmcnt(4)
    v_mfma_f32_16x16x32_bf16 v[128:131], v[56:59], a[240:243], v[128:131]
    ds_read_b64_tr_b16 v[48:49], v16 offset:57344
    global_load_dwordx4 a[56:59], v1, s[10:11] offset:2048 sc1
    v_mfma_f32_16x16x32_bf16 v[136:139], v[56:59], a[244:247], v[136:139]
    ds_read_b64_tr_b16 v[50:51], v16 offset:61440
    v_mfma_f32_16x16x32_bf16 v[132:135], v[60:63], a[240:243], v[132:135]
    ds_read_b64_tr_b16 v[52:53], v17 offset:57344
    v_mfma_f32_16x16x32_bf16 v[140:143], v[60:63], a[244:247], v[140:143]
    ds_read_b64_tr_b16 v[54:55], v17 offset:61440
    global_load_lds_dwordx4 v8, s[8:9] offset:2048
    v_mfma_f32_16x16x32_bf16 v[144:147], v[32:35], a[240:243], v[144:147]
    ds_read_b64_tr_b16 v[56:57], v14 offset:57856
    v_mfma_f32_16x16x32_bf16 v[152:155], v[32:35], a[244:247], v[152:155]
    ds_read_b64_tr_b16 v[58:59], v14 offset:61952
    v_mfma_f32_16x16x32_bf16 v[148:151], v[36:39], a[240:243], v[148:151]
    ds_read_b64_tr_b16 v[60:61], v15 offset:57856
    global_load_dwordx4 a[60:63], v1, s[10:11] offset:3072 sc1
    v_mfma_f32_16x16x32_bf16 v[156:159], v[36:39], a[244:247], v[156:159]
    ds_read_b64_tr_b16 v[62:63], v15 offset:61952
    s_waitcnt lgkmcnt(4)
    v_mfma_f32_16x16x32_bf16 v[96:99], v[40:43], a[248:251], v[96:99]
    ds_read_b64_tr_b16 v[32:33], v16 offset:57856
    v_mfma_f32_16x16x32_bf16 v[104:107], v[40:43], a[252:255], v[104:107]
    ds_read_b64_tr_b16 v[34:35], v16 offset:61952
    global_load_lds_dwordx4 v9, s[8:9] offset:3072
    v_mfma_f32_16x16x32_bf16 v[100:103], v[44:47], a[248:251], v[100:103]
    ds_read_b64_tr_b16 v[36:37], v17 offset:57856
    v_mfma_f32_16x16x32_bf16 v[108:111], v[44:47], a[252:255], v[108:111]
    ds_read_b64_tr_b16 v[38:39], v17 offset:61952
    v_mfma_f32_16x16x32_bf16 v[112:115], v[48:51], a[248:251], v[112:115]
    v_mfma_f32_16x16x32_bf16 v[120:123], v[48:51], a[252:255], v[120:123]
    v_mfma_f32_16x16x32_bf16 v[116:119], v[52:55], a[248:251], v[116:119]
    v_mfma_f32_16x16x32_bf16 v[124:127], v[52:55], a[252:255], v[124:127]
    s_waitcnt lgkmcnt(0)
    v_mfma_f32_16x16x32_bf16 v[128:131], v[56:59], a[248:251], v[128:131]
    v_add_u32 v14, 65536, v14
    v_add_u32 v15, 65536, v15
    v_add_u32 v16, 65536, v16
    v_add_u32 v17, 65536, v17
    v_mfma_f32_16x16x32_bf16 v[136:139], v[56:59], a[252:255], v[136:139]
    s_waitcnt vmcnt(21)
    s_barrier
    ds_read_b64_tr_b16 v[40:41], v14 offset:0
    ds_read_b64_tr_b16 v[42:43], v14 offset:4096
    ds_read_b64_tr_b16 v[44:45], v15 offset:0
    ds_read_b64_tr_b16 v[46:47], v15 offset:4096
    v_mfma_f32_16x16x32_bf16 v[132:135], v[60:63], a[248:251], v[132:135]
    ds_read_b64_tr_b16 v[48:49], v16 offset:0
    ds_read_b64_tr_b16 v[50:51], v16 offset:4096
    s_add_u32 s10, s16, 81920
    s_addc_u32 s11, s17, 0
    v_mfma_f32_16x16x32_bf16 v[140:143], v[60:63], a[252:255], v[140:143]
    ds_read_b64_tr_b16 v[52:53], v17 offset:0
    ds_read_b64_tr_b16 v[54:55], v17 offset:4096
    global_load_dwordx4 a[64:67], v1, s[10:11] offset:-4096 sc1
    v_mfma_f32_16x16x32_bf16 v[144:147], v[32:35], a[248:251], v[144:147]
    ds_read_b64_tr_b16 v[56:57], v14 offset:512
    s_add_u32 m0, s39, 32768
    s_add_u32 s8, s44, 2621440
    s_addc_u32 s9, s45, 0
    v_mfma_f32_16x16x32_bf16 v[152:155], v[32:35], a[252:255], v[152:155]
    ds_read_b64_tr_b16 v[58:59], v14 offset:4608
    global_load_lds_dwordx4 v2, s[8:9] offset:0
    v_mfma_f32_16x16x32_bf16 v[148:151], v[36:39], a[248:251], v[148:151]
    ds_read_b64_tr_b16 v[60:61], v15 offset:512
    v_mfma_f32_16x16x32_bf16 v[156:159], v[36:39], a[252:255], v[156:159]
    ds_read_b64_tr_b16 v[62:63], v15 offset:4608
    s_waitcnt lgkmcnt(4)
    v_mfma_f32_16x16x32_bf16 v[96:99], v[40:43], a[0:3], v[96:99]
    ds_read_b64_tr_b16 v[32:33], v16 offset:512
    v_mfma_f32_16x16x32_bf16 v[104:107], v[40:43], a[4:7], v[104:107]
    ds_read_b64_tr_b16 v[34:35], v16 offset:4608
    v_mfma_f32_16x16x32_bf16 v[100:103], v[44:47], a[0:3], v[100:103]
    ds_read_b64_tr_b16 v[36:37], v17 offset:512
    v_mfma_f32_16x16x32_bf16 v[108:111], v[44:47], a[4:7], v[108:111]
    ds_read_b64_tr_b16 v[38:39], v17 offset:4608
    v_mfma_f32_16x16x32_bf16 v[112:115], v[48:51], a[0:3], v[112:115]
    ds_read_b64_tr_b16 v[40:41], v14 offset:8192
    v_mfma_f32_16x16x32_bf16 v[120:123], v[48:51], a[4:7], v[120:123]
    ds_read_b64_tr_b16 v[42:43], v14 offset:12288
    v_mfma_f32_16x16x32_bf16 v[116:119], v[52:55], a[0:3], v[116:119]
    ds_read_b64_tr_b16 v[44:45], v15 offset:8192
    global_load_dwordx4 a[68:71], v1, s[10:11] offset:-3072 sc1
    v_mfma_f32_16x16x32_bf16 v[124:127], v[52:55], a[4:7], v[124:127]
    ds_read_b64_tr_b16 v[46:47], v15 offset:12288
    s_waitcnt lgkmcnt(4)
    v_mfma_f32_16x16x32_bf16 v[128:131], v[56:59], a[0:3], v[128:131]
    ds_read_b64_tr_b16 v[48:49], v16 offset:8192
    v_mfma_f32_16x16x32_bf16 v[136:139], v[56:59], a[4:7], v[136:139]
    ds_read_b64_tr_b16 v[50:51], v16 offset:12288
    v_mfma_f32_16x16x32_bf16 v[132:135], v[60:63], a[0:3], v[132:135]
    ds_read_b64_tr_b16 v[52:53], v17 offset:8192
    v_mfma_f32_16x16x32_bf16 v[140:143], v[60:63], a[4:7], v[140:143]
    ds_read_b64_tr_b16 v[54:55], v17 offset:12288
    global_load_lds_dwordx4 v3, s[8:9] offset:1024
    v_mfma_f32_16x16x32_bf16 v[144:147], v[32:35], a[0:3], v[144:147]
    ds_read_b64_tr_b16 v[56:57], v14 offset:8704
    v_mfma_f32_16x16x32_bf16 v[152:155], v[32:35], a[4:7], v[152:155]
    ds_read_b64_tr_b16 v[58:59], v14 offset:12800
    v_mfma_f32_16x16x32_bf16 v[148:151], v[36:39], a[0:3], v[148:151]
    ds_read_b64_tr_b16 v[60:61], v15 offset:8704
    global_load_dwordx4 a[72:75], v1, s[10:11] offset:-2048 sc1
    v_mfma_f32_16x16x32_bf16 v[156:159], v[36:39], a[4:7], v[156:159]
    ds_read_b64_tr_b16 v[62:63], v15 offset:12800
    s_waitcnt lgkmcnt(4)
    v_mfma_f32_16x16x32_bf16 v[96:99], v[40:43], a[8:11], v[96:99]
    ds_read_b64_tr_b16 v[32:33], v16 offset:8704
    v_mfma_f32_16x16x32_bf16 v[104:107], v[40:43], a[12:15], v[104:107]
    ds_read_b64_tr_b16 v[34:35], v16 offset:12800
    global_load_lds_dwordx4 v4, s[8:9] offset:2048
    v_mfma_f32_16x16x32_bf16 v[100:103], v[44:47], a[8:11], v[100:103]
    ds_read_b64_tr_b16 v[36:37], v17 offset:8704
    v_mfma_f32_16x16x32_bf16 v[108:111], v[44:47], a[12:15], v[108:111]
    ds_read_b64_tr_b16 v[38:39], v17 offset:12800
    v_mfma_f32_16x16x32_bf16 v[112:115], v[48:51], a[8:11], v[112:115]
    ds_read_b64_tr_b16 v[40:41], v14 offset:16384
    global_load_dwordx4 a[76:79], v1, s[10:11] offset:-1024 sc1
    v_mfma_f32_16x16x32_bf16 v[120:123], v[48:51], a[12:15], v[120:123]
    ds_read_b64_tr_b16 v[42:43], v14 offset:20480
    v_mfma_f32_16x16x32_bf16 v[116:119], v[52:55], a[8:11], v[116:119]
    ds_read_b64_tr_b16 v[44:45], v15 offset:16384
    v_mfma_f32_16x16x32_bf16 v[124:127], v[52:55], a[12:15], v[124:127]
    ds_read_b64_tr_b16 v[46:47], v15 offset:20480
    global_load_lds_dwordx4 v5, s[8:9] offset:3072
    s_add_u32 m0, s39, 36864
    s_waitcnt lgkmcnt(4)
    v_mfma_f32_16x16x32_bf16 v[128:131], v[56:59], a[8:11], v[128:131]
    ds_read_b64_tr_b16 v[48:49], v16 offset:16384
    v_mfma_f32_16x16x32_bf16 v[136:139], v[56:59], a[12:15], v[136:139]
    ds_read_b64_tr_b16 v[50:51], v16 offset:20480
    v_mfma_f32_16x16x32_bf16 v[132:135], v[60:63], a[8:11], v[132:135]
    ds_read_b64_tr_b16 v[52:53], v17 offset:16384
    global_load_dwordx4 a[80:83], v1, s[10:11] offset:0 sc1
    v_mfma_f32_16x16x32_bf16 v[140:143], v[60:63], a[12:15], v[140:143]
    ds_read_b64_tr_b16 v[54:55], v17 offset:20480
    v_mfma_f32_16x16x32_bf16 v[144:147], v[32:35], a[8:11], v[144:147]
    ds_read_b64_tr_b16 v[56:57], v14 offset:16896
    v_mfma_f32_16x16x32_bf16 v[152:155], v[32:35], a[12:15], v[152:155]
    ds_read_b64_tr_b16 v[58:59], v14 offset:20992
    v_mfma_f32_16x16x32_bf16 v[148:151], v[36:39], a[8:11], v[148:151]
    ds_read_b64_tr_b16 v[60:61], v15 offset:16896
    v_mfma_f32_16x16x32_bf16 v[156:159], v[36:39], a[12:15], v[156:159]
    ds_read_b64_tr_b16 v[62:63], v15 offset:20992
    global_load_lds_dwordx4 v6, s[8:9] offset:0
    s_waitcnt lgkmcnt(4)
    v_mfma_f32_16x16x32_bf16 v[96:99], v[40:43], a[16:19], v[96:99]
    ds_read_b64_tr_b16 v[32:33], v16 offset:16896
    v_mfma_f32_16x16x32_bf16 v[104:107], v[40:43], a[20:23], v[104:107]
    ds_read_b64_tr_b16 v[34:35], v16 offset:20992
    v_mfma_f32_16x16x32_bf16 v[100:103], v[44:47], a[16:19], v[100:103]
    ds_read_b64_tr_b16 v[36:37], v17 offset:16896
    global_load_dwordx4 a[84:87], v1, s[10:11] offset:1024 sc1
    v_mfma_f32_16x16x32_bf16 v[108:111], v[44:47], a[20:23], v[108:111]
    ds_read_b64_tr_b16 v[38:39], v17 offset:20992
    v_mfma_f32_16x16x32_bf16 v[112:115], v[48:51], a[16:19], v[112:115]
    ds_read_b64_tr_b16 v[40:41], v14 offset:24576
    v_mfma_f32_16x16x32_bf16 v[120:123], v[48:51], a[20:23], v[120:123]
    ds_read_b64_tr_b16 v[42:43], v14 offset:28672
    global_load_lds_dwordx4 v7, s[8:9] offset:1024
    v_mfma_f32_16x16x32_bf16 v[116:119], v[52:55], a[16:19], v[116:119]
    ds_read_b64_tr_b16 v[44:45], v15 offset:24576
    v_mfma_f32_16x16x32_bf16 v[124:127], v[52:55], a[20:23], v[124:127]
    ds_read_b64_tr_b16 v[46:47], v15 offset:28672
    s_waitcnt lgkmcnt(4)
    v_mfma_f32_16x16x32_bf16 v[128:131], v[56:59], a[16:19], v[128:131]
    ds_read_b64_tr_b16 v[48:49], v16 offset:24576
    global_load_dwordx4 a[88:91], v1, s[10:11] offset:2048 sc1
    v_mfma_f32_16x16x32_bf16 v[136:139], v[56:59], a[20:23], v[136:139]
    ds_read_b64_tr_b16 v[50:51], v16 offset:28672
    v_mfma_f32_16x16x32_bf16 v[132:135], v[60:63], a[16:19], v[132:135]
    ds_read_b64_tr_b16 v[52:53], v17 offset:24576
    v_mfma_f32_16x16x32_bf16 v[140:143], v[60:63], a[20:23], v[140:143]
    ds_read_b64_tr_b16 v[54:55], v17 offset:28672
    global_load_lds_dwordx4 v8, s[8:9] offset:2048
    v_mfma_f32_16x16x32_bf16 v[144:147], v[32:35], a[16:19], v[144:147]
    ds_read_b64_tr_b16 v[56:57], v14 offset:25088
    v_mfma_f32_16x16x32_bf16 v[152:155], v[32:35], a[20:23], v[152:155]
    ds_read_b64_tr_b16 v[58:59], v14 offset:29184
    v_mfma_f32_16x16x32_bf16 v[148:151], v[36:39], a[16:19], v[148:151]
    ds_read_b64_tr_b16 v[60:61], v15 offset:25088
    global_load_dwordx4 a[92:95], v1, s[10:11] offset:3072 sc1
    v_mfma_f32_16x16x32_bf16 v[156:159], v[36:39], a[20:23], v[156:159]
    ds_read_b64_tr_b16 v[62:63], v15 offset:29184
    s_waitcnt lgkmcnt(4)
    v_mfma_f32_16x16x32_bf16 v[96:99], v[40:43], a[24:27], v[96:99]
    ds_read_b64_tr_b16 v[32:33], v16 offset:25088
    v_mfma_f32_16x16x32_bf16 v[104:107], v[40:43], a[28:31], v[104:107]
    ds_read_b64_tr_b16 v[34:35], v16 offset:29184
    global_load_lds_dwordx4 v9, s[8:9] offset:3072
    v_mfma_f32_16x16x32_bf16 v[100:103], v[44:47], a[24:27], v[100:103]
    ds_read_b64_tr_b16 v[36:37], v17 offset:25088
    v_mfma_f32_16x16x32_bf16 v[108:111], v[44:47], a[28:31], v[108:111]
    ds_read_b64_tr_b16 v[38:39], v17 offset:29184
    v_mfma_f32_16x16x32_bf16 v[112:115], v[48:51], a[24:27], v[112:115]
    v_mfma_f32_16x16x32_bf16 v[120:123], v[48:51], a[28:31], v[120:123]
    v_mfma_f32_16x16x32_bf16 v[116:119], v[52:55], a[24:27], v[116:119]
    v_mfma_f32_16x16x32_bf16 v[124:127], v[52:55], a[28:31], v[124:127]
    s_waitcnt lgkmcnt(0)
    v_mfma_f32_16x16x32_bf16 v[128:131], v[56:59], a[24:27], v[128:131]
    v_mfma_f32_16x16x32_bf16 v[136:139], v[56:59], a[28:31], v[136:139]
    s_waitcnt vmcnt(17)
    s_barrier
    buffer_load_dword v24, v25, s[12:15], s40 offen sc1
    ds_read_b64_tr_b16 v[40:41], v14 offset:32768
    ds_read_b64_tr_b16 v[42:43], v14 offset:36864
    ds_read_b64_tr_b16 v[44:45], v15 offset:32768
    ds_read_b64_tr_b16 v[46:47], v15 offset:36864
    v_mfma_f32_16x16x32_bf16 v[132:135], v[60:63], a[24:27], v[132:135]
    ds_read_b64_tr_b16 v[48:49], v16 offset:32768
    ds_read_b64_tr_b16 v[50:51], v16 offset:36864
    s_add_u32 s10, s16, 90112
    s_addc_u32 s11, s17, 0
    v_mfma_f32_16x16x32_bf16 v[140:143], v[60:63], a[28:31], v[140:143]
    ds_read_b64_tr_b16 v[52:53], v17 offset:32768
    ds_read_b64_tr_b16 v[54:55], v17 offset:36864
    global_load_dwordx4 a[96:99], v1, s[10:11] offset:-4096 sc1
    v_mfma_f32_16x16x32_bf16 v[144:147], v[32:35], a[24:27], v[144:147]
    ds_read_b64_tr_b16 v[56:57], v14 offset:33280
    s_lshl_b32 s34, s31, 20
    v_mfma_f32_16x16x32_bf16 v[152:155], v[32:35], a[28:31], v[152:155]
    ds_read_b64_tr_b16 v[58:59], v14 offset:37376
    v_mfma_f32_16x16x32_bf16 v[148:151], v[36:39], a[24:27], v[148:151]
    ds_read_b64_tr_b16 v[60:61], v15 offset:33280
    s_lshl_b32 s32, s28, 16
    v_mfma_f32_16x16x32_bf16 v[156:159], v[36:39], a[28:31], v[156:159]
    ds_read_b64_tr_b16 v[62:63], v15 offset:37376
    s_add_u32 s34, s34, s32
    s_waitcnt lgkmcnt(4)
    v_mfma_f32_16x16x32_bf16 v[96:99], v[40:43], a[32:35], v[96:99]
    ds_read_b64_tr_b16 v[32:33], v16 offset:33280
    v_mfma_f32_16x16x32_bf16 v[104:107], v[40:43], a[36:39], v[104:107]
    ds_read_b64_tr_b16 v[34:35], v16 offset:37376
    v_mfma_f32_16x16x32_bf16 v[100:103], v[44:47], a[32:35], v[100:103]
    ds_read_b64_tr_b16 v[36:37], v17 offset:33280
    s_add_u32 s44, s80, s34
    v_mfma_f32_16x16x32_bf16 v[108:111], v[44:47], a[36:39], v[108:111]
    ds_read_b64_tr_b16 v[38:39], v17 offset:37376
    s_addc_u32 s45, s81, 0
    v_mfma_f32_16x16x32_bf16 v[112:115], v[48:51], a[32:35], v[112:115]
    ds_read_b64_tr_b16 v[40:41], v14 offset:40960
    v_cvt_pk_bf16_f32 v28, v28, v28
    v_mfma_f32_16x16x32_bf16 v[120:123], v[48:51], a[36:39], v[120:123]
    ds_read_b64_tr_b16 v[42:43], v14 offset:45056
    v_mfma_f32_16x16x32_bf16 v[116:119], v[52:55], a[32:35], v[116:119]
    ds_read_b64_tr_b16 v[44:45], v15 offset:40960
    v_cvt_pk_bf16_f32 v29, v29, v29
    v_mfma_f32_16x16x32_bf16 v[124:127], v[52:55], a[36:39], v[124:127]
    ds_read_b64_tr_b16 v[46:47], v15 offset:45056
    global_load_dwordx4 a[100:103], v1, s[10:11] offset:-3072 sc1
    s_waitcnt lgkmcnt(4)
    v_mfma_f32_16x16x32_bf16 v[128:131], v[56:59], a[32:35], v[128:131]
    ds_read_b64_tr_b16 v[48:49], v16 offset:40960
    v_lshlrev_b32 v28, 16, v28
    s_add_u32 m0, s39, 65536
    s_add_u32 s8, s44, 0
    v_mfma_f32_16x16x32_bf16 v[136:139], v[56:59], a[36:39], v[136:139]
    ds_read_b64_tr_b16 v[50:51], v16 offset:45056
    s_addc_u32 s9, s45, 0
    global_load_lds_dwordx4 v2, s[8:9] offset:0
    v_mfma_f32_16x16x32_bf16 v[132:135], v[60:63], a[32:35], v[132:135]
    ds_read_b64_tr_b16 v[52:53], v17 offset:40960
    v_lshlrev_b32 v29, 16, v29
    v_mfma_f32_16x16x32_bf16 v[140:143], v[60:63], a[36:39], v[140:143]
    ds_read_b64_tr_b16 v[54:55], v17 offset:45056
    v_mfma_f32_16x16x32_bf16 v[144:147], v[32:35], a[32:35], v[144:147]
    ds_read_b64_tr_b16 v[56:57], v14 offset:41472
    v_mul_f32 v28, 0xbfb8aa3b, v28
    v_mfma_f32_16x16x32_bf16 v[152:155], v[32:35], a[36:39], v[152:155]
    ds_read_b64_tr_b16 v[58:59], v14 offset:45568
    v_mfma_f32_16x16x32_bf16 v[148:151], v[36:39], a[32:35], v[148:151]
    ds_read_b64_tr_b16 v[60:61], v15 offset:41472
    v_mul_f32 v29, 0xbfb8aa3b, v29
    v_mfma_f32_16x16x32_bf16 v[156:159], v[36:39], a[36:39], v[156:159]
    ds_read_b64_tr_b16 v[62:63], v15 offset:45568
    global_load_dwordx4 a[104:107], v1, s[10:11] offset:-2048 sc1
    s_waitcnt lgkmcnt(4)
    v_mfma_f32_16x16x32_bf16 v[96:99], v[40:43], a[40:43], v[96:99]
    ds_read_b64_tr_b16 v[32:33], v16 offset:41472
    v_exp_f32 v28, v28
    v_mfma_f32_16x16x32_bf16 v[104:107], v[40:43], a[44:47], v[104:107]
    ds_read_b64_tr_b16 v[34:35], v16 offset:45568
    v_mfma_f32_16x16x32_bf16 v[100:103], v[44:47], a[40:43], v[100:103]
    ds_read_b64_tr_b16 v[36:37], v17 offset:41472
    v_mfma_f32_16x16x32_bf16 v[108:111], v[44:47], a[44:47], v[108:111]
    ds_read_b64_tr_b16 v[38:39], v17 offset:45568
    global_load_lds_dwordx4 v3, s[8:9] offset:1024
    v_mfma_f32_16x16x32_bf16 v[112:115], v[48:51], a[40:43], v[112:115]
    ds_read_b64_tr_b16 v[40:41], v14 offset:49152
    v_exp_f32 v29, v29
    v_mfma_f32_16x16x32_bf16 v[120:123], v[48:51], a[44:47], v[120:123]
    ds_read_b64_tr_b16 v[42:43], v14 offset:53248
    global_load_dwordx4 a[108:111], v1, s[10:11] offset:-1024 sc1
    v_mfma_f32_16x16x32_bf16 v[116:119], v[52:55], a[40:43], v[116:119]
    ds_read_b64_tr_b16 v[44:45], v15 offset:49152
    s_nop 0
    v_mfma_f32_16x16x32_bf16 v[124:127], v[52:55], a[44:47], v[124:127]
    ds_read_b64_tr_b16 v[46:47], v15 offset:53248
    s_waitcnt lgkmcnt(4)
    v_mfma_f32_16x16x32_bf16 v[128:131], v[56:59], a[40:43], v[128:131]
    ds_read_b64_tr_b16 v[48:49], v16 offset:49152
    v_add_f32 v28, 1.0, v28
    v_mfma_f32_16x16x32_bf16 v[136:139], v[56:59], a[44:47], v[136:139]
    ds_read_b64_tr_b16 v[50:51], v16 offset:53248
    global_load_lds_dwordx4 v4, s[8:9] offset:2048
    v_mfma_f32_16x16x32_bf16 v[132:135], v[60:63], a[40:43], v[132:135]
    ds_read_b64_tr_b16 v[52:53], v17 offset:49152
    v_add_f32 v29, 1.0, v29
    v_mfma_f32_16x16x32_bf16 v[140:143], v[60:63], a[44:47], v[140:143]
    ds_read_b64_tr_b16 v[54:55], v17 offset:53248
    global_load_dwordx4 a[112:115], v1, s[10:11] offset:0 sc1
    v_mfma_f32_16x16x32_bf16 v[144:147], v[32:35], a[40:43], v[144:147]
    ds_read_b64_tr_b16 v[56:57], v14 offset:49664
    v_rcp_f32 v28, v28
    v_mfma_f32_16x16x32_bf16 v[152:155], v[32:35], a[44:47], v[152:155]
    ds_read_b64_tr_b16 v[58:59], v14 offset:53760
    global_load_lds_dwordx4 v5, s[8:9] offset:3072
    s_add_u32 m0, s39, 69632
    v_mfma_f32_16x16x32_bf16 v[148:151], v[36:39], a[40:43], v[148:151]
    ds_read_b64_tr_b16 v[60:61], v15 offset:49664
    v_mfma_f32_16x16x32_bf16 v[156:159], v[36:39], a[44:47], v[156:159]
    ds_read_b64_tr_b16 v[62:63], v15 offset:53760
    s_waitcnt lgkmcnt(4)
    v_mfma_f32_16x16x32_bf16 v[96:99], v[40:43], a[48:51], v[96:99]
    ds_read_b64_tr_b16 v[32:33], v16 offset:49664
    v_rcp_f32 v29, v29
    v_mfma_f32_16x16x32_bf16 v[104:107], v[40:43], a[52:55], v[104:107]
    ds_read_b64_tr_b16 v[34:35], v16 offset:53760
    v_mfma_f32_16x16x32_bf16 v[100:103], v[44:47], a[48:51], v[100:103]
    ds_read_b64_tr_b16 v[36:37], v17 offset:49664
    global_load_dwordx4 a[116:119], v1, s[10:11] offset:1024 sc1
    v_mfma_f32_16x16x32_bf16 v[108:111], v[44:47], a[52:55], v[108:111]
    ds_read_b64_tr_b16 v[38:39], v17 offset:53760
    global_load_lds_dwordx4 v6, s[8:9] offset:0
    v_mfma_f32_16x16x32_bf16 v[112:115], v[48:51], a[48:51], v[112:115]
    ds_read_b64_tr_b16 v[40:41], v14 offset:57344
    s_nop 0
    v_mfma_f32_16x16x32_bf16 v[120:123], v[48:51], a[52:55], v[120:123]
    ds_read_b64_tr_b16 v[42:43], v14 offset:61440
    v_mfma_f32_16x16x32_bf16 v[116:119], v[52:55], a[48:51], v[116:119]
    ds_read_b64_tr_b16 v[44:45], v15 offset:57344
    v_cvt_pk_bf16_f32 v28, v28, v28
    v_mfma_f32_16x16x32_bf16 v[124:127], v[52:55], a[52:55], v[124:127]
    ds_read_b64_tr_b16 v[46:47], v15 offset:61440
    v_cvt_pk_bf16_f32 v29, v29, v29
    s_waitcnt lgkmcnt(4)
    v_mfma_f32_16x16x32_bf16 v[128:131], v[56:59], a[48:51], v[128:131]
    ds_read_b64_tr_b16 v[48:49], v16 offset:57344
    v_lshlrev_b32 v28, 16, v28
    global_load_dwordx4 a[120:123], v1, s[10:11] offset:2048 sc1
    v_mfma_f32_16x16x32_bf16 v[136:139], v[56:59], a[52:55], v[136:139]
    ds_read_b64_tr_b16 v[50:51], v16 offset:61440
    global_load_lds_dwordx4 v7, s[8:9] offset:1024
    v_mfma_f32_16x16x32_bf16 v[132:135], v[60:63], a[48:51], v[132:135]
    ds_read_b64_tr_b16 v[52:53], v17 offset:57344
    v_lshlrev_b32 v29, 16, v29
    v_mfma_f32_16x16x32_bf16 v[140:143], v[60:63], a[52:55], v[140:143]
    ds_read_b64_tr_b16 v[54:55], v17 offset:61440
    v_mfma_f32_16x16x32_bf16 v[144:147], v[32:35], a[48:51], v[144:147]
    ds_read_b64_tr_b16 v[56:57], v14 offset:57856
    v_sub_f32 v26, 1.0, v28
    v_mfma_f32_16x16x32_bf16 v[152:155], v[32:35], a[52:55], v[152:155]
    ds_read_b64_tr_b16 v[58:59], v14 offset:61952
    global_load_lds_dwordx4 v8, s[8:9] offset:2048
    v_mfma_f32_16x16x32_bf16 v[148:151], v[36:39], a[48:51], v[148:151]
    ds_read_b64_tr_b16 v[60:61], v15 offset:57856
    v_sub_f32 v27, 1.0, v29
    v_mfma_f32_16x16x32_bf16 v[156:159], v[36:39], a[52:55], v[156:159]
    ds_read_b64_tr_b16 v[62:63], v15 offset:61952
    global_load_dwordx4 a[124:127], v1, s[10:11] offset:3072 sc1
    s_waitcnt lgkmcnt(4)
    v_mfma_f32_16x16x32_bf16 v[96:99], v[40:43], a[56:59], v[96:99]
    ds_read_b64_tr_b16 v[32:33], v16 offset:57856
    v_cvt_pk_bf16_f32 v26, v26, v26
    v_mfma_f32_16x16x32_bf16 v[104:107], v[40:43], a[60:63], v[104:107]
    ds_read_b64_tr_b16 v[34:35], v16 offset:61952
    global_load_lds_dwordx4 v9, s[8:9] offset:3072
    v_mfma_f32_16x16x32_bf16 v[100:103], v[44:47], a[56:59], v[100:103]
    ds_read_b64_tr_b16 v[36:37], v17 offset:57856
    v_cvt_pk_bf16_f32 v27, v27, v27
    v_mfma_f32_16x16x32_bf16 v[108:111], v[44:47], a[60:63], v[108:111]
    ds_read_b64_tr_b16 v[38:39], v17 offset:61952
    v_mfma_f32_16x16x32_bf16 v[112:115], v[48:51], a[56:59], v[112:115]
    v_lshlrev_b32 v26, 16, v26
    v_mfma_f32_16x16x32_bf16 v[120:123], v[48:51], a[60:63], v[120:123]
    v_mfma_f32_16x16x32_bf16 v[116:119], v[52:55], a[56:59], v[116:119]
    v_lshlrev_b32 v27, 16, v27
    v_mfma_f32_16x16x32_bf16 v[124:127], v[52:55], a[60:63], v[124:127]
    s_waitcnt lgkmcnt(0)
    v_mfma_f32_16x16x32_bf16 v[128:131], v[56:59], a[56:59], v[128:131]
    v_add_u32 v14, 4294901760, v14
    v_add_u32 v15, 4294901760, v15
    v_add_u32 v16, 4294901760, v16
    v_add_u32 v17, 4294901760, v17
    s_waitcnt vmcnt(16)
    v_cmp_gt_u32 vcc, 4, v24
    s_nop 0
    s_and_b32 s32, vcc_lo, s1
    s_cbranch_scc1 L_poll_6
L_poll_6_ok:
    v_mfma_f32_16x16x32_bf16 v[136:139], v[56:59], a[60:63], v[136:139]
    s_barrier
    ds_read_b64_tr_b16 v[40:41], v14 offset:0
    ds_read_b64_tr_b16 v[42:43], v14 offset:4096
    ds_read_b64_tr_b16 v[44:45], v15 offset:0
    ds_read_b64_tr_b16 v[46:47], v15 offset:4096
    v_mfma_f32_16x16x32_bf16 v[132:135], v[60:63], a[56:59], v[132:135]
    ds_read_b64_tr_b16 v[48:49], v16 offset:0
    ds_read_b64_tr_b16 v[50:51], v16 offset:4096
    s_add_u32 s10, s16, 98304
    s_addc_u32 s11, s17, 0
    v_mfma_f32_16x16x32_bf16 v[140:143], v[60:63], a[60:63], v[140:143]
    ds_read_b64_tr_b16 v[52:53], v17 offset:0
    ds_read_b64_tr_b16 v[54:55], v17 offset:4096
    global_load_dwordx4 a[128:131], v1, s[10:11] offset:-4096 sc1
    v_mfma_f32_16x16x32_bf16 v[144:147], v[32:35], a[56:59], v[144:147]
    ds_read_b64_tr_b16 v[56:57], v14 offset:512
    s_add_u32 m0, s39, 98304
    s_add_u32 s8, s44, 262144
    s_addc_u32 s9, s45, 0
    v_mfma_f32_16x16x32_bf16 v[152:155], v[32:35], a[60:63], v[152:155]
    ds_read_b64_tr_b16 v[58:59], v14 offset:4608
    global_load_lds_dwordx4 v2, s[8:9] offset:0
    v_mfma_f32_16x16x32_bf16 v[148:151], v[36:39], a[56:59], v[148:151]
    ds_read_b64_tr_b16 v[60:61], v15 offset:512
    v_mfma_f32_16x16x32_bf16 v[156:159], v[36:39], a[60:63], v[156:159]
    ds_read_b64_tr_b16 v[62:63], v15 offset:4608
    s_waitcnt lgkmcnt(4)
    v_mfma_f32_16x16x32_bf16 v[96:99], v[40:43], a[64:67], v[96:99]
    ds_read_b64_tr_b16 v[32:33], v16 offset:512
    v_mfma_f32_16x16x32_bf16 v[104:107], v[40:43], a[68:71], v[104:107]
    ds_read_b64_tr_b16 v[34:35], v16 offset:4608
    v_mfma_f32_16x16x32_bf16 v[100:103], v[44:47], a[64:67], v[100:103]
    ds_read_b64_tr_b16 v[36:37], v17 offset:512
    v_mfma_f32_16x16x32_bf16 v[108:111], v[44:47], a[68:71], v[108:111]
    ds_read_b64_tr_b16 v[38:39], v17 offset:4608
    v_mfma_f32_16x16x32_bf16 v[112:115], v[48:51], a[64:67], v[112:115]
    ds_read_b64_tr_b16 v[40:41], v14 offset:8192
    v_mfma_f32_16x16x32_bf16 v[120:123], v[48:51], a[68:71], v[120:123]
    ds_read_b64_tr_b16 v[42:43], v14 offset:12288
    v_mfma_f32_16x16x32_bf16 v[116:119], v[52:55], a[64:67], v[116:119]
    ds_read_b64_tr_b16 v[44:45], v15 offset:8192
    global_load_dwordx4 a[132:135], v1, s[10:11] offset:-3072 sc1
    v_mfma_f32_16x16x32_bf16 v[124:127], v[52:55], a[68:71], v[124:127]
    ds_read_b64_tr_b16 v[46:47], v15 offset:12288
    s_waitcnt lgkmcnt(4)
    v_mfma_f32_16x16x32_bf16 v[128:131], v[56:59], a[64:67], v[128:131]
    ds_read_b64_tr_b16 v[48:49], v16 offset:8192
    v_mfma_f32_16x16x32_bf16 v[136:139], v[56:59], a[68:71], v[136:139]
    ds_read_b64_tr_b16 v[50:51], v16 offset:12288
    v_mfma_f32_16x16x32_bf16 v[132:135], v[60:63], a[64:67], v[132:135]
    ds_read_b64_tr_b16 v[52:53], v17 offset:8192
    v_mfma_f32_16x16x32_bf16 v[140:143], v[60:63], a[68:71], v[140:143]
    ds_read_b64_tr_b16 v[54:55], v17 offset:12288
    global_load_lds_dwordx4 v3, s[8:9] offset:1024
    v_mfma_f32_16x16x32_bf16 v[144:147], v[32:35], a[64:67], v[144:147]
    ds_read_b64_tr_b16 v[56:57], v14 offset:8704
    v_mfma_f32_16x16x32_bf16 v[152:155], v[32:35], a[68:71], v[152:155]
    ds_read_b64_tr_b16 v[58:59], v14 offset:12800
    v_mfma_f32_16x16x32_bf16 v[148:151], v[36:39], a[64:67], v[148:151]
    ds_read_b64_tr_b16 v[60:61], v15 offset:8704
    global_load_dwordx4 a[136:139], v1, s[10:11] offset:-2048 sc1
    v_mfma_f32_16x16x32_bf16 v[156:159], v[36:39], a[68:71], v[156:159]
    ds_read_b64_tr_b16 v[62:63], v15 offset:12800
    s_waitcnt lgkmcnt(4)
    v_mfma_f32_16x16x32_bf16 v[96:99], v[40:43], a[72:75], v[96:99]
    ds_read_b64_tr_b16 v[32:33], v16 offset:8704
    v_mfma_f32_16x16x32_bf16 v[104:107], v[40:43], a[76:79], v[104:107]
    ds_read_b64_tr_b16 v[34:35], v16 offset:12800
    global_load_lds_dwordx4 v4, s[8:9] offset:2048
    v_mfma_f32_16x16x32_bf16 v[100:103], v[44:47], a[72:75], v[100:103]
    ds_read_b64_tr_b16 v[36:37], v17 offset:8704
    v_mfma_f32_16x16x32_bf16 v[108:111], v[44:47], a[76:79], v[108:111]
    ds_read_b64_tr_b16 v[38:39], v17 offset:12800
    v_mfma_f32_16x16x32_bf16 v[112:115], v[48:51], a[72:75], v[112:115]
    ds_read_b64_tr_b16 v[40:41], v14 offset:16384
    global_load_dwordx4 a[140:143], v1, s[10:11] offset:-1024 sc1
    v_mfma_f32_16x16x32_bf16 v[120:123], v[48:51], a[76:79], v[120:123]
    ds_read_b64_tr_b16 v[42:43], v14 offset:20480
    v_mfma_f32_16x16x32_bf16 v[116:119], v[52:55], a[72:75], v[116:119]
    ds_read_b64_tr_b16 v[44:45], v15 offset:16384
    v_mfma_f32_16x16x32_bf16 v[124:127], v[52:55], a[76:79], v[124:127]
    ds_read_b64_tr_b16 v[46:47], v15 offset:20480
    global_load_lds_dwordx4 v5, s[8:9] offset:3072
    s_add_u32 m0, s39, 102400
    s_waitcnt lgkmcnt(4)
    v_mfma_f32_16x16x32_bf16 v[128:131], v[56:59], a[72:75], v[128:131]
    ds_read_b64_tr_b16 v[48:49], v16 offset:16384
    v_mfma_f32_16x16x32_bf16 v[136:139], v[56:59], a[76:79], v[136:139]
    ds_read_b64_tr_b16 v[50:51], v16 offset:20480
    v_mfma_f32_16x16x32_bf16 v[132:135], v[60:63], a[72:75], v[132:135]
    ds_read_b64_tr_b16 v[52:53], v17 offset:16384
    global_load_dwordx4 a[144:147], v1, s[10:11] offset:0 sc1
    v_mfma_f32_16x16x32_bf16 v[140:143], v[60:63], a[76:79], v[140:143]
    ds_read_b64_tr_b16 v[54:55], v17 offset:20480
    v_mfma_f32_16x16x32_bf16 v[144:147], v[32:35], a[72:75], v[144:147]
    ds_read_b64_tr_b16 v[56:57], v14 offset:16896
    v_mfma_f32_16x16x32_bf16 v[152:155], v[32:35], a[76:79], v[152:155]
    ds_read_b64_tr_b16 v[58:59], v14 offset:20992
    v_mfma_f32_16x16x32_bf16 v[148:151], v[36:39], a[72:75], v[148:151]
    ds_read_b64_tr_b16 v[60:61], v15 offset:16896
    v_mfma_f32_16x16x32_bf16 v[156:159], v[36:39], a[76:79], v[156:159]
    ds_read_b64_tr_b16 v[62:63], v15 offset:20992
    global_load_lds_dwordx4 v6, s[8:9] offset:0
    s_waitcnt lgkmcnt(4)
    v_mfma_f32_16x16x32_bf16 v[96:99], v[40:43], a[80:83], v[96:99]
    ds_read_b64_tr_b16 v[32:33], v16 offset:16896
    v_mfma_f32_16x16x32_bf16 v[104:107], v[40:43], a[84:87], v[104:107]
    ds_read_b64_tr_b16 v[34:35], v16 offset:20992
    v_mfma_f32_16x16x32_bf16 v[100:103], v[44:47], a[80:83], v[100:103]
    ds_read_b64_tr_b16 v[36:37], v17 offset:16896
    global_load_dwordx4 a[148:151], v1, s[10:11] offset:1024 sc1
    v_mfma_f32_16x16x32_bf16 v[108:111], v[44:47], a[84:87], v[108:111]
    ds_read_b64_tr_b16 v[38:39], v17 offset:20992
    v_mfma_f32_16x16x32_bf16 v[112:115], v[48:51], a[80:83], v[112:115]
    ds_read_b64_tr_b16 v[40:41], v14 offset:24576
    v_mfma_f32_16x16x32_bf16 v[120:123], v[48:51], a[84:87], v[120:123]
    ds_read_b64_tr_b16 v[42:43], v14 offset:28672
    global_load_lds_dwordx4 v7, s[8:9] offset:1024
    v_mfma_f32_16x16x32_bf16 v[116:119], v[52:55], a[80:83], v[116:119]
    ds_read_b64_tr_b16 v[44:45], v15 offset:24576
    v_mfma_f32_16x16x32_bf16 v[124:127], v[52:55], a[84:87], v[124:127]
    ds_read_b64_tr_b16 v[46:47], v15 offset:28672
    s_waitcnt lgkmcnt(4)
    v_mfma_f32_16x16x32_bf16 v[128:131], v[56:59], a[80:83], v[128:131]
    ds_read_b64_tr_b16 v[48:49], v16 offset:24576
    global_load_dwordx4 a[152:155], v1, s[10:11] offset:2048 sc1
    v_mfma_f32_16x16x32_bf16 v[136:139], v[56:59], a[84:87], v[136:139]
    ds_read_b64_tr_b16 v[50:51], v16 offset:28672
    v_mfma_f32_16x16x32_bf16 v[132:135], v[60:63], a[80:83], v[132:135]
    ds_read_b64_tr_b16 v[52:53], v17 offset:24576
    v_mfma_f32_16x16x32_bf16 v[140:143], v[60:63], a[84:87], v[140:143]
    ds_read_b64_tr_b16 v[54:55], v17 offset:28672
    global_load_lds_dwordx4 v8, s[8:9] offset:2048
    v_mfma_f32_16x16x32_bf16 v[144:147], v[32:35], a[80:83], v[144:147]
    ds_read_b64_tr_b16 v[56:57], v14 offset:25088
    v_mfma_f32_16x16x32_bf16 v[152:155], v[32:35], a[84:87], v[152:155]
    ds_read_b64_tr_b16 v[58:59], v14 offset:29184
    v_mfma_f32_16x16x32_bf16 v[148:151], v[36:39], a[80:83], v[148:151]
    ds_read_b64_tr_b16 v[60:61], v15 offset:25088
    global_load_dwordx4 a[156:159], v1, s[10:11] offset:3072 sc1
    v_mfma_f32_16x16x32_bf16 v[156:159], v[36:39], a[84:87], v[156:159]
    ds_read_b64_tr_b16 v[62:63], v15 offset:29184
    s_waitcnt lgkmcnt(4)
    v_mfma_f32_16x16x32_bf16 v[96:99], v[40:43], a[88:91], v[96:99]
    ds_read_b64_tr_b16 v[32:33], v16 offset:25088
    v_mfma_f32_16x16x32_bf16 v[104:107], v[40:43], a[92:95], v[104:107]
    ds_read_b64_tr_b16 v[34:35], v16 offset:29184
    global_load_lds_dwordx4 v9, s[8:9] offset:3072
    v_mfma_f32_16x16x32_bf16 v[100:103], v[44:47], a[88:91], v[100:103]
    ds_read_b64_tr_b16 v[36:37], v17 offset:25088
    v_mfma_f32_16x16x32_bf16 v[108:111], v[44:47], a[92:95], v[108:111]
    ds_read_b64_tr_b16 v[38:39], v17 offset:29184
    v_mfma_f32_16x16x32_bf16 v[112:115], v[48:51], a[88:91], v[112:115]
    v_mfma_f32_16x16x32_bf16 v[120:123], v[48:51], a[92:95], v[120:123]
    v_mfma_f32_16x16x32_bf16 v[116:119], v[52:55], a[88:91], v[116:119]
    v_mfma_f32_16x16x32_bf16 v[124:127], v[52:55], a[92:95], v[124:127]
    s_waitcnt lgkmcnt(0)
    v_mfma_f32_16x16x32_bf16 v[128:131], v[56:59], a[88:91], v[128:131]
    v_mfma_f32_16x16x32_bf16 v[136:139], v[56:59], a[92:95], v[136:139]
    s_waitcnt vmcnt(17)
    s_barrier
    ds_read_b64_tr_b16 v[40:41], v14 offset:32768
    ds_read_b64_tr_b16 v[42:43], v14 offset:36864
    ds_read_b64_tr_b16 v[44:45], v15 offset:32768
    ds_read_b64_tr_b16 v[46:47], v15 offset:36864
    v_mfma_f32_16x16x32_bf16 v[132:135], v[60:63], a[88:91], v[132:135]
    ds_read_b64_tr_b16 v[48:49], v16 offset:32768
    ds_read_b64_tr_b16 v[50:51], v16 offset:36864
    s_add_u32 s10, s16, 106496
    s_addc_u32 s11, s17, 0
    v_mfma_f32_16x16x32_bf16 v[140:143], v[60:63], a[92:95], v[140:143]
    ds_read_b64_tr_b16 v[52:53], v17 offset:32768
    ds_read_b64_tr_b16 v[54:55], v17 offset:36864
    global_load_dwordx4 a[160:163], v1, s[10:11] offset:-4096 sc1
    v_mfma_f32_16x16x32_bf16 v[144:147], v[32:35], a[88:91], v[144:147]
    ds_read_b64_tr_b16 v[56:57], v14 offset:33280
    s_add_u32 m0, s39, 0
    s_add_u32 s8, s44, 524288
    s_addc_u32 s9, s45, 0
    v_mfma_f32_16x16x32_bf16 v[152:155], v[32:35], a[92:95], v[152:155]
    ds_read_b64_tr_b16 v[58:59], v14 offset:37376
    global_load_lds_dwordx4 v2, s[8:9] offset:0
    v_mfma_f32_16x16x32_bf16 v[148:151], v[36:39], a[88:91], v[148:151]
    ds_read_b64_tr_b16 v[60:61], v15 offset:33280
    v_mfma_f32_16x16x32_bf16 v[156:159], v[36:39], a[92:95], v[156:159]
    ds_read_b64_tr_b16 v[62:63], v15 offset:37376
    s_waitcnt lgkmcnt(4)
    v_mfma_f32_16x16x32_bf16 v[96:99], v[40:43], a[96:99], v[96:99]
    ds_read_b64_tr_b16 v[32:33], v16 offset:33280
    v_mfma_f32_16x16x32_bf16 v[104:107], v[40:43], a[100:103], v[104:107]
    ds_read_b64_tr_b16 v[34:35], v16 offset:37376
    v_mfma_f32_16x16x32_bf16 v[100:103], v[44:47], a[96:99], v[100:103]
    ds_read_b64_tr_b16 v[36:37], v17 offset:33280
    v_mfma_f32_16x16x32_bf16 v[108:111], v[44:47], a[100:103], v[108:111]
    ds_read_b64_tr_b16 v[38:39], v17 offset:37376
    v_mfma_f32_16x16x32_bf16 v[112:115], v[48:51], a[96:99], v[112:115]
    ds_read_b64_tr_b16 v[40:41], v14 offset:40960
    v_mfma_f32_16x16x32_bf16 v[120:123], v[48:51], a[100:103], v[120:123]
    ds_read_b64_tr_b16 v[42:43], v14 offset:45056
    v_mfma_f32_16x16x32_bf16 v[116:119], v[52:55], a[96:99], v[116:119]
    ds_read_b64_tr_b16 v[44:45], v15 offset:40960
    global_load_dwordx4 a[164:167], v1, s[10:11] offset:-3072 sc1
    v_mfma_f32_16x16x32_bf16 v[124:127], v[52:55], a[100:103], v[124:127]
    ds_read_b64_tr_b16 v[46:47], v15 offset:45056
    s_waitcnt lgkmcnt(4)
    v_mfma_f32_16x16x32_bf16 v[128:131], v[56:59], a[96:99], v[128:131]
    ds_read_b64_tr_b16 v[48:49], v16 offset:40960
    v_mfma_f32_16x16x32_bf16 v[136:139], v[56:59], a[100:103], v[136:139]
    ds_read_b64_tr_b16 v[50:51], v16 offset:45056
    v_mfma_f32_16x16x32_bf16 v[132:135], v[60:63], a[96:99], v[132:135]
    ds_read_b64_tr_b16 v[52:53], v17 offset:40960
    v_mfma_f32_16x16x32_bf16 v[140:143], v[60:63], a[100:103], v[140:143]
    ds_read_b64_tr_b16 v[54:55], v17 offset:45056
    global_load_lds_dwordx4 v3, s[8:9] offset:1024
    v_mfma_f32_16x16x32_bf16 v[144:147], v[32:35], a[96:99], v[144:147]
    ds_read_b64_tr_b16 v[56:57], v14 offset:41472
    v_mfma_f32_16x16x32_bf16 v[152:155], v[32:35], a[100:103], v[152:155]
    ds_read_b64_tr_b16 v[58:59], v14 offset:45568
    v_mfma_f32_16x16x32_bf16 v[148:151], v[36:39], a[96:99], v[148:151]
    ds_read_b64_tr_b16 v[60:61], v15 offset:41472
    global_load_dwordx4 a[168:171], v1, s[10:11] offset:-2048 sc1
    v_mfma_f32_16x16x32_bf16 v[156:159], v[36:39], a[100:103], v[156:159]
    ds_read_b64_tr_b16 v[62:63], v15 offset:45568
    s_waitcnt lgkmcnt(4)
    v_mfma_f32_16x16x32_bf16 v[96:99], v[40:43], a[104:107], v[96:99]
    ds_read_b64_tr_b16 v[32:33], v16 offset:41472
    v_mfma_f32_16x16x32_bf16 v[104:107], v[40:43], a[108:111], v[104:107]
    ds_read_b64_tr_b16 v[34:35], v16 offset:45568
    global_load_lds_dwordx4 v4, s[8:9] offset:2048
    v_mfma_f32_16x16x32_bf16 v[100:103], v[44:47], a[104:107], v[100:103]
    ds_read_b64_tr_b16 v[36:37], v17 offset:41472
    v_mfma_f32_16x16x32_bf16 v[108:111], v[44:47], a[108:111], v[108:111]
    ds_read_b64_tr_b16 v[38:39], v17 offset:45568
    v_mfma_f32_16x16x32_bf16 v[112:115], v[48:51], a[104:107], v[112:115]
    ds_read_b64_tr_b16 v[40:41], v14 offset:49152
    global_load_dwordx4 a[172:175], v1, s[10:11] offset:-1024 sc1
    v_mfma_f32_16x16x32_bf16 v[120:123], v[48:51], a[108:111], v[120:123]
    ds_read_b64_tr_b16 v[42:43], v14 offset:53248
    v_mfma_f32_16x16x32_bf16 v[116:119], v[52:55], a[104:107], v[116:119]
    ds_read_b64_tr_b16 v[44:45], v15 offset:49152
    v_mfma_f32_16x16x32_bf16 v[124:127], v[52:55], a[108:111], v[124:127]
    ds_read_b64_tr_b16 v[46:47], v15 offset:53248
    global_load_lds_dwordx4 v5, s[8:9] offset:3072
    s_add_u32 m0, s39, 4096
    s_waitcnt lgkmcnt(4)
    v_mfma_f32_16x16x32_bf16 v[128:131], v[56:59], a[104:107], v[128:131]
    ds_read_b64_tr_b16 v[48:49], v16 offset:49152
    v_mfma_f32_16x16x32_bf16 v[136:139], v[56:59], a[108:111], v[136:139]
    ds_read_b64_tr_b16 v[50:51], v16 offset:53248
    v_mfma_f32_16x16x32_bf16 v[132:135], v[60:63], a[104:107], v[132:135]
    ds_read_b64_tr_b16 v[52:53], v17 offset:49152
    global_load_dwordx4 a[176:179], v1, s[10:11] offset:0 sc1
    v_mfma_f32_16x16x32_bf16 v[140:143], v[60:63], a[108:111], v[140:143]
    ds_read_b64_tr_b16 v[54:55], v17 offset:53248
    v_mfma_f32_16x16x32_bf16 v[144:147], v[32:35], a[104:107], v[144:147]
    ds_read_b64_tr_b16 v[56:57], v14 offset:49664
    v_mfma_f32_16x16x32_bf16 v[152:155], v[32:35], a[108:111], v[152:155]
    ds_read_b64_tr_b16 v[58:59], v14 offset:53760
    v_mfma_f32_16x16x32_bf16 v[148:151], v[36:39], a[104:107], v[148:151]
    ds_read_b64_tr_b16 v[60:61], v15 offset:49664
    v_mfma_f32_16x16x32_bf16 v[156:159], v[36:39], a[108:111], v[156:159]
    ds_read_b64_tr_b16 v[62:63], v15 offset:53760
    global_load_lds_dwordx4 v6, s[8:9] offset:0
    s_waitcnt lgkmcnt(4)
    v_mfma_f32_16x16x32_bf16 v[96:99], v[40:43], a[112:115], v[96:99]
    ds_read_b64_tr_b16 v[32:33], v16 offset:49664
    v_mfma_f32_16x16x32_bf16 v[104:107], v[40:43], a[116:119], v[104:107]
    ds_read_b64_tr_b16 v[34:35], v16 offset:53760
    v_mfma_f32_16x16x32_bf16 v[100:103], v[44:47], a[112:115], v[100:103]
    ds_read_b64_tr_b16 v[36:37], v17 offset:49664
    global_load_dwordx4 a[180:183], v1, s[10:11] offset:1024 sc1
    v_mfma_f32_16x16x32_bf16 v[108:111], v[44:47], a[116:119], v[108:111]
    ds_read_b64_tr_b16 v[38:39], v17 offset:53760
    v_mfma_f32_16x16x32_bf16 v[112:115], v[48:51], a[112:115], v[112:115]
    ds_read_b64_tr_b16 v[40:41], v14 offset:57344
    v_mfma_f32_16x16x32_bf16 v[120:123], v[48:51], a[116:119], v[120:123]
    ds_read_b64_tr_b16 v[42:43], v14 offset:61440
    global_load_lds_dwordx4 v7, s[8:9] offset:1024
    v_mfma_f32_16x16x32_bf16 v[116:119], v[52:55], a[112:115], v[116:119]
    ds_read_b64_tr_b16 v[44:45], v15 offset:57344
    v_mfma_f32_16x16x32_bf16 v[124:127], v[52:55], a[116:119], v[124:127]
    ds_read_b64_tr_b16 v[46:47], v15 offset:61440
    s_waitcnt lgkmcnt(4)
    v_mfma_f32_16x16x32_bf16 v[128:131], v[56:59], a[112:115], v[128:131]
    ds_read_b64_tr_b16 v[48:49], v16 offset:57344
    global_load_dwordx4 a[184:187], v1, s[10:11] offset:2048 sc1
    v_mfma_f32_16x16x32_bf16 v[136:139], v[56:59], a[116:119], v[136:139]
    ds_read_b64_tr_b16 v[50:51], v16 offset:61440
    v_mfma_f32_16x16x32_bf16 v[132:135], v[60:63], a[112:115], v[132:135]
    ds_read_b64_tr_b16 v[52:53], v17 offset:57344
    v_mfma_f32_16x16x32_bf16 v[140:143], v[60:63], a[116:119], v[140:143]
    ds_read_b64_tr_b16 v[54:55], v17 offset:61440
    global_load_lds_dwordx4 v8, s[8:9] offset:2048
    v_mfma_f32_16x16x32_bf16 v[144:147], v[32:35], a[112:115], v[144:147]
    ds_read_b64_tr_b16 v[56:57], v14 offset:57856
    v_mfma_f32_16x16x32_bf16 v[152:155], v[32:35], a[116:119], v[152:155]
    ds_read_b64_tr_b16 v[58:59], v14 offset:61952
    v_mfma_f32_16x16x32_bf16 v[148:151], v[36:39], a[112:115], v[148:151]
    ds_read_b64_tr_b16 v[60:61], v15 offset:57856
    global_load_dwordx4 a[188:191], v1, s[10:11] offset:3072 sc1
    v_mfma_f32_16x16x32_bf16 v[156:159], v[36:39], a[116:119], v[156:159]
    ds_read_b64_tr_b16 v[62:63], v15 offset:61952
    s_waitcnt lgkmcnt(4)
    v_mfma_f32_16x16x32_bf16 v[96:99], v[40:43], a[120:123], v[96:99]
    ds_read_b64_tr_b16 v[32:33], v16 offset:57856
    v_mfma_f32_16x16x32_bf16 v[104:107], v[40:43], a[124:127], v[104:107]
    ds_read_b64_tr_b16 v[34:35], v16 offset:61952
    global_load_lds_dwordx4 v9, s[8:9] offset:3072
    v_mfma_f32_16x16x32_bf16 v[100:103], v[44:47], a[120:123], v[100:103]
    ds_read_b64_tr_b16 v[36:37], v17 offset:57856
    v_mfma_f32_16x16x32_bf16 v[108:111], v[44:47], a[124:127], v[108:111]
    ds_read_b64_tr_b16 v[38:39], v17 offset:61952
    v_mfma_f32_16x16x32_bf16 v[112:115], v[48:51], a[120:123], v[112:115]
    v_mfma_f32_16x16x32_bf16 v[120:123], v[48:51], a[124:127], v[120:123]
    v_mfma_f32_16x16x32_bf16 v[116:119], v[52:55], a[120:123], v[116:119]
    v_mfma_f32_16x16x32_bf16 v[124:127], v[52:55], a[124:127], v[124:127]
    s_waitcnt lgkmcnt(0)
    v_mfma_f32_16x16x32_bf16 v[128:131], v[56:59], a[120:123], v[128:131]
    v_add_u32 v14, 65536, v14
    v_add_u32 v15, 65536, v15
    v_add_u32 v16, 65536, v16
    v_add_u32 v17, 65536, v17
    v_mfma_f32_16x16x32_bf16 v[136:139], v[56:59], a[124:127], v[136:139]
    s_waitcnt vmcnt(17)
    s_barrier
    ds_read_b64_tr_b16 v[40:41], v14 offset:0
    ds_read_b64_tr_b16 v[42:43], v14 offset:4096
    ds_read_b64_tr_b16 v[44:45], v15 offset:0
    ds_read_b64_tr_b16 v[46:47], v15 offset:4096
    v_mfma_f32_16x16x32_bf16 v[132:135], v[60:63], a[120:123], v[132:135]
    ds_read_b64_tr_b16 v[48:49], v16 offset:0
    ds_read_b64_tr_b16 v[50:51], v16 offset:4096
    s_add_u32 s10, s16, 114688
    s_addc_u32 s11, s17, 0
    v_mfma_f32_16x16x32_bf16 v[140:143], v[60:63], a[124:127], v[140:143]
    ds_read_b64_tr_b16 v[52:53], v17 offset:0
    ds_read_b64_tr_b16 v[54:55], v17 offset:4096
    global_load_dwordx4 a[192:195], v1, s[10:11] offset:-4096 sc1
    v_mfma_f32_16x16x32_bf16 v[144:147], v[32:35], a[120:123], v[144:147]
    ds_read_b64_tr_b16 v[56:57], v14 offset:512
    s_add_u32 m0, s39, 32768
    s_add_u32 s8, s44, 786432
    s_addc_u32 s9, s45, 0
    v_mfma_f32_16x16x32_bf16 v[152:155], v[32:35], a[124:127], v[152:155]
    ds_read_b64_tr_b16 v[58:59], v14 offset:4608
    global_load_lds_dwordx4 v2, s[8:9] offset:0
    v_mfma_f32_16x16x32_bf16 v[148:151], v[36:39], a[120:123], v[148:151]
    ds_read_b64_tr_b16 v[60:61], v15 offset:512
    v_mfma_f32_16x16x32_bf16 v[156:159], v[36:39], a[124:127], v[156:159]
    ds_read_b64_tr_b16 v[62:63], v15 offset:4608
    s_waitcnt lgkmcnt(4)
    v_mfma_f32_16x16x32_bf16 v[160:163], v[40:43], a[128:131], 0
    ds_read_b64_tr_b16 v[32:33], v16 offset:512
    v_mfma_f32_16x16x32_bf16 v[168:171], v[40:43], a[132:135], 0
    ds_read_b64_tr_b16 v[34:35], v16 offset:4608
    v_mfma_f32_16x16x32_bf16 v[164:167], v[44:47], a[128:131], 0
    ds_read_b64_tr_b16 v[36:37], v17 offset:512
    v_mfma_f32_16x16x32_bf16 v[172:175], v[44:47], a[132:135], 0
    ds_read_b64_tr_b16 v[38:39], v17 offset:4608
    v_mfma_f32_16x16x32_bf16 v[176:179], v[48:51], a[128:131], 0
    ds_read_b64_tr_b16 v[40:41], v14 offset:8192
    v_mfma_f32_16x16x32_bf16 v[184:187], v[48:51], a[132:135], 0
    ds_read_b64_tr_b16 v[42:43], v14 offset:12288
    v_mfma_f32_16x16x32_bf16 v[180:183], v[52:55], a[128:131], 0
    ds_read_b64_tr_b16 v[44:45], v15 offset:8192
    global_load_dwordx4 a[196:199], v1, s[10:11] offset:-3072 sc1
    v_mfma_f32_16x16x32_bf16 v[188:191], v[52:55], a[132:135], 0
    ds_read_b64_tr_b16 v[46:47], v15 offset:12288
    s_waitcnt lgkmcnt(4)
    v_mfma_f32_16x16x32_bf16 v[192:195], v[56:59], a[128:131], 0
    ds_read_b64_tr_b16 v[48:49], v16 offset:8192
    v_mul_f32 v128, v26, v128
    v_mfma_f32_16x16x32_bf16 v[200:203], v[56:59], a[132:135], 0
    ds_read_b64_tr_b16 v[50:51], v16 offset:12288
    v_mfma_f32_16x16x32_bf16 v[196:199], v[60:63], a[128:131], 0
    ds_read_b64_tr_b16 v[52:53], v17 offset:8192
    v_mul_f32 v129, v26, v129
    v_mfma_f32_16x16x32_bf16 v[204:207], v[60:63], a[132:135], 0
    ds_read_b64_tr_b16 v[54:55], v17 offset:12288
    global_load_lds_dwordx4 v3, s[8:9] offset:1024
    v_mfma_f32_16x16x32_bf16 v[208:211], v[32:35], a[128:131], 0
    ds_read_b64_tr_b16 v[56:57], v14 offset:8704
    v_mfma_f32_16x16x32_bf16 v[216:219], v[32:35], a[132:135], 0
    ds_read_b64_tr_b16 v[58:59], v14 offset:12800
    v_mfma_f32_16x16x32_bf16 v[212:215], v[36:39], a[128:131], 0
    ds_read_b64_tr_b16 v[60:61], v15 offset:8704
    v_mul_f32 v130, v26, v130
    v_mfma_f32_16x16x32_bf16 v[220:223], v[36:39], a[132:135], 0
    ds_read_b64_tr_b16 v[62:63], v15 offset:12800
    global_load_dwordx4 a[200:203], v1, s[10:11] offset:-2048 sc1
    s_waitcnt lgkmcnt(4)
    v_mfma_f32_16x16x32_bf16 v[160:163], v[40:43], a[136:139], v[160:163]
    ds_read_b64_tr_b16 v[32:33], v16 offset:8704
    v_mfma_f32_16x16x32_bf16 v[168:171], v[40:43], a[140:143], v[168:171]
    ds_read_b64_tr_b16 v[34:35], v16 offset:12800
    global_load_lds_dwordx4 v4, s[8:9] offset:2048
    v_mfma_f32_16x16x32_bf16 v[164:167], v[44:47], a[136:139], v[164:167]
    ds_read_b64_tr_b16 v[36:37], v17 offset:8704
    v_mul_f32 v131, v26, v131
    v_mfma_f32_16x16x32_bf16 v[172:175], v[44:47], a[140:143], v[172:175]
    ds_read_b64_tr_b16 v[38:39], v17 offset:12800
    v_mfma_f32_16x16x32_bf16 v[176:179], v[48:51], a[136:139], v[176:179]
    ds_read_b64_tr_b16 v[40:41], v14 offset:16384
    global_load_dwordx4 a[204:207], v1, s[10:11] offset:-1024 sc1
    v_mfma_f32_16x16x32_bf16 v[184:187], v[48:51], a[140:143], v[184:187]
    ds_read_b64_tr_b16 v[42:43], v14 offset:20480
    v_mfma_f32_16x16x32_bf16 v[180:183], v[52:55], a[136:139], v[180:183]
    ds_read_b64_tr_b16 v[44:45], v15 offset:16384
    v_mul_f32 v132, v26, v132
    v_mfma_f32_16x16x32_bf16 v[188:191], v[52:55], a[140:143], v[188:191]
    ds_read_b64_tr_b16 v[46:47], v15 offset:20480
    global_load_lds_dwordx4 v5, s[8:9] offset:3072
    s_add_u32 m0, s39, 36864
    s_waitcnt lgkmcnt(4)
    v_mfma_f32_16x16x32_bf16 v[192:195], v[56:59], a[136:139], v[192:195]
    ds_read_b64_tr_b16 v[48:49], v16 offset:16384
    v_mul_f32 v133, v26, v133
    v_mfma_f32_16x16x32_bf16 v[200:203], v[56:59], a[140:143], v[200:203]
    ds_read_b64_tr_b16 v[50:51], v16 offset:20480
    v_mfma_f32_16x16x32_bf16 v[196:199], v[60:63], a[136:139], v[196:199]
    ds_read_b64_tr_b16 v[52:53], v17 offset:16384
    global_load_dwordx4 a[208:211], v1, s[10:11] offset:0 sc1
    v_mfma_f32_16x16x32_bf16 v[204:207], v[60:63], a[140:143], v[204:207]
    ds_read_b64_tr_b16 v[54:55], v17 offset:20480
    v_mfma_f32_16x16x32_bf16 v[208:211], v[32:35], a[136:139], v[208:211]
    ds_read_b64_tr_b16 v[56:57], v14 offset:16896
    v_mul_f32 v134, v26, v134
    v_mfma_f32_16x16x32_bf16 v[216:219], v[32:35], a[140:143], v[216:219]
    ds_read_b64_tr_b16 v[58:59], v14 offset:20992
    v_mfma_f32_16x16x32_bf16 v[212:215], v[36:39], a[136:139], v[212:215]
    ds_read_b64_tr_b16 v[60:61], v15 offset:16896
    v_mfma_f32_16x16x32_bf16 v[220:223], v[36:39], a[140:143], v[220:223]
    ds_read_b64_tr_b16 v[62:63], v15 offset:20992
    global_load_lds_dwordx4 v6, s[8:9] offset:0
    s_waitcnt lgkmcnt(4)
    v_mfma_f32_16x16x32_bf16 v[160:163], v[40:43], a[144:147], v[160:163]
    ds_read_b64_tr_b16 v[32:33], v16 offset:16896
    v_mul_f32 v135, v26, v135
    v_mfma_f32_16x16x32_bf16 v[168:171], v[40:43], a[148:151], v[168:171]
    ds_read_b64_tr_b16 v[34:35], v16 offset:20992
    v_mfma_f32_16x16x32_bf16 v[164:167], v[44:47], a[144:147], v[164:167]
    ds_read_b64_tr_b16 v[36:37], v17 offset:16896
    global_load_dwordx4 a[212:215], v1, s[10:11] offset:1024 sc1
    v_mfma_f32_16x16x32_bf16 v[172:175], v[44:47], a[148:151], v[172:175]
    ds_read_b64_tr_b16 v[38:39], v17 offset:20992
    v_mfma_f32_16x16x32_bf16 v[176:179], v[48:51], a[144:147], v[176:179]
    ds_read_b64_tr_b16 v[40:41], v14 offset:24576
    v_mul_f32 v136, v27, v136
    v_mfma_f32_16x16x32_bf16 v[184:187], v[48:51], a[148:151], v[184:187]
    ds_read_b64_tr_b16 v[42:43], v14 offset:28672
    global_load_lds_dwordx4 v7, s[8:9] offset:1024
    v_mfma_f32_16x16x32_bf16 v[180:183], v[52:55], a[144:147], v[180:183]
    ds_read_b64_tr_b16 v[44:45], v15 offset:24576
    v_mul_f32 v137, v27, v137
    v_mfma_f32_16x16x32_bf16 v[188:191], v[52:55], a[148:151], v[188:191]
    ds_read_b64_tr_b16 v[46:47], v15 offset:28672
    s_waitcnt lgkmcnt(4)
    v_mfma_f32_16x16x32_bf16 v[192:195], v[56:59], a[144:147], v[192:195]
    ds_read_b64_tr_b16 v[48:49], v16 offset:24576
    global_load_dwordx4 a[216:219], v1, s[10:11] offset:2048 sc1
    v_mfma_f32_16x16x32_bf16 v[200:203], v[56:59], a[148:151], v[200:203]
    ds_read_b64_tr_b16 v[50:51], v16 offset:28672
    v_mfma_f32_16x16x32_bf16 v[196:199], v[60:63], a[144:147], v[196:199]
    ds_read_b64_tr_b16 v[52:53], v17 offset:24576
    v_mul_f32 v138, v27, v138
    v_mfma_f32_16x16x32_bf16 v[204:207], v[60:63], a[148:151], v[204:207]
    ds_read_b64_tr_b16 v[54:55], v17 offset:28672
    global_load_lds_dwordx4 v8, s[8:9] offset:2048
    v_mfma_f32_16x16x32_bf16 v[208:211], v[32:35], a[144:147], v[208:211]
    ds_read_b64_tr_b16 v[56:57], v14 offset:25088
    v_mfma_f32_16x16x32_bf16 v[216:219], v[32:35], a[148:151], v[216:219]
    ds_read_b64_tr_b16 v[58:59], v14 offset:29184
    v_mfma_f32_16x16x32_bf16 v[212:215], v[36:39], a[144:147], v[212:215]
    ds_read_b64_tr_b16 v[60:61], v15 offset:25088
    v_mul_f32 v139, v27, v139
    v_mfma_f32_16x16x32_bf16 v[220:223], v[36:39], a[148:151], v[220:223]
    ds_read_b64_tr_b16 v[62:63], v15 offset:29184
    global_load_dwordx4 a[220:223], v1, s[10:11] offset:3072 sc1
    s_waitcnt lgkmcnt(4)
    v_mfma_f32_16x16x32_bf16 v[160:163], v[40:43], a[152:155], v[160:163]
    ds_read_b64_tr_b16 v[32:33], v16 offset:25088
    v_mfma_f32_16x16x32_bf16 v[168:171], v[40:43], a[156:159], v[168:171]
    ds_read_b64_tr_b16 v[34:35], v16 offset:29184
    global_load_lds_dwordx4 v9, s[8:9] offset:3072
    v_mfma_f32_16x16x32_bf16 v[164:167], v[44:47], a[152:155], v[164:167]
    ds_read_b64_tr_b16 v[36:37], v17 offset:25088
    v_mul_f32 v140, v27, v140
    v_mfma_f32_16x16x32_bf16 v[172:175], v[44:47], a[156:159], v[172:175]
    ds_read_b64_tr_b16 v[38:39], v17 offset:29184
    v_mfma_f32_16x16x32_bf16 v[176:179], v[48:51], a[152:155], v[176:179]
    v_mul_f32 v141, v27, v141
    v_mfma_f32_16x16x32_bf16 v[184:187], v[48:51], a[156:159], v[184:187]
    v_mfma_f32_16x16x32_bf16 v[180:183], v[52:55], a[152:155], v[180:183]
    v_mfma_f32_16x16x32_bf16 v[188:191], v[52:55], a[156:159], v[188:191]
    s_waitcnt lgkmcnt(0)
    v_mfma_f32_16x16x32_bf16 v[192:195], v[56:59], a[152:155], v[192:195]
    v_mfma_f32_16x16x32_bf16 v[200:203], v[56:59], a[156:159], v[200:203]
    s_waitcnt vmcnt(17)
    s_barrier
    ds_read_b64_tr_b16 v[40:41], v14 offset:32768
    ds_read_b64_tr_b16 v[42:43], v14 offset:36864
    ds_read_b64_tr_b16 v[44:45], v15 offset:32768
    ds_read_b64_tr_b16 v[46:47], v15 offset:36864
    v_mul_f32 v142, v27, v142
    v_mfma_f32_16x16x32_bf16 v[196:199], v[60:63], a[152:155], v[196:199]
    ds_read_b64_tr_b16 v[48:49], v16 offset:32768
    ds_read_b64_tr_b16 v[50:51], v16 offset:36864
    s_add_u32 s10, s16, 122880
    s_addc_u32 s11, s17, 0
    v_mfma_f32_16x16x32_bf16 v[204:207], v[60:63], a[156:159], v[204:207]
    ds_read_b64_tr_b16 v[52:53], v17 offset:32768
    ds_read_b64_tr_b16 v[54:55], v17 offset:36864
    global_load_dwordx4 a[224:227], v1, s[10:11] offset:-4096 sc1
    v_mfma_f32_16x16x32_bf16 v[208:211], v[32:35], a[152:155], v[208:211]
    ds_read_b64_tr_b16 v[56:57], v14 offset:33280
    v_mul_f32 v143, v27, v143
    v_lshrrev_b32 v0, 9, v1
    v_mfma_f32_16x16x32_bf16 v[216:219], v[32:35], a[156:159], v[216:219]
    ds_read_b64_tr_b16 v[58:59], v14 offset:37376
    v_lshlrev_b32 v25, 18, v0
    v_xor_b32 v0, s31, v0
    v_mfma_f32_16x16x32_bf16 v[212:215], v[36:39], a[152:155], v[212:215]
    ds_read_b64_tr_b16 v[60:61], v15 offset:33280
    v_subrev_u32 v0, s31, v0
    v_lshlrev_b32 v0, 7, v0
    v_mfma_f32_16x16x32_bf16 v[220:223], v[36:39], a[156:159], v[220:223]
    ds_read_b64_tr_b16 v[62:63], v15 offset:37376
    v_sub_u32 v25, v25, v0
    s_waitcnt lgkmcnt(4)
    v_mfma_f32_16x16x32_bf16 v[160:163], v[40:43], a[160:163], v[160:163]
    ds_read_b64_tr_b16 v[32:33], v16 offset:33280
    v_mul_f32 v144, v26, v144
    s_lshl_b32 s34, s28, 16
    s_add_u32 s34, s34, 6291456
    v_mfma_f32_16x16x32_bf16 v[168:171], v[40:43], a[164:167], v[168:171]
    ds_read_b64_tr_b16 v[34:35], v16 offset:37376
    s_add_u32 s44, s88, s34
    s_addc_u32 s45, s89, 0
    v_mfma_f32_16x16x32_bf16 v[164:167], v[44:47], a[160:163], v[164:167]
    ds_read_b64_tr_b16 v[36:37], v17 offset:33280
    v_mul_f32 v145, v26, v145
    global_load_dwordx4 a[228:231], v1, s[10:11] offset:-3072 sc1
    v_mfma_f32_16x16x32_bf16 v[172:175], v[44:47], a[164:167], v[172:175]
    ds_read_b64_tr_b16 v[38:39], v17 offset:37376
    v_add_u32 v2, v25, v2
    v_add_u32 v3, v25, v3
    v_mfma_f32_16x16x32_bf16 v[176:179], v[48:51], a[160:163], v[176:179]
    ds_read_b64_tr_b16 v[40:41], v14 offset:40960
    v_add_u32 v4, v25, v4
    v_add_u32 v5, v25, v5
    v_mfma_f32_16x16x32_bf16 v[184:187], v[48:51], a[164:167], v[184:187]
    ds_read_b64_tr_b16 v[42:43], v14 offset:45056
    v_add_u32 v6, v25, v6
    v_mfma_f32_16x16x32_bf16 v[180:183], v[52:55], a[160:163], v[180:183]
    ds_read_b64_tr_b16 v[44:45], v15 offset:40960
    v_mul_f32 v146, v26, v146
    global_load_dwordx4 a[232:235], v1, s[10:11] offset:-2048 sc1
    v_add_u32 v7, v25, v7
    v_mfma_f32_16x16x32_bf16 v[188:191], v[52:55], a[164:167], v[188:191]
    ds_read_b64_tr_b16 v[46:47], v15 offset:45056
    v_add_u32 v8, v25, v8
    v_add_u32 v9, v25, v9
    s_waitcnt lgkmcnt(4)
    v_mfma_f32_16x16x32_bf16 v[192:195], v[56:59], a[160:163], v[192:195]
    ds_read_b64_tr_b16 v[48:49], v16 offset:40960
    s_add_u32 m0, s39, 65536
    s_add_u32 s8, s44, 0
    s_addc_u32 s9, s45, 0
    v_mfma_f32_16x16x32_bf16 v[200:203], v[56:59], a[164:167], v[200:203]
    ds_read_b64_tr_b16 v[50:51], v16 offset:45056
    global_load_lds_dwordx4 v2, s[8:9] offset:0
    v_mfma_f32_16x16x32_bf16 v[196:199], v[60:63], a[160:163], v[196:199]
    ds_read_b64_tr_b16 v[52:53], v17 offset:40960
    v_mul_f32 v147, v26, v147
    v_mfma_f32_16x16x32_bf16 v[204:207], v[60:63], a[164:167], v[204:207]
    ds_read_b64_tr_b16 v[54:55], v17 offset:45056
    global_load_dwordx4 a[236:239], v1, s[10:11] offset:-1024 sc1
    v_mfma_f32_16x16x32_bf16 v[208:211], v[32:35], a[160:163], v[208:211]
    ds_read_b64_tr_b16 v[56:57], v14 offset:41472
    v_mfma_f32_16x16x32_bf16 v[216:219], v[32:35], a[164:167], v[216:219]
    ds_read_b64_tr_b16 v[58:59], v14 offset:45568
    v_mfma_f32_16x16x32_bf16 v[212:215], v[36:39], a[160:163], v[212:215]
    ds_read_b64_tr_b16 v[60:61], v15 offset:41472
    v_mul_f32 v148, v26, v148
    v_mfma_f32_16x16x32_bf16 v[220:223], v[36:39], a[164:167], v[220:223]
    ds_read_b64_tr_b16 v[62:63], v15 offset:45568
    s_waitcnt lgkmcnt(4)
    v_mfma_f32_16x16x32_bf16 v[160:163], v[40:43], a[168:171], v[160:163]
    ds_read_b64_tr_b16 v[32:33], v16 offset:41472
    v_mul_f32 v149, v26, v149
    v_mfma_f32_16x16x32_bf16 v[168:171], v[40:43], a[172:175], v[168:171]
    ds_read_b64_tr_b16 v[34:35], v16 offset:45568
    global_load_dwordx4 a[240:243], v1, s[10:11] offset:0 sc1
    v_mfma_f32_16x16x32_bf16 v[164:167], v[44:47], a[168:171], v[164:167]
    ds_read_b64_tr_b16 v[36:37], v17 offset:41472
    v_mfma_f32_16x16x32_bf16 v[172:175], v[44:47], a[172:175], v[172:175]
    ds_read_b64_tr_b16 v[38:39], v17 offset:45568
    global_load_lds_dwordx4 v3, s[8:9] offset:1024
    v_mfma_f32_16x16x32_bf16 v[176:179], v[48:51], a[168:171], v[176:179]
    ds_read_b64_tr_b16 v[40:41], v14 offset:49152
    v_mul_f32 v150, v26, v150
    v_mfma_f32_16x16x32_bf16 v[184:187], v[48:51], a[172:175], v[184:187]
    ds_read_b64_tr_b16 v[42:43], v14 offset:53248
    global_load_dwordx4 a[244:247], v1, s[10:11] offset:1024 sc1
    v_mfma_f32_16x16x32_bf16 v[180:183], v[52:55], a[168:171], v[180:183]
    ds_read_b64_tr_b16 v[44:45], v15 offset:49152
    v_mfma_f32_16x16x32_bf16 v[188:191], v[52:55], a[172:175], v[188:191]
    ds_read_b64_tr_b16 v[46:47], v15 offset:53248
    s_waitcnt lgkmcnt(4)
    v_mfma_f32_16x16x32_bf16 v[192:195], v[56:59], a[168:171], v[192:195]
    ds_read_b64_tr_b16 v[48:49], v16 offset:49152
    v_mul_f32 v151, v26, v151
    global_load_dwordx4 a[248:251], v1, s[10:11] offset:2048 sc1
    v_mfma_f32_16x16x32_bf16 v[200:203], v[56:59], a[172:175], v[200:203]
    ds_read_b64_tr_b16 v[50:51], v16 offset:53248
    global_load_lds_dwordx4 v4, s[8:9] offset:2048
    v_mfma_f32_16x16x32_bf16 v[196:199], v[60:63], a[168:171], v[196:199]
    ds_read_b64_tr_b16 v[52:53], v17 offset:49152
    v_mfma_f32_16x16x32_bf16 v[204:207], v[60:63], a[172:175], v[204:207]
    ds_read_b64_tr_b16 v[54:55], v17 offset:53248
    v_mfma_f32_16x16x32_bf16 v[208:211], v[32:35], a[168:171], v[208:211]
    ds_read_b64_tr_b16 v[56:57], v14 offset:49664
    v_mul_f32 v152, v27, v152
    global_load_dwordx4 a[252:255], v1, s[10:11] offset:3072 sc1
    v_mfma_f32_16x16x32_bf16 v[216:219], v[32:35], a[172:175], v[216:219]
    ds_read_b64_tr_b16 v[58:59], v14 offset:53760
    global_load_lds_dwordx4 v5, s[8:9] offset:3072
    s_add_u32 m0, s39, 69632
    v_mfma_f32_16x16x32_bf16 v[212:215], v[36:39], a[168:171], v[212:215]
    ds_read_b64_tr_b16 v[60:61], v15 offset:49664
    v_mul_f32 v153, v27, v153
    v_mfma_f32_16x16x32_bf16 v[220:223], v[36:39], a[172:175], v[220:223]
    ds_read_b64_tr_b16 v[62:63], v15 offset:53760
    s_waitcnt lgkmcnt(4)
    v_mfma_f32_16x16x32_bf16 v[160:163], v[40:43], a[176:179], v[160:163]
    ds_read_b64_tr_b16 v[32:33], v16 offset:49664
    v_mfma_f32_16x16x32_bf16 v[168:171], v[40:43], a[180:183], v[168:171]
    ds_read_b64_tr_b16 v[34:35], v16 offset:53760
    v_mfma_f32_16x16x32_bf16 v[164:167], v[44:47], a[176:179], v[164:167]
    ds_read_b64_tr_b16 v[36:37], v17 offset:49664
    v_mul_f32 v154, v27, v154
    v_mfma_f32_16x16x32_bf16 v[172:175], v[44:47], a[180:183], v[172:175]
    ds_read_b64_tr_b16 v[38:39], v17 offset:53760
    global_load_lds_dwordx4 v6, s[8:9] offset:0
    v_mfma_f32_16x16x32_bf16 v[176:179], v[48:51], a[176:179], v[176:179]
    ds_read_b64_tr_b16 v[40:41], v14 offset:57344
    v_mfma_f32_16x16x32_bf16 v[184:187], v[48:51], a[180:183], v[184:187]
    ds_read_b64_tr_b16 v[42:43], v14 offset:61440
    v_mfma_f32_16x16x32_bf16 v[180:183], v[52:55], a[176:179], v[180:183]
    ds_read_b64_tr_b16 v[44:45], v15 offset:57344
    v_mul_f32 v155, v27, v155
    s_add_u32 s6, s18, 0
    v_mfma_f32_16x16x32_bf16 v[188:191], v[52:55], a[180:183], v[188:191]
    ds_read_b64_tr_b16 v[46:47], v15 offset:61440
    s_addc_u32 s7, s19, 0
    global_load_dwordx4 a[0:3], v1, s[6:7] offset:-4096 sc1
    s_waitcnt lgkmcnt(4)
    v_mfma_f32_16x16x32_bf16 v[192:195], v[56:59], a[176:179], v[192:195]
    ds_read_b64_tr_b16 v[48:49], v16 offset:57344
    v_mfma_f32_16x16x32_bf16 v[200:203], v[56:59], a[180:183], v[200:203]
    ds_read_b64_tr_b16 v[50:51], v16 offset:61440
    global_load_lds_dwordx4 v7, s[8:9] offset:1024
    v_mfma_f32_16x16x32_bf16 v[196:199], v[60:63], a[176:179], v[196:199]
    ds_read_b64_tr_b16 v[52:53], v17 offset:57344
    v_mul_f32 v156, v27, v156
    v_mfma_f32_16x16x32_bf16 v[204:207], v[60:63], a[180:183], v[204:207]
    ds_read_b64_tr_b16 v[54:55], v17 offset:61440
    v_mfma_f32_16x16x32_bf16 v[208:211], v[32:35], a[176:179], v[208:211]
    ds_read_b64_tr_b16 v[56:57], v14 offset:57856
    v_mul_f32 v157, v27, v157
    v_mfma_f32_16x16x32_bf16 v[216:219], v[32:35], a[180:183], v[216:219]
    ds_read_b64_tr_b16 v[58:59], v14 offset:61952
    global_load_lds_dwordx4 v8, s[8:9] offset:2048
    v_mfma_f32_16x16x32_bf16 v[212:215], v[36:39], a[176:179], v[212:215]
    ds_read_b64_tr_b16 v[60:61], v15 offset:57856
    v_mfma_f32_16x16x32_bf16 v[220:223], v[36:39], a[180:183], v[220:223]
    ds_read_b64_tr_b16 v[62:63], v15 offset:61952
    s_waitcnt lgkmcnt(4)
    v_mfma_f32_16x16x32_bf16 v[160:163], v[40:43], a[184:187], v[160:163]
    ds_read_b64_tr_b16 v[32:33], v16 offset:57856
    v_mul_f32 v158, v27, v158
    global_load_dwordx4 a[4:7], v1, s[6:7] offset:-3072 sc1
    v_mfma_f32_16x16x32_bf16 v[168:171], v[40:43], a[188:191], v[168:171]
    ds_read_b64_tr_b16 v[34:35], v16 offset:61952
    global_load_lds_dwordx4 v9, s[8:9] offset:3072
    v_mfma_f32_16x16x32_bf16 v[164:167], v[44:47], a[184:187], v[164:167]
    ds_read_b64_tr_b16 v[36:37], v17 offset:57856
    v_mfma_f32_16x16x32_bf16 v[172:175], v[44:47], a[188:191], v[172:175]
    ds_read_b64_tr_b16 v[38:39], v17 offset:61952
    v_mfma_f32_16x16x32_bf16 v[176:179], v[48:51], a[184:187], v[176:179]
    v_mul_f32 v159, v27, v159
    v_mfma_f32_16x16x32_bf16 v[184:187], v[48:51], a[188:191], v[184:187]
    global_load_dwordx4 a[8:11], v1, s[6:7] offset:-2048 sc1
    v_mfma_f32_16x16x32_bf16 v[180:183], v[52:55], a[184:187], v[180:183]
    v_mfma_f32_16x16x32_bf16 v[188:191], v[52:55], a[188:191], v[188:191]
    s_waitcnt lgkmcnt(0)
    v_mfma_f32_16x16x32_bf16 v[192:195], v[56:59], a[184:187], v[192:195]
    v_add_u32 v14, 4294901760, v14
    v_add_u32 v15, 4294901760, v15
    v_add_u32 v16, 4294901760, v16
    v_add_u32 v17, 4294901760, v17
    v_mfma_f32_16x16x32_bf16 v[200:203], v[56:59], a[188:191], v[200:203]
    s_waitcnt vmcnt(20)
    s_barrier
    ds_read_b64_tr_b16 v[40:41], v14 offset:512
    ds_read_b64_tr_b16 v[42:43], v14 offset:4608
    ds_read_b64_tr_b16 v[44:45], v15 offset:512
    ds_read_b64_tr_b16 v[46:47], v15 offset:4608
    v_mfma_f32_16x16x32_bf16 v[196:199], v[60:63], a[184:187], v[196:199]
    ds_read_b64_tr_b16 v[48:49], v16 offset:512
    ds_read_b64_tr_b16 v[50:51], v16 offset:4608
    global_load_dwordx4 a[12:15], v1, s[6:7] offset:-1024 sc1
    v_mfma_f32_16x16x32_bf16 v[204:207], v[60:63], a[188:191], v[204:207]
    ds_read_b64_tr_b16 v[52:53], v17 offset:512
    ds_read_b64_tr_b16 v[54:55], v17 offset:4608
    v_mfma_f32_16x16x32_bf16 v[208:211], v[32:35], a[184:187], v[208:211]
    ds_read_b64_tr_b16 v[56:57], v14 offset:8704
    s_add_u32 m0, s39, 98304
    s_add_u32 s8, s44, 524288
    s_addc_u32 s9, s45, 0
    v_mfma_f32_16x16x32_bf16 v[216:219], v[32:35], a[188:191], v[216:219]
    ds_read_b64_tr_b16 v[58:59], v14 offset:12800
    global_load_lds_dwordx4 v2, s[8:9] offset:0
    v_mfma_f32_16x16x32_bf16 v[212:215], v[36:39], a[184:187], v[212:215]
    ds_read_b64_tr_b16 v[60:61], v15 offset:8704
    global_load_dwordx4 a[16:19], v1, s[6:7] offset:0 sc1
    v_mfma_f32_16x16x32_bf16 v[220:223], v[36:39], a[188:191], v[220:223]
    ds_read_b64_tr_b16 v[62:63], v15 offset:12800
    s_waitcnt lgkmcnt(4)
    v_mfma_f32_16x16x32_bf16 v[192:195], v[40:43], a[192:195], v[192:195]
    ds_read_b64_tr_b16 v[32:33], v16 offset:8704
    v_mfma_f32_16x16x32_bf16 v[200:203], v[40:43], a[196:199], v[200:203]
    ds_read_b64_tr_b16 v[34:35], v16 offset:12800
    v_mfma_f32_16x16x32_bf16 v[196:199], v[44:47], a[192:195], v[196:199]
    ds_read_b64_tr_b16 v[36:37], v17 offset:8704
    v_mfma_f32_16x16x32_bf16 v[204:207], v[44:47], a[196:199], v[204:207]
    ds_read_b64_tr_b16 v[38:39], v17 offset:12800
    v_mfma_f32_16x16x32_bf16 v[208:211], v[48:51], a[192:195], v[208:211]
    ds_read_b64_tr_b16 v[40:41], v14 offset:16896
    global_load_dwordx4 a[20:23], v1, s[6:7] offset:1024 sc1
    v_mfma_f32_16x16x32_bf16 v[216:219], v[48:51], a[196:199], v[216:219]
    ds_read_b64_tr_b16 v[42:43], v14 offset:20992
    v_mfma_f32_16x16x32_bf16 v[212:215], v[52:55], a[192:195], v[212:215]
    ds_read_b64_tr_b16 v[44:45], v15 offset:16896
    v_mfma_f32_16x16x32_bf16 v[220:223], v[52:55], a[196:199], v[220:223]
    ds_read_b64_tr_b16 v[46:47], v15 offset:20992
    s_waitcnt lgkmcnt(4)
    v_mfma_f32_16x16x32_bf16 v[192:195], v[56:59], a[200:203], v[192:195]
    ds_read_b64_tr_b16 v[48:49], v16 offset:16896
    global_load_dwordx4 a[24:27], v1, s[6:7] offset:2048 sc1
    s_lshl_b32 s32, s29, 4
    s_add_u32 s32, s32, s0
    s_lshl_b32 s32, s32, 2
    s_add_u32 s32, s32, s28
    s_lshl_b32 s46, s32, 13
    v_mfma_f32_16x16x32_bf16 v[200:203], v[56:59], a[204:207], v[200:203]
    ds_read_b64_tr_b16 v[50:51], v16 offset:20992
    s_add_u32 s46, s46, 25165824
    s_lshl_b32 s40, s32, 6
    s_add_u32 s40, s40, 20250624
    v_mov_b32 v30, 0
    v_mov_b32 v31, 1
    v_mfma_f32_16x16x32_bf16 v[196:199], v[60:63], a[200:203], v[196:199]
    ds_read_b64_tr_b16 v[52:53], v17 offset:16896
    v_mfma_f32_16x16x32_bf16 v[204:207], v[60:63], a[204:207], v[204:207]
    ds_read_b64_tr_b16 v[54:55], v17 offset:20992
    v_mfma_f32_16x16x32_bf16 v[208:211], v[32:35], a[200:203], v[208:211]
    ds_read_b64_tr_b16 v[56:57], v14 offset:25088
    v_mfma_f32_16x16x32_bf16 v[216:219], v[32:35], a[204:207], v[216:219]
    ds_read_b64_tr_b16 v[58:59], v14 offset:29184
    global_load_lds_dwordx4 v3, s[8:9] offset:1024
    v_mfma_f32_16x16x32_bf16 v[212:215], v[36:39], a[200:203], v[212:215]
    ds_read_b64_tr_b16 v[60:61], v15 offset:25088
    global_load_dwordx4 a[28:31], v1, s[6:7] offset:3072 sc1
    v_mfma_f32_16x16x32_bf16 v[220:223], v[36:39], a[204:207], v[220:223]
    ds_read_b64_tr_b16 v[62:63], v15 offset:29184
    s_waitcnt lgkmcnt(4)
    v_mfma_f32_16x16x32_bf16 v[192:195], v[40:43], a[208:211], v[192:195]
    ds_read_b64_tr_b16 v[32:33], v16 offset:25088
    v_mfma_f32_16x16x32_bf16 v[200:203], v[40:43], a[212:215], v[200:203]
    ds_read_b64_tr_b16 v[34:35], v16 offset:29184
    v_mfma_f32_16x16x32_bf16 v[196:199], v[44:47], a[208:211], v[196:199]
    ds_read_b64_tr_b16 v[36:37], v17 offset:25088
    v_mfma_f32_16x16x32_bf16 v[204:207], v[44:47], a[212:215], v[204:207]
    ds_read_b64_tr_b16 v[38:39], v17 offset:29184
    v_mfma_f32_16x16x32_bf16 v[208:211], v[48:51], a[208:211], v[208:211]
    s_add_u32 s6, s18, 8192
    s_addc_u32 s7, s19, 0
    global_load_dwordx4 a[32:35], v1, s[6:7] offset:-4096 sc1
    v_mfma_f32_16x16x32_bf16 v[216:219], v[48:51], a[212:215], v[216:219]
    global_load_lds_dwordx4 v4, s[8:9] offset:2048
    v_mfma_f32_16x16x32_bf16 v[212:215], v[52:55], a[208:211], v[212:215]
    v_mfma_f32_16x16x32_bf16 v[220:223], v[52:55], a[212:215], v[220:223]
    s_waitcnt lgkmcnt(0)
    v_mfma_f32_16x16x32_bf16 v[192:195], v[56:59], a[216:219], v[192:195]
    v_mfma_f32_16x16x32_bf16 v[200:203], v[56:59], a[220:223], v[200:203]
    s_waitcnt vmcnt(17)
    s_barrier
    ds_read_b64_tr_b16 v[40:41], v14 offset:33280
    ds_read_b64_tr_b16 v[42:43], v14 offset:37376
    ds_read_b64_tr_b16 v[44:45], v15 offset:33280
    ds_read_b64_tr_b16 v[46:47], v15 offset:37376
    v_mfma_f32_16x16x32_bf16 v[196:199], v[60:63], a[216:219], v[196:199]
    ds_read_b64_tr_b16 v[48:49], v16 offset:33280
    ds_read_b64_tr_b16 v[50:51], v16 offset:37376
    v_mfma_f32_16x16x32_bf16 v[204:207], v[60:63], a[220:223], v[204:207]
    ds_read_b64_tr_b16 v[52:53], v17 offset:33280
    ds_read_b64_tr_b16 v[54:55], v17 offset:37376
    global_load_lds_dwordx4 v5, s[8:9] offset:3072
    s_add_u32 m0, s39, 102400
    v_mfma_f32_16x16x32_bf16 v[208:211], v[32:35], a[216:219], v[208:211]
    ds_read_b64_tr_b16 v[56:57], v14 offset:41472
    v_mfma_f32_16x16x32_bf16 v[216:219], v[32:35], a[220:223], v[216:219]
    ds_read_b64_tr_b16 v[58:59], v14 offset:45568
    v_mfma_f32_16x16x32_bf16 v[212:215], v[36:39], a[216:219], v[212:215]
    ds_read_b64_tr_b16 v[60:61], v15 offset:41472
    global_load_dwordx4 a[36:39], v1, s[6:7] offset:-3072 sc1
    v_mfma_f32_16x16x32_bf16 v[220:223], v[36:39], a[220:223], v[220:223]
    ds_read_b64_tr_b16 v[62:63], v15 offset:45568
    s_waitcnt lgkmcnt(4)
    v_mfma_f32_16x16x32_bf16 v[192:195], v[40:43], a[224:227], v[192:195]
    ds_read_b64_tr_b16 v[32:33], v16 offset:41472
    v_mfma_f32_16x16x32_bf16 v[200:203], v[40:43], a[228:231], v[200:203]
    ds_read_b64_tr_b16 v[34:35], v16 offset:45568
    v_mfma_f32_16x16x32_bf16 v[196:199], v[44:47], a[224:227], v[196:199]
    ds_read_b64_tr_b16 v[36:37], v17 offset:41472
    global_load_dwordx4 a[40:43], v1, s[6:7] offset:-2048 sc1
    v_mfma_f32_16x16x32_bf16 v[204:207], v[44:47], a[228:231], v[204:207]
    ds_read_b64_tr_b16 v[38:39], v17 offset:45568
    v_mfma_f32_16x16x32_bf16 v[208:211], v[48:51], a[224:227], v[208:211]
    ds_read_b64_tr_b16 v[40:41], v14 offset:49664
    v_mfma_f32_16x16x32_bf16 v[216:219], v[48:51], a[228:231], v[216:219]
    ds_read_b64_tr_b16 v[42:43], v14 offset:53760
    v_mfma_f32_16x16x32_bf16 v[212:215], v[52:55], a[224:227], v[212:215]
    ds_read_b64_tr_b16 v[44:45], v15 offset:49664
    v_mfma_f32_16x16x32_bf16 v[220:223], v[52:55], a[228:231], v[220:223]
    ds_read_b64_tr_b16 v[46:47], v15 offset:53760
    global_load_lds_dwordx4 v6, s[8:9] offset:0
    s_waitcnt lgkmcnt(4)
    v_mfma_f32_16x16x32_bf16 v[192:195], v[56:59], a[232:235], v[192:195]
    ds_read_b64_tr_b16 v[48:49], v16 offset:49664
    global_load_dwordx4 a[44:47], v1, s[6:7] offset:-1024 sc1
    v_mfma_f32_16x16x32_bf16 v[200:203], v[56:59], a[236:239], v[200:203]
    ds_read_b64_tr_b16 v[50:51], v16 offset:53760
    v_mfma_f32_16x16x32_bf16 v[196:199], v[60:63], a[232:235], v[196:199]
    ds_read_b64_tr_b16 v[52:53], v17 offset:49664
    v_mfma_f32_16x16x32_bf16 v[204:207], v[60:63], a[236:239], v[204:207]
    ds_read_b64_tr_b16 v[54:55], v17 offset:53760
    v_mfma_f32_16x16x32_bf16 v[208:211], v[32:35], a[232:235], v[208:211]
    ds_read_b64_tr_b16 v[56:57], v14 offset:57856
    global_load_dwordx4 a[48:51], v1, s[6:7] offset:0 sc1
    v_mfma_f32_16x16x32_bf16 v[216:219], v[32:35], a[236:239], v[216:219]
    ds_read_b64_tr_b16 v[58:59], v14 offset:61952
    global_load_lds_dwordx4 v7, s[8:9] offset:1024
    v_mfma_f32_16x16x32_bf16 v[212:215], v[36:39], a[232:235], v[212:215]
    ds_read_b64_tr_b16 v[60:61], v15 offset:57856
    v_mfma_f32_16x16x32_bf16 v[220:223], v[36:39], a[236:239], v[220:223]
    ds_read_b64_tr_b16 v[62:63], v15 offset:61952
    s_waitcnt lgkmcnt(4)
    v_mfma_f32_16x16x32_bf16 v[192:195], v[40:43], a[240:243], v[192:195]
    ds_read_b64_tr_b16 v[32:33], v16 offset:57856
    v_mfma_f32_16x16x32_bf16 v[200:203], v[40:43], a[244:247], v[200:203]
    ds_read_b64_tr_b16 v[34:35], v16 offset:61952
    v_mfma_f32_16x16x32_bf16 v[196:199], v[44:47], a[240:243], v[196:199]
    ds_read_b64_tr_b16 v[36:37], v17 offset:57856
    global_load_dwordx4 a[52:55], v1, s[6:7] offset:1024 sc1
    v_mfma_f32_16x16x32_bf16 v[204:207], v[44:47], a[244:247], v[204:207]
    ds_read_b64_tr_b16 v[38:39], v17 offset:61952
    v_mfma_f32_16x16x32_bf16 v[208:211], v[48:51], a[240:243], v[208:211]
    ds_read_b64_tr_b16 v[40:41], v14 offset:0
    v_mfma_f32_16x16x32_bf16 v[216:219], v[48:51], a[244:247], v[216:219]
    ds_read_b64_tr_b16 v[42:43], v14 offset:4096
    global_load_lds_dwordx4 v8, s[8:9] offset:2048
    v_mfma_f32_16x16x32_bf16 v[212:215], v[52:55], a[240:243], v[212:215]
    ds_read_b64_tr_b16 v[44:45], v15 offset:0
    global_load_dwordx4 a[56:59], v1, s[6:7] offset:2048 sc1
    v_mfma_f32_16x16x32_bf16 v[220:223], v[52:55], a[244:247], v[220:223]
    ds_read_b64_tr_b16 v[46:47], v15 offset:4096
    s_waitcnt lgkmcnt(4)
    v_mfma_f32_16x16x32_bf16 v[192:195], v[56:59], a[248:251], v[192:195]
    ds_read_b64_tr_b16 v[48:49], v16 offset:0
    v_mfma_f32_16x16x32_bf16 v[200:203], v[56:59], a[252:255], v[200:203]
    ds_read_b64_tr_b16 v[50:51], v16 offset:4096
    v_mfma_f32_16x16x32_bf16 v[196:199], v[60:63], a[248:251], v[196:199]
    ds_read_b64_tr_b16 v[52:53], v17 offset:0
    v_mfma_f32_16x16x32_bf16 v[204:207], v[60:63], a[252:255], v[204:207]
    ds_read_b64_tr_b16 v[54:55], v17 offset:4096
    global_load_lds_dwordx4 v9, s[8:9] offset:3072
    v_mfma_f32_16x16x32_bf16 v[208:211], v[32:35], a[248:251], v[208:211]
    ds_read_b64_tr_b16 v[56:57], v14 offset:8192
    global_load_dwordx4 a[60:63], v1, s[6:7] offset:3072 sc1
    v_mfma_f32_16x16x32_bf16 v[216:219], v[32:35], a[252:255], v[216:219]
    ds_read_b64_tr_b16 v[58:59], v14 offset:12288
    v_mfma_f32_16x16x32_bf16 v[212:215], v[36:39], a[248:251], v[212:215]
    ds_read_b64_tr_b16 v[60:61], v15 offset:8192
    v_mfma_f32_16x16x32_bf16 v[220:223], v[36:39], a[252:255], v[220:223]
    ds_read_b64_tr_b16 v[62:63], v15 offset:12288
    s_waitcnt lgkmcnt(4)
    v_mfma_f32_16x16x32_bf16 v[160:163], v[40:43], a[192:195], v[160:163]
    ds_read_b64_tr_b16 v[32:33], v16 offset:8192
    v_mfma_f32_16x16x32_bf16 v[168:171], v[40:43], a[196:199], v[168:171]
    ds_read_b64_tr_b16 v[34:35], v16 offset:12288
    v_mfma_f32_16x16x32_bf16 v[164:167], v[44:47], a[192:195], v[164:167]
    ds_read_b64_tr_b16 v[36:37], v17 offset:8192
    v_mfma_f32_16x16x32_bf16 v[172:175], v[44:47], a[196:199], v[172:175]
    ds_read_b64_tr_b16 v[38:39], v17 offset:12288
    v_mfma_f32_16x16x32_bf16 v[176:179], v[48:51], a[192:195], v[176:179]
    ds_read_b64_tr_b16 v[40:41], v14 offset:16384
    v_mfma_f32_16x16x32_bf16 v[184:187], v[48:51], a[196:199], v[184:187]
    ds_read_b64_tr_b16 v[42:43], v14 offset:20480
    v_mfma_f32_16x16x32_bf16 v[180:183], v[52:55], a[192:195], v[180:183]
    ds_read_b64_tr_b16 v[44:45], v15 offset:16384
    s_xor_b32 s35, s46, 32768
    v_fma_f32 v128, v28, v192, v128
    v_mfma_f32_16x16x32_bf16 v[188:191], v[52:55], a[196:199], v[188:191]
    ds_read_b64_tr_b16 v[46:47], v15 offset:20480
    v_fma_f32 v129, v28, v193, v129
    v_fma_f32 v130, v28, v194, v130
    s_waitcnt lgkmcnt(4)
    v_mfma_f32_16x16x32_bf16 v[160:163], v[56:59], a[200:203], v[160:163]
    ds_read_b64_tr_b16 v[48:49], v16 offset:16384
    v_fma_f32 v131, v28, v195, v131
    v_fma_f32 v132, v28, v196, v132
    v_mfma_f32_16x16x32_bf16 v[168:171], v[56:59], a[204:207], v[168:171]
    ds_read_b64_tr_b16 v[50:51], v16 offset:20480
    v_fma_f32 v133, v28, v197, v133
    v_mfma_f32_16x16x32_bf16 v[164:167], v[60:63], a[200:203], v[164:167]
    ds_read_b64_tr_b16 v[52:53], v17 offset:16384
    v_fma_f32 v134, v28, v198, v134
    v_fma_f32 v135, v28, v199, v135
    v_mfma_f32_16x16x32_bf16 v[172:175], v[60:63], a[204:207], v[172:175]
    ds_read_b64_tr_b16 v[54:55], v17 offset:20480
    v_cvt_pk_bf16_f32 v128, v128, v129
    v_cvt_pk_bf16_f32 v129, v130, v131
    v_mfma_f32_16x16x32_bf16 v[176:179], v[32:35], a[200:203], v[176:179]
    ds_read_b64_tr_b16 v[56:57], v14 offset:24576
    v_cvt_pk_bf16_f32 v130, v132, v133
    v_cvt_pk_bf16_f32 v131, v134, v135
    v_mfma_f32_16x16x32_bf16 v[184:187], v[32:35], a[204:207], v[184:187]
    ds_read_b64_tr_b16 v[58:59], v14 offset:28672
    buffer_store_dwordx4 v[128:131], v1, s[12:15], s35 offen offset:0 sc1
    v_mfma_f32_16x16x32_bf16 v[180:183], v[36:39], a[200:203], v[180:183]
    ds_read_b64_tr_b16 v[60:61], v15 offset:24576
    v_fma_f32 v136, v29, v200, v136
    v_mfma_f32_16x16x32_bf16 v[188:191], v[36:39], a[204:207], v[188:191]
    ds_read_b64_tr_b16 v[62:63], v15 offset:28672
    v_fma_f32 v137, v29, v201, v137
    s_waitcnt lgkmcnt(4)
    v_mfma_f32_16x16x32_bf16 v[160:163], v[40:43], a[208:211], v[160:163]
    ds_read_b64_tr_b16 v[32:33], v16 offset:24576
    v_fma_f32 v138, v29, v202, v138
    v_fma_f32 v139, v29, v203, v139
    v_mfma_f32_16x16x32_bf16 v[168:171], v[40:43], a[212:215], v[168:171]
    ds_read_b64_tr_b16 v[34:35], v16 offset:28672
    v_fma_f32 v140, v29, v204, v140
    v_fma_f32 v141, v29, v205, v141
    v_mfma_f32_16x16x32_bf16 v[164:167], v[44:47], a[208:211], v[164:167]
    ds_read_b64_tr_b16 v[36:37], v17 offset:24576
    v_fma_f32 v142, v29, v206, v142
    v_fma_f32 v143, v29, v207, v143
    v_mfma_f32_16x16x32_bf16 v[172:175], v[44:47], a[212:215], v[172:175]
    ds_read_b64_tr_b16 v[38:39], v17 offset:28672
    v_cvt_pk_bf16_f32 v136, v136, v137
    v_mfma_f32_16x16x32_bf16 v[176:179], v[48:51], a[208:211], v[176:179]
    ds_read_b64_tr_b16 v[40:41], v14 offset:32768
    v_cvt_pk_bf16_f32 v137, v138, v139
    v_cvt_pk_bf16_f32 v138, v140, v141
    v_mfma_f32_16x16x32_bf16 v[184:187], v[48:51], a[212:215], v[184:187]
    ds_read_b64_tr_b16 v[42:43], v14 offset:36864
    v_cvt_pk_bf16_f32 v139, v142, v143
    v_mfma_f32_16x16x32_bf16 v[180:183], v[52:55], a[208:211], v[180:183]
    ds_read_b64_tr_b16 v[44:45], v15 offset:32768
    buffer_store_dwordx4 v[136:139], v1, s[12:15], s35 offen offset:1024 sc1
    v_mfma_f32_16x16x32_bf16 v[188:191], v[52:55], a[212:215], v[188:191]
    ds_read_b64_tr_b16 v[46:47], v15 offset:36864
    v_fma_f32 v144, v28, v208, v144
    v_fma_f32 v145, v28, v209, v145
    s_waitcnt lgkmcnt(4)
    v_mfma_f32_16x16x32_bf16 v[160:163], v[56:59], a[216:219], v[160:163]
    ds_read_b64_tr_b16 v[48:49], v16 offset:32768
    v_fma_f32 v146, v28, v210, v146
    v_fma_f32 v147, v28, v211, v147
    v_mfma_f32_16x16x32_bf16 v[168:171], v[56:59], a[220:223], v[168:171]
    ds_read_b64_tr_b16 v[50:51], v16 offset:36864
    v_fma_f32 v148, v28, v212, v148
    v_mfma_f32_16x16x32_bf16 v[164:167], v[60:63], a[216:219], v[164:167]
    ds_read_b64_tr_b16 v[52:53], v17 offset:32768
    v_fma_f32 v149, v28, v213, v149
    v_fma_f32 v150, v28, v214, v150
    v_mfma_f32_16x16x32_bf16 v[172:175], v[60:63], a[220:223], v[172:175]
    ds_read_b64_tr_b16 v[54:55], v17 offset:36864
    v_fma_f32 v151, v28, v215, v151
    v_mfma_f32_16x16x32_bf16 v[176:179], v[32:35], a[216:219], v[176:179]
    ds_read_b64_tr_b16 v[56:57], v14 offset:40960
    s_add_u32 s6, s18, 16384
    s_addc_u32 s7, s19, 0
    global_load_dwordx4 a[64:67], v1, s[6:7] offset:-4096 sc1
    v_cvt_pk_bf16_f32 v144, v144, v145
    v_mfma_f32_16x16x32_bf16 v[184:187], v[32:35], a[220:223], v[184:187]
    ds_read_b64_tr_b16 v[58:59], v14 offset:45056
    v_cvt_pk_bf16_f32 v145, v146, v147
    v_cvt_pk_bf16_f32 v146, v148, v149
    v_cvt_pk_bf16_f32 v147, v150, v151
    v_mfma_f32_16x16x32_bf16 v[180:183], v[36:39], a[216:219], v[180:183]
    ds_read_b64_tr_b16 v[60:61], v15 offset:40960
    buffer_store_dwordx4 v[144:147], v1, s[12:15], s35 offen offset:2048 sc1
    v_mfma_f32_16x16x32_bf16 v[188:191], v[36:39], a[220:223], v[188:191]
    ds_read_b64_tr_b16 v[62:63], v15 offset:45056
    v_fma_f32 v152, v29, v216, v152
    s_waitcnt lgkmcnt(4)
    v_mfma_f32_16x16x32_bf16 v[160:163], v[40:43], a[224:227], v[160:163]
    ds_read_b64_tr_b16 v[32:33], v16 offset:40960
    global_load_dwordx4 a[68:71], v1, s[6:7] offset:-3072 sc1
    v_fma_f32 v153, v29, v217, v153
    v_mfma_f32_16x16x32_bf16 v[168:171], v[40:43], a[228:231], v[168:171]
    ds_read_b64_tr_b16 v[34:35], v16 offset:45056
    v_fma_f32 v154, v29, v218, v154
    v_fma_f32 v155, v29, v219, v155
    v_mfma_f32_16x16x32_bf16 v[164:167], v[44:47], a[224:227], v[164:167]
    ds_read_b64_tr_b16 v[36:37], v17 offset:40960
    global_load_dwordx4 a[72:75], v1, s[6:7] offset:-2048 sc1
    v_fma_f32 v156, v29, v220, v156
    v_fma_f32 v157, v29, v221, v157
    v_mfma_f32_16x16x32_bf16 v[172:175], v[44:47], a[228:231], v[172:175]
    ds_read_b64_tr_b16 v[38:39], v17 offset:45056
    v_fma_f32 v158, v29, v222, v158
    v_fma_f32 v159, v29, v223, v159
    v_mfma_f32_16x16x32_bf16 v[176:179], v[48:51], a[224:227], v[176:179]
    ds_read_b64_tr_b16 v[40:41], v14 offset:49152
    global_load_dwordx4 a[76:79], v1, s[6:7] offset:-1024 sc1
    v_cvt_pk_bf16_f32 v152, v152, v153
    v_mfma_f32_16x16x32_bf16 v[184:187], v[48:51], a[228:231], v[184:187]
    ds_read_b64_tr_b16 v[42:43], v14 offset:53248
    v_cvt_pk_bf16_f32 v153, v154, v155
    v_cvt_pk_bf16_f32 v154, v156, v157
    v_mfma_f32_16x16x32_bf16 v[180:183], v[52:55], a[224:227], v[180:183]
    ds_read_b64_tr_b16 v[44:45], v15 offset:49152
    global_load_dwordx4 a[80:83], v1, s[6:7] offset:0 sc1
    v_cvt_pk_bf16_f32 v155, v158, v159
    v_mfma_f32_16x16x32_bf16 v[188:191], v[52:55], a[228:231], v[188:191]
    ds_read_b64_tr_b16 v[46:47], v15 offset:53248
    buffer_store_dwordx4 v[152:155], v1, s[12:15], s35 offen offset:3072 sc1
    s_waitcnt lgkmcnt(4)
    v_mfma_f32_16x16x32_bf16 v[160:163], v[56:59], a[232:235], v[160:163]
    ds_read_b64_tr_b16 v[48:49], v16 offset:49152
    v_mfma_f32_16x16x32_bf16 v[168:171], v[56:59], a[236:239], v[168:171]
    ds_read_b64_tr_b16 v[50:51], v16 offset:53248
    v_mfma_f32_16x16x32_bf16 v[164:167], v[60:63], a[232:235], v[164:167]
    ds_read_b64_tr_b16 v[52:53], v17 offset:49152
    global_load_dwordx4 a[84:87], v1, s[6:7] offset:1024 sc1
    v_mfma_f32_16x16x32_bf16 v[172:175], v[60:63], a[236:239], v[172:175]
    ds_read_b64_tr_b16 v[54:55], v17 offset:53248
    v_mfma_f32_16x16x32_bf16 v[176:179], v[32:35], a[232:235], v[176:179]
    ds_read_b64_tr_b16 v[56:57], v14 offset:57344
    global_load_dwordx4 a[88:91], v1, s[6:7] offset:2048 sc1
    v_mfma_f32_16x16x32_bf16 v[184:187], v[32:35], a[236:239], v[184:187]
    ds_read_b64_tr_b16 v[58:59], v14 offset:61440
    v_mfma_f32_16x16x32_bf16 v[180:183], v[36:39], a[232:235], v[180:183]
    ds_read_b64_tr_b16 v[60:61], v15 offset:57344
    global_load_dwordx4 a[92:95], v1, s[6:7] offset:3072 sc1
    v_mfma_f32_16x16x32_bf16 v[188:191], v[36:39], a[236:239], v[188:191]
    ds_read_b64_tr_b16 v[62:63], v15 offset:61440
    s_waitcnt lgkmcnt(4)
    v_mfma_f32_16x16x32_bf16 v[160:163], v[40:43], a[240:243], v[160:163]
    ds_read_b64_tr_b16 v[32:33], v16 offset:57344
    s_add_u32 s6, s18, 24576
    s_addc_u32 s7, s19, 0
    v_mfma_f32_16x16x32_bf16 v[168:171], v[40:43], a[244:247], v[168:171]
    ds_read_b64_tr_b16 v[34:35], v16 offset:61440
    global_load_dwordx4 a[96:99], v1, s[6:7] offset:-4096 sc1
    v_mfma_f32_16x16x32_bf16 v[164:167], v[44:47], a[240:243], v[164:167]
    ds_read_b64_tr_b16 v[36:37], v17 offset:57344
    v_mfma_f32_16x16x32_bf16 v[172:175], v[44:47], a[244:247], v[172:175]
    ds_read_b64_tr_b16 v[38:39], v17 offset:61440
    v_mfma_f32_16x16x32_bf16 v[176:179], v[48:51], a[240:243], v[176:179]
    global_load_dwordx4 a[100:103], v1, s[6:7] offset:-3072 sc1
    v_mfma_f32_16x16x32_bf16 v[184:187], v[48:51], a[244:247], v[184:187]
    v_mfma_f32_16x16x32_bf16 v[180:183], v[52:55], a[240:243], v[180:183]
    v_mfma_f32_16x16x32_bf16 v[188:191], v[52:55], a[244:247], v[188:191]
    s_waitcnt lgkmcnt(0)
    v_mfma_f32_16x16x32_bf16 v[160:163], v[56:59], a[248:251], v[160:163]
    v_add_u32 v14, 65536, v14
    v_add_u32 v15, 65536, v15
    v_add_u32 v16, 65536, v16
    v_add_u32 v17, 65536, v17
    v_mfma_f32_16x16x32_bf16 v[168:171], v[56:59], a[252:255], v[168:171]
    s_waitcnt vmcnt(14)
    s_barrier
    ds_read_b64_tr_b16 v[40:41], v14 offset:0
    ds_read_b64_tr_b16 v[42:43], v14 offset:4096
    ds_read_b64_tr_b16 v[44:45], v15 offset:0
    ds_read_b64_tr_b16 v[46:47], v15 offset:4096
    global_load_dwordx4 a[104:107], v1, s[6:7] offset:-2048 sc1
    s_waitcnt vmcnt(6)
    s_xor_b32 s32, s40, 256
    buffer_store_dword v31, v30, s[12:15], s32 offen sc1
    v_mfma_f32_16x16x32_bf16 v[164:167], v[60:63], a[248:251], v[164:167]
    ds_read_b64_tr_b16 v[48:49], v16 offset:0
    ds_read_b64_tr_b16 v[50:51], v16 offset:4096
    global_load_dwordx4 a[108:111], v1, s[6:7] offset:-1024 sc1
    v_mfma_f32_16x16x32_bf16 v[172:175], v[60:63], a[252:255], v[172:175]
    ds_read_b64_tr_b16 v[52:53], v17 offset:0
    ds_read_b64_tr_b16 v[54:55], v17 offset:4096
    v_mfma_f32_16x16x32_bf16 v[176:179], v[32:35], a[248:251], v[176:179]
    ds_read_b64_tr_b16 v[56:57], v14 offset:8192
    global_load_dwordx4 a[112:115], v1, s[6:7] offset:0 sc1
    v_mfma_f32_16x16x32_bf16 v[184:187], v[32:35], a[252:255], v[184:187]
    ds_read_b64_tr_b16 v[58:59], v14 offset:12288
    v_mfma_f32_16x16x32_bf16 v[180:183], v[36:39], a[248:251], v[180:183]
    ds_read_b64_tr_b16 v[60:61], v15 offset:8192
    global_load_dwordx4 a[116:119], v1, s[6:7] offset:1024 sc1
    v_mfma_f32_16x16x32_bf16 v[188:191], v[36:39], a[252:255], v[188:191]
    ds_read_b64_tr_b16 v[62:63], v15 offset:12288
    s_waitcnt lgkmcnt(4)
    v_mfma_f32_16x16x32_bf16 v[96:99], v[40:43], a[0:3], v[96:99]
    ds_read_b64_tr_b16 v[32:33], v16 offset:8192
    global_load_dwordx4 a[120:123], v1, s[6:7] offset:2048 sc1
    v_mfma_f32_16x16x32_bf16 v[104:107], v[40:43], a[4:7], v[104:107]
    ds_read_b64_tr_b16 v[34:35], v16 offset:12288
    v_mfma_f32_16x16x32_bf16 v[100:103], v[44:47], a[0:3], v[100:103]
    ds_read_b64_tr_b16 v[36:37], v17 offset:8192
    global_load_dwordx4 a[124:127], v1, s[6:7] offset:3072 sc1
    v_mfma_f32_16x16x32_bf16 v[108:111], v[44:47], a[4:7], v[108:111]
    ds_read_b64_tr_b16 v[38:39], v17 offset:12288
    v_mfma_f32_16x16x32_bf16 v[112:115], v[48:51], a[0:3], v[112:115]
    ds_read_b64_tr_b16 v[40:41], v14 offset:16384
    v_mfma_f32_16x16x32_bf16 v[120:123], v[48:51], a[4:7], v[120:123]
    ds_read_b64_tr_b16 v[42:43], v14 offset:20480
    v_mfma_f32_16x16x32_bf16 v[116:119], v[52:55], a[0:3], v[116:119]
    ds_read_b64_tr_b16 v[44:45], v15 offset:16384
    v_mfma_f32_16x16x32_bf16 v[124:127], v[52:55], a[4:7], v[124:127]
    ds_read_b64_tr_b16 v[46:47], v15 offset:20480
    s_waitcnt lgkmcnt(4)
    v_mfma_f32_16x16x32_bf16 v[96:99], v[56:59], a[8:11], v[96:99]
    ds_read_b64_tr_b16 v[48:49], v16 offset:16384
    v_mfma_f32_16x16x32_bf16 v[104:107], v[56:59], a[12:15], v[104:107]
    ds_read_b64_tr_b16 v[50:51], v16 offset:20480
    v_mfma_f32_16x16x32_bf16 v[100:103], v[60:63], a[8:11], v[100:103]
    ds_read_b64_tr_b16 v[52:53], v17 offset:16384
    v_mfma_f32_16x16x32_bf16 v[108:111], v[60:63], a[12:15], v[108:111]
    ds_read_b64_tr_b16 v[54:55], v17 offset:20480
    v_mfma_f32_16x16x32_bf16 v[112:115], v[32:35], a[8:11], v[112:115]
    ds_read_b64_tr_b16 v[56:57], v14 offset:24576
    v_mfma_f32_16x16x32_bf16 v[120:123], v[32:35], a[12:15], v[120:123]
    ds_read_b64_tr_b16 v[58:59], v14 offset:28672
    v_mfma_f32_16x16x32_bf16 v[116:119], v[36:39], a[8:11], v[116:119]
    ds_read_b64_tr_b16 v[60:61], v15 offset:24576
    v_mfma_f32_16x16x32_bf16 v[124:127], v[36:39], a[12:15], v[124:127]
    ds_read_b64_tr_b16 v[62:63], v15 offset:28672
    s_waitcnt lgkmcnt(4)
    v_mfma_f32_16x16x32_bf16 v[96:99], v[40:43], a[16:19], v[96:99]
    ds_read_b64_tr_b16 v[32:33], v16 offset:24576
    v_mfma_f32_16x16x32_bf16 v[104:107], v[40:43], a[20:23], v[104:107]
    ds_read_b64_tr_b16 v[34:35], v16 offset:28672
    v_mfma_f32_16x16x32_bf16 v[100:103], v[44:47], a[16:19], v[100:103]
    ds_read_b64_tr_b16 v[36:37], v17 offset:24576
    v_mfma_f32_16x16x32_bf16 v[108:111], v[44:47], a[20:23], v[108:111]
    ds_read_b64_tr_b16 v[38:39], v17 offset:28672
    v_mfma_f32_16x16x32_bf16 v[112:115], v[48:51], a[16:19], v[112:115]
    ds_read_b64_tr_b16 v[40:41], v14 offset:512
    v_mfma_f32_16x16x32_bf16 v[120:123], v[48:51], a[20:23], v[120:123]
    ds_read_b64_tr_b16 v[42:43], v14 offset:4608
    v_mfma_f32_16x16x32_bf16 v[116:119], v[52:55], a[16:19], v[116:119]
    ds_read_b64_tr_b16 v[44:45], v15 offset:512
    v_mfma_f32_16x16x32_bf16 v[124:127], v[52:55], a[20:23], v[124:127]
    ds_read_b64_tr_b16 v[46:47], v15 offset:4608
    s_waitcnt lgkmcnt(4)
    v_mfma_f32_16x16x32_bf16 v[96:99], v[56:59], a[24:27], v[96:99]
    ds_read_b64_tr_b16 v[48:49], v16 offset:512
    v_mfma_f32_16x16x32_bf16 v[104:107], v[56:59], a[28:31], v[104:107]
    ds_read_b64_tr_b16 v[50:51], v16 offset:4608
    v_mfma_f32_16x16x32_bf16 v[100:103], v[60:63], a[24:27], v[100:103]
    ds_read_b64_tr_b16 v[52:53], v17 offset:512
    v_mfma_f32_16x16x32_bf16 v[108:111], v[60:63], a[28:31], v[108:111]
    ds_read_b64_tr_b16 v[54:55], v17 offset:4608
    v_mfma_f32_16x16x32_bf16 v[112:115], v[32:35], a[24:27], v[112:115]
    ds_read_b64_tr_b16 v[56:57], v14 offset:8704
    v_mfma_f32_16x16x32_bf16 v[120:123], v[32:35], a[28:31], v[120:123]
    ds_read_b64_tr_b16 v[58:59], v14 offset:12800
    v_mfma_f32_16x16x32_bf16 v[116:119], v[36:39], a[24:27], v[116:119]
    ds_read_b64_tr_b16 v[60:61], v15 offset:8704
    v_mfma_f32_16x16x32_bf16 v[124:127], v[36:39], a[28:31], v[124:127]
    ds_read_b64_tr_b16 v[62:63], v15 offset:12800
    s_waitcnt lgkmcnt(4)
    v_mfma_f32_16x16x32_bf16 v[96:99], v[40:43], a[32:35], v[96:99]
    ds_read_b64_tr_b16 v[32:33], v16 offset:8704
    buffer_load_dword v24, v30, s[12:15], s40 offen sc1
    v_mfma_f32_16x16x32_bf16 v[104:107], v[40:43], a[36:39], v[104:107]
    ds_read_b64_tr_b16 v[34:35], v16 offset:12800
    v_mfma_f32_16x16x32_bf16 v[100:103], v[44:47], a[32:35], v[100:103]
    ds_read_b64_tr_b16 v[36:37], v17 offset:8704
    v_mfma_f32_16x16x32_bf16 v[108:111], v[44:47], a[36:39], v[108:111]
    ds_read_b64_tr_b16 v[38:39], v17 offset:12800
    v_mfma_f32_16x16x32_bf16 v[112:115], v[48:51], a[32:35], v[112:115]
    ds_read_b64_tr_b16 v[40:41], v14 offset:16896
    v_mfma_f32_16x16x32_bf16 v[120:123], v[48:51], a[36:39], v[120:123]
    ds_read_b64_tr_b16 v[42:43], v14 offset:20992
    v_mfma_f32_16x16x32_bf16 v[116:119], v[52:55], a[32:35], v[116:119]
    ds_read_b64_tr_b16 v[44:45], v15 offset:16896
    v_mfma_f32_16x16x32_bf16 v[124:127], v[52:55], a[36:39], v[124:127]
    ds_read_b64_tr_b16 v[46:47], v15 offset:20992
    s_waitcnt lgkmcnt(4)
    v_mfma_f32_16x16x32_bf16 v[96:99], v[56:59], a[40:43], v[96:99]
    ds_read_b64_tr_b16 v[48:49], v16 offset:16896
    v_mfma_f32_16x16x32_bf16 v[104:107], v[56:59], a[44:47], v[104:107]
    ds_read_b64_tr_b16 v[50:51], v16 offset:20992
    v_mfma_f32_16x16x32_bf16 v[100:103], v[60:63], a[40:43], v[100:103]
    ds_read_b64_tr_b16 v[52:53], v17 offset:16896
    v_mfma_f32_16x16x32_bf16 v[108:111], v[60:63], a[44:47], v[108:111]
    ds_read_b64_tr_b16 v[54:55], v17 offset:20992
    v_mfma_f32_16x16x32_bf16 v[112:115], v[32:35], a[40:43], v[112:115]
    ds_read_b64_tr_b16 v[56:57], v14 offset:25088
    v_mfma_f32_16x16x32_bf16 v[120:123], v[32:35], a[44:47], v[120:123]
    ds_read_b64_tr_b16 v[58:59], v14 offset:29184
    v_mfma_f32_16x16x32_bf16 v[116:119], v[36:39], a[40:43], v[116:119]
    ds_read_b64_tr_b16 v[60:61], v15 offset:25088
    v_mfma_f32_16x16x32_bf16 v[124:127], v[36:39], a[44:47], v[124:127]
    ds_read_b64_tr_b16 v[62:63], v15 offset:29184
    s_waitcnt lgkmcnt(4)
    v_mfma_f32_16x16x32_bf16 v[96:99], v[40:43], a[48:51], v[96:99]
    ds_read_b64_tr_b16 v[32:33], v16 offset:25088
    v_mfma_f32_16x16x32_bf16 v[104:107], v[40:43], a[52:55], v[104:107]
    ds_read_b64_tr_b16 v[34:35], v16 offset:29184
    v_mfma_f32_16x16x32_bf16 v[100:103], v[44:47], a[48:51], v[100:103]
    ds_read_b64_tr_b16 v[36:37], v17 offset:25088
    v_mfma_f32_16x16x32_bf16 v[108:111], v[44:47], a[52:55], v[108:111]
    ds_read_b64_tr_b16 v[38:39], v17 offset:29184
    v_mfma_f32_16x16x32_bf16 v[112:115], v[48:51], a[48:51], v[112:115]
    v_mfma_f32_16x16x32_bf16 v[120:123], v[48:51], a[52:55], v[120:123]
    v_mfma_f32_16x16x32_bf16 v[116:119], v[52:55], a[48:51], v[116:119]
    v_mfma_f32_16x16x32_bf16 v[124:127], v[52:55], a[52:55], v[124:127]
    s_waitcnt lgkmcnt(0)
    v_mfma_f32_16x16x32_bf16 v[96:99], v[56:59], a[56:59], v[96:99]
    v_mfma_f32_16x16x32_bf16 v[104:107], v[56:59], a[60:63], v[104:107]
    s_waitcnt vmcnt(1)
    s_barrier
    ds_read_b64_tr_b16 v[40:41], v14 offset:32768
    ds_read_b64_tr_b16 v[42:43], v14 offset:36864
    ds_read_b64_tr_b16 v[44:45], v15 offset:32768
    ds_read_b64_tr_b16 v[46:47], v15 offset:36864
    v_mfma_f32_16x16x32_bf16 v[100:103], v[60:63], a[56:59], v[100:103]
    ds_read_b64_tr_b16 v[48:49], v16 offset:32768
    ds_read_b64_tr_b16 v[50:51], v16 offset:36864
    v_mfma_f32_16x16x32_bf16 v[108:111], v[60:63], a[60:63], v[108:111]
    ds_read_b64_tr_b16 v[52:53], v17 offset:32768
    ds_read_b64_tr_b16 v[54:55], v17 offset:36864
    v_mfma_f32_16x16x32_bf16 v[112:115], v[32:35], a[56:59], v[112:115]
    ds_read_b64_tr_b16 v[56:57], v14 offset:40960
    v_mfma_f32_16x16x32_bf16 v[120:123], v[32:35], a[60:63], v[120:123]
    ds_read_b64_tr_b16 v[58:59], v14 offset:45056
    v_mfma_f32_16x16x32_bf16 v[116:119], v[36:39], a[56:59], v[116:119]
    ds_read_b64_tr_b16 v[60:61], v15 offset:40960
    v_mfma_f32_16x16x32_bf16 v[124:127], v[36:39], a[60:63], v[124:127]
    ds_read_b64_tr_b16 v[62:63], v15 offset:45056
    s_waitcnt lgkmcnt(4)
    v_mfma_f32_16x16x32_bf16 v[96:99], v[40:43], a[64:67], v[96:99]
    ds_read_b64_tr_b16 v[32:33], v16 offset:40960
    v_mfma_f32_16x16x32_bf16 v[104:107], v[40:43], a[68:71], v[104:107]
    ds_read_b64_tr_b16 v[34:35], v16 offset:45056
    v_mfma_f32_16x16x32_bf16 v[100:103], v[44:47], a[64:67], v[100:103]
    ds_read_b64_tr_b16 v[36:37], v17 offset:40960
    v_mfma_f32_16x16x32_bf16 v[108:111], v[44:47], a[68:71], v[108:111]
    ds_read_b64_tr_b16 v[38:39], v17 offset:45056
    v_mfma_f32_16x16x32_bf16 v[112:115], v[48:51], a[64:67], v[112:115]
    ds_read_b64_tr_b16 v[40:41], v14 offset:49152
    s_mov_b32 s20, s94
    s_mov_b32 s21, s95
    s_mov_b32 s22, 4194304
    v_and_b32 v228, 0xf0, v1
    v_lshlrev_b32 v228, 7, v228
    v_mfma_f32_16x16x32_bf16 v[120:123], v[48:51], a[68:71], v[120:123]
    ds_read_b64_tr_b16 v[42:43], v14 offset:53248
    v_lshrrev_b32 v229, 9, v1
    v_lshl_add_u32 v228, v229, 4, v228
    v_bfe_u32 v229, v1, 8, 1
    v_lshl_add_u32 v228, v229, 5, v228
    v_mfma_f32_16x16x32_bf16 v[116:119], v[52:55], a[64:67], v[116:119]
    ds_read_b64_tr_b16 v[44:45], v15 offset:49152
    s_lshl_b32 s35, s29, 2
    s_add_u32 s35, s35, s28
    s_lshl_b32 s35, s35, 16
    v_mfma_f32_16x16x32_bf16 v[124:127], v[52:55], a[68:71], v[124:127]
    ds_read_b64_tr_b16 v[46:47], v15 offset:53248
    s_lshl_b32 s33, s0, 7
    s_add_u32 s35, s35, s33
    s_add_u32 s36, s35, 32768
    s_waitcnt lgkmcnt(4)
    v_mfma_f32_16x16x32_bf16 v[96:99], v[56:59], a[72:75], v[96:99]
    ds_read_b64_tr_b16 v[48:49], v16 offset:49152
    v_mfma_f32_16x16x32_bf16 v[104:107], v[56:59], a[76:79], v[104:107]
    ds_read_b64_tr_b16 v[50:51], v16 offset:53248
    v_mfma_f32_16x16x32_bf16 v[100:103], v[60:63], a[72:75], v[100:103]
    ds_read_b64_tr_b16 v[52:53], v17 offset:49152
    v_mfma_f32_16x16x32_bf16 v[108:111], v[60:63], a[76:79], v[108:111]
    ds_read_b64_tr_b16 v[54:55], v17 offset:53248
    v_mfma_f32_16x16x32_bf16 v[112:115], v[32:35], a[72:75], v[112:115]
    ds_read_b64_tr_b16 v[56:57], v14 offset:57344
    v_mfma_f32_16x16x32_bf16 v[120:123], v[32:35], a[76:79], v[120:123]
    ds_read_b64_tr_b16 v[58:59], v14 offset:61440
    s_waitcnt vmcnt(0)
    v_cmp_gt_u32 vcc, 1, v24
    s_cbranch_vccnz L_poll_7
L_poll_7_ok:
    buffer_load_dwordx4 v[240:243], v1, s[12:15], s46 offen offset:0 sc1
    v_mfma_f32_16x16x32_bf16 v[116:119], v[36:39], a[72:75], v[116:119]
    ds_read_b64_tr_b16 v[60:61], v15 offset:57344
    buffer_load_dwordx4 v[244:247], v1, s[12:15], s46 offen offset:1024 sc1
    v_mfma_f32_16x16x32_bf16 v[124:127], v[36:39], a[76:79], v[124:127]
    ds_read_b64_tr_b16 v[62:63], v15 offset:61440
    s_waitcnt lgkmcnt(4)
    v_mfma_f32_16x16x32_bf16 v[96:99], v[40:43], a[80:83], v[96:99]
    ds_read_b64_tr_b16 v[32:33], v16 offset:57344
    buffer_load_dwordx4 v[248:251], v1, s[12:15], s46 offen offset:2048 sc1
    v_mfma_f32_16x16x32_bf16 v[104:107], v[40:43], a[84:87], v[104:107]
    ds_read_b64_tr_b16 v[34:35], v16 offset:61440
    v_mfma_f32_16x16x32_bf16 v[100:103], v[44:47], a[80:83], v[100:103]
    ds_read_b64_tr_b16 v[36:37], v17 offset:57344
    buffer_load_dwordx4 v[252:255], v1, s[12:15], s46 offen offset:3072 sc1
    v_mfma_f32_16x16x32_bf16 v[108:111], v[44:47], a[84:87], v[108:111]
    ds_read_b64_tr_b16 v[38:39], v17 offset:61440
    v_mfma_f32_16x16x32_bf16 v[112:115], v[48:51], a[80:83], v[112:115]
    ds_read_b64_tr_b16 v[40:41], v14 offset:33280
    v_mfma_f32_16x16x32_bf16 v[120:123], v[48:51], a[84:87], v[120:123]
    ds_read_b64_tr_b16 v[42:43], v14 offset:37376
    v_mfma_f32_16x16x32_bf16 v[116:119], v[52:55], a[80:83], v[116:119]
    ds_read_b64_tr_b16 v[44:45], v15 offset:33280
    v_mfma_f32_16x16x32_bf16 v[124:127], v[52:55], a[84:87], v[124:127]
    ds_read_b64_tr_b16 v[46:47], v15 offset:37376
    s_waitcnt lgkmcnt(4)
    v_mfma_f32_16x16x32_bf16 v[96:99], v[56:59], a[88:91], v[96:99]
    ds_read_b64_tr_b16 v[48:49], v16 offset:33280
    v_mfma_f32_16x16x32_bf16 v[104:107], v[56:59], a[92:95], v[104:107]
    ds_read_b64_tr_b16 v[50:51], v16 offset:37376
    v_mfma_f32_16x16x32_bf16 v[100:103], v[60:63], a[88:91], v[100:103]
    ds_read_b64_tr_b16 v[52:53], v17 offset:33280
    v_mfma_f32_16x16x32_bf16 v[108:111], v[60:63], a[92:95], v[108:111]
    ds_read_b64_tr_b16 v[54:55], v17 offset:37376
    v_mfma_f32_16x16x32_bf16 v[112:115], v[32:35], a[88:91], v[112:115]
    ds_read_b64_tr_b16 v[56:57], v14 offset:41472
    v_mfma_f32_16x16x32_bf16 v[120:123], v[32:35], a[92:95], v[120:123]
    ds_read_b64_tr_b16 v[58:59], v14 offset:45568
    v_mfma_f32_16x16x32_bf16 v[116:119], v[36:39], a[88:91], v[116:119]
    ds_read_b64_tr_b16 v[60:61], v15 offset:41472
    v_mfma_f32_16x16x32_bf16 v[124:127], v[36:39], a[92:95], v[124:127]
    ds_read_b64_tr_b16 v[62:63], v15 offset:45568
    s_waitcnt lgkmcnt(4)
    v_mfma_f32_16x16x32_bf16 v[96:99], v[40:43], a[96:99], v[96:99]
    ds_read_b64_tr_b16 v[32:33], v16 offset:41472
    v_mfma_f32_16x16x32_bf16 v[104:107], v[40:43], a[100:103], v[104:107]
    ds_read_b64_tr_b16 v[34:35], v16 offset:45568
    v_mfma_f32_16x16x32_bf16 v[100:103], v[44:47], a[96:99], v[100:103]
    ds_read_b64_tr_b16 v[36:37], v17 offset:41472
    v_mfma_f32_16x16x32_bf16 v[108:111], v[44:47], a[100:103], v[108:111]
    ds_read_b64_tr_b16 v[38:39], v17 offset:45568
    v_mfma_f32_16x16x32_bf16 v[112:115], v[48:51], a[96:99], v[112:115]
    ds_read_b64_tr_b16 v[40:41], v14 offset:49664
    v_mfma_f32_16x16x32_bf16 v[120:123], v[48:51], a[100:103], v[120:123]
    ds_read_b64_tr_b16 v[42:43], v14 offset:53760
    v_mfma_f32_16x16x32_bf16 v[116:119], v[52:55], a[96:99], v[116:119]
    ds_read_b64_tr_b16 v[44:45], v15 offset:49664
    v_mfma_f32_16x16x32_bf16 v[124:127], v[52:55], a[100:103], v[124:127]
    ds_read_b64_tr_b16 v[46:47], v15 offset:53760
    s_waitcnt lgkmcnt(4)
    v_mfma_f32_16x16x32_bf16 v[96:99], v[56:59], a[104:107], v[96:99]
    ds_read_b64_tr_b16 v[48:49], v16 offset:49664
    v_mfma_f32_16x16x32_bf16 v[104:107], v[56:59], a[108:111], v[104:107]
    ds_read_b64_tr_b16 v[50:51], v16 offset:53760
    v_mfma_f32_16x16x32_bf16 v[100:103], v[60:63], a[104:107], v[100:103]
    ds_read_b64_tr_b16 v[52:53], v17 offset:49664
    v_mfma_f32_16x16x32_bf16 v[108:111], v[60:63], a[108:111], v[108:111]
    ds_read_b64_tr_b16 v[54:55], v17 offset:53760
    v_mfma_f32_16x16x32_bf16 v[112:115], v[32:35], a[104:107], v[112:115]
    ds_read_b64_tr_b16 v[56:57], v14 offset:57856
    v_mfma_f32_16x16x32_bf16 v[120:123], v[32:35], a[108:111], v[120:123]
    ds_read_b64_tr_b16 v[58:59], v14 offset:61952
    v_mfma_f32_16x16x32_bf16 v[116:119], v[36:39], a[104:107], v[116:119]
    ds_read_b64_tr_b16 v[60:61], v15 offset:57856
    v_mfma_f32_16x16x32_bf16 v[124:127], v[36:39], a[108:111], v[124:127]
    ds_read_b64_tr_b16 v[62:63], v15 offset:61952
    s_waitcnt lgkmcnt(4)
    v_mfma_f32_16x16x32_bf16 v[96:99], v[40:43], a[112:115], v[96:99]
    ds_read_b64_tr_b16 v[32:33], v16 offset:57856
    v_mfma_f32_16x16x32_bf16 v[104:107], v[40:43], a[116:119], v[104:107]
    ds_read_b64_tr_b16 v[34:35], v16 offset:61952
    s_waitcnt vmcnt(0)
    v_lshlrev_b32 v64, 16, v240
    v_and_b32 v65, 0xffff0000, v240
    v_lshlrev_b32 v66, 16, v241
    v_and_b32 v67, 0xffff0000, v241
    v_mfma_f32_16x16x32_bf16 v[100:103], v[44:47], a[112:115], v[100:103]
    ds_read_b64_tr_b16 v[36:37], v17 offset:57856
    v_lshlrev_b32 v68, 16, v242
    v_and_b32 v69, 0xffff0000, v242
    v_mfma_f32_16x16x32_bf16 v[108:111], v[44:47], a[116:119], v[108:111]
    ds_read_b64_tr_b16 v[38:39], v17 offset:61952
    v_lshlrev_b32 v70, 16, v243
    v_and_b32 v71, 0xffff0000, v243
    v_mfma_f32_16x16x32_bf16 v[112:115], v[48:51], a[112:115], v[112:115]
    v_lshlrev_b32 v72, 16, v244
    v_and_b32 v73, 0xffff0000, v244
    v_mfma_f32_16x16x32_bf16 v[120:123], v[48:51], a[116:119], v[120:123]
    v_lshlrev_b32 v74, 16, v245
    v_and_b32 v75, 0xffff0000, v245
    v_mfma_f32_16x16x32_bf16 v[116:119], v[52:55], a[112:115], v[116:119]
    v_lshlrev_b32 v76, 16, v246
    v_and_b32 v77, 0xffff0000, v246
    v_mfma_f32_16x16x32_bf16 v[124:127], v[52:55], a[116:119], v[124:127]
    v_lshlrev_b32 v78, 16, v247
    v_and_b32 v79, 0xffff0000, v247
    s_waitcnt lgkmcnt(0)
    v_mfma_f32_16x16x32_bf16 v[96:99], v[56:59], a[120:123], v[96:99]
    v_lshlrev_b32 v80, 16, v248
    v_and_b32 v81, 0xffff0000, v248
    v_mfma_f32_16x16x32_bf16 v[104:107], v[56:59], a[124:127], v[104:107]
    v_lshlrev_b32 v82, 16, v249
    v_and_b32 v83, 0xffff0000, v249
    v_mfma_f32_16x16x32_bf16 v[100:103], v[60:63], a[120:123], v[100:103]
    v_lshlrev_b32 v84, 16, v250
    v_and_b32 v85, 0xffff0000, v250
    v_mfma_f32_16x16x32_bf16 v[108:111], v[60:63], a[124:127], v[108:111]
    v_lshlrev_b32 v86, 16, v251
    v_and_b32 v87, 0xffff0000, v251
    v_mfma_f32_16x16x32_bf16 v[112:115], v[32:35], a[120:123], v[112:115]
    v_lshlrev_b32 v88, 16, v252
    v_and_b32 v89, 0xffff0000, v252
    v_mfma_f32_16x16x32_bf16 v[120:123], v[32:35], a[124:127], v[120:123]
    v_lshlrev_b32 v90, 16, v253
    v_and_b32 v91, 0xffff0000, v253
    v_mfma_f32_16x16x32_bf16 v[116:119], v[36:39], a[120:123], v[116:119]
    v_lshlrev_b32 v92, 16, v254
    v_and_b32 v93, 0xffff0000, v254
    v_mfma_f32_16x16x32_bf16 v[124:127], v[36:39], a[124:127], v[124:127]
    v_lshlrev_b32 v94, 16, v255
    v_and_b32 v95, 0xffff0000, v255
    s_nop 7
    s_nop 3
    v_pk_fma_f32 v[64:65], v[160:161], v[28:29], v[64:65] op_sel_hi:[1,0,1]
    v_pk_fma_f32 v[66:67], v[162:163], v[28:29], v[66:67] op_sel_hi:[1,0,1]
    v_pk_fma_f32 v[68:69], v[164:165], v[28:29], v[68:69] op_sel_hi:[1,0,1]
    v_pk_fma_f32 v[70:71], v[166:167], v[28:29], v[70:71] op_sel_hi:[1,0,1]
    v_pk_fma_f32 v[72:73], v[168:169], v[28:29], v[72:73] op_sel:[0,1,0] op_sel_hi:[1,1,1]
    v_pk_fma_f32 v[74:75], v[170:171], v[28:29], v[74:75] op_sel:[0,1,0] op_sel_hi:[1,1,1]
    v_pk_fma_f32 v[76:77], v[172:173], v[28:29], v[76:77] op_sel:[0,1,0] op_sel_hi:[1,1,1]
    v_pk_fma_f32 v[78:79], v[174:175], v[28:29], v[78:79] op_sel:[0,1,0] op_sel_hi:[1,1,1]
    v_pk_fma_f32 v[96:97], v[96:97], v[26:27], v[64:65] op_sel_hi:[1,0,1]
    v_pk_fma_f32 v[98:99], v[98:99], v[26:27], v[66:67] op_sel_hi:[1,0,1]
    v_pk_fma_f32 v[100:101], v[100:101], v[26:27], v[68:69] op_sel_hi:[1,0,1]
    v_pk_fma_f32 v[102:103], v[102:103], v[26:27], v[70:71] op_sel_hi:[1,0,1]
    v_pk_fma_f32 v[104:105], v[104:105], v[26:27], v[72:73] op_sel:[0,1,0] op_sel_hi:[1,1,1]
    v_pk_fma_f32 v[106:107], v[106:107], v[26:27], v[74:75] op_sel:[0,1,0] op_sel_hi:[1,1,1]
    v_pk_fma_f32 v[108:109], v[108:109], v[26:27], v[76:77] op_sel:[0,1,0] op_sel_hi:[1,1,1]
    v_pk_fma_f32 v[110:111], v[110:111], v[26:27], v[78:79] op_sel:[0,1,0] op_sel_hi:[1,1,1]
    v_cvt_pk_bf16_f32 v96, v96, v97
    v_cvt_pk_bf16_f32 v97, v98, v99
    v_cvt_pk_bf16_f32 v98, v100, v101
    v_cvt_pk_bf16_f32 v99, v102, v103
    v_cvt_pk_bf16_f32 v100, v104, v105
    v_cvt_pk_bf16_f32 v101, v106, v107
    v_cvt_pk_bf16_f32 v102, v108, v109
    v_cvt_pk_bf16_f32 v103, v110, v111
    s_nop 1
    v_permlane16_swap_b32 v96, v98
    v_permlane16_swap_b32 v97, v99
    v_permlane16_swap_b32 v100, v102
    v_permlane16_swap_b32 v101, v103
    buffer_store_dwordx4 v[96:99], v228, s[20:23], s35 offen offset:0
    buffer_store_dwordx4 v[100:103], v228, s[20:23], s36 offen offset:0
    v_pk_fma_f32 v[80:81], v[176:177], v[28:29], v[80:81] op_sel_hi:[1,0,1]
    v_pk_fma_f32 v[82:83], v[178:179], v[28:29], v[82:83] op_sel_hi:[1,0,1]
    v_pk_fma_f32 v[84:85], v[180:181], v[28:29], v[84:85] op_sel_hi:[1,0,1]
    v_pk_fma_f32 v[86:87], v[182:183], v[28:29], v[86:87] op_sel_hi:[1,0,1]
    v_pk_fma_f32 v[88:89], v[184:185], v[28:29], v[88:89] op_sel:[0,1,0] op_sel_hi:[1,1,1]
    v_pk_fma_f32 v[90:91], v[186:187], v[28:29], v[90:91] op_sel:[0,1,0] op_sel_hi:[1,1,1]
    v_pk_fma_f32 v[92:93], v[188:189], v[28:29], v[92:93] op_sel:[0,1,0] op_sel_hi:[1,1,1]
    v_pk_fma_f32 v[94:95], v[190:191], v[28:29], v[94:95] op_sel:[0,1,0] op_sel_hi:[1,1,1]
    v_pk_fma_f32 v[112:113], v[112:113], v[26:27], v[80:81] op_sel_hi:[1,0,1]
    v_pk_fma_f32 v[114:115], v[114:115], v[26:27], v[82:83] op_sel_hi:[1,0,1]
    v_pk_fma_f32 v[116:117], v[116:117], v[26:27], v[84:85] op_sel_hi:[1,0,1]
    v_pk_fma_f32 v[118:119], v[118:119], v[26:27], v[86:87] op_sel_hi:[1,0,1]
    v_pk_fma_f32 v[120:121], v[120:121], v[26:27], v[88:89] op_sel:[0,1,0] op_sel_hi:[1,1,1]
    v_pk_fma_f32 v[122:123], v[122:123], v[26:27], v[90:91] op_sel:[0,1,0] op_sel_hi:[1,1,1]
    v_pk_fma_f32 v[124:125], v[124:125], v[26:27], v[92:93] op_sel:[0,1,0] op_sel_hi:[1,1,1]
    v_pk_fma_f32 v[126:127], v[126:127], v[26:27], v[94:95] op_sel:[0,1,0] op_sel_hi:[1,1,1]
    v_cvt_pk_bf16_f32 v112, v112, v113
    v_cvt_pk_bf16_f32 v113, v114, v115
    v_cvt_pk_bf16_f32 v114, v116, v117
    v_cvt_pk_bf16_f32 v115, v118, v119
    v_cvt_pk_bf16_f32 v116, v120, v121
    v_cvt_pk_bf16_f32 v117, v122, v123
    v_cvt_pk_bf16_f32 v118, v124, v125
    v_cvt_pk_bf16_f32 v119, v126, v127
    s_nop 1
    v_permlane16_swap_b32 v112, v114
    v_permlane16_swap_b32 v113, v115
    v_permlane16_swap_b32 v116, v118
    v_permlane16_swap_b32 v117, v119
    buffer_store_dwordx4 v[112:115], v228, s[20:23], s35 offen offset:64
    buffer_store_dwordx4 v[116:119], v228, s[20:23], s36 offen offset:64
L_end:
    s_endpgm
L_poll_1:
    s_mov_b32 s48, 0
L_poll_1_l:
    s_sleep 4
    buffer_load_dword v157, v156, s[24:27], 0 offen sc1
    s_waitcnt vmcnt(0)
    s_add_u32 s48, s48, 1
    v_cmp_gt_u32 vcc, 1, v157
    s_nop 0
    s_and_b32 s32, vcc_lo, s1
    s_cbranch_scc0 L_poll_1_ok
    s_cmp_lt_u32 s48, 0x40000
    s_cbranch_scc1 L_poll_1_l
    s_branch L_poll_1_ok
L_poll_2:
    s_mov_b32 s48, 0
L_poll_2_l:
    s_sleep 4
    buffer_load_dword v159, v158, s[12:15], s35 offen sc1
    s_waitcnt vmcnt(0)
    s_add_u32 s48, s48, 1
    v_cmp_gt_u32 vcc, 1, v159
    s_nop 0
    s_and_b32 s32, vcc_lo, s1
    s_cbranch_scc0 L_poll_2_ok
    s_cmp_lt_u32 s48, 0x40000
    s_cbranch_scc1 L_poll_2_l
    s_branch L_poll_2_ok
L_poll_3:
    s_mov_b32 s48, 0
L_poll_3_l:
    s_sleep 4
    buffer_load_dword v24, v25, s[12:15], s40 offen sc1
    s_waitcnt vmcnt(0)
    s_add_u32 s48, s48, 1
    v_cmp_gt_u32 vcc, 1, v24
    s_nop 0
    s_and_b32 s32, vcc_lo, s1
    s_cbranch_scc0 L_poll_3_ok
    s_cmp_lt_u32 s48, 0x40000
    s_cbranch_scc1 L_poll_3_l
    s_branch L_poll_3_ok
L_poll_4:
    s_mov_b32 s48, 0
L_poll_4_l:
    s_sleep 4
    buffer_load_dword v197, v196, s[12:15], s40 offen sc1
    s_waitcnt vmcnt(0)
    s_add_u32 s48, s48, 1
    v_cmp_gt_u32 vcc, 2, v197
    s_nop 0
    s_and_b32 s32, vcc_lo, s1
    s_cbranch_scc0 L_poll_4_ok
    s_cmp_lt_u32 s48, 0x40000
    s_cbranch_scc1 L_poll_4_l
    s_branch L_poll_4_ok
L_poll_5:
    s_mov_b32 s48, 0
L_poll_5_l:
    s_sleep 4
    buffer_load_dword v24, v25, s[12:15], s40 offen sc1
    s_waitcnt vmcnt(0)
    s_add_u32 s48, s48, 1
    v_cmp_gt_u32 vcc, 3, v24
    s_nop 0
    s_and_b32 s32, vcc_lo, s1
    s_cbranch_scc0 L_poll_5_ok
    s_cmp_lt_u32 s48, 0x40000
    s_cbranch_scc1 L_poll_5_l
    s_branch L_poll_5_ok
L_poll_6:
    s_mov_b32 s48, 0
L_poll_6_l:
    s_sleep 4
    buffer_load_dword v24, v25, s[12:15], s40 offen sc1
    s_waitcnt vmcnt(0)
    s_add_u32 s48, s48, 1
    v_cmp_gt_u32 vcc, 4, v24
    s_nop 0
    s_and_b32 s32, vcc_lo, s1
    s_cbranch_scc0 L_poll_6_ok
    s_cmp_lt_u32 s48, 0x40000
    s_cbranch_scc1 L_poll_6_l
    s_branch L_poll_6_ok
L_poll_7:
    s_mov_b32 s48, 0
L_poll_7_l:
    s_sleep 4
    buffer_load_dword v24, v30, s[12:15], s40 offen sc1
    s_waitcnt vmcnt(0)
    s_add_u32 s48, s48, 1
    v_cmp_gt_u32 vcc, 1, v24
    s_cbranch_vccz L_poll_7_ok
    s_cmp_lt_u32 s48, 0x40000
    s_cbranch_scc1 L_poll_7_l
    s_branch L_poll_7_ok
.section .rodata,"a"
.p2align 6
.amdhsa_kernel gated_mix__linear_attn_block__dense_activation_gelu__prompt_kernel
  .amdhsa_next_free_vgpr 512
  .amdhsa_next_free_sgpr 102
  .amdhsa_accum_offset 256
  .amdhsa_group_segment_fixed_size 0
  .amdhsa_kernarg_size 96
  .amdhsa_user_sgpr_count 2
  .amdhsa_user_sgpr_kernarg_segment_ptr 1
  .amdhsa_system_sgpr_workgroup_id_x 1
  .amdhsa_float_denorm_mode_32 3
.end_amdhsa_kernel
```
